```python
import torch

def _softmax(x, axis=-1):
    return torch.softmax(x, dim=axis)

def _gelu(x):
    return torch.nn.functional.gelu(x, approximate='tanh')

def _silu(x):
    return torch.nn.functional.silu(x)

def _sigmoid(x):
    return torch.sigmoid(x)

def _layernorm(x, axis=-1, eps=1e-05):
    m = x.mean(dim=axis, keepdim=True)
    v = x.var(dim=axis, keepdim=True, unbiased=False)
    return (x - m) / torch.sqrt(v + eps)

def _scatter_add(tgt, idx, src, axis=0):
    return tgt.clone().index_add_(axis, idx, src)

def _segment_sum(src, seg, n):
    out = torch.zeros((n,) + src.shape[1:], dtype=src.dtype)
    return out.index_add_(0, seg, src)

def _pad(x, pw):
    flat = tuple((v for pair in reversed(pw) for v in pair))
    return torch.nn.functional.pad(x, flat)
kernel_name = 'sequential_preLN__memory_aug_recurrent_mem_tr__mixer_s_mlp__prompt'

def setup_inputs():

    _w = lambda a: (lambda t: t.to(torch.bfloat16) if t.is_floating_point() else t)(torch.as_tensor(a))

    def _A_setup():
        B, S, Dm = (1, 2048, 1024)
        H, Dh = (32, 128)
        M, seg = (8, 32)
        seg = min(seg, S)
        S = S // seg * seg
        return {'x': _w((lambda *s: torch.randn(*s, dtype=torch.bfloat16) * 0.05)(B, S, Dm)), 'mem0': _w((lambda *s: torch.randn(*s, dtype=torch.bfloat16) * 0.2)(B, M, Dm)), 'Wq': _w((lambda *s: torch.randn(*s, dtype=torch.bfloat16) * 1.6)(Dm, H, Dh) * Dm ** (-0.5)), 'Wk': _w((lambda *s: torch.randn(*s, dtype=torch.bfloat16) * 1.6)(Dm, H, Dh) * Dm ** (-0.5)), 'Wv': _w((lambda *s: torch.randn(*s, dtype=torch.bfloat16) * 0.2)(Dm, H, Dh) * Dm ** (-0.5)), 'Wo': _w((lambda *s: torch.randn(*s, dtype=torch.bfloat16) * 0.2)(H, Dh, Dm) * (H * Dh) ** (-0.5)), 'seg_len': seg}
    _A_in = _A_setup()

    def _B_setup():
        B, S, D, F = (1, 2048, 1024, 3584)
        return {'x': _w((lambda *s: torch.randn(*s, dtype=torch.bfloat16) * 0.05)(B, S, D)), 'w1': _w((lambda *s: torch.randn(*s, dtype=torch.bfloat16) * 0.8)(D, D) * D ** (-0.5)), 'w2': _w((lambda *s: torch.randn(*s, dtype=torch.bfloat16) * 0.8)(D, D) * D ** (-0.5)), 'w3': _w((lambda *s: torch.randn(*s, dtype=torch.bfloat16) * 0.8)(D, F) * D ** (-0.5)), 'w4': _w((lambda *s: torch.randn(*s, dtype=torch.bfloat16) * 0.8)(F, D) * F ** (-0.5))}
    _B_in = _B_setup()
    return {'A_x': _A_in['x'], 'A_mem0': _A_in['mem0'], 'A_Wq': _A_in['Wq'], 'A_Wk': _A_in['Wk'], 'A_Wv': _A_in['Wv'], 'A_Wo': _A_in['Wo'], 'A_seg_len': _A_in['seg_len'], 'B_x': _B_in['x'], 'B_w1': _B_in['w1'], 'B_w2': _B_in['w2'], 'B_w3': _B_in['w3'], 'B_w4': _B_in['w4']}

def reference(A_x, A_mem0, A_Wq, A_Wk, A_Wv, A_Wo, A_seg_len, B_x, B_w1, B_w2, B_w3, B_w4):

    def _A_ref(x, mem0, Wq, Wk, Wv, Wo, seg_len):
        B, S, Dm = x.shape
        H, Dh = (Wq.shape[1], Wq.shape[2])
        M = mem0.shape[1]
        scale = Dh ** (-0.5)
        n_seg = S // seg_len
        L = M + seg_len
        idx = torch.arange(L)
        mask = (idx[:, None] < M) | (idx[:, None] >= idx[None, :])
        mem = mem0
        outs = []
        for s in range(n_seg):
            xs = x[:, s * seg_len:(s + 1) * seg_len, :].clone()
            h = torch.concatenate([mem, xs], axis=1)
            q = torch.einsum('btd,dhe->bhte', h, Wq)
            k = torch.einsum('btd,dhe->bhte', h, Wk)
            v = torch.einsum('btd,dhe->bhte', h, Wv)
            scores = torch.einsum('bhqe,bhke->bhqk', q, k) * scale
            scores = torch.where(mask[None, None], scores, -1000000000.0)
            p = _softmax(scores, axis=-1)
            o = torch.einsum('bhqk,bhke->bhqe', p, v)
            o = torch.einsum('bhte,hed->btd', o, Wo)
            mem = o[:, :M, :].clone()
            outs.append(o[:, M:, :])
        return torch.concatenate(outs, axis=1)

    def _B_ref(x, w1, w2, w3, w4):
        B, S, D = x.shape
        h = _gelu(_layernorm(x, axis=-1) @ w1)
        c = D // 4
        g0 = _pad(h[:, :, 0 * c:1 * c], ((0, 0), (1, 0), (0, 0)))[:, :S, :]
        g1 = _pad(h[:, :, 1 * c:2 * c], ((0, 0), (0, 1), (0, 0)))[:, 1:, :]
        g2 = _pad(h[:, :, 2 * c:3 * c], ((0, 0), (2, 0), (0, 0)))[:, :S, :]
        g3 = _pad(h[:, :, 3 * c:], ((0, 0), (0, 2), (0, 0)))[:, 2:, :]
        hs = torch.concatenate([g0, g1, g2, g3], axis=-1) @ w2
        x1 = x + hs
        h2 = _gelu(_layernorm(x1, axis=-1) @ w3) @ w4
        return x1 + h2
    x = A_x
    h = x + _A_ref(_layernorm(x, axis=-1), A_mem0, A_Wq, A_Wk, A_Wv, A_Wo, A_seg_len)
    h2 = h + _B_ref(_layernorm(h, axis=-1), B_w1, B_w2, B_w3, B_w4)
    return h2
```

```asm
; @launch kernel=prep_kernel grid=(512,1,1) block=(256,1,1) lds=0
; @launch kernel=mega_kernel grid=(256,1,1) block=(512,1,1) lds=163840
.amdgcn_target "amdgcn-amd-amdhsa--gfx950"
.text
.macro MM d,a,b
v_mfma_f32_32x32x16_bf16 a[\d:\d+15], v[\a:\a+3], v[\b:\b+3], a[\d:\d+15]
.endm
.macro RT d,a,o
ds_read_b64_tr_b16 v[\d:\d+1], v\a offset:\o
.endm
.macro RB d,a,o
ds_read_b128 v[\d:\d+3], v\a offset:\o
.endm
.globl prep_kernel
.p2align 8
.type prep_kernel,@function
prep_kernel:
s_cmp_ge_u32 s2, 512
s_cbranch_scc1 prep_kernel_end
s_load_dwordx2 s[22:23], s[0:1], 112
s_load_dwordx2 s[12:13], s[0:1], 0
v_and_b32 v1, 63, v0
v_lshrrev_b32 v2, 6, v0
s_lshl_b32 s3, s2, 2
v_add_u32 v2, s3, v2
v_lshlrev_b32 v2, 11, v2
v_lshl_add_u32 v2, v1, 4, v2
s_waitcnt lgkmcnt(0)
s_mov_b32 s4, s22
s_and_b32 s5, s23, 0xffff
s_mov_b32 s6, 0x10000000
s_mov_b32 s7, 0x00020000
s_mov_b32 s8, s12
s_and_b32 s9, s13, 0xffff
s_mov_b32 s10, 0x400000
s_mov_b32 s11, 0x00020000
buffer_load_dwordx4 v[4:7], v2, s[8:11], 0 offen
buffer_load_dwordx4 v[8:11], v2, s[8:11], 0 offen offset:1024
s_load_dwordx2 s[16:17], s[0:1], 24
s_waitcnt lgkmcnt(0)
s_mov_b32 s24, s16
s_and_b32 s25, s17, 0xffff
s_mov_b32 s26, 0x800000
s_mov_b32 s27, 0x00020000
s_mul_i32 s20, s2, 16384
v_lshlrev_b32 v52, 4, v0
s_add_u32 s21, s20, 0
buffer_load_dwordx4 v[56:59], v52, s[24:27], s21 offen
s_add_u32 s21, s20, 4096
buffer_load_dwordx4 v[60:63], v52, s[24:27], s21 offen
s_add_u32 s21, s20, 8192
buffer_load_dwordx4 v[64:67], v52, s[24:27], s21 offen
s_add_u32 s21, s20, 12288
buffer_load_dwordx4 v[68:71], v52, s[24:27], s21 offen
s_load_dwordx2 s[16:17], s[0:1], 32
s_waitcnt lgkmcnt(0)
s_mov_b32 s24, s16
s_and_b32 s25, s17, 0xffff
s_mov_b32 s26, 0x800000
s_mov_b32 s27, 0x00020000
s_mul_i32 s20, s2, 16384
v_lshlrev_b32 v52, 4, v0
s_add_u32 s21, s20, 0
buffer_load_dwordx4 v[56:59], v52, s[24:27], s21 offen
s_add_u32 s21, s20, 4096
buffer_load_dwordx4 v[60:63], v52, s[24:27], s21 offen
s_add_u32 s21, s20, 8192
buffer_load_dwordx4 v[64:67], v52, s[24:27], s21 offen
s_add_u32 s21, s20, 12288
buffer_load_dwordx4 v[68:71], v52, s[24:27], s21 offen
s_load_dwordx2 s[16:17], s[0:1], 16
s_waitcnt lgkmcnt(0)
s_mov_b32 s24, s16
s_and_b32 s25, s17, 0xffff
s_mov_b32 s26, 0x800000
s_mov_b32 s27, 0x00020000
s_mul_i32 s20, s2, 16384
v_lshlrev_b32 v52, 4, v0
s_add_u32 s21, s20, 0
buffer_load_dwordx4 v[56:59], v52, s[24:27], s21 offen
s_add_u32 s21, s20, 4096
buffer_load_dwordx4 v[60:63], v52, s[24:27], s21 offen
s_add_u32 s21, s20, 8192
buffer_load_dwordx4 v[64:67], v52, s[24:27], s21 offen
s_add_u32 s21, s20, 12288
buffer_load_dwordx4 v[68:71], v52, s[24:27], s21 offen
s_load_dwordx2 s[16:17], s[0:1], 40
s_waitcnt lgkmcnt(0)
s_mov_b32 s24, s16
s_and_b32 s25, s17, 0xffff
s_mov_b32 s26, 0x800000
s_mov_b32 s27, 0x00020000
s_mul_i32 s20, s2, 16384
v_lshlrev_b32 v52, 4, v0
s_add_u32 s21, s20, 0
buffer_load_dwordx4 v[56:59], v52, s[24:27], s21 offen
s_add_u32 s21, s20, 4096
buffer_load_dwordx4 v[60:63], v52, s[24:27], s21 offen
s_add_u32 s21, s20, 8192
buffer_load_dwordx4 v[64:67], v52, s[24:27], s21 offen
s_add_u32 s21, s20, 12288
buffer_load_dwordx4 v[68:71], v52, s[24:27], s21 offen
v_mov_b32 v40, -1
v_mov_b32 v41, -1
v_mov_b32 v42, -1
v_mov_b32 v43, -1
s_mul_i32 s15, s2, 3584
s_add_u32 s15, s15, 262144
v_lshlrev_b32 v44, 4, v0
v_add_u32 v45, 0, v44
v_cmp_gt_u32 vcc, 3584, v44
v_mov_b32 v46, 0x40000000
s_nop 0
v_cndmask_b32 v45, v46, v45, vcc
buffer_store_dwordx4 v[40:43], v45, s[4:7], s15 offen
v_mov_b32 v46, 0
s_cmp_ge_u32 s2, 2
s_cbranch_scc1 zp_1
s_mul_i32 s15, s2, 4198400
s_add_u32 s15, s15, 94371840
v_mov_b32 v48, 0
v_mov_b32 v49, 0
v_mov_b32 v50, 0
v_mov_b32 v51, 0
buffer_store_dwordx4 v[48:51], v44, s[4:7], s15 offen
zp_1:
v_lshlrev_b32 v45, 2, v0
v_cmp_gt_u32 vcc, 128, v0
v_mov_b32 v47, 0x40000000
s_nop 0
v_cndmask_b32 v45, v47, v45, vcc
s_lshl_b32 s15, s2, 9
buffer_store_dword v46, v45, s[4:7], s15 offen
s_waitcnt vmcnt(0)
v_lshlrev_b32 v12, 16, v4
v_and_b32 v13, 0xffff0000, v4
v_lshlrev_b32 v14, 16, v5
v_and_b32 v15, 0xffff0000, v5
v_lshlrev_b32 v16, 16, v6
v_and_b32 v17, 0xffff0000, v6
v_lshlrev_b32 v18, 16, v7
v_and_b32 v19, 0xffff0000, v7
v_lshlrev_b32 v20, 16, v8
v_and_b32 v21, 0xffff0000, v8
v_lshlrev_b32 v22, 16, v9
v_and_b32 v23, 0xffff0000, v9
v_lshlrev_b32 v24, 16, v10
v_and_b32 v25, 0xffff0000, v10
v_lshlrev_b32 v26, 16, v11
v_and_b32 v27, 0xffff0000, v11
v_add_f32 v28, v12, v13
v_add_f32 v28, v28, v14
v_add_f32 v28, v28, v15
v_add_f32 v28, v28, v16
v_add_f32 v28, v28, v17
v_add_f32 v28, v28, v18
v_add_f32 v28, v28, v19
v_add_f32 v28, v28, v20
v_add_f32 v28, v28, v21
v_add_f32 v28, v28, v22
v_add_f32 v28, v28, v23
v_add_f32 v28, v28, v24
v_add_f32 v28, v28, v25
v_add_f32 v28, v28, v26
v_add_f32 v28, v28, v27
s_nop 1
v_add_f32_dpp v28, v28, v28 row_ror:8 row_mask:0xf bank_mask:0xf
s_nop 1
v_add_f32_dpp v28, v28, v28 row_ror:4 row_mask:0xf bank_mask:0xf
s_nop 1
v_add_f32_dpp v28, v28, v28 row_ror:2 row_mask:0xf bank_mask:0xf
s_nop 1
v_add_f32_dpp v28, v28, v28 row_ror:1 row_mask:0xf bank_mask:0xf
v_mov_b32 v29, v28
s_nop 1
v_permlane16_swap_b32 v28, v29
v_add_f32 v28, v28, v29
v_mov_b32 v29, v28
s_nop 1
v_permlane32_swap_b32 v28, v29
v_add_f32 v28, v28, v29
v_mul_f32 v28, 0x3a800000, v28
v_sub_f32 v12, v12, v28
v_sub_f32 v13, v13, v28
v_sub_f32 v14, v14, v28
v_sub_f32 v15, v15, v28
v_sub_f32 v16, v16, v28
v_sub_f32 v17, v17, v28
v_sub_f32 v18, v18, v28
v_sub_f32 v19, v19, v28
v_sub_f32 v20, v20, v28
v_sub_f32 v21, v21, v28
v_sub_f32 v22, v22, v28
v_sub_f32 v23, v23, v28
v_sub_f32 v24, v24, v28
v_sub_f32 v25, v25, v28
v_sub_f32 v26, v26, v28
v_sub_f32 v27, v27, v28
v_mul_f32 v30, v12, v12
v_fmac_f32 v30, v13, v13
v_fmac_f32 v30, v14, v14
v_fmac_f32 v30, v15, v15
v_fmac_f32 v30, v16, v16
v_fmac_f32 v30, v17, v17
v_fmac_f32 v30, v18, v18
v_fmac_f32 v30, v19, v19
v_fmac_f32 v30, v20, v20
v_fmac_f32 v30, v21, v21
v_fmac_f32 v30, v22, v22
v_fmac_f32 v30, v23, v23
v_fmac_f32 v30, v24, v24
v_fmac_f32 v30, v25, v25
v_fmac_f32 v30, v26, v26
v_fmac_f32 v30, v27, v27
s_nop 1
v_add_f32_dpp v30, v30, v30 row_ror:8 row_mask:0xf bank_mask:0xf
s_nop 1
v_add_f32_dpp v30, v30, v30 row_ror:4 row_mask:0xf bank_mask:0xf
s_nop 1
v_add_f32_dpp v30, v30, v30 row_ror:2 row_mask:0xf bank_mask:0xf
s_nop 1
v_add_f32_dpp v30, v30, v30 row_ror:1 row_mask:0xf bank_mask:0xf
v_mov_b32 v29, v30
s_nop 1
v_permlane16_swap_b32 v30, v29
v_add_f32 v30, v30, v29
v_mov_b32 v29, v30
s_nop 1
v_permlane32_swap_b32 v30, v29
v_add_f32 v30, v30, v29
v_mov_b32 v31, 0x3727c5ac
v_fmac_f32 v31, 0x3a800000, v30
v_rsq_f32 v31, v31
s_nop 0
v_mul_f32 v12, v12, v31
v_mul_f32 v13, v13, v31
v_mul_f32 v14, v14, v31
v_mul_f32 v15, v15, v31
v_mul_f32 v16, v16, v31
v_mul_f32 v17, v17, v31
v_mul_f32 v18, v18, v31
v_mul_f32 v19, v19, v31
v_mul_f32 v20, v20, v31
v_mul_f32 v21, v21, v31
v_mul_f32 v22, v22, v31
v_mul_f32 v23, v23, v31
v_mul_f32 v24, v24, v31
v_mul_f32 v25, v25, v31
v_mul_f32 v26, v26, v31
v_mul_f32 v27, v27, v31
v_cvt_pk_bf16_f32 v4, v12, v13
v_cvt_pk_bf16_f32 v5, v14, v15
v_cvt_pk_bf16_f32 v6, v16, v17
v_cvt_pk_bf16_f32 v7, v18, v19
v_cvt_pk_bf16_f32 v8, v20, v21
v_cvt_pk_bf16_f32 v9, v22, v23
v_cvt_pk_bf16_f32 v10, v24, v25
v_cvt_pk_bf16_f32 v11, v26, v27
s_mov_b32 s14, 2097152
buffer_store_dwordx4 v[4:7], v2, s[4:7], s14 offen
buffer_store_dwordx4 v[8:11], v2, s[4:7], s14 offen offset:1024
prep_kernel_end:
s_endpgm
.globl mega_kernel
.p2align 8
.type mega_kernel,@function
mega_kernel:
s_cmp_ge_u32 s2, 256
s_cbranch_scc1 mega_kernel_end0
s_load_dwordx4 s[12:15], s[0:1], 8
s_load_dwordx4 s[16:19], s[0:1], 24
s_load_dwordx2 s[20:21], s[0:1], 40
s_load_dwordx2 s[22:23], s[0:1], 112
s_getreg_b32 s24, hwreg(HW_REG_XCC_ID)
s_and_b32 s24, s24, 7
v_lshrrev_b32 v3, 6, v0
v_and_b32 v0, 63, v0
v_readfirstlane_b32 s26, v3
v_and_b32 v1, 15, v0
v_lshrrev_b32 v2, 4, v0
s_mov_b32 s29, 0
s_waitcnt lgkmcnt(0)
s_mov_b32 s4, s22
s_and_b32 s5, s23, 0xffff
s_mov_b32 s6, 0x10000000
s_mov_b32 s7, 0x00020000
s_cmp_lg_u32 s26, 0
s_cbranch_scc1 role_2
s_lshl_b32 s48, s24, 8
v_mov_b32 v3, s48
v_mov_b32 v4, 1
s_mov_b64 exec, 1
buffer_atomic_add v4, v3, s[4:7], 0 offen sc0
s_waitcnt vmcnt(0)
s_mov_b64 exec, -1
v_readfirstlane_b32 s25, v4
v_lshlrev_b32 v3, 8, v0
v_min_u32 v3, 0x700, v3
rp_3:
s_add_u32 s29, s29, 1
s_cmp_gt_u32 s29, 262144
s_cbranch_scc1 mega_kernel_end0
buffer_load_dword v5, v3, s[4:7], 0 offen sc1
s_waitcnt vmcnt(0)
s_mov_b32 s48, 0
s_mov_b32 s27, 0
v_readlane_b32 s49, v5, 0
s_nop 0
s_add_u32 s48, s48, s49
s_cmp_lg_u32 s49, 32
s_cselect_b32 s27, 1, s27
v_readlane_b32 s49, v5, 1
s_nop 0
s_add_u32 s48, s48, s49
s_cmp_lg_u32 s49, 32
s_cselect_b32 s27, 1, s27
v_readlane_b32 s49, v5, 2
s_nop 0
s_add_u32 s48, s48, s49
s_cmp_lg_u32 s49, 32
s_cselect_b32 s27, 1, s27
v_readlane_b32 s49, v5, 3
s_nop 0
s_add_u32 s48, s48, s49
s_cmp_lg_u32 s49, 32
s_cselect_b32 s27, 1, s27
v_readlane_b32 s49, v5, 4
s_nop 0
s_add_u32 s48, s48, s49
s_cmp_lg_u32 s49, 32
s_cselect_b32 s27, 1, s27
v_readlane_b32 s49, v5, 5
s_nop 0
s_add_u32 s48, s48, s49
s_cmp_lg_u32 s49, 32
s_cselect_b32 s27, 1, s27
v_readlane_b32 s49, v5, 6
s_nop 0
s_add_u32 s48, s48, s49
s_cmp_lg_u32 s49, 32
s_cselect_b32 s27, 1, s27
v_readlane_b32 s49, v5, 7
s_nop 0
s_add_u32 s48, s48, s49
s_cmp_lg_u32 s49, 32
s_cselect_b32 s27, 1, s27
s_cmp_lg_u32 s48, 256
s_cbranch_scc1 rp_3
s_cmp_eq_u32 s27, 0
s_cbranch_scc1 fast_4
v_mov_b32 v3, 0x800
v_mov_b32 v4, 1
s_mov_b64 exec, 1
buffer_atomic_add v4, v3, s[4:7], 0 offen sc0
s_waitcnt vmcnt(0)
s_mov_b64 exec, -1
v_readfirstlane_b32 s48, v4
s_nop 0
s_lshr_b32 s24, s48, 5
s_and_b32 s25, s48, 31
fast_4:
v_mov_b32 v3, 0
v_mov_b32 v4, s24
v_mov_b32 v5, s25
v_mov_b32 v6, s27
ds_write_b32 v3, v4
ds_write_b32 v3, v5 offset:4
ds_write_b32 v3, v6 offset:8
s_waitcnt lgkmcnt(0)
role_2:
s_barrier
v_mov_b32 v3, 0
ds_read_b32 v4, v3
ds_read_b32 v5, v3 offset:4
ds_read_b32 v6, v3 offset:8
s_waitcnt lgkmcnt(0)
v_readfirstlane_b32 s24, v4
v_readfirstlane_b32 s25, v5
v_readfirstlane_b32 s27, v6
s_barrier
s_cmp_ge_u32 s25, 16
s_cbranch_scc1 mega_kernel_worker
s_mov_b32 s94, 0
s_lshr_b32 s30, s25, 2
s_and_b32 s31, s25, 3
s_lshl_b32 s32, s24, 2
s_add_u32 s32, s32, s30
v_lshrrev_b32 v3, 2, v0
s_lshl_b32 s48, s26, 7
v_add_u32 v3, s48, v3
v_lshlrev_b32 v3, 13, v3
v_and_b32 v9, 3, v0
v_lshl_add_u32 v3, v9, 4, v3
s_lshl_b32 s48, s32, 8
s_lshl_b32 s49, s31, 6
s_add_u32 s48, s48, s49
v_add_u32 v3, s48, v3
v_lshrrev_b32 v10, 3, v0
s_lshl_b32 s48, s24, 9
s_lshl_b32 s49, s26, 6
s_add_u32 s48, s48, s49
v_add_u32 v10, s48, v10
v_lshlrev_b32 v10, 11, v10
v_and_b32 v9, 7, v0
v_lshl_add_u32 v10, v9, 4, v10
s_lshl_b32 s48, s25, 7
v_add_u32 v10, s48, v10
s_lshl_b32 s51, s26, 13
s_mov_b32 s8, s14
s_and_b32 s9, s15, 0xffff
s_mov_b32 s10, 0x800000
s_mov_b32 s11, 0x00020000
s_add_u32 m0, s51, 0
s_mov_b32 s49, 0
buffer_load_dwordx4 v3, s[8:11], s49 offen lds
s_add_u32 m0, s51, 1024
s_mov_b32 s49, 131072
buffer_load_dwordx4 v3, s[8:11], s49 offen lds
s_add_u32 m0, s51, 2048
s_mov_b32 s49, 262144
buffer_load_dwordx4 v3, s[8:11], s49 offen lds
s_add_u32 m0, s51, 3072
s_mov_b32 s49, 393216
buffer_load_dwordx4 v3, s[8:11], s49 offen lds
s_add_u32 m0, s51, 4096
s_mov_b32 s49, 524288
buffer_load_dwordx4 v3, s[8:11], s49 offen lds
s_add_u32 m0, s51, 5120
s_mov_b32 s49, 655360
buffer_load_dwordx4 v3, s[8:11], s49 offen lds
s_add_u32 m0, s51, 6144
s_mov_b32 s49, 786432
buffer_load_dwordx4 v3, s[8:11], s49 offen lds
s_add_u32 m0, s51, 7168
s_mov_b32 s49, 917504
buffer_load_dwordx4 v3, s[8:11], s49 offen lds
s_mov_b32 s8, s16
s_and_b32 s9, s17, 0xffff
s_mov_b32 s10, 0x800000
s_mov_b32 s11, 0x00020000
s_add_u32 m0, s51, 65536
s_mov_b32 s49, 0
buffer_load_dwordx4 v3, s[8:11], s49 offen lds
s_add_u32 m0, s51, 66560
s_mov_b32 s49, 131072
buffer_load_dwordx4 v3, s[8:11], s49 offen lds
s_add_u32 m0, s51, 67584
s_mov_b32 s49, 262144
buffer_load_dwordx4 v3, s[8:11], s49 offen lds
s_add_u32 m0, s51, 68608
s_mov_b32 s49, 393216
buffer_load_dwordx4 v3, s[8:11], s49 offen lds
s_add_u32 m0, s51, 69632
s_mov_b32 s49, 524288
buffer_load_dwordx4 v3, s[8:11], s49 offen lds
s_add_u32 m0, s51, 70656
s_mov_b32 s49, 655360
buffer_load_dwordx4 v3, s[8:11], s49 offen lds
s_add_u32 m0, s51, 71680
s_mov_b32 s49, 786432
buffer_load_dwordx4 v3, s[8:11], s49 offen lds
s_add_u32 m0, s51, 72704
s_mov_b32 s49, 917504
buffer_load_dwordx4 v3, s[8:11], s49 offen lds
v_lshrrev_b32 v11, 2, v1
v_and_b32 v12, 3, v1
v_lshlrev_b32 v12, 3, v12
v_lshl_add_u32 v13, v2, 3, v11
v_lshl_add_u32 v14, v13, 7, v12
v_lshl_add_u32 v13, v13, 6, v12
s_and_b32 s48, s26, 1
s_lshl_b32 s48, s48, 5
v_add_u32 v13, s48, v13
s_bfe_u32 s49, s26, 65537
s_lshl_b32 s50, s49, 16
v_add_u32 v15, s50, v13
s_lshl_b32 s50, s49, 15
v_add_u32 v16, s50, v13
s_and_b32 s48, s26, 3
s_lshl_b32 s48, s48, 5
s_add_u32 s48, s48, 65536
v_add_u32 v14, s48, v14
s_waitcnt vmcnt(0)
s_barrier
s_cmp_ge_u32 s26, 4
s_cbranch_scc1 w1_5
ds_read_b64_tr_b16 a[0:1], v15 offset:0
ds_read_b64_tr_b16 a[2:3], v15 offset:256
ds_read_b64_tr_b16 a[4:5], v15 offset:2048
ds_read_b64_tr_b16 a[6:7], v15 offset:2304
ds_read_b64_tr_b16 a[8:9], v15 offset:4096
ds_read_b64_tr_b16 a[10:11], v15 offset:4352
ds_read_b64_tr_b16 a[12:13], v15 offset:6144
ds_read_b64_tr_b16 a[14:15], v15 offset:6400
s_waitcnt lgkmcnt(0)
ds_read_b64_tr_b16 a[16:17], v15 offset:8192
ds_read_b64_tr_b16 a[18:19], v15 offset:8448
ds_read_b64_tr_b16 a[20:21], v15 offset:10240
ds_read_b64_tr_b16 a[22:23], v15 offset:10496
ds_read_b64_tr_b16 a[24:25], v15 offset:12288
ds_read_b64_tr_b16 a[26:27], v15 offset:12544
ds_read_b64_tr_b16 a[28:29], v15 offset:14336
ds_read_b64_tr_b16 a[30:31], v15 offset:14592
s_waitcnt lgkmcnt(0)
ds_read_b64_tr_b16 a[32:33], v15 offset:16384
ds_read_b64_tr_b16 a[34:35], v15 offset:16640
ds_read_b64_tr_b16 a[36:37], v15 offset:18432
ds_read_b64_tr_b16 a[38:39], v15 offset:18688
ds_read_b64_tr_b16 a[40:41], v15 offset:20480
ds_read_b64_tr_b16 a[42:43], v15 offset:20736
ds_read_b64_tr_b16 a[44:45], v15 offset:22528
ds_read_b64_tr_b16 a[46:47], v15 offset:22784
s_waitcnt lgkmcnt(0)
ds_read_b64_tr_b16 a[48:49], v15 offset:24576
ds_read_b64_tr_b16 a[50:51], v15 offset:24832
ds_read_b64_tr_b16 a[52:53], v15 offset:26624
ds_read_b64_tr_b16 a[54:55], v15 offset:26880
ds_read_b64_tr_b16 a[56:57], v15 offset:28672
ds_read_b64_tr_b16 a[58:59], v15 offset:28928
ds_read_b64_tr_b16 a[60:61], v15 offset:30720
ds_read_b64_tr_b16 a[62:63], v15 offset:30976
s_waitcnt lgkmcnt(0)
ds_read_b64_tr_b16 a[64:65], v15 offset:32768
ds_read_b64_tr_b16 a[66:67], v15 offset:33024
ds_read_b64_tr_b16 a[68:69], v15 offset:34816
ds_read_b64_tr_b16 a[70:71], v15 offset:35072
ds_read_b64_tr_b16 a[72:73], v15 offset:36864
ds_read_b64_tr_b16 a[74:75], v15 offset:37120
ds_read_b64_tr_b16 a[76:77], v15 offset:38912
ds_read_b64_tr_b16 a[78:79], v15 offset:39168
s_waitcnt lgkmcnt(0)
ds_read_b64_tr_b16 a[80:81], v15 offset:40960
ds_read_b64_tr_b16 a[82:83], v15 offset:41216
ds_read_b64_tr_b16 a[84:85], v15 offset:43008
ds_read_b64_tr_b16 a[86:87], v15 offset:43264
ds_read_b64_tr_b16 a[88:89], v15 offset:45056
ds_read_b64_tr_b16 a[90:91], v15 offset:45312
ds_read_b64_tr_b16 a[92:93], v15 offset:47104
ds_read_b64_tr_b16 a[94:95], v15 offset:47360
s_waitcnt lgkmcnt(0)
ds_read_b64_tr_b16 a[96:97], v15 offset:49152
ds_read_b64_tr_b16 a[98:99], v15 offset:49408
ds_read_b64_tr_b16 a[100:101], v15 offset:51200
ds_read_b64_tr_b16 a[102:103], v15 offset:51456
ds_read_b64_tr_b16 a[104:105], v15 offset:53248
ds_read_b64_tr_b16 a[106:107], v15 offset:53504
ds_read_b64_tr_b16 a[108:109], v15 offset:55296
ds_read_b64_tr_b16 a[110:111], v15 offset:55552
s_waitcnt lgkmcnt(0)
ds_read_b64_tr_b16 a[112:113], v15 offset:57344
ds_read_b64_tr_b16 a[114:115], v15 offset:57600
ds_read_b64_tr_b16 a[116:117], v15 offset:59392
ds_read_b64_tr_b16 a[118:119], v15 offset:59648
ds_read_b64_tr_b16 a[120:121], v15 offset:61440
ds_read_b64_tr_b16 a[122:123], v15 offset:61696
ds_read_b64_tr_b16 a[124:125], v15 offset:63488
ds_read_b64_tr_b16 a[126:127], v15 offset:63744
s_waitcnt lgkmcnt(0)
w1_5:
s_barrier
s_mov_b32 s8, s18
s_and_b32 s9, s19, 0xffff
s_mov_b32 s10, 0x800000
s_mov_b32 s11, 0x00020000
s_add_u32 m0, s51, 0
s_mov_b32 s49, 0
buffer_load_dwordx4 v3, s[8:11], s49 offen lds
s_add_u32 m0, s51, 1024
s_mov_b32 s49, 131072
buffer_load_dwordx4 v3, s[8:11], s49 offen lds
s_add_u32 m0, s51, 2048
s_mov_b32 s49, 262144
buffer_load_dwordx4 v3, s[8:11], s49 offen lds
s_add_u32 m0, s51, 3072
s_mov_b32 s49, 393216
buffer_load_dwordx4 v3, s[8:11], s49 offen lds
s_add_u32 m0, s51, 4096
s_mov_b32 s49, 524288
buffer_load_dwordx4 v3, s[8:11], s49 offen lds
s_add_u32 m0, s51, 5120
s_mov_b32 s49, 655360
buffer_load_dwordx4 v3, s[8:11], s49 offen lds
s_add_u32 m0, s51, 6144
s_mov_b32 s49, 786432
buffer_load_dwordx4 v3, s[8:11], s49 offen lds
s_add_u32 m0, s51, 7168
s_mov_b32 s49, 917504
buffer_load_dwordx4 v3, s[8:11], s49 offen lds
s_mov_b32 s8, s20
s_and_b32 s9, s21, 0xffff
s_mov_b32 s10, 0x800000
s_mov_b32 s11, 0x00020000
s_add_u32 m0, s51, 65536
s_mov_b32 s49, 0
buffer_load_dwordx4 v10, s[8:11], s49 offen lds
s_add_u32 m0, s51, 66560
s_mov_b32 s49, 16384
buffer_load_dwordx4 v10, s[8:11], s49 offen lds
s_add_u32 m0, s51, 67584
s_mov_b32 s49, 32768
buffer_load_dwordx4 v10, s[8:11], s49 offen lds
s_add_u32 m0, s51, 68608
s_mov_b32 s49, 49152
buffer_load_dwordx4 v10, s[8:11], s49 offen lds
s_add_u32 m0, s51, 69632
s_mov_b32 s49, 65536
buffer_load_dwordx4 v10, s[8:11], s49 offen lds
s_add_u32 m0, s51, 70656
s_mov_b32 s49, 81920
buffer_load_dwordx4 v10, s[8:11], s49 offen lds
s_add_u32 m0, s51, 71680
s_mov_b32 s49, 98304
buffer_load_dwordx4 v10, s[8:11], s49 offen lds
s_add_u32 m0, s51, 72704
s_mov_b32 s49, 114688
buffer_load_dwordx4 v10, s[8:11], s49 offen lds
s_waitcnt vmcnt(0)
s_barrier
s_cmp_lt_u32 s26, 4
s_cbranch_scc1 w2_6
ds_read_b64_tr_b16 a[0:1], v16 offset:0
ds_read_b64_tr_b16 a[2:3], v16 offset:256
ds_read_b64_tr_b16 a[4:5], v16 offset:2048
ds_read_b64_tr_b16 a[6:7], v16 offset:2304
ds_read_b64_tr_b16 a[8:9], v16 offset:4096
ds_read_b64_tr_b16 a[10:11], v16 offset:4352
ds_read_b64_tr_b16 a[12:13], v16 offset:6144
ds_read_b64_tr_b16 a[14:15], v16 offset:6400
s_waitcnt lgkmcnt(0)
ds_read_b64_tr_b16 a[16:17], v16 offset:8192
ds_read_b64_tr_b16 a[18:19], v16 offset:8448
ds_read_b64_tr_b16 a[20:21], v16 offset:10240
ds_read_b64_tr_b16 a[22:23], v16 offset:10496
ds_read_b64_tr_b16 a[24:25], v16 offset:12288
ds_read_b64_tr_b16 a[26:27], v16 offset:12544
ds_read_b64_tr_b16 a[28:29], v16 offset:14336
ds_read_b64_tr_b16 a[30:31], v16 offset:14592
s_waitcnt lgkmcnt(0)
ds_read_b64_tr_b16 a[32:33], v16 offset:16384
ds_read_b64_tr_b16 a[34:35], v16 offset:16640
ds_read_b64_tr_b16 a[36:37], v16 offset:18432
ds_read_b64_tr_b16 a[38:39], v16 offset:18688
ds_read_b64_tr_b16 a[40:41], v16 offset:20480
ds_read_b64_tr_b16 a[42:43], v16 offset:20736
ds_read_b64_tr_b16 a[44:45], v16 offset:22528
ds_read_b64_tr_b16 a[46:47], v16 offset:22784
s_waitcnt lgkmcnt(0)
ds_read_b64_tr_b16 a[48:49], v16 offset:24576
ds_read_b64_tr_b16 a[50:51], v16 offset:24832
ds_read_b64_tr_b16 a[52:53], v16 offset:26624
ds_read_b64_tr_b16 a[54:55], v16 offset:26880
ds_read_b64_tr_b16 a[56:57], v16 offset:28672
ds_read_b64_tr_b16 a[58:59], v16 offset:28928
ds_read_b64_tr_b16 a[60:61], v16 offset:30720
ds_read_b64_tr_b16 a[62:63], v16 offset:30976
s_waitcnt lgkmcnt(0)
ds_read_b64_tr_b16 a[64:65], v14 offset:0
ds_read_b64_tr_b16 a[66:67], v14 offset:512
ds_read_b64_tr_b16 a[68:69], v14 offset:4096
ds_read_b64_tr_b16 a[70:71], v14 offset:4608
ds_read_b64_tr_b16 a[72:73], v14 offset:8192
ds_read_b64_tr_b16 a[74:75], v14 offset:8704
ds_read_b64_tr_b16 a[76:77], v14 offset:12288
ds_read_b64_tr_b16 a[78:79], v14 offset:12800
s_waitcnt lgkmcnt(0)
ds_read_b64_tr_b16 a[80:81], v14 offset:16384
ds_read_b64_tr_b16 a[82:83], v14 offset:16896
ds_read_b64_tr_b16 a[84:85], v14 offset:20480
ds_read_b64_tr_b16 a[86:87], v14 offset:20992
ds_read_b64_tr_b16 a[88:89], v14 offset:24576
ds_read_b64_tr_b16 a[90:91], v14 offset:25088
ds_read_b64_tr_b16 a[92:93], v14 offset:28672
ds_read_b64_tr_b16 a[94:95], v14 offset:29184
s_waitcnt lgkmcnt(0)
ds_read_b64_tr_b16 a[96:97], v14 offset:32768
ds_read_b64_tr_b16 a[98:99], v14 offset:33280
ds_read_b64_tr_b16 a[100:101], v14 offset:36864
ds_read_b64_tr_b16 a[102:103], v14 offset:37376
ds_read_b64_tr_b16 a[104:105], v14 offset:40960
ds_read_b64_tr_b16 a[106:107], v14 offset:41472
ds_read_b64_tr_b16 a[108:109], v14 offset:45056
ds_read_b64_tr_b16 a[110:111], v14 offset:45568
s_waitcnt lgkmcnt(0)
ds_read_b64_tr_b16 a[112:113], v14 offset:49152
ds_read_b64_tr_b16 a[114:115], v14 offset:49664
ds_read_b64_tr_b16 a[116:117], v14 offset:53248
ds_read_b64_tr_b16 a[118:119], v14 offset:53760
ds_read_b64_tr_b16 a[120:121], v14 offset:57344
ds_read_b64_tr_b16 a[122:123], v14 offset:57856
ds_read_b64_tr_b16 a[124:125], v14 offset:61440
ds_read_b64_tr_b16 a[126:127], v14 offset:61952
s_waitcnt lgkmcnt(0)
w2_6:
s_barrier
v_and_b32 v30, 7, v1
v_mov_b32 v31, 0x40000000
v_cmp_gt_u32 s[58:59], 8, v1
v_cmp_gt_u32 s[60:61], 2, v2
v_lshlrev_b32 v17, 4, v0
s_lshl_b32 s48, s26, 11
v_add_u32 v10, s48, v17
s_and_b32 s50, s26, 3
s_lshl_b32 s48, s50, 11
v_add_u32 v18, s48, v17
v_lshrrev_b32 v3, 3, v1
v_lshlrev_b32 v3, 9, v3
v_lshl_add_u32 v3, v2, 7, v3
v_lshl_add_u32 v11, v30, 4, v3
s_lshl_b32 s48, s30, 12
s_lshl_b32 s51, s31, 10
s_add_u32 s48, s48, s51
s_lshl_b32 s51, s50, 8
s_add_u32 s48, s48, s51
v_lshlrev_b32 v3, 5, v1
v_lshl_add_u32 v3, v2, 3, v3
v_add_u32 v12, s48, v3
v_cndmask_b32 v12, v31, v12, s[58:59]
s_and_b32 s49, s26, 1
s_lshl_b32 s48, s32, 11
s_lshl_b32 s51, s31, 6
s_add_u32 s48, s48, s51
s_lshl_b32 s51, s49, 5
s_add_u32 s48, s48, s51
v_lshlrev_b32 v3, 8, v1
v_lshl_add_u32 v3, v2, 3, v3
v_add_u32 v13, s48, v3
v_cndmask_b32 v13, v31, v13, s[58:59]
s_lshl_b32 s48, s32, 7
s_lshl_b32 s51, s31, 5
s_add_u32 s48, s48, s51
s_lshl_b32 s51, s49, 4
s_add_u32 s48, s48, s51
v_add_u32 v3, s48, v1
v_lshlrev_b32 v3, 4, v3
v_and_b32 v9, 1, v2
v_lshl_add_u32 v22, v9, 3, v3
v_cndmask_b32 v22, v22, v31, s[60:61]
s_lshl_b32 s48, s50, 10
s_add_u32 s48, s48, 24576
v_add_u32 v21, s48, v17
s_lshl_b32 s48, s30, 12
v_lshrrev_b32 v3, 3, v1
v_lshlrev_b32 v3, 9, v3
v_lshrrev_b32 v9, 1, v2
v_lshl_add_u32 v3, v9, 8, v3
v_lshl_add_u32 v3, v30, 5, v3
v_and_b32 v9, 1, v2
v_lshl_add_u32 v3, v9, 4, v3
v_add_u32 v14, s48, v3
s_lshl_b32 s48, s25, 9
s_lshl_b32 s51, s49, 8
s_add_u32 s48, s48, s51
v_lshrrev_b32 v3, 1, v2
v_lshlrev_b32 v3, 7, v3
v_lshl_add_u32 v3, v1, 4, v3
v_and_b32 v9, 1, v2
v_lshl_add_u32 v3, v9, 3, v3
v_add_u32 v15, s48, v3
v_cndmask_b32 v15, v31, v15, s[58:59]
s_lshl_b32 s48, s32, 13
v_add_u32 v16, s48, v17
s_lshl_b32 s48, s25, 2
s_add_u32 s48, s48, s50
s_mul_i32 s48, s48, 256
v_lshlrev_b32 v3, 5, v1
v_lshl_add_u32 v3, v2, 3, v3
v_add_u32 v19, s48, v3
v_cndmask_b32 v19, v31, v19, s[58:59]
v_lshrrev_b32 v9, 3, v0
v_and_b32 v30, 7, v0
v_lshlrev_b32 v3, 5, v9
v_lshl_add_u32 v3, v30, 2, v3
v_add_u32 v24, s48, v3
v_add_u32 v25, 65536, v24
s_lshl_b32 s48, s25, 10
s_lshl_b32 s49, s50, 8
s_add_u32 s48, s48, s49
v_lshrrev_b32 v3, 2, v30
v_lshlrev_b32 v3, 7, v3
v_lshl_add_u32 v3, v9, 4, v3
v_and_b32 v28, 3, v30
v_lshl_add_u32 v3, v28, 2, v3
v_add_u32 v20, s48, v3
s_lshl_b32 s48, s25, 7
s_lshl_b32 s49, s50, 5
s_add_u32 s48, s48, s49
v_lshlrev_b32 v3, 11, v9
v_lshl_add_u32 v3, v30, 2, v3
v_add_u32 v3, s48, v3
s_mov_b32 s8, s12
s_and_b32 s9, s13, 0xffff
s_mov_b32 s10, 0x4000
s_mov_b32 s11, 0x00020000
buffer_load_dword v32, v3, s[8:11], 0 offen
v_mov_b32 v28, -1
v_mov_b32 v29, -1
s_mov_b32 s52, 0x3e0293ee
s_mov_b32 s57, 0xbe0293ee
v_mov_b32 v26, s52
v_mov_b32 v27, s52
v_mov_b32 v4, 0x3f803f80
v_mov_b32 v5, 0x3f803f80
v_mov_b32 v6, 0x3f803f80
v_mov_b32 v7, 0x3f803f80
v_mov_b32 v3, 0xff800000
v_mov_b32 v8, 0
v_cndmask_b32 v8, v8, v3, s[60:61]
s_lshl_b32 s62, s24, 14
s_add_u32 s62, s62, 262144
s_lshl_b32 s63, s24, 13
s_add_u32 s63, s63, 1310720
s_lshl_b32 s33, s24, 14
s_waitcnt vmcnt(0)
s_cmp_lg_u32 s27, 0
s_cbranch_scc1 mega_kernel_ch_m1_start
mega_kernel_ch_m0_start:
s_mov_b32 s28, 0
s_cmp_ge_u32 s26, 4
s_cbranch_scc1 mega_kernel_ch_m0_Cstart
buffer_store_dword v32, v20, s[4:7], s62 offen
s_cmp_lt_u32 s26, 2
s_cbranch_scc1 pf0_7
s_lshl_b32 s48, s28, 18
s_add_u32 s40, s48, 23068672
s_add_u32 s41, s48, 39845888
s_lshl_b32 s48, s31, 11
s_add_u32 s41, s41, s48
s_mov_b32 s54, 28672
s_lshr_b32 s51, s28, 2
s_cmp_lt_u32 s51, s94
s_cbranch_scc1 kvok_8
s_add_u32 s94, s51, 1
s_lshl_b32 s48, s24, 4
s_add_u32 s48, s48, s51
s_lshl_b32 s48, s48, 7
s_add_u32 s48, s48, 8192
v_mov_b32 v3, s48
kvp_9:
s_add_u32 s29, s29, 1
s_cmp_gt_u32 s29, 262144
s_cbranch_scc1 mega_kernel_end0
buffer_load_dword v9, v3, s[4:7], 0 offen sc1
s_waitcnt vmcnt(0)
v_cmp_gt_u32 vcc, 16, v9
s_nop 0
s_cbranch_vccnz kvp_9
kvok_8:
s_cmp_eq_u32 s26, 3
s_cbranch_scc1 pf3_10
s_add_u32 m0, s54, 0
s_add_u32 s49, s40, 0
buffer_load_dwordx4 v16, s[4:7], s49 offen sc1 lds
s_add_u32 m0, s54, 1024
s_add_u32 s49, s40, 1024
buffer_load_dwordx4 v16, s[4:7], s49 offen sc1 lds
s_add_u32 m0, s54, 2048
s_add_u32 s49, s40, 2048
buffer_load_dwordx4 v16, s[4:7], s49 offen sc1 lds
s_add_u32 m0, s54, 3072
s_add_u32 s49, s40, 3072
buffer_load_dwordx4 v16, s[4:7], s49 offen sc1 lds
s_add_u32 m0, s54, 4096
s_add_u32 s49, s40, 4096
buffer_load_dwordx4 v16, s[4:7], s49 offen sc1 lds
s_branch pfe_11
pf3_10:
s_add_u32 m0, s54, 5120
s_add_u32 s49, s40, 5120
buffer_load_dwordx4 v16, s[4:7], s49 offen sc1 lds
s_add_u32 m0, s54, 6144
s_add_u32 s49, s40, 6144
buffer_load_dwordx4 v16, s[4:7], s49 offen sc1 lds
s_add_u32 m0, s54, 7168
s_add_u32 s49, s40, 7168
buffer_load_dwordx4 v16, s[4:7], s49 offen sc1 lds
s_add_u32 m0, s54, 8192
s_add_u32 s49, s41, 0
buffer_load_dwordx4 v16, s[4:7], s49 offen sc1 lds
s_add_u32 m0, s54, 9216
s_add_u32 s49, s41, 1024
buffer_load_dwordx4 v16, s[4:7], s49 offen sc1 lds
pfe_11:
pf0_7:
s_and_b32 s48, s28, 3
s_xor_b32 s50, s48, 2
s_lshl_b32 s34, s48, 17
s_add_u32 s34, s34, s62
s_lshl_b32 s44, s50, 17
s_add_u32 s44, s44, s62
s_add_u32 s36, s34, 524288
s_add_u32 s45, s44, 524288
s_lshl_b32 s37, s48, 16
s_add_u32 s37, s37, s63
s_lshl_b32 s46, s50, 16
s_add_u32 s46, s46, s63
s_lshl_b32 s48, s28, 16
s_add_u32 s42, s48, 56623104
s_add_u32 s43, s48, 60817408
s_and_b32 s48, s28, 1
s_mul_i32 s53, s48, 10240
s_add_u32 s53, s53, 28672
s_xor_b32 s48, s48, 1
s_mul_i32 s54, s48, 10240
s_add_u32 s54, s54, 28672
mega_kernel_ch_m0_Aloop:
s_sleep 2
mega_kernel_ch_m0A_pa:
buffer_load_dwordx4 v[32:35], v10, s[4:7], s34 offen offset:0 sc1
buffer_load_dwordx4 v[36:39], v10, s[4:7], s34 offen offset:1024 sc1
s_add_u32 s29, s29, 1
s_cmp_gt_u32 s29, 262144
s_cbranch_scc1 mega_kernel_end0
s_waitcnt vmcnt(0)
ds_write_b128 v10, v[32:35] offset:0
ds_write_b128 v10, v[36:39] offset:1024
v_max3_u32 v3, v32, v33, v34
v_max3_u32 v3, v3, v35, v36
v_max3_u32 v3, v3, v37, v38
v_max_u32 v3, v3, v39
v_cmp_eq_u32 vcc, -1, v3
s_nop 0
s_cbranch_vccnz mega_kernel_ch_m0A_pa
s_waitcnt lgkmcnt(0)
s_barrier
s_setprio 3
RB 32,11,0
RB 36,11,1024
RB 40,11,2048
RB 44,11,3072
RB 48,11,4096
RB 52,11,5120
s_waitcnt lgkmcnt(5)
v_mfma_f32_16x16x32_bf16 v[96:99], a[0:3], v[32:35], 0
RB 56,11,6144
v_mfma_f32_16x16x32_bf16 v[100:103], a[4:7], v[32:35], 0
s_waitcnt lgkmcnt(5)
v_mfma_f32_16x16x32_bf16 v[96:99], a[8:11], v[36:39], v[96:99]
RB 60,11,7168
v_mfma_f32_16x16x32_bf16 v[100:103], a[12:15], v[36:39], v[100:103]
s_waitcnt lgkmcnt(5)
v_mfma_f32_16x16x32_bf16 v[96:99], a[16:19], v[40:43], v[96:99]
RB 64,11,8192
v_mfma_f32_16x16x32_bf16 v[100:103], a[20:23], v[40:43], v[100:103]
s_waitcnt lgkmcnt(5)
v_mfma_f32_16x16x32_bf16 v[96:99], a[24:27], v[44:47], v[96:99]
RB 68,11,9216
v_mfma_f32_16x16x32_bf16 v[100:103], a[28:31], v[44:47], v[100:103]
s_waitcnt lgkmcnt(5)
v_mfma_f32_16x16x32_bf16 v[96:99], a[32:35], v[48:51], v[96:99]
RB 72,11,10240
v_mfma_f32_16x16x32_bf16 v[100:103], a[36:39], v[48:51], v[100:103]
s_waitcnt lgkmcnt(5)
v_mfma_f32_16x16x32_bf16 v[96:99], a[40:43], v[52:55], v[96:99]
RB 76,11,11264
v_mfma_f32_16x16x32_bf16 v[100:103], a[44:47], v[52:55], v[100:103]
s_waitcnt lgkmcnt(5)
v_mfma_f32_16x16x32_bf16 v[96:99], a[48:51], v[56:59], v[96:99]
RB 80,11,12288
v_mfma_f32_16x16x32_bf16 v[100:103], a[52:55], v[56:59], v[100:103]
s_waitcnt lgkmcnt(5)
v_mfma_f32_16x16x32_bf16 v[96:99], a[56:59], v[60:63], v[96:99]
RB 84,11,13312
v_mfma_f32_16x16x32_bf16 v[100:103], a[60:63], v[60:63], v[100:103]
s_waitcnt lgkmcnt(5)
v_mfma_f32_16x16x32_bf16 v[96:99], a[64:67], v[64:67], v[96:99]
RB 88,11,14336
v_mfma_f32_16x16x32_bf16 v[100:103], a[68:71], v[64:67], v[100:103]
s_waitcnt lgkmcnt(5)
v_mfma_f32_16x16x32_bf16 v[96:99], a[72:75], v[68:71], v[96:99]
RB 92,11,15360
v_mfma_f32_16x16x32_bf16 v[100:103], a[76:79], v[68:71], v[100:103]
s_waitcnt lgkmcnt(5)
v_mfma_f32_16x16x32_bf16 v[96:99], a[80:83], v[72:75], v[96:99]
v_mfma_f32_16x16x32_bf16 v[100:103], a[84:87], v[72:75], v[100:103]
s_waitcnt lgkmcnt(4)
v_mfma_f32_16x16x32_bf16 v[96:99], a[88:91], v[76:79], v[96:99]
v_mfma_f32_16x16x32_bf16 v[100:103], a[92:95], v[76:79], v[100:103]
s_waitcnt lgkmcnt(3)
v_mfma_f32_16x16x32_bf16 v[96:99], a[96:99], v[80:83], v[96:99]
v_mfma_f32_16x16x32_bf16 v[100:103], a[100:103], v[80:83], v[100:103]
s_waitcnt lgkmcnt(2)
v_mfma_f32_16x16x32_bf16 v[96:99], a[104:107], v[84:87], v[96:99]
v_mfma_f32_16x16x32_bf16 v[100:103], a[108:111], v[84:87], v[100:103]
s_waitcnt lgkmcnt(1)
v_mfma_f32_16x16x32_bf16 v[96:99], a[112:115], v[88:91], v[96:99]
v_mfma_f32_16x16x32_bf16 v[100:103], a[116:119], v[88:91], v[100:103]
s_waitcnt lgkmcnt(0)
v_mfma_f32_16x16x32_bf16 v[96:99], a[120:123], v[92:95], v[96:99]
v_mfma_f32_16x16x32_bf16 v[100:103], a[124:127], v[92:95], v[100:103]
s_barrier
s_nop 6
v_add_f32_dpp v96, v100, v96 row_ror:8 row_mask:0xf bank_mask:0xf
v_add_f32_dpp v97, v101, v97 row_ror:8 row_mask:0xf bank_mask:0xf
v_add_f32_dpp v98, v102, v98 row_ror:8 row_mask:0xf bank_mask:0xf
v_add_f32_dpp v99, v103, v99 row_ror:8 row_mask:0xf bank_mask:0xf
v_cvt_pk_bf16_f32 v96, v96, v97
v_cvt_pk_bf16_f32 v97, v98, v99
buffer_store_dwordx2 v[96:97], v12, s[4:7], s36 offen
s_cmp_ge_u32 s26, 2
s_cbranch_scc1 mega_kernel_ch_m0_kw
s_cmp_eq_u32 s28, 63
s_cbranch_scc1 mega_kernel_ch_m0_last01
v_add_u32 v3, s53, v17
RB 32,3,0
RB 36,3,1024
RB 40,3,2048
RB 44,3,3072
RB 48,3,4096
RB 52,3,5120
RB 56,3,6144
RB 60,3,7168
s_lshl_b32 s48, s26, 10
v_add_u32 v3, s48, v3
RB 64,3,8192
s_sleep 2
mega_kernel_ch_m0_pb:
buffer_load_dwordx4 v[68:71], v14, s[4:7], s36 offen offset:0 sc1
buffer_load_dwordx4 v[72:75], v14, s[4:7], s36 offen offset:1024 sc1
buffer_load_dwordx4 v[76:79], v14, s[4:7], s36 offen offset:2048 sc1
buffer_load_dwordx4 v[80:83], v14, s[4:7], s36 offen offset:3072 sc1
s_add_u32 s29, s29, 1
s_cmp_gt_u32 s29, 262144
s_cbranch_scc1 mega_kernel_end0
v_mov_b32 v84, v8
v_mov_b32 v85, v8
v_mov_b32 v86, v8
v_mov_b32 v87, v8
s_waitcnt vmcnt(0) lgkmcnt(0)
s_nop 0
v_mfma_f32_16x16x32_bf16 v[84:87], v[68:71], v[68:71], v[84:87]
v_max3_u32 v3, v68, v69, v70
v_mfma_f32_16x16x32_bf16 v[88:91], v[32:35], v[68:71], 0
v_max3_u32 v3, v3, v71, v72
v_mfma_f32_16x16x32_bf16 v[92:95], v[48:51], v[68:71], 0
v_max3_u32 v3, v3, v73, v74
v_mfma_f32_16x16x32_bf16 v[84:87], v[72:75], v[72:75], v[84:87]
v_max3_u32 v3, v3, v75, v76
v_mfma_f32_16x16x32_bf16 v[88:91], v[36:39], v[72:75], v[88:91]
v_max3_u32 v3, v3, v77, v78
v_mfma_f32_16x16x32_bf16 v[92:95], v[52:55], v[72:75], v[92:95]
v_max3_u32 v3, v3, v79, v80
v_mfma_f32_16x16x32_bf16 v[84:87], v[76:79], v[76:79], v[84:87]
v_max3_u32 v3, v3, v81, v82
v_mfma_f32_16x16x32_bf16 v[88:91], v[40:43], v[76:79], v[88:91]
v_max_u32 v3, v3, v83
v_mfma_f32_16x16x32_bf16 v[92:95], v[56:59], v[76:79], v[92:95]
v_cmp_eq_u32 vcc, -1, v3
v_mfma_f32_16x16x32_bf16 v[84:87], v[80:83], v[80:83], v[84:87]
v_mfma_f32_16x16x32_bf16 v[88:91], v[44:47], v[80:83], v[88:91]
v_mfma_f32_16x16x32_bf16 v[92:95], v[60:63], v[80:83], v[92:95]
s_cbranch_vccnz mega_kernel_ch_m0_pbr
s_barrier
ds_read_b128 v[120:123], v21
RB 124,21,2048
s_nop 1
v_max3_f32 v30, v84, v85, v86
v_max3_f32 v30, v30, v87, v88
v_max3_f32 v30, v30, v89, v90
v_max3_f32 v30, v30, v91, v92
v_max3_f32 v30, v30, v93, v94
v_max_f32 v30, v30, v95
v_mov_b32 v31, v30
s_nop 1
v_permlane32_swap_b32 v30, v31
v_max_f32 v30, v30, v31
v_mov_b32 v31, v30
s_nop 1
v_permlane16_swap_b32 v30, v31
v_max_f32 v30, v30, v31
v_mul_f32 v31, s57, v30
v_mul_f32 v30, s57, v30
v_pk_fma_f32 v[88:89], v[88:89], v[26:27], v[30:31]
v_pk_fma_f32 v[90:91], v[90:91], v[26:27], v[30:31]
v_pk_fma_f32 v[92:93], v[92:93], v[26:27], v[30:31]
v_pk_fma_f32 v[94:95], v[94:95], v[26:27], v[30:31]
v_exp_f32 v88, v88
v_exp_f32 v89, v89
v_exp_f32 v90, v90
v_exp_f32 v91, v91
v_exp_f32 v92, v92
v_exp_f32 v93, v93
v_exp_f32 v94, v94
v_exp_f32 v95, v95
v_cvt_pk_bf16_f32 v106, v88, v89
v_cvt_pk_bf16_f32 v107, v90, v91
v_cvt_pk_bf16_f32 v108, v92, v93
v_cvt_pk_bf16_f32 v109, v94, v95
v_pk_fma_f32 v[84:85], v[84:85], v[26:27], v[30:31]
v_pk_fma_f32 v[86:87], v[86:87], v[26:27], v[30:31]
v_mfma_f32_16x16x32_bf16 v[110:113], v[4:7], v[106:109], 0
v_mfma_f32_16x16x32_bf16 v[114:117], v[64:67], v[106:109], 0
v_exp_f32 v84, v84
v_exp_f32 v85, v85
v_exp_f32 v86, v86
v_exp_f32 v87, v87
s_waitcnt lgkmcnt(0)
v_pk_add_f32 v[120:121], v[120:121], v[124:125]
v_pk_add_f32 v[122:123], v[122:123], v[126:127]
v_cvt_pk_bf16_f32 v104, v84, v85
v_cvt_pk_bf16_f32 v105, v86, v87
v_cvt_pk_bf16_f32 v118, v120, v121
v_cvt_pk_bf16_f32 v119, v122, v123
v_mfma_f32_16x16x16_bf16 v[110:113], v[4:5], v[104:105], v[110:113]
s_nop 0
v_mfma_f32_16x16x16_bf16 v[114:117], v[118:119], v[104:105], v[114:117]
s_nop 5
v_rcp_f32 v30, v110
s_nop 0
v_mul_f32 v114, v114, v30
v_mul_f32 v115, v115, v30
v_mul_f32 v116, v116, v30
v_mul_f32 v117, v117, v30
v_cvt_pk_bf16_f32 v114, v114, v115
v_cvt_pk_bf16_f32 v115, v116, v117
buffer_store_dwordx2 v[114:115], v15, s[4:7], s37 offen
s_barrier
s_setprio 0
buffer_store_dwordx2 v[118:119], v22, s[4:7], s43 offen
buffer_store_dwordx2 v[28:29], v15, s[4:7], s46 offen
s_branch mega_kernel_ch_m0_Ajoin
mega_kernel_ch_m0_pbr:
s_nop 7
s_nop 7
s_branch mega_kernel_ch_m0_pb
mega_kernel_ch_m0_last01:
s_barrier
ds_read_b128 v[120:123], v21
RB 124,21,2048
s_waitcnt lgkmcnt(0)
v_add_f32 v120, v120, v124
v_add_f32 v121, v121, v125
v_add_f32 v122, v122, v126
v_add_f32 v123, v123, v127
v_cvt_pk_bf16_f32 v118, v120, v121
v_cvt_pk_bf16_f32 v119, v122, v123
buffer_store_dwordx2 v[118:119], v22, s[4:7], s43 offen
s_branch mega_kernel_ch_m0_fin
mega_kernel_ch_m0_kw:
s_setprio 0
buffer_store_dwordx2 v[96:97], v13, s[4:7], s42 offen
s_cmp_eq_u32 s28, 63
s_cbranch_scc1 mega_kernel_ch_m0_l23
s_barrier
s_barrier
mega_kernel_ch_m0_Ajoin:
buffer_store_dwordx2 v[28:29], v12, s[4:7], s45 offen
s_waitcnt vmcnt(0)
s_barrier
s_cmp_lg_u32 s26, 3
s_cbranch_scc1 chf_12
s_lshl_b32 s48, s24, 7
s_add_u32 s48, s48, 4096
v_mov_b32 v3, s48
v_mov_b32 v9, 1
s_mov_b64 exec, 1
buffer_atomic_add v9, v3, s[4:7], 0 offen
s_mov_b64 exec, -1
chf_12:
s_cmp_lt_u32 s26, 2
s_cbranch_scc1 nopf_13
s_add_u32 s50, s28, 1
s_lshl_b32 s48, s50, 18
s_add_u32 s40, s48, 23068672
s_add_u32 s41, s48, 39845888
s_lshl_b32 s48, s31, 11
s_add_u32 s41, s41, s48
s_add_u32 s50, s28, 1
s_lshr_b32 s51, s50, 2
s_cmp_lt_u32 s51, s94
s_cbranch_scc1 kvok_14
s_add_u32 s94, s51, 1
s_lshl_b32 s48, s24, 4
s_add_u32 s48, s48, s51
s_lshl_b32 s48, s48, 7
s_add_u32 s48, s48, 8192
v_mov_b32 v3, s48
kvp_15:
s_add_u32 s29, s29, 1
s_cmp_gt_u32 s29, 262144
s_cbranch_scc1 mega_kernel_end0
buffer_load_dword v9, v3, s[4:7], 0 offen sc1
s_waitcnt vmcnt(0)
v_cmp_gt_u32 vcc, 16, v9
s_nop 0
s_cbranch_vccnz kvp_15
kvok_14:
s_cmp_eq_u32 s26, 3
s_cbranch_scc1 pf3_16
s_add_u32 m0, s54, 0
s_add_u32 s49, s40, 0
buffer_load_dwordx4 v16, s[4:7], s49 offen sc1 lds
s_add_u32 m0, s54, 1024
s_add_u32 s49, s40, 1024
buffer_load_dwordx4 v16, s[4:7], s49 offen sc1 lds
s_add_u32 m0, s54, 2048
s_add_u32 s49, s40, 2048
buffer_load_dwordx4 v16, s[4:7], s49 offen sc1 lds
s_add_u32 m0, s54, 3072
s_add_u32 s49, s40, 3072
buffer_load_dwordx4 v16, s[4:7], s49 offen sc1 lds
s_add_u32 m0, s54, 4096
s_add_u32 s49, s40, 4096
buffer_load_dwordx4 v16, s[4:7], s49 offen sc1 lds
s_branch pfe_17
pf3_16:
s_add_u32 m0, s54, 5120
s_add_u32 s49, s40, 5120
buffer_load_dwordx4 v16, s[4:7], s49 offen sc1 lds
s_add_u32 m0, s54, 6144
s_add_u32 s49, s40, 6144
buffer_load_dwordx4 v16, s[4:7], s49 offen sc1 lds
s_add_u32 m0, s54, 7168
s_add_u32 s49, s40, 7168
buffer_load_dwordx4 v16, s[4:7], s49 offen sc1 lds
s_add_u32 m0, s54, 8192
s_add_u32 s49, s41, 0
buffer_load_dwordx4 v16, s[4:7], s49 offen sc1 lds
s_add_u32 m0, s54, 9216
s_add_u32 s49, s41, 1024
buffer_load_dwordx4 v16, s[4:7], s49 offen sc1 lds
pfe_17:
nopf_13:
buffer_store_dword v28, v20, s[4:7], s44 offen
s_add_u32 s48, s28, 0
s_and_b32 s48, s48, 3
s_add_u32 s49, s48, 1
s_and_b32 s49, s49, 3
s_lshl_b32 s35, s49, 17
s_add_u32 s35, s35, s62
s_mul_i32 s39, s48, 131072
s_add_u32 s39, s39, 1572864
s_add_u32 s90, s39, 16384
s_add_u32 s91, s39, 32768
s_add_u32 s92, s39, 49152
s_add_u32 s28, s28, 1
s_and_b32 s48, s28, 3
s_xor_b32 s50, s48, 2
s_lshl_b32 s34, s48, 17
s_add_u32 s34, s34, s62
s_lshl_b32 s44, s50, 17
s_add_u32 s44, s44, s62
s_add_u32 s36, s34, 524288
s_add_u32 s45, s44, 524288
s_lshl_b32 s37, s48, 16
s_add_u32 s37, s37, s63
s_lshl_b32 s46, s50, 16
s_add_u32 s46, s46, s63
s_lshl_b32 s48, s28, 16
s_add_u32 s42, s48, 56623104
s_add_u32 s43, s48, 60817408
s_and_b32 s48, s28, 1
s_mul_i32 s53, s48, 10240
s_add_u32 s53, s53, 28672
s_xor_b32 s48, s48, 1
s_mul_i32 s54, s48, 10240
s_add_u32 s54, s54, 28672
s_setprio 3
s_barrier
s_sleep 9
mega_kernel_ch_m0_pd:
buffer_load_dword v32, v24, s[4:7], s39 offen sc1
buffer_load_dword v33, v24, s[4:7], s90 offen sc1
buffer_load_dword v34, v24, s[4:7], s91 offen sc1
buffer_load_dword v35, v24, s[4:7], s92 offen sc1
buffer_load_dword v36, v25, s[4:7], s39 offen sc1
buffer_load_dword v37, v25, s[4:7], s90 offen sc1
buffer_load_dword v38, v25, s[4:7], s91 offen sc1
buffer_load_dword v39, v25, s[4:7], s92 offen sc1
s_add_u32 s29, s29, 1
s_cmp_gt_u32 s29, 262144
s_cbranch_scc1 mega_kernel_end0
s_waitcnt vmcnt(0)
v_max3_u32 v3, v32, v33, v34
v_max3_u32 v3, v3, v35, v36
v_max3_u32 v3, v3, v37, v38
v_max_u32 v3, v3, v39
v_cmp_eq_u32 vcc, -1, v3
s_nop 0
s_cbranch_vccnz mega_kernel_ch_m0_pd
v_lshlrev_b32 v40, 16, v32
v_and_b32 v41, 0xffff0000, v32
v_lshlrev_b32 v44, 16, v33
v_and_b32 v45, 0xffff0000, v33
v_pk_add_f32 v[40:41], v[40:41], v[44:45]
v_lshlrev_b32 v42, 16, v34
v_and_b32 v43, 0xffff0000, v34
v_pk_add_f32 v[40:41], v[40:41], v[42:43]
v_lshlrev_b32 v44, 16, v35
v_and_b32 v45, 0xffff0000, v35
v_pk_add_f32 v[40:41], v[40:41], v[44:45]
v_lshlrev_b32 v42, 16, v36
v_and_b32 v43, 0xffff0000, v36
v_pk_add_f32 v[40:41], v[40:41], v[42:43]
v_lshlrev_b32 v44, 16, v37
v_and_b32 v45, 0xffff0000, v37
v_pk_add_f32 v[40:41], v[40:41], v[44:45]
v_lshlrev_b32 v42, 16, v38
v_and_b32 v43, 0xffff0000, v38
v_pk_add_f32 v[40:41], v[40:41], v[42:43]
v_lshlrev_b32 v44, 16, v39
v_and_b32 v45, 0xffff0000, v39
v_pk_add_f32 v[40:41], v[40:41], v[44:45]
v_cvt_pk_bf16_f32 v40, v40, v41
buffer_store_dword v40, v20, s[4:7], s35 offen
s_barrier
s_branch mega_kernel_ch_m0_Aloop
mega_kernel_ch_m0_l23:
s_barrier
s_branch mega_kernel_ch_m0_fin
mega_kernel_ch_m0_Cstart:
s_bfe_u32 s48, s26, 65537
s_lshl_b32 s48, s48, 13
v_add_u32 v14, s48, v11
s_and_b32 s48, s28, 3
s_xor_b32 s50, s48, 2
s_lshl_b32 s34, s48, 17
s_add_u32 s34, s34, s62
s_lshl_b32 s37, s48, 16
s_add_u32 s37, s37, s63
s_mul_i32 s38, s48, 131072
s_add_u32 s38, s38, 1572864
s_add_u32 s38, s38, s33
s_mul_i32 s47, s50, 131072
s_add_u32 s47, s47, 1572864
s_add_u32 s47, s47, s33
mega_kernel_ch_m0_Cloop:
s_sleep 2
mega_kernel_ch_m0C_pa:
buffer_load_dwordx4 v[32:35], v10, s[4:7], s34 offen offset:0 sc1
buffer_load_dwordx4 v[36:39], v10, s[4:7], s34 offen offset:1024 sc1
s_add_u32 s29, s29, 1
s_cmp_gt_u32 s29, 262144
s_cbranch_scc1 mega_kernel_end0
s_waitcnt vmcnt(0)
ds_write_b128 v10, v[32:35] offset:0
ds_write_b128 v10, v[36:39] offset:1024
v_max3_u32 v3, v32, v33, v34
v_max3_u32 v3, v3, v35, v36
v_max3_u32 v3, v3, v37, v38
v_max_u32 v3, v3, v39
v_cmp_eq_u32 vcc, -1, v3
s_nop 0
s_cbranch_vccnz mega_kernel_ch_m0C_pa
s_waitcnt lgkmcnt(0)
s_barrier
s_setprio 0
RB 32,14,0
RB 36,14,1024
RB 40,14,2048
RB 44,14,3072
RB 48,14,4096
RB 52,14,5120
RB 56,14,6144
RB 60,14,7168
s_barrier
s_waitcnt lgkmcnt(7)
v_mfma_f32_16x16x32_bf16 v[96:99], v[32:35], a[0:3], 0
v_mfma_f32_16x16x32_bf16 v[100:103], v[32:35], a[4:7], 0
s_waitcnt lgkmcnt(6)
v_mfma_f32_16x16x32_bf16 v[96:99], v[36:39], a[8:11], v[96:99]
v_mfma_f32_16x16x32_bf16 v[100:103], v[36:39], a[12:15], v[100:103]
s_waitcnt lgkmcnt(5)
v_mfma_f32_16x16x32_bf16 v[96:99], v[40:43], a[16:19], v[96:99]
v_mfma_f32_16x16x32_bf16 v[100:103], v[40:43], a[20:23], v[100:103]
s_waitcnt lgkmcnt(4)
v_mfma_f32_16x16x32_bf16 v[96:99], v[44:47], a[24:27], v[96:99]
v_mfma_f32_16x16x32_bf16 v[100:103], v[44:47], a[28:31], v[100:103]
s_waitcnt lgkmcnt(3)
v_mfma_f32_16x16x32_bf16 v[96:99], v[48:51], a[32:35], v[96:99]
v_mfma_f32_16x16x32_bf16 v[100:103], v[48:51], a[36:39], v[100:103]
s_waitcnt lgkmcnt(2)
v_mfma_f32_16x16x32_bf16 v[96:99], v[52:55], a[40:43], v[96:99]
v_mfma_f32_16x16x32_bf16 v[100:103], v[52:55], a[44:47], v[100:103]
s_waitcnt lgkmcnt(1)
v_mfma_f32_16x16x32_bf16 v[96:99], v[56:59], a[48:51], v[96:99]
v_mfma_f32_16x16x32_bf16 v[100:103], v[56:59], a[52:55], v[100:103]
s_waitcnt lgkmcnt(0)
v_mfma_f32_16x16x32_bf16 v[96:99], v[60:63], a[56:59], v[96:99]
v_mfma_f32_16x16x32_bf16 v[100:103], v[60:63], a[60:63], v[100:103]
s_nop 7
v_mov_b32 v114, v100
v_mov_b32 v115, v101
v_mov_b32 v116, v102
v_mov_b32 v117, v103
v_permlane32_swap_b32 v114, v96
v_permlane32_swap_b32 v115, v97
v_permlane32_swap_b32 v116, v98
v_permlane32_swap_b32 v117, v99
v_add_f32 v114, v114, v100
v_add_f32 v115, v115, v101
v_add_f32 v116, v116, v102
v_add_f32 v117, v117, v103
ds_write_b128 v21, v[114:117]
s_waitcnt lgkmcnt(0)
s_barrier
s_cmp_eq_u32 s28, 63
s_cbranch_scc1 mega_kernel_ch_m0_fin
s_setprio 3
s_barrier
s_sleep 2
mega_kernel_ch_m0_pc:
buffer_load_dwordx4 v[32:35], v18, s[4:7], s37 offen offset:0 sc1
buffer_load_dwordx4 v[36:39], v18, s[4:7], s37 offen offset:1024 sc1
s_add_u32 s29, s29, 1
s_cmp_gt_u32 s29, 262144
s_cbranch_scc1 mega_kernel_end0
s_waitcnt vmcnt(0)
ds_write_b128 v18, v[32:35] offset:16384
ds_write_b128 v18, v[36:39] offset:17408
v_max3_u32 v3, v32, v33, v34
v_max3_u32 v3, v3, v35, v36
v_max3_u32 v3, v3, v37, v38
v_max_u32 v3, v3, v39
v_cmp_eq_u32 vcc, -1, v3
s_nop 0
s_cbranch_vccnz mega_kernel_ch_m0_pc
s_waitcnt lgkmcnt(0)
s_barrier
RB 32,11,16384
RB 36,11,17408
RB 40,11,18432
RB 44,11,19456
RB 48,11,20480
s_waitcnt lgkmcnt(4)
v_mfma_f32_16x16x32_bf16 v[96:99], a[64:67], v[32:35], 0
RB 52,11,21504
v_mfma_f32_16x16x32_bf16 v[100:103], a[68:71], v[32:35], 0
s_waitcnt lgkmcnt(4)
v_mfma_f32_16x16x32_bf16 v[96:99], a[72:75], v[36:39], v[96:99]
RB 56,11,22528
v_mfma_f32_16x16x32_bf16 v[100:103], a[76:79], v[36:39], v[100:103]
s_waitcnt lgkmcnt(4)
v_mfma_f32_16x16x32_bf16 v[96:99], a[80:83], v[40:43], v[96:99]
RB 60,11,23552
v_mfma_f32_16x16x32_bf16 v[100:103], a[84:87], v[40:43], v[100:103]
s_waitcnt lgkmcnt(4)
v_mfma_f32_16x16x32_bf16 v[96:99], a[88:91], v[44:47], v[96:99]
v_mfma_f32_16x16x32_bf16 v[100:103], a[92:95], v[44:47], v[100:103]
s_waitcnt lgkmcnt(3)
v_mfma_f32_16x16x32_bf16 v[96:99], a[96:99], v[48:51], v[96:99]
v_mfma_f32_16x16x32_bf16 v[100:103], a[100:103], v[48:51], v[100:103]
s_waitcnt lgkmcnt(2)
v_mfma_f32_16x16x32_bf16 v[96:99], a[104:107], v[52:55], v[96:99]
v_mfma_f32_16x16x32_bf16 v[100:103], a[108:111], v[52:55], v[100:103]
s_waitcnt lgkmcnt(1)
v_mfma_f32_16x16x32_bf16 v[96:99], a[112:115], v[56:59], v[96:99]
v_mfma_f32_16x16x32_bf16 v[100:103], a[116:119], v[56:59], v[100:103]
s_waitcnt lgkmcnt(0)
v_mfma_f32_16x16x32_bf16 v[96:99], a[120:123], v[60:63], v[96:99]
v_mfma_f32_16x16x32_bf16 v[100:103], a[124:127], v[60:63], v[100:103]
s_nop 7
v_add_f32_dpp v96, v100, v96 row_ror:8 row_mask:0xf bank_mask:0xf
v_add_f32_dpp v97, v101, v97 row_ror:8 row_mask:0xf bank_mask:0xf
v_add_f32_dpp v98, v102, v98 row_ror:8 row_mask:0xf bank_mask:0xf
v_add_f32_dpp v99, v103, v99 row_ror:8 row_mask:0xf bank_mask:0xf
v_cvt_pk_bf16_f32 v96, v96, v97
v_cvt_pk_bf16_f32 v97, v98, v99
buffer_store_dwordx2 v[96:97], v19, s[4:7], s38 offen sc1
s_barrier
s_add_u32 s48, s47, 0
buffer_store_dwordx2 v[28:29], v19, s[4:7], s48 offen sc1
s_setprio 0
s_add_u32 s28, s28, 1
s_and_b32 s48, s28, 3
s_xor_b32 s50, s48, 2
s_lshl_b32 s34, s48, 17
s_add_u32 s34, s34, s62
s_lshl_b32 s37, s48, 16
s_add_u32 s37, s37, s63
s_mul_i32 s38, s48, 131072
s_add_u32 s38, s38, 1572864
s_add_u32 s38, s38, s33
s_mul_i32 s47, s50, 131072
s_add_u32 s47, s47, 1572864
s_add_u32 s47, s47, s33
s_barrier
s_branch mega_kernel_ch_m0_Cloop
mega_kernel_ch_m0_fin:
s_waitcnt vmcnt(0)
s_barrier
s_cmp_lg_u32 s26, 3
s_cbranch_scc1 chf_18
s_lshl_b32 s48, s24, 7
s_add_u32 s48, s48, 4096
v_mov_b32 v3, s48
v_mov_b32 v9, 1
s_mov_b64 exec, 1
buffer_atomic_add v9, v3, s[4:7], 0 offen
s_mov_b64 exec, -1
chf_18:
s_branch mega_kernel_ch_done
mega_kernel_ch_m1_start:
s_mov_b32 s28, 0
s_cmp_ge_u32 s26, 4
s_cbranch_scc1 mega_kernel_ch_m1_Cstart
buffer_store_dword v32, v20, s[4:7], s62 offen sc1
s_cmp_lt_u32 s26, 2
s_cbranch_scc1 pf0_19
s_lshl_b32 s48, s28, 18
s_add_u32 s40, s48, 23068672
s_add_u32 s41, s48, 39845888
s_lshl_b32 s48, s31, 11
s_add_u32 s41, s41, s48
s_mov_b32 s54, 28672
s_lshr_b32 s51, s28, 2
s_cmp_lt_u32 s51, s94
s_cbranch_scc1 kvok_20
s_add_u32 s94, s51, 1
s_lshl_b32 s48, s24, 4
s_add_u32 s48, s48, s51
s_lshl_b32 s48, s48, 7
s_add_u32 s48, s48, 8192
v_mov_b32 v3, s48
kvp_21:
s_add_u32 s29, s29, 1
s_cmp_gt_u32 s29, 262144
s_cbranch_scc1 mega_kernel_end0
buffer_load_dword v9, v3, s[4:7], 0 offen sc1
s_waitcnt vmcnt(0)
v_cmp_gt_u32 vcc, 16, v9
s_nop 0
s_cbranch_vccnz kvp_21
kvok_20:
s_cmp_eq_u32 s26, 3
s_cbranch_scc1 pf3_22
s_add_u32 m0, s54, 0
s_add_u32 s49, s40, 0
buffer_load_dwordx4 v16, s[4:7], s49 offen sc1 lds
s_add_u32 m0, s54, 1024
s_add_u32 s49, s40, 1024
buffer_load_dwordx4 v16, s[4:7], s49 offen sc1 lds
s_add_u32 m0, s54, 2048
s_add_u32 s49, s40, 2048
buffer_load_dwordx4 v16, s[4:7], s49 offen sc1 lds
s_add_u32 m0, s54, 3072
s_add_u32 s49, s40, 3072
buffer_load_dwordx4 v16, s[4:7], s49 offen sc1 lds
s_add_u32 m0, s54, 4096
s_add_u32 s49, s40, 4096
buffer_load_dwordx4 v16, s[4:7], s49 offen sc1 lds
s_branch pfe_23
pf3_22:
s_add_u32 m0, s54, 5120
s_add_u32 s49, s40, 5120
buffer_load_dwordx4 v16, s[4:7], s49 offen sc1 lds
s_add_u32 m0, s54, 6144
s_add_u32 s49, s40, 6144
buffer_load_dwordx4 v16, s[4:7], s49 offen sc1 lds
s_add_u32 m0, s54, 7168
s_add_u32 s49, s40, 7168
buffer_load_dwordx4 v16, s[4:7], s49 offen sc1 lds
s_add_u32 m0, s54, 8192
s_add_u32 s49, s41, 0
buffer_load_dwordx4 v16, s[4:7], s49 offen sc1 lds
s_add_u32 m0, s54, 9216
s_add_u32 s49, s41, 1024
buffer_load_dwordx4 v16, s[4:7], s49 offen sc1 lds
pfe_23:
pf0_19:
s_and_b32 s48, s28, 3
s_xor_b32 s50, s48, 2
s_lshl_b32 s34, s48, 17
s_add_u32 s34, s34, s62
s_lshl_b32 s44, s50, 17
s_add_u32 s44, s44, s62
s_add_u32 s36, s34, 524288
s_add_u32 s45, s44, 524288
s_lshl_b32 s37, s48, 16
s_add_u32 s37, s37, s63
s_lshl_b32 s46, s50, 16
s_add_u32 s46, s46, s63
s_lshl_b32 s48, s28, 16
s_add_u32 s42, s48, 56623104
s_add_u32 s43, s48, 60817408
s_and_b32 s48, s28, 1
s_mul_i32 s53, s48, 10240
s_add_u32 s53, s53, 28672
s_xor_b32 s48, s48, 1
s_mul_i32 s54, s48, 10240
s_add_u32 s54, s54, 28672
mega_kernel_ch_m1_Aloop:
s_sleep 2
mega_kernel_ch_m1A_pa:
buffer_load_dwordx4 v[32:35], v10, s[4:7], s34 offen offset:0 sc1
buffer_load_dwordx4 v[36:39], v10, s[4:7], s34 offen offset:1024 sc1
s_add_u32 s29, s29, 1
s_cmp_gt_u32 s29, 262144
s_cbranch_scc1 mega_kernel_end0
s_waitcnt vmcnt(0)
ds_write_b128 v10, v[32:35] offset:0
ds_write_b128 v10, v[36:39] offset:1024
v_max3_u32 v3, v32, v33, v34
v_max3_u32 v3, v3, v35, v36
v_max3_u32 v3, v3, v37, v38
v_max_u32 v3, v3, v39
v_cmp_eq_u32 vcc, -1, v3
s_nop 0
s_cbranch_vccnz mega_kernel_ch_m1A_pa
s_waitcnt lgkmcnt(0)
s_barrier
s_setprio 3
RB 32,11,0
RB 36,11,1024
RB 40,11,2048
RB 44,11,3072
RB 48,11,4096
RB 52,11,5120
s_waitcnt lgkmcnt(5)
v_mfma_f32_16x16x32_bf16 v[96:99], a[0:3], v[32:35], 0
RB 56,11,6144
v_mfma_f32_16x16x32_bf16 v[100:103], a[4:7], v[32:35], 0
s_waitcnt lgkmcnt(5)
v_mfma_f32_16x16x32_bf16 v[96:99], a[8:11], v[36:39], v[96:99]
RB 60,11,7168
v_mfma_f32_16x16x32_bf16 v[100:103], a[12:15], v[36:39], v[100:103]
s_waitcnt lgkmcnt(5)
v_mfma_f32_16x16x32_bf16 v[96:99], a[16:19], v[40:43], v[96:99]
RB 64,11,8192
v_mfma_f32_16x16x32_bf16 v[100:103], a[20:23], v[40:43], v[100:103]
s_waitcnt lgkmcnt(5)
v_mfma_f32_16x16x32_bf16 v[96:99], a[24:27], v[44:47], v[96:99]
RB 68,11,9216
v_mfma_f32_16x16x32_bf16 v[100:103], a[28:31], v[44:47], v[100:103]
s_waitcnt lgkmcnt(5)
v_mfma_f32_16x16x32_bf16 v[96:99], a[32:35], v[48:51], v[96:99]
RB 72,11,10240
v_mfma_f32_16x16x32_bf16 v[100:103], a[36:39], v[48:51], v[100:103]
s_waitcnt lgkmcnt(5)
v_mfma_f32_16x16x32_bf16 v[96:99], a[40:43], v[52:55], v[96:99]
RB 76,11,11264
v_mfma_f32_16x16x32_bf16 v[100:103], a[44:47], v[52:55], v[100:103]
s_waitcnt lgkmcnt(5)
v_mfma_f32_16x16x32_bf16 v[96:99], a[48:51], v[56:59], v[96:99]
RB 80,11,12288
v_mfma_f32_16x16x32_bf16 v[100:103], a[52:55], v[56:59], v[100:103]
s_waitcnt lgkmcnt(5)
v_mfma_f32_16x16x32_bf16 v[96:99], a[56:59], v[60:63], v[96:99]
RB 84,11,13312
v_mfma_f32_16x16x32_bf16 v[100:103], a[60:63], v[60:63], v[100:103]
s_waitcnt lgkmcnt(5)
v_mfma_f32_16x16x32_bf16 v[96:99], a[64:67], v[64:67], v[96:99]
RB 88,11,14336
v_mfma_f32_16x16x32_bf16 v[100:103], a[68:71], v[64:67], v[100:103]
s_waitcnt lgkmcnt(5)
v_mfma_f32_16x16x32_bf16 v[96:99], a[72:75], v[68:71], v[96:99]
RB 92,11,15360
v_mfma_f32_16x16x32_bf16 v[100:103], a[76:79], v[68:71], v[100:103]
s_waitcnt lgkmcnt(5)
v_mfma_f32_16x16x32_bf16 v[96:99], a[80:83], v[72:75], v[96:99]
v_mfma_f32_16x16x32_bf16 v[100:103], a[84:87], v[72:75], v[100:103]
s_waitcnt lgkmcnt(4)
v_mfma_f32_16x16x32_bf16 v[96:99], a[88:91], v[76:79], v[96:99]
v_mfma_f32_16x16x32_bf16 v[100:103], a[92:95], v[76:79], v[100:103]
s_waitcnt lgkmcnt(3)
v_mfma_f32_16x16x32_bf16 v[96:99], a[96:99], v[80:83], v[96:99]
v_mfma_f32_16x16x32_bf16 v[100:103], a[100:103], v[80:83], v[100:103]
s_waitcnt lgkmcnt(2)
v_mfma_f32_16x16x32_bf16 v[96:99], a[104:107], v[84:87], v[96:99]
v_mfma_f32_16x16x32_bf16 v[100:103], a[108:111], v[84:87], v[100:103]
s_waitcnt lgkmcnt(1)
v_mfma_f32_16x16x32_bf16 v[96:99], a[112:115], v[88:91], v[96:99]
v_mfma_f32_16x16x32_bf16 v[100:103], a[116:119], v[88:91], v[100:103]
s_waitcnt lgkmcnt(0)
v_mfma_f32_16x16x32_bf16 v[96:99], a[120:123], v[92:95], v[96:99]
v_mfma_f32_16x16x32_bf16 v[100:103], a[124:127], v[92:95], v[100:103]
s_barrier
s_nop 6
v_add_f32_dpp v96, v100, v96 row_ror:8 row_mask:0xf bank_mask:0xf
v_add_f32_dpp v97, v101, v97 row_ror:8 row_mask:0xf bank_mask:0xf
v_add_f32_dpp v98, v102, v98 row_ror:8 row_mask:0xf bank_mask:0xf
v_add_f32_dpp v99, v103, v99 row_ror:8 row_mask:0xf bank_mask:0xf
v_cvt_pk_bf16_f32 v96, v96, v97
v_cvt_pk_bf16_f32 v97, v98, v99
buffer_store_dwordx2 v[96:97], v12, s[4:7], s36 offen sc1
s_cmp_ge_u32 s26, 2
s_cbranch_scc1 mega_kernel_ch_m1_kw
s_cmp_eq_u32 s28, 63
s_cbranch_scc1 mega_kernel_ch_m1_last01
v_add_u32 v3, s53, v17
RB 32,3,0
RB 36,3,1024
RB 40,3,2048
RB 44,3,3072
RB 48,3,4096
RB 52,3,5120
RB 56,3,6144
RB 60,3,7168
s_lshl_b32 s48, s26, 10
v_add_u32 v3, s48, v3
RB 64,3,8192
s_sleep 2
mega_kernel_ch_m1_pb:
buffer_load_dwordx4 v[68:71], v14, s[4:7], s36 offen offset:0 sc1
buffer_load_dwordx4 v[72:75], v14, s[4:7], s36 offen offset:1024 sc1
buffer_load_dwordx4 v[76:79], v14, s[4:7], s36 offen offset:2048 sc1
buffer_load_dwordx4 v[80:83], v14, s[4:7], s36 offen offset:3072 sc1
s_add_u32 s29, s29, 1
s_cmp_gt_u32 s29, 262144
s_cbranch_scc1 mega_kernel_end0
v_mov_b32 v84, v8
v_mov_b32 v85, v8
v_mov_b32 v86, v8
v_mov_b32 v87, v8
s_waitcnt vmcnt(0) lgkmcnt(0)
s_nop 0
v_mfma_f32_16x16x32_bf16 v[84:87], v[68:71], v[68:71], v[84:87]
v_max3_u32 v3, v68, v69, v70
v_mfma_f32_16x16x32_bf16 v[88:91], v[32:35], v[68:71], 0
v_max3_u32 v3, v3, v71, v72
v_mfma_f32_16x16x32_bf16 v[92:95], v[48:51], v[68:71], 0
v_max3_u32 v3, v3, v73, v74
v_mfma_f32_16x16x32_bf16 v[84:87], v[72:75], v[72:75], v[84:87]
v_max3_u32 v3, v3, v75, v76
v_mfma_f32_16x16x32_bf16 v[88:91], v[36:39], v[72:75], v[88:91]
v_max3_u32 v3, v3, v77, v78
v_mfma_f32_16x16x32_bf16 v[92:95], v[52:55], v[72:75], v[92:95]
v_max3_u32 v3, v3, v79, v80
v_mfma_f32_16x16x32_bf16 v[84:87], v[76:79], v[76:79], v[84:87]
v_max3_u32 v3, v3, v81, v82
v_mfma_f32_16x16x32_bf16 v[88:91], v[40:43], v[76:79], v[88:91]
v_max_u32 v3, v3, v83
v_mfma_f32_16x16x32_bf16 v[92:95], v[56:59], v[76:79], v[92:95]
v_cmp_eq_u32 vcc, -1, v3
v_mfma_f32_16x16x32_bf16 v[84:87], v[80:83], v[80:83], v[84:87]
v_mfma_f32_16x16x32_bf16 v[88:91], v[44:47], v[80:83], v[88:91]
v_mfma_f32_16x16x32_bf16 v[92:95], v[60:63], v[80:83], v[92:95]
s_cbranch_vccnz mega_kernel_ch_m1_pbr
s_barrier
ds_read_b128 v[120:123], v21
RB 124,21,2048
s_nop 1
v_max3_f32 v30, v84, v85, v86
v_max3_f32 v30, v30, v87, v88
v_max3_f32 v30, v30, v89, v90
v_max3_f32 v30, v30, v91, v92
v_max3_f32 v30, v30, v93, v94
v_max_f32 v30, v30, v95
v_mov_b32 v31, v30
s_nop 1
v_permlane32_swap_b32 v30, v31
v_max_f32 v30, v30, v31
v_mov_b32 v31, v30
s_nop 1
v_permlane16_swap_b32 v30, v31
v_max_f32 v30, v30, v31
v_mul_f32 v31, s57, v30
v_mul_f32 v30, s57, v30
v_pk_fma_f32 v[88:89], v[88:89], v[26:27], v[30:31]
v_pk_fma_f32 v[90:91], v[90:91], v[26:27], v[30:31]
v_pk_fma_f32 v[92:93], v[92:93], v[26:27], v[30:31]
v_pk_fma_f32 v[94:95], v[94:95], v[26:27], v[30:31]
v_exp_f32 v88, v88
v_exp_f32 v89, v89
v_exp_f32 v90, v90
v_exp_f32 v91, v91
v_exp_f32 v92, v92
v_exp_f32 v93, v93
v_exp_f32 v94, v94
v_exp_f32 v95, v95
v_cvt_pk_bf16_f32 v106, v88, v89
v_cvt_pk_bf16_f32 v107, v90, v91
v_cvt_pk_bf16_f32 v108, v92, v93
v_cvt_pk_bf16_f32 v109, v94, v95
v_pk_fma_f32 v[84:85], v[84:85], v[26:27], v[30:31]
v_pk_fma_f32 v[86:87], v[86:87], v[26:27], v[30:31]
v_mfma_f32_16x16x32_bf16 v[110:113], v[4:7], v[106:109], 0
v_mfma_f32_16x16x32_bf16 v[114:117], v[64:67], v[106:109], 0
v_exp_f32 v84, v84
v_exp_f32 v85, v85
v_exp_f32 v86, v86
v_exp_f32 v87, v87
s_waitcnt lgkmcnt(0)
v_pk_add_f32 v[120:121], v[120:121], v[124:125]
v_pk_add_f32 v[122:123], v[122:123], v[126:127]
v_cvt_pk_bf16_f32 v104, v84, v85
v_cvt_pk_bf16_f32 v105, v86, v87
v_cvt_pk_bf16_f32 v118, v120, v121
v_cvt_pk_bf16_f32 v119, v122, v123
v_mfma_f32_16x16x16_bf16 v[110:113], v[4:5], v[104:105], v[110:113]
s_nop 0
v_mfma_f32_16x16x16_bf16 v[114:117], v[118:119], v[104:105], v[114:117]
s_nop 5
v_rcp_f32 v30, v110
s_nop 0
v_mul_f32 v114, v114, v30
v_mul_f32 v115, v115, v30
v_mul_f32 v116, v116, v30
v_mul_f32 v117, v117, v30
v_cvt_pk_bf16_f32 v114, v114, v115
v_cvt_pk_bf16_f32 v115, v116, v117
buffer_store_dwordx2 v[114:115], v15, s[4:7], s37 offen sc1
s_barrier
s_setprio 0
buffer_store_dwordx2 v[118:119], v22, s[4:7], s43 offen sc1
buffer_store_dwordx2 v[28:29], v15, s[4:7], s46 offen sc1
s_branch mega_kernel_ch_m1_Ajoin
mega_kernel_ch_m1_pbr:
s_nop 7
s_nop 7
s_branch mega_kernel_ch_m1_pb
mega_kernel_ch_m1_last01:
s_barrier
ds_read_b128 v[120:123], v21
RB 124,21,2048
s_waitcnt lgkmcnt(0)
v_add_f32 v120, v120, v124
v_add_f32 v121, v121, v125
v_add_f32 v122, v122, v126
v_add_f32 v123, v123, v127
v_cvt_pk_bf16_f32 v118, v120, v121
v_cvt_pk_bf16_f32 v119, v122, v123
buffer_store_dwordx2 v[118:119], v22, s[4:7], s43 offen sc1
s_branch mega_kernel_ch_m1_fin
mega_kernel_ch_m1_kw:
s_setprio 0
buffer_store_dwordx2 v[96:97], v13, s[4:7], s42 offen sc1
s_cmp_eq_u32 s28, 63
s_cbranch_scc1 mega_kernel_ch_m1_l23
s_barrier
s_barrier
mega_kernel_ch_m1_Ajoin:
buffer_store_dwordx2 v[28:29], v12, s[4:7], s45 offen sc1
s_waitcnt vmcnt(0)
s_barrier
s_cmp_lg_u32 s26, 3
s_cbranch_scc1 chf_24
s_lshl_b32 s48, s24, 7
s_add_u32 s48, s48, 4096
v_mov_b32 v3, s48
v_mov_b32 v9, 1
s_mov_b64 exec, 1
buffer_atomic_add v9, v3, s[4:7], 0 offen
s_mov_b64 exec, -1
chf_24:
s_cmp_lt_u32 s26, 2
s_cbranch_scc1 nopf_25
s_add_u32 s50, s28, 1
s_lshl_b32 s48, s50, 18
s_add_u32 s40, s48, 23068672
s_add_u32 s41, s48, 39845888
s_lshl_b32 s48, s31, 11
s_add_u32 s41, s41, s48
s_add_u32 s50, s28, 1
s_lshr_b32 s51, s50, 2
s_cmp_lt_u32 s51, s94
s_cbranch_scc1 kvok_26
s_add_u32 s94, s51, 1
s_lshl_b32 s48, s24, 4
s_add_u32 s48, s48, s51
s_lshl_b32 s48, s48, 7
s_add_u32 s48, s48, 8192
v_mov_b32 v3, s48
kvp_27:
s_add_u32 s29, s29, 1
s_cmp_gt_u32 s29, 262144
s_cbranch_scc1 mega_kernel_end0
buffer_load_dword v9, v3, s[4:7], 0 offen sc1
s_waitcnt vmcnt(0)
v_cmp_gt_u32 vcc, 16, v9
s_nop 0
s_cbranch_vccnz kvp_27
kvok_26:
s_cmp_eq_u32 s26, 3
s_cbranch_scc1 pf3_28
s_add_u32 m0, s54, 0
s_add_u32 s49, s40, 0
buffer_load_dwordx4 v16, s[4:7], s49 offen sc1 lds
s_add_u32 m0, s54, 1024
s_add_u32 s49, s40, 1024
buffer_load_dwordx4 v16, s[4:7], s49 offen sc1 lds
s_add_u32 m0, s54, 2048
s_add_u32 s49, s40, 2048
buffer_load_dwordx4 v16, s[4:7], s49 offen sc1 lds
s_add_u32 m0, s54, 3072
s_add_u32 s49, s40, 3072
buffer_load_dwordx4 v16, s[4:7], s49 offen sc1 lds
s_add_u32 m0, s54, 4096
s_add_u32 s49, s40, 4096
buffer_load_dwordx4 v16, s[4:7], s49 offen sc1 lds
s_branch pfe_29
pf3_28:
s_add_u32 m0, s54, 5120
s_add_u32 s49, s40, 5120
buffer_load_dwordx4 v16, s[4:7], s49 offen sc1 lds
s_add_u32 m0, s54, 6144
s_add_u32 s49, s40, 6144
buffer_load_dwordx4 v16, s[4:7], s49 offen sc1 lds
s_add_u32 m0, s54, 7168
s_add_u32 s49, s40, 7168
buffer_load_dwordx4 v16, s[4:7], s49 offen sc1 lds
s_add_u32 m0, s54, 8192
s_add_u32 s49, s41, 0
buffer_load_dwordx4 v16, s[4:7], s49 offen sc1 lds
s_add_u32 m0, s54, 9216
s_add_u32 s49, s41, 1024
buffer_load_dwordx4 v16, s[4:7], s49 offen sc1 lds
pfe_29:
nopf_25:
buffer_store_dword v28, v20, s[4:7], s44 offen sc1
s_add_u32 s48, s28, 0
s_and_b32 s48, s48, 3
s_add_u32 s49, s48, 1
s_and_b32 s49, s49, 3
s_lshl_b32 s35, s49, 17
s_add_u32 s35, s35, s62
s_mul_i32 s39, s48, 131072
s_add_u32 s39, s39, 1572864
s_add_u32 s90, s39, 16384
s_add_u32 s91, s39, 32768
s_add_u32 s92, s39, 49152
s_add_u32 s28, s28, 1
s_and_b32 s48, s28, 3
s_xor_b32 s50, s48, 2
s_lshl_b32 s34, s48, 17
s_add_u32 s34, s34, s62
s_lshl_b32 s44, s50, 17
s_add_u32 s44, s44, s62
s_add_u32 s36, s34, 524288
s_add_u32 s45, s44, 524288
s_lshl_b32 s37, s48, 16
s_add_u32 s37, s37, s63
s_lshl_b32 s46, s50, 16
s_add_u32 s46, s46, s63
s_lshl_b32 s48, s28, 16
s_add_u32 s42, s48, 56623104
s_add_u32 s43, s48, 60817408
s_and_b32 s48, s28, 1
s_mul_i32 s53, s48, 10240
s_add_u32 s53, s53, 28672
s_xor_b32 s48, s48, 1
s_mul_i32 s54, s48, 10240
s_add_u32 s54, s54, 28672
s_setprio 3
s_barrier
s_sleep 9
mega_kernel_ch_m1_pd:
buffer_load_dword v32, v24, s[4:7], s39 offen sc1
buffer_load_dword v33, v24, s[4:7], s90 offen sc1
buffer_load_dword v34, v24, s[4:7], s91 offen sc1
buffer_load_dword v35, v24, s[4:7], s92 offen sc1
buffer_load_dword v36, v25, s[4:7], s39 offen sc1
buffer_load_dword v37, v25, s[4:7], s90 offen sc1
buffer_load_dword v38, v25, s[4:7], s91 offen sc1
buffer_load_dword v39, v25, s[4:7], s92 offen sc1
s_add_u32 s29, s29, 1
s_cmp_gt_u32 s29, 262144
s_cbranch_scc1 mega_kernel_end0
s_waitcnt vmcnt(0)
v_max3_u32 v3, v32, v33, v34
v_max3_u32 v3, v3, v35, v36
v_max3_u32 v3, v3, v37, v38
v_max_u32 v3, v3, v39
v_cmp_eq_u32 vcc, -1, v3
s_nop 0
s_cbranch_vccnz mega_kernel_ch_m1_pd
v_lshlrev_b32 v40, 16, v32
v_and_b32 v41, 0xffff0000, v32
v_lshlrev_b32 v44, 16, v33
v_and_b32 v45, 0xffff0000, v33
v_pk_add_f32 v[40:41], v[40:41], v[44:45]
v_lshlrev_b32 v42, 16, v34
v_and_b32 v43, 0xffff0000, v34
v_pk_add_f32 v[40:41], v[40:41], v[42:43]
v_lshlrev_b32 v44, 16, v35
v_and_b32 v45, 0xffff0000, v35
v_pk_add_f32 v[40:41], v[40:41], v[44:45]
v_lshlrev_b32 v42, 16, v36
v_and_b32 v43, 0xffff0000, v36
v_pk_add_f32 v[40:41], v[40:41], v[42:43]
v_lshlrev_b32 v44, 16, v37
v_and_b32 v45, 0xffff0000, v37
v_pk_add_f32 v[40:41], v[40:41], v[44:45]
v_lshlrev_b32 v42, 16, v38
v_and_b32 v43, 0xffff0000, v38
v_pk_add_f32 v[40:41], v[40:41], v[42:43]
v_lshlrev_b32 v44, 16, v39
v_and_b32 v45, 0xffff0000, v39
v_pk_add_f32 v[40:41], v[40:41], v[44:45]
v_cvt_pk_bf16_f32 v40, v40, v41
buffer_store_dword v40, v20, s[4:7], s35 offen sc1
s_barrier
s_branch mega_kernel_ch_m1_Aloop
mega_kernel_ch_m1_l23:
s_barrier
s_branch mega_kernel_ch_m1_fin
mega_kernel_ch_m1_Cstart:
s_bfe_u32 s48, s26, 65537
s_lshl_b32 s48, s48, 13
v_add_u32 v14, s48, v11
s_and_b32 s48, s28, 3
s_xor_b32 s50, s48, 2
s_lshl_b32 s34, s48, 17
s_add_u32 s34, s34, s62
s_lshl_b32 s37, s48, 16
s_add_u32 s37, s37, s63
s_mul_i32 s38, s48, 131072
s_add_u32 s38, s38, 1572864
s_add_u32 s38, s38, s33
s_mul_i32 s47, s50, 131072
s_add_u32 s47, s47, 1572864
s_add_u32 s47, s47, s33
mega_kernel_ch_m1_Cloop:
s_sleep 2
mega_kernel_ch_m1C_pa:
buffer_load_dwordx4 v[32:35], v10, s[4:7], s34 offen offset:0 sc1
buffer_load_dwordx4 v[36:39], v10, s[4:7], s34 offen offset:1024 sc1
s_add_u32 s29, s29, 1
s_cmp_gt_u32 s29, 262144
s_cbranch_scc1 mega_kernel_end0
s_waitcnt vmcnt(0)
ds_write_b128 v10, v[32:35] offset:0
ds_write_b128 v10, v[36:39] offset:1024
v_max3_u32 v3, v32, v33, v34
v_max3_u32 v3, v3, v35, v36
v_max3_u32 v3, v3, v37, v38
v_max_u32 v3, v3, v39
v_cmp_eq_u32 vcc, -1, v3
s_nop 0
s_cbranch_vccnz mega_kernel_ch_m1C_pa
s_waitcnt lgkmcnt(0)
s_barrier
s_setprio 0
RB 32,14,0
RB 36,14,1024
RB 40,14,2048
RB 44,14,3072
RB 48,14,4096
RB 52,14,5120
RB 56,14,6144
RB 60,14,7168
s_barrier
s_waitcnt lgkmcnt(7)
v_mfma_f32_16x16x32_bf16 v[96:99], v[32:35], a[0:3], 0
v_mfma_f32_16x16x32_bf16 v[100:103], v[32:35], a[4:7], 0
s_waitcnt lgkmcnt(6)
v_mfma_f32_16x16x32_bf16 v[96:99], v[36:39], a[8:11], v[96:99]
v_mfma_f32_16x16x32_bf16 v[100:103], v[36:39], a[12:15], v[100:103]
s_waitcnt lgkmcnt(5)
v_mfma_f32_16x16x32_bf16 v[96:99], v[40:43], a[16:19], v[96:99]
v_mfma_f32_16x16x32_bf16 v[100:103], v[40:43], a[20:23], v[100:103]
s_waitcnt lgkmcnt(4)
v_mfma_f32_16x16x32_bf16 v[96:99], v[44:47], a[24:27], v[96:99]
v_mfma_f32_16x16x32_bf16 v[100:103], v[44:47], a[28:31], v[100:103]
s_waitcnt lgkmcnt(3)
v_mfma_f32_16x16x32_bf16 v[96:99], v[48:51], a[32:35], v[96:99]
v_mfma_f32_16x16x32_bf16 v[100:103], v[48:51], a[36:39], v[100:103]
s_waitcnt lgkmcnt(2)
v_mfma_f32_16x16x32_bf16 v[96:99], v[52:55], a[40:43], v[96:99]
v_mfma_f32_16x16x32_bf16 v[100:103], v[52:55], a[44:47], v[100:103]
s_waitcnt lgkmcnt(1)
v_mfma_f32_16x16x32_bf16 v[96:99], v[56:59], a[48:51], v[96:99]
v_mfma_f32_16x16x32_bf16 v[100:103], v[56:59], a[52:55], v[100:103]
s_waitcnt lgkmcnt(0)
v_mfma_f32_16x16x32_bf16 v[96:99], v[60:63], a[56:59], v[96:99]
v_mfma_f32_16x16x32_bf16 v[100:103], v[60:63], a[60:63], v[100:103]
s_nop 7
v_mov_b32 v114, v100
v_mov_b32 v115, v101
v_mov_b32 v116, v102
v_mov_b32 v117, v103
v_permlane32_swap_b32 v114, v96
v_permlane32_swap_b32 v115, v97
v_permlane32_swap_b32 v116, v98
v_permlane32_swap_b32 v117, v99
v_add_f32 v114, v114, v100
v_add_f32 v115, v115, v101
v_add_f32 v116, v116, v102
v_add_f32 v117, v117, v103
ds_write_b128 v21, v[114:117]
s_waitcnt lgkmcnt(0)
s_barrier
s_cmp_eq_u32 s28, 63
s_cbranch_scc1 mega_kernel_ch_m1_fin
s_setprio 3
s_barrier
s_sleep 2
mega_kernel_ch_m1_pc:
buffer_load_dwordx4 v[32:35], v18, s[4:7], s37 offen offset:0 sc1
buffer_load_dwordx4 v[36:39], v18, s[4:7], s37 offen offset:1024 sc1
s_add_u32 s29, s29, 1
s_cmp_gt_u32 s29, 262144
s_cbranch_scc1 mega_kernel_end0
s_waitcnt vmcnt(0)
ds_write_b128 v18, v[32:35] offset:16384
ds_write_b128 v18, v[36:39] offset:17408
v_max3_u32 v3, v32, v33, v34
v_max3_u32 v3, v3, v35, v36
v_max3_u32 v3, v3, v37, v38
v_max_u32 v3, v3, v39
v_cmp_eq_u32 vcc, -1, v3
s_nop 0
s_cbranch_vccnz mega_kernel_ch_m1_pc
s_waitcnt lgkmcnt(0)
s_barrier
RB 32,11,16384
RB 36,11,17408
RB 40,11,18432
RB 44,11,19456
RB 48,11,20480
s_waitcnt lgkmcnt(4)
v_mfma_f32_16x16x32_bf16 v[96:99], a[64:67], v[32:35], 0
RB 52,11,21504
v_mfma_f32_16x16x32_bf16 v[100:103], a[68:71], v[32:35], 0
s_waitcnt lgkmcnt(4)
v_mfma_f32_16x16x32_bf16 v[96:99], a[72:75], v[36:39], v[96:99]
RB 56,11,22528
v_mfma_f32_16x16x32_bf16 v[100:103], a[76:79], v[36:39], v[100:103]
s_waitcnt lgkmcnt(4)
v_mfma_f32_16x16x32_bf16 v[96:99], a[80:83], v[40:43], v[96:99]
RB 60,11,23552
v_mfma_f32_16x16x32_bf16 v[100:103], a[84:87], v[40:43], v[100:103]
s_waitcnt lgkmcnt(4)
v_mfma_f32_16x16x32_bf16 v[96:99], a[88:91], v[44:47], v[96:99]
v_mfma_f32_16x16x32_bf16 v[100:103], a[92:95], v[44:47], v[100:103]
s_waitcnt lgkmcnt(3)
v_mfma_f32_16x16x32_bf16 v[96:99], a[96:99], v[48:51], v[96:99]
v_mfma_f32_16x16x32_bf16 v[100:103], a[100:103], v[48:51], v[100:103]
s_waitcnt lgkmcnt(2)
v_mfma_f32_16x16x32_bf16 v[96:99], a[104:107], v[52:55], v[96:99]
v_mfma_f32_16x16x32_bf16 v[100:103], a[108:111], v[52:55], v[100:103]
s_waitcnt lgkmcnt(1)
v_mfma_f32_16x16x32_bf16 v[96:99], a[112:115], v[56:59], v[96:99]
v_mfma_f32_16x16x32_bf16 v[100:103], a[116:119], v[56:59], v[100:103]
s_waitcnt lgkmcnt(0)
v_mfma_f32_16x16x32_bf16 v[96:99], a[120:123], v[60:63], v[96:99]
v_mfma_f32_16x16x32_bf16 v[100:103], a[124:127], v[60:63], v[100:103]
s_nop 7
v_add_f32_dpp v96, v100, v96 row_ror:8 row_mask:0xf bank_mask:0xf
v_add_f32_dpp v97, v101, v97 row_ror:8 row_mask:0xf bank_mask:0xf
v_add_f32_dpp v98, v102, v98 row_ror:8 row_mask:0xf bank_mask:0xf
v_add_f32_dpp v99, v103, v99 row_ror:8 row_mask:0xf bank_mask:0xf
v_cvt_pk_bf16_f32 v96, v96, v97
v_cvt_pk_bf16_f32 v97, v98, v99
buffer_store_dwordx2 v[96:97], v19, s[4:7], s38 offen sc1
s_barrier
s_add_u32 s48, s47, 0
buffer_store_dwordx2 v[28:29], v19, s[4:7], s48 offen sc1
s_setprio 0
s_add_u32 s28, s28, 1
s_and_b32 s48, s28, 3
s_xor_b32 s50, s48, 2
s_lshl_b32 s34, s48, 17
s_add_u32 s34, s34, s62
s_lshl_b32 s37, s48, 16
s_add_u32 s37, s37, s63
s_mul_i32 s38, s48, 131072
s_add_u32 s38, s38, 1572864
s_add_u32 s38, s38, s33
s_mul_i32 s47, s50, 131072
s_add_u32 s47, s47, 1572864
s_add_u32 s47, s47, s33
s_barrier
s_branch mega_kernel_ch_m1_Cloop
mega_kernel_ch_m1_fin:
s_waitcnt vmcnt(0)
s_barrier
s_cmp_lg_u32 s26, 3
s_cbranch_scc1 chf_30
s_lshl_b32 s48, s24, 7
s_add_u32 s48, s48, 4096
v_mov_b32 v3, s48
v_mov_b32 v9, 1
s_mov_b64 exec, 1
buffer_atomic_add v9, v3, s[4:7], 0 offen
s_mov_b64 exec, -1
chf_30:
s_branch mega_kernel_ch_done
mega_kernel_ch_done:
s_setprio 0
s_branch mega_kernel_worker
mega_kernel_end0:
s_endpgm
mega_kernel_t0:
s_lshr_b32 s74, s79, 1
s_add_u32 s74, s74, 1
s_cmp_eq_u32 s72, 1
s_cselect_b32 s74, 0, s74
s_and_b32 s73, s79, 1
s_lshr_b32 s17, s16, 2
s_and_b32 s18, s16, 3
v_lshrrev_b32 v1, 3, v0
s_mov_b32 s24, 2048
v_mul_lo_u32 v1, v1, s24
v_lshrrev_b32 v2, 4, v0
v_and_b32 v3, 7, v0
s_mov_b32 s25, 0
s_xor_b32 s26, s25, 0
v_add_u32 v4, s26, v2
v_xor_b32 v4, v4, v3
v_lshl_add_u32 v8, v4, 4, v1
s_xor_b32 s26, s25, 4
v_add_u32 v4, s26, v2
v_xor_b32 v4, v4, v3
v_lshl_add_u32 v9, v4, 4, v1
v_lshrrev_b32 v1, 5, v0
v_and_b32 v3, 31, v0
s_mov_b32 s24, 8192
v_mul_lo_u32 v2, v1, s24
v_add_u32 v4, 0, v1
v_and_b32 v4, 3, v4
v_lshlrev_b32 v4, 2, v4
v_xor_b32 v4, v4, v3
v_lshl_add_u32 v10, v4, 4, v2
v_add_u32 v4, 2, v1
v_and_b32 v4, 3, v4
v_lshlrev_b32 v4, 2, v4
v_xor_b32 v4, v4, v3
v_lshl_add_u32 v11, v4, 4, v2
v_and_b32 v1, 31, v0
v_lshrrev_b32 v2, 5, v0
v_bfe_u32 v3, v1, 1, 3
s_mul_i32 s24, s17, 8192
v_lshlrev_b32 v4, 7, v1
v_add_u32 v4, s24, v4
v_add_u32 v5, 0, v2
v_xor_b32 v5, v5, v3
v_lshl_add_u32 v13, v5, 4, v4
v_add_u32 v5, 2, v2
v_xor_b32 v5, v5, v3
v_lshl_add_u32 v14, v5, 4, v4
v_add_u32 v5, 4, v2
v_xor_b32 v5, v5, v3
v_lshl_add_u32 v15, v5, 4, v4
v_add_u32 v5, 6, v2
v_xor_b32 v5, v5, v3
v_lshl_add_u32 v16, v5, 4, v4
v_and_b32 v1, 15, v0
v_lshrrev_b32 v2, 2, v1
v_lshrrev_b32 v3, 5, v0
v_lshl_add_u32 v3, v3, 3, v2
v_mul_u32_u24 v3, 512, v3
v_and_b32 v4, 3, v1
v_lshl_add_u32 v3, v4, 3, v3
v_bfe_u32 v4, v0, 4, 1
v_lshl_add_u32 v3, v4, 5, v3
v_add_u32 v3, 16384, v3
s_mul_i32 s24, s18, 2
s_add_u32 s24, s24, 0
v_xor_b32 v4, s24, v2
v_lshl_add_u32 v17, v4, 6, v3
s_mul_i32 s24, s18, 2
s_add_u32 s24, s24, 1
v_xor_b32 v4, s24, v2
v_lshl_add_u32 v18, v4, 6, v3
v_add_u32 v19, 49152, v13
v_add_u32 v20, 49152, v14
v_add_u32 v21, 49152, v15
v_add_u32 v22, 49152, v16
v_add_u32 v23, 49152, v17
v_add_u32 v24, 49152, v18
v_add_u32 v25, 98304, v13
v_add_u32 v26, 98304, v14
v_add_u32 v27, 98304, v15
v_add_u32 v28, 98304, v16
v_add_u32 v29, 98304, v17
v_add_u32 v30, 98304, v18
s_mul_i32 s22, s16, 2048
s_mul_i32 s23, s16, 4096
s_add_u32 s23, s23, 16384
s_mov_b64 s[36:37], s[64:65]
s_cmp_eq_u32 s74, 1
s_cselect_b32 s36, s66, s36
s_cselect_b32 s37, s67, s37
s_cmp_eq_u32 s74, 2
s_cselect_b32 s36, s68, s36
s_cselect_b32 s37, s69, s37
s_mov_b32 s8, s36
s_and_b32 s9, s37, 0xffff
s_mov_b32 s10, 0x800000
s_mov_b32 s11, 0x00020000
s_lshl_b32 s28, s77, 7
s_lshl_b32 s29, s60, 9
s_lshl_b32 s24, s73, 8
s_add_u32 s29, s29, s24
s_mul_i32 s24, s16, 16
s_add_u32 s24, s24, s28
s_mul_i32 s19, s24, 2048
s_add_u32 s19, s19, 2097152
s_mul_i32 s20, s16, 65536
s_lshl_b32 s24, s29, 1
s_add_u32 s20, s20, s24
s_mov_b32 s33, 6291456
s_cmp_eq_u32 s74, 1
s_cselect_b32 s33, 23068672, s33
s_cmp_eq_u32 s74, 2
s_cselect_b32 s33, 39845888, s33
s_lshl_b32 s24, s28, 13
s_add_u32 s33, s33, s24
s_lshl_b32 s24, s29, 6
s_add_u32 s33, s33, s24
s_lshl_b32 s76, s60, 4
s_add_u32 s76, s76, s77
s_lshl_b32 s76, s76, 7
s_add_u32 s76, s76, 8192
s_cmp_eq_u32 s74, 0
s_cselect_b32 s24, 16384, 0
s_add_u32 s76, s76, s24
s_cmp_eq_u32 s74, 2
s_cbranch_scc1 vt_36
s_add_u32 m0, s22, 0
s_add_u32 s24, s19, 0
buffer_load_dwordx4 v8, s[4:7], s24 offen lds
s_add_u32 m0, s22, 1024
s_add_u32 s24, s19, 16384
buffer_load_dwordx4 v9, s[4:7], s24 offen lds
s_add_u32 m0, s23, 0
s_add_u32 s25, s20, 0
buffer_load_dwordx4 v10, s[8:11], s25 offen lds
s_add_u32 m0, s23, 1024
s_add_u32 s25, s20, 16384
buffer_load_dwordx4 v11, s[8:11], s25 offen lds
s_add_u32 m0, s23, 2048
s_add_u32 s25, s20, 32768
buffer_load_dwordx4 v10, s[8:11], s25 offen lds
s_add_u32 m0, s23, 3072
s_add_u32 s25, s20, 49152
buffer_load_dwordx4 v11, s[8:11], s25 offen lds
s_add_u32 m0, s22, 49152
s_add_u32 s24, s19, 128
buffer_load_dwordx4 v8, s[4:7], s24 offen lds
s_add_u32 m0, s22, 50176
s_add_u32 s24, s19, 16512
buffer_load_dwordx4 v9, s[4:7], s24 offen lds
s_add_u32 m0, s23, 49152
s_add_u32 s25, s20, 524288
buffer_load_dwordx4 v10, s[8:11], s25 offen lds
s_add_u32 m0, s23, 50176
s_add_u32 s25, s20, 540672
buffer_load_dwordx4 v11, s[8:11], s25 offen lds
s_add_u32 m0, s23, 51200
s_add_u32 s25, s20, 557056
buffer_load_dwordx4 v10, s[8:11], s25 offen lds
s_add_u32 m0, s23, 52224
s_add_u32 s25, s20, 573440
buffer_load_dwordx4 v11, s[8:11], s25 offen lds
v_accvgpr_write_b32 a0, 0
v_accvgpr_write_b32 a1, 0
v_accvgpr_write_b32 a2, 0
v_accvgpr_write_b32 a3, 0
v_accvgpr_write_b32 a4, 0
v_accvgpr_write_b32 a5, 0
v_accvgpr_write_b32 a6, 0
v_accvgpr_write_b32 a7, 0
v_accvgpr_write_b32 a8, 0
v_accvgpr_write_b32 a9, 0
v_accvgpr_write_b32 a10, 0
v_accvgpr_write_b32 a11, 0
v_accvgpr_write_b32 a12, 0
v_accvgpr_write_b32 a13, 0
v_accvgpr_write_b32 a14, 0
v_accvgpr_write_b32 a15, 0
v_accvgpr_write_b32 a16, 0
v_accvgpr_write_b32 a17, 0
v_accvgpr_write_b32 a18, 0
v_accvgpr_write_b32 a19, 0
v_accvgpr_write_b32 a20, 0
v_accvgpr_write_b32 a21, 0
v_accvgpr_write_b32 a22, 0
v_accvgpr_write_b32 a23, 0
v_accvgpr_write_b32 a24, 0
v_accvgpr_write_b32 a25, 0
v_accvgpr_write_b32 a26, 0
v_accvgpr_write_b32 a27, 0
v_accvgpr_write_b32 a28, 0
v_accvgpr_write_b32 a29, 0
v_accvgpr_write_b32 a30, 0
v_accvgpr_write_b32 a31, 0
v_accvgpr_write_b32 a32, 0
v_accvgpr_write_b32 a33, 0
v_accvgpr_write_b32 a34, 0
v_accvgpr_write_b32 a35, 0
v_accvgpr_write_b32 a36, 0
v_accvgpr_write_b32 a37, 0
v_accvgpr_write_b32 a38, 0
v_accvgpr_write_b32 a39, 0
v_accvgpr_write_b32 a40, 0
v_accvgpr_write_b32 a41, 0
v_accvgpr_write_b32 a42, 0
v_accvgpr_write_b32 a43, 0
v_accvgpr_write_b32 a44, 0
v_accvgpr_write_b32 a45, 0
v_accvgpr_write_b32 a46, 0
v_accvgpr_write_b32 a47, 0
v_accvgpr_write_b32 a48, 0
v_accvgpr_write_b32 a49, 0
v_accvgpr_write_b32 a50, 0
v_accvgpr_write_b32 a51, 0
v_accvgpr_write_b32 a52, 0
v_accvgpr_write_b32 a53, 0
v_accvgpr_write_b32 a54, 0
v_accvgpr_write_b32 a55, 0
v_accvgpr_write_b32 a56, 0
v_accvgpr_write_b32 a57, 0
v_accvgpr_write_b32 a58, 0
v_accvgpr_write_b32 a59, 0
v_accvgpr_write_b32 a60, 0
v_accvgpr_write_b32 a61, 0
v_accvgpr_write_b32 a62, 0
v_accvgpr_write_b32 a63, 0
s_waitcnt vmcnt(6)
s_barrier
RB 32,13,0
RB 36,13,4096
RT 40,17,0
RT 42,17,2048
RT 44,18,0
RT 46,18,2048
RB 48,14,0
RB 52,14,4096
RT 56,17,8192
RT 58,17,10240
RT 60,18,8192
RT 62,18,10240
RB 64,15,0
RB 68,15,4096
RT 72,17,16384
RT 74,17,18432
RT 76,18,16384
RT 78,18,18432
s_waitcnt lgkmcnt(12)
MM 0,40,32
RB 80,16,0
RB 84,16,4096
RT 88,17,24576
MM 16,44,32
RT 90,17,26624
RT 92,18,24576
RT 94,18,26624
MM 32,40,36
s_add_u32 m0, s22, 98304
s_add_u32 s24, s19, 256
buffer_load_dwordx4 v8, s[4:7], s24 offen lds
s_add_u32 m0, s22, 99328
s_add_u32 s24, s19, 16640
buffer_load_dwordx4 v9, s[4:7], s24 offen lds
s_add_u32 m0, s23, 98304
s_add_u32 s25, s20, 1048576
buffer_load_dwordx4 v10, s[8:11], s25 offen lds
MM 48,44,36
s_add_u32 m0, s23, 99328
s_add_u32 s25, s20, 1064960
buffer_load_dwordx4 v11, s[8:11], s25 offen lds
s_add_u32 m0, s23, 100352
s_add_u32 s25, s20, 1081344
buffer_load_dwordx4 v10, s[8:11], s25 offen lds
s_add_u32 m0, s23, 101376
s_add_u32 s25, s20, 1097728
buffer_load_dwordx4 v11, s[8:11], s25 offen lds
s_waitcnt lgkmcnt(0) vmcnt(6)
s_barrier
MM 0,56,48
RB 32,19,0
RB 36,19,4096
MM 16,60,48
RT 40,23,0
RT 42,23,2048
MM 32,56,52
RT 44,24,0
RT 46,24,2048
MM 48,60,52
s_add_u32 m0, s22, 0
s_add_u32 s24, s19, 384
buffer_load_dwordx4 v8, s[4:7], s24 offen lds
s_waitcnt lgkmcnt(12)
MM 0,72,64
RB 48,20,0
RB 52,20,4096
MM 16,76,64
RT 56,23,8192
RT 58,23,10240
MM 32,72,68
RT 60,24,8192
RT 62,24,10240
MM 48,76,68
s_add_u32 m0, s22, 1024
s_add_u32 s24, s19, 16768
buffer_load_dwordx4 v9, s[4:7], s24 offen lds
s_add_u32 m0, s23, 0
s_add_u32 s25, s20, 1572864
buffer_load_dwordx4 v10, s[8:11], s25 offen lds
s_waitcnt lgkmcnt(12)
MM 0,88,80
RB 64,21,0
RB 68,21,4096
MM 16,92,80
RT 72,23,16384
RT 74,23,18432
MM 32,88,84
RT 76,24,16384
RT 78,24,18432
MM 48,92,84
s_add_u32 m0, s23, 1024
s_add_u32 s25, s20, 1589248
buffer_load_dwordx4 v11, s[8:11], s25 offen lds
s_waitcnt lgkmcnt(12)
MM 0,40,32
RB 80,22,0
RB 84,22,4096
MM 16,44,32
RT 88,23,24576
RT 90,23,26624
MM 32,40,36
RT 92,24,24576
RT 94,24,26624
MM 48,44,36
s_add_u32 m0, s23, 2048
s_add_u32 s25, s20, 1605632
buffer_load_dwordx4 v10, s[8:11], s25 offen lds
s_add_u32 m0, s23, 3072
s_add_u32 s25, s20, 1622016
buffer_load_dwordx4 v11, s[8:11], s25 offen lds
s_waitcnt lgkmcnt(0) vmcnt(6)
s_barrier
MM 0,56,48
RB 32,25,0
RB 36,25,4096
MM 16,60,48
RT 40,29,0
RT 42,29,2048
MM 32,56,52
RT 44,30,0
RT 46,30,2048
MM 48,60,52
s_add_u32 m0, s22, 49152
s_add_u32 s24, s19, 512
buffer_load_dwordx4 v8, s[4:7], s24 offen lds
s_waitcnt lgkmcnt(12)
MM 0,72,64
RB 48,26,0
RB 52,26,4096
MM 16,76,64
RT 56,29,8192
RT 58,29,10240
MM 32,72,68
RT 60,30,8192
RT 62,30,10240
MM 48,76,68
s_add_u32 m0, s22, 50176
s_add_u32 s24, s19, 16896
buffer_load_dwordx4 v9, s[4:7], s24 offen lds
s_add_u32 m0, s23, 49152
s_add_u32 s25, s20, 2097152
buffer_load_dwordx4 v10, s[8:11], s25 offen lds
s_waitcnt lgkmcnt(12)
MM 0,88,80
RB 64,27,0
RB 68,27,4096
MM 16,92,80
RT 72,29,16384
RT 74,29,18432
MM 32,88,84
RT 76,30,16384
RT 78,30,18432
MM 48,92,84
s_add_u32 m0, s23, 50176
s_add_u32 s25, s20, 2113536
buffer_load_dwordx4 v11, s[8:11], s25 offen lds
s_waitcnt lgkmcnt(12)
MM 0,40,32
RB 80,28,0
RB 84,28,4096
MM 16,44,32
RT 88,29,24576
RT 90,29,26624
MM 32,40,36
RT 92,30,24576
RT 94,30,26624
MM 48,44,36
s_add_u32 m0, s23, 51200
s_add_u32 s25, s20, 2129920
buffer_load_dwordx4 v10, s[8:11], s25 offen lds
s_add_u32 m0, s23, 52224
s_add_u32 s25, s20, 2146304
buffer_load_dwordx4 v11, s[8:11], s25 offen lds
s_waitcnt lgkmcnt(0) vmcnt(6)
s_barrier
MM 0,56,48
RB 32,13,0
RB 36,13,4096
MM 16,60,48
RT 40,17,0
RT 42,17,2048
MM 32,56,52
RT 44,18,0
RT 46,18,2048
MM 48,60,52
s_add_u32 m0, s22, 98304
s_add_u32 s24, s19, 640
buffer_load_dwordx4 v8, s[4:7], s24 offen lds
s_waitcnt lgkmcnt(12)
MM 0,72,64
RB 48,14,0
RB 52,14,4096
MM 16,76,64
RT 56,17,8192
RT 58,17,10240
MM 32,72,68
RT 60,18,8192
RT 62,18,10240
MM 48,76,68
s_add_u32 m0, s22, 99328
s_add_u32 s24, s19, 17024
buffer_load_dwordx4 v9, s[4:7], s24 offen lds
s_add_u32 m0, s23, 98304
s_add_u32 s25, s20, 2621440
buffer_load_dwordx4 v10, s[8:11], s25 offen lds
s_waitcnt lgkmcnt(12)
MM 0,88,80
RB 64,15,0
RB 68,15,4096
MM 16,92,80
RT 72,17,16384
RT 74,17,18432
MM 32,88,84
RT 76,18,16384
RT 78,18,18432
MM 48,92,84
s_add_u32 m0, s23, 99328
s_add_u32 s25, s20, 2637824
buffer_load_dwordx4 v11, s[8:11], s25 offen lds
s_waitcnt lgkmcnt(12)
MM 0,40,32
RB 80,16,0
RB 84,16,4096
MM 16,44,32
RT 88,17,24576
RT 90,17,26624
MM 32,40,36
RT 92,18,24576
RT 94,18,26624
MM 48,44,36
s_add_u32 m0, s23, 100352
s_add_u32 s25, s20, 2654208
buffer_load_dwordx4 v10, s[8:11], s25 offen lds
s_add_u32 m0, s23, 101376
s_add_u32 s25, s20, 2670592
buffer_load_dwordx4 v11, s[8:11], s25 offen lds
s_waitcnt lgkmcnt(0) vmcnt(6)
s_barrier
MM 0,56,48
RB 32,19,0
RB 36,19,4096
MM 16,60,48
RT 40,23,0
RT 42,23,2048
MM 32,56,52
RT 44,24,0
RT 46,24,2048
MM 48,60,52
s_add_u32 m0, s22, 0
s_add_u32 s24, s19, 768
buffer_load_dwordx4 v8, s[4:7], s24 offen lds
s_waitcnt lgkmcnt(12)
MM 0,72,64
RB 48,20,0
RB 52,20,4096
MM 16,76,64
RT 56,23,8192
RT 58,23,10240
MM 32,72,68
RT 60,24,8192
RT 62,24,10240
MM 48,76,68
s_add_u32 m0, s22, 1024
s_add_u32 s24, s19, 17152
buffer_load_dwordx4 v9, s[4:7], s24 offen lds
s_add_u32 m0, s23, 0
s_add_u32 s25, s20, 3145728
buffer_load_dwordx4 v10, s[8:11], s25 offen lds
s_waitcnt lgkmcnt(12)
MM 0,88,80
RB 64,21,0
RB 68,21,4096
MM 16,92,80
RT 72,23,16384
RT 74,23,18432
MM 32,88,84
RT 76,24,16384
RT 78,24,18432
MM 48,92,84
s_add_u32 m0, s23, 1024
s_add_u32 s25, s20, 3162112
buffer_load_dwordx4 v11, s[8:11], s25 offen lds
s_waitcnt lgkmcnt(12)
MM 0,40,32
RB 80,22,0
RB 84,22,4096
MM 16,44,32
RT 88,23,24576
RT 90,23,26624
MM 32,40,36
RT 92,24,24576
RT 94,24,26624
MM 48,44,36
s_add_u32 m0, s23, 2048
s_add_u32 s25, s20, 3178496
buffer_load_dwordx4 v10, s[8:11], s25 offen lds
s_add_u32 m0, s23, 3072
s_add_u32 s25, s20, 3194880
buffer_load_dwordx4 v11, s[8:11], s25 offen lds
s_waitcnt lgkmcnt(0) vmcnt(6)
s_barrier
MM 0,56,48
RB 32,25,0
RB 36,25,4096
MM 16,60,48
RT 40,29,0
RT 42,29,2048
MM 32,56,52
RT 44,30,0
RT 46,30,2048
MM 48,60,52
s_add_u32 m0, s22, 49152
s_add_u32 s24, s19, 896
buffer_load_dwordx4 v8, s[4:7], s24 offen lds
s_waitcnt lgkmcnt(12)
MM 0,72,64
RB 48,26,0
RB 52,26,4096
MM 16,76,64
RT 56,29,8192
RT 58,29,10240
MM 32,72,68
RT 60,30,8192
RT 62,30,10240
MM 48,76,68
s_add_u32 m0, s22, 50176
s_add_u32 s24, s19, 17280
buffer_load_dwordx4 v9, s[4:7], s24 offen lds
s_add_u32 m0, s23, 49152
s_add_u32 s25, s20, 3670016
buffer_load_dwordx4 v10, s[8:11], s25 offen lds
s_waitcnt lgkmcnt(12)
MM 0,88,80
RB 64,27,0
RB 68,27,4096
MM 16,92,80
RT 72,29,16384
RT 74,29,18432
MM 32,88,84
RT 76,30,16384
RT 78,30,18432
MM 48,92,84
s_add_u32 m0, s23, 50176
s_add_u32 s25, s20, 3686400
buffer_load_dwordx4 v11, s[8:11], s25 offen lds
s_waitcnt lgkmcnt(12)
MM 0,40,32
RB 80,28,0
RB 84,28,4096
MM 16,44,32
RT 88,29,24576
RT 90,29,26624
MM 32,40,36
RT 92,30,24576
RT 94,30,26624
MM 48,44,36
s_add_u32 m0, s23, 51200
s_add_u32 s25, s20, 3702784
buffer_load_dwordx4 v10, s[8:11], s25 offen lds
s_add_u32 m0, s23, 52224
s_add_u32 s25, s20, 3719168
buffer_load_dwordx4 v11, s[8:11], s25 offen lds
s_waitcnt lgkmcnt(0) vmcnt(6)
s_barrier
MM 0,56,48
RB 32,13,0
RB 36,13,4096
MM 16,60,48
RT 40,17,0
RT 42,17,2048
MM 32,56,52
RT 44,18,0
RT 46,18,2048
MM 48,60,52
s_add_u32 m0, s22, 98304
s_add_u32 s24, s19, 1024
buffer_load_dwordx4 v8, s[4:7], s24 offen lds
s_waitcnt lgkmcnt(12)
MM 0,72,64
RB 48,14,0
RB 52,14,4096
MM 16,76,64
RT 56,17,8192
RT 58,17,10240
MM 32,72,68
RT 60,18,8192
RT 62,18,10240
MM 48,76,68
s_add_u32 m0, s22, 99328
s_add_u32 s24, s19, 17408
buffer_load_dwordx4 v9, s[4:7], s24 offen lds
s_add_u32 m0, s23, 98304
s_add_u32 s25, s20, 4194304
buffer_load_dwordx4 v10, s[8:11], s25 offen lds
s_waitcnt lgkmcnt(12)
MM 0,88,80
RB 64,15,0
RB 68,15,4096
MM 16,92,80
RT 72,17,16384
RT 74,17,18432
MM 32,88,84
RT 76,18,16384
RT 78,18,18432
MM 48,92,84
s_add_u32 m0, s23, 99328
s_add_u32 s25, s20, 4210688
buffer_load_dwordx4 v11, s[8:11], s25 offen lds
s_waitcnt lgkmcnt(12)
MM 0,40,32
RB 80,16,0
RB 84,16,4096
MM 16,44,32
RT 88,17,24576
RT 90,17,26624
MM 32,40,36
RT 92,18,24576
RT 94,18,26624
MM 48,44,36
s_add_u32 m0, s23, 100352
s_add_u32 s25, s20, 4227072
buffer_load_dwordx4 v10, s[8:11], s25 offen lds
s_add_u32 m0, s23, 101376
s_add_u32 s25, s20, 4243456
buffer_load_dwordx4 v11, s[8:11], s25 offen lds
s_waitcnt lgkmcnt(0) vmcnt(6)
s_barrier
MM 0,56,48
RB 32,19,0
RB 36,19,4096
MM 16,60,48
RT 40,23,0
RT 42,23,2048
MM 32,56,52
RT 44,24,0
RT 46,24,2048
MM 48,60,52
s_add_u32 m0, s22, 0
s_add_u32 s24, s19, 1152
buffer_load_dwordx4 v8, s[4:7], s24 offen lds
s_waitcnt lgkmcnt(12)
MM 0,72,64
RB 48,20,0
RB 52,20,4096
MM 16,76,64
RT 56,23,8192
RT 58,23,10240
MM 32,72,68
RT 60,24,8192
RT 62,24,10240
MM 48,76,68
s_add_u32 m0, s22, 1024
s_add_u32 s24, s19, 17536
buffer_load_dwordx4 v9, s[4:7], s24 offen lds
s_add_u32 m0, s23, 0
s_add_u32 s25, s20, 4718592
buffer_load_dwordx4 v10, s[8:11], s25 offen lds
s_waitcnt lgkmcnt(12)
MM 0,88,80
RB 64,21,0
RB 68,21,4096
MM 16,92,80
RT 72,23,16384
RT 74,23,18432
MM 32,88,84
RT 76,24,16384
RT 78,24,18432
MM 48,92,84
s_add_u32 m0, s23, 1024
s_add_u32 s25, s20, 4734976
buffer_load_dwordx4 v11, s[8:11], s25 offen lds
s_waitcnt lgkmcnt(12)
MM 0,40,32
RB 80,22,0
RB 84,22,4096
MM 16,44,32
RT 88,23,24576
RT 90,23,26624
MM 32,40,36
RT 92,24,24576
RT 94,24,26624
MM 48,44,36
s_add_u32 m0, s23, 2048
s_add_u32 s25, s20, 4751360
buffer_load_dwordx4 v10, s[8:11], s25 offen lds
s_add_u32 m0, s23, 3072
s_add_u32 s25, s20, 4767744
buffer_load_dwordx4 v11, s[8:11], s25 offen lds
s_waitcnt lgkmcnt(0) vmcnt(6)
s_barrier
MM 0,56,48
RB 32,25,0
RB 36,25,4096
MM 16,60,48
RT 40,29,0
RT 42,29,2048
MM 32,56,52
RT 44,30,0
RT 46,30,2048
MM 48,60,52
s_add_u32 m0, s22, 49152
s_add_u32 s24, s19, 1280
buffer_load_dwordx4 v8, s[4:7], s24 offen lds
s_waitcnt lgkmcnt(12)
MM 0,72,64
RB 48,26,0
RB 52,26,4096
MM 16,76,64
RT 56,29,8192
RT 58,29,10240
MM 32,72,68
RT 60,30,8192
RT 62,30,10240
MM 48,76,68
s_add_u32 m0, s22, 50176
s_add_u32 s24, s19, 17664
buffer_load_dwordx4 v9, s[4:7], s24 offen lds
s_add_u32 m0, s23, 49152
s_add_u32 s25, s20, 5242880
buffer_load_dwordx4 v10, s[8:11], s25 offen lds
s_waitcnt lgkmcnt(12)
MM 0,88,80
RB 64,27,0
RB 68,27,4096
MM 16,92,80
RT 72,29,16384
RT 74,29,18432
MM 32,88,84
RT 76,30,16384
RT 78,30,18432
MM 48,92,84
s_add_u32 m0, s23, 50176
s_add_u32 s25, s20, 5259264
buffer_load_dwordx4 v11, s[8:11], s25 offen lds
s_waitcnt lgkmcnt(12)
MM 0,40,32
RB 80,28,0
RB 84,28,4096
MM 16,44,32
RT 88,29,24576
RT 90,29,26624
MM 32,40,36
RT 92,30,24576
RT 94,30,26624
MM 48,44,36
s_add_u32 m0, s23, 51200
s_add_u32 s25, s20, 5275648
buffer_load_dwordx4 v10, s[8:11], s25 offen lds
s_add_u32 m0, s23, 52224
s_add_u32 s25, s20, 5292032
buffer_load_dwordx4 v11, s[8:11], s25 offen lds
s_waitcnt lgkmcnt(0) vmcnt(6)
s_barrier
MM 0,56,48
RB 32,13,0
RB 36,13,4096
MM 16,60,48
RT 40,17,0
RT 42,17,2048
MM 32,56,52
RT 44,18,0
RT 46,18,2048
MM 48,60,52
s_add_u32 m0, s22, 98304
s_add_u32 s24, s19, 1408
buffer_load_dwordx4 v8, s[4:7], s24 offen lds
s_waitcnt lgkmcnt(12)
MM 0,72,64
RB 48,14,0
RB 52,14,4096
MM 16,76,64
RT 56,17,8192
RT 58,17,10240
MM 32,72,68
RT 60,18,8192
RT 62,18,10240
MM 48,76,68
s_add_u32 m0, s22, 99328
s_add_u32 s24, s19, 17792
buffer_load_dwordx4 v9, s[4:7], s24 offen lds
s_add_u32 m0, s23, 98304
s_add_u32 s25, s20, 5767168
buffer_load_dwordx4 v10, s[8:11], s25 offen lds
s_waitcnt lgkmcnt(12)
MM 0,88,80
RB 64,15,0
RB 68,15,4096
MM 16,92,80
RT 72,17,16384
RT 74,17,18432
MM 32,88,84
RT 76,18,16384
RT 78,18,18432
MM 48,92,84
s_add_u32 m0, s23, 99328
s_add_u32 s25, s20, 5783552
buffer_load_dwordx4 v11, s[8:11], s25 offen lds
s_waitcnt lgkmcnt(12)
MM 0,40,32
RB 80,16,0
RB 84,16,4096
MM 16,44,32
RT 88,17,24576
RT 90,17,26624
MM 32,40,36
RT 92,18,24576
RT 94,18,26624
MM 48,44,36
s_add_u32 m0, s23, 100352
s_add_u32 s25, s20, 5799936
buffer_load_dwordx4 v10, s[8:11], s25 offen lds
s_add_u32 m0, s23, 101376
s_add_u32 s25, s20, 5816320
buffer_load_dwordx4 v11, s[8:11], s25 offen lds
s_waitcnt lgkmcnt(0) vmcnt(6)
s_barrier
MM 0,56,48
RB 32,19,0
RB 36,19,4096
MM 16,60,48
RT 40,23,0
RT 42,23,2048
MM 32,56,52
RT 44,24,0
RT 46,24,2048
MM 48,60,52
s_add_u32 m0, s22, 0
s_add_u32 s24, s19, 1536
buffer_load_dwordx4 v8, s[4:7], s24 offen lds
s_waitcnt lgkmcnt(12)
MM 0,72,64
RB 48,20,0
RB 52,20,4096
MM 16,76,64
RT 56,23,8192
RT 58,23,10240
MM 32,72,68
RT 60,24,8192
RT 62,24,10240
MM 48,76,68
s_add_u32 m0, s22, 1024
s_add_u32 s24, s19, 17920
buffer_load_dwordx4 v9, s[4:7], s24 offen lds
s_add_u32 m0, s23, 0
s_add_u32 s25, s20, 6291456
buffer_load_dwordx4 v10, s[8:11], s25 offen lds
s_waitcnt lgkmcnt(12)
MM 0,88,80
RB 64,21,0
RB 68,21,4096
MM 16,92,80
RT 72,23,16384
RT 74,23,18432
MM 32,88,84
RT 76,24,16384
RT 78,24,18432
MM 48,92,84
s_add_u32 m0, s23, 1024
s_add_u32 s25, s20, 6307840
buffer_load_dwordx4 v11, s[8:11], s25 offen lds
s_waitcnt lgkmcnt(12)
MM 0,40,32
RB 80,22,0
RB 84,22,4096
MM 16,44,32
RT 88,23,24576
RT 90,23,26624
MM 32,40,36
RT 92,24,24576
RT 94,24,26624
MM 48,44,36
s_add_u32 m0, s23, 2048
s_add_u32 s25, s20, 6324224
buffer_load_dwordx4 v10, s[8:11], s25 offen lds
s_add_u32 m0, s23, 3072
s_add_u32 s25, s20, 6340608
buffer_load_dwordx4 v11, s[8:11], s25 offen lds
s_waitcnt lgkmcnt(0) vmcnt(6)
s_barrier
MM 0,56,48
RB 32,25,0
RB 36,25,4096
MM 16,60,48
RT 40,29,0
RT 42,29,2048
MM 32,56,52
RT 44,30,0
RT 46,30,2048
MM 48,60,52
s_add_u32 m0, s22, 49152
s_add_u32 s24, s19, 1664
buffer_load_dwordx4 v8, s[4:7], s24 offen lds
s_waitcnt lgkmcnt(12)
MM 0,72,64
RB 48,26,0
RB 52,26,4096
MM 16,76,64
RT 56,29,8192
RT 58,29,10240
MM 32,72,68
RT 60,30,8192
RT 62,30,10240
MM 48,76,68
s_add_u32 m0, s22, 50176
s_add_u32 s24, s19, 18048
buffer_load_dwordx4 v9, s[4:7], s24 offen lds
s_add_u32 m0, s23, 49152
s_add_u32 s25, s20, 6815744
buffer_load_dwordx4 v10, s[8:11], s25 offen lds
s_waitcnt lgkmcnt(12)
MM 0,88,80
RB 64,27,0
RB 68,27,4096
MM 16,92,80
RT 72,29,16384
RT 74,29,18432
MM 32,88,84
RT 76,30,16384
RT 78,30,18432
MM 48,92,84
s_add_u32 m0, s23, 50176
s_add_u32 s25, s20, 6832128
buffer_load_dwordx4 v11, s[8:11], s25 offen lds
s_waitcnt lgkmcnt(12)
MM 0,40,32
RB 80,28,0
RB 84,28,4096
MM 16,44,32
RT 88,29,24576
RT 90,29,26624
MM 32,40,36
RT 92,30,24576
RT 94,30,26624
MM 48,44,36
s_add_u32 m0, s23, 51200
s_add_u32 s25, s20, 6848512
buffer_load_dwordx4 v10, s[8:11], s25 offen lds
s_add_u32 m0, s23, 52224
s_add_u32 s25, s20, 6864896
buffer_load_dwordx4 v11, s[8:11], s25 offen lds
s_waitcnt lgkmcnt(0) vmcnt(6)
s_barrier
MM 0,56,48
RB 32,13,0
RB 36,13,4096
MM 16,60,48
RT 40,17,0
RT 42,17,2048
MM 32,56,52
RT 44,18,0
RT 46,18,2048
MM 48,60,52
s_add_u32 m0, s22, 98304
s_add_u32 s24, s19, 1792
buffer_load_dwordx4 v8, s[4:7], s24 offen lds
s_waitcnt lgkmcnt(12)
MM 0,72,64
RB 48,14,0
RB 52,14,4096
MM 16,76,64
RT 56,17,8192
RT 58,17,10240
MM 32,72,68
RT 60,18,8192
RT 62,18,10240
MM 48,76,68
s_add_u32 m0, s22, 99328
s_add_u32 s24, s19, 18176
buffer_load_dwordx4 v9, s[4:7], s24 offen lds
s_add_u32 m0, s23, 98304
s_add_u32 s25, s20, 7340032
buffer_load_dwordx4 v10, s[8:11], s25 offen lds
s_waitcnt lgkmcnt(12)
MM 0,88,80
RB 64,15,0
RB 68,15,4096
MM 16,92,80
RT 72,17,16384
RT 74,17,18432
MM 32,88,84
RT 76,18,16384
RT 78,18,18432
MM 48,92,84
s_add_u32 m0, s23, 99328
s_add_u32 s25, s20, 7356416
buffer_load_dwordx4 v11, s[8:11], s25 offen lds
s_waitcnt lgkmcnt(12)
MM 0,40,32
RB 80,16,0
RB 84,16,4096
MM 16,44,32
RT 88,17,24576
RT 90,17,26624
MM 32,40,36
RT 92,18,24576
RT 94,18,26624
MM 48,44,36
s_add_u32 m0, s23, 100352
s_add_u32 s25, s20, 7372800
buffer_load_dwordx4 v10, s[8:11], s25 offen lds
s_add_u32 m0, s23, 101376
s_add_u32 s25, s20, 7389184
buffer_load_dwordx4 v11, s[8:11], s25 offen lds
s_waitcnt lgkmcnt(0) vmcnt(6)
s_barrier
MM 0,56,48
RB 32,19,0
RB 36,19,4096
MM 16,60,48
RT 40,23,0
RT 42,23,2048
MM 32,56,52
RT 44,24,0
RT 46,24,2048
MM 48,60,52
s_add_u32 m0, s22, 0
s_add_u32 s24, s19, 1920
buffer_load_dwordx4 v8, s[4:7], s24 offen lds
s_waitcnt lgkmcnt(12)
MM 0,72,64
RB 48,20,0
RB 52,20,4096
MM 16,76,64
RT 56,23,8192
RT 58,23,10240
MM 32,72,68
RT 60,24,8192
RT 62,24,10240
MM 48,76,68
s_add_u32 m0, s22, 1024
s_add_u32 s24, s19, 18304
buffer_load_dwordx4 v9, s[4:7], s24 offen lds
s_add_u32 m0, s23, 0
s_add_u32 s25, s20, 7864320
buffer_load_dwordx4 v10, s[8:11], s25 offen lds
s_waitcnt lgkmcnt(12)
MM 0,88,80
RB 64,21,0
RB 68,21,4096
MM 16,92,80
RT 72,23,16384
RT 74,23,18432
MM 32,88,84
RT 76,24,16384
RT 78,24,18432
MM 48,92,84
s_add_u32 m0, s23, 1024
s_add_u32 s25, s20, 7880704
buffer_load_dwordx4 v11, s[8:11], s25 offen lds
s_waitcnt lgkmcnt(12)
MM 0,40,32
RB 80,22,0
RB 84,22,4096
MM 16,44,32
RT 88,23,24576
RT 90,23,26624
MM 32,40,36
RT 92,24,24576
RT 94,24,26624
MM 48,44,36
s_add_u32 m0, s23, 2048
s_add_u32 s25, s20, 7897088
buffer_load_dwordx4 v10, s[8:11], s25 offen lds
s_add_u32 m0, s23, 3072
s_add_u32 s25, s20, 7913472
buffer_load_dwordx4 v11, s[8:11], s25 offen lds
s_waitcnt lgkmcnt(0) vmcnt(6)
s_barrier
MM 0,56,48
RB 32,25,0
RB 36,25,4096
MM 16,60,48
RT 40,29,0
MM 32,56,52
RT 42,29,2048
RT 44,30,0
MM 48,60,52
RT 46,30,2048
s_waitcnt lgkmcnt(12)
MM 0,72,64
RB 48,26,0
RB 52,26,4096
MM 16,76,64
RT 56,29,8192
MM 32,72,68
RT 58,29,10240
RT 60,30,8192
MM 48,76,68
RT 62,30,10240
s_waitcnt lgkmcnt(12)
MM 0,88,80
RB 64,27,0
RB 68,27,4096
MM 16,92,80
RT 72,29,16384
MM 32,88,84
RT 74,29,18432
RT 76,30,16384
MM 48,92,84
RT 78,30,18432
s_waitcnt lgkmcnt(12)
MM 0,40,32
RB 80,28,0
RB 84,28,4096
MM 16,44,32
RT 88,29,24576
MM 32,40,36
RT 90,29,26624
RT 92,30,24576
MM 48,44,36
RT 94,30,26624
s_waitcnt lgkmcnt(0) vmcnt(0)
s_barrier
MM 0,56,48
RB 32,13,0
RB 36,13,4096
MM 16,60,48
RT 40,17,0
MM 32,56,52
RT 42,17,2048
RT 44,18,0
MM 48,60,52
RT 46,18,2048
s_waitcnt lgkmcnt(12)
MM 0,72,64
RB 48,14,0
RB 52,14,4096
MM 16,76,64
RT 56,17,8192
MM 32,72,68
RT 58,17,10240
RT 60,18,8192
MM 48,76,68
RT 62,18,10240
s_waitcnt lgkmcnt(12)
MM 0,88,80
RB 64,15,0
RB 68,15,4096
MM 16,92,80
RT 72,17,16384
MM 32,88,84
RT 74,17,18432
RT 76,18,16384
MM 48,92,84
RT 78,18,18432
s_waitcnt lgkmcnt(12)
MM 0,40,32
RB 80,16,0
RB 84,16,4096
MM 16,44,32
RT 88,17,24576
MM 32,40,36
RT 90,17,26624
RT 92,18,24576
MM 48,44,36
RT 94,18,26624
s_waitcnt lgkmcnt(0)
MM 0,56,48
MM 16,60,48
MM 32,56,52
MM 48,60,52
s_waitcnt lgkmcnt(0)
MM 0,72,64
MM 16,76,64
MM 32,72,68
MM 48,76,68
s_waitcnt lgkmcnt(0)
MM 0,88,80
MM 16,92,80
MM 32,88,84
MM 48,92,84
s_barrier
s_cmp_lg_u32 s16, 0
s_cbranch_scc1 tt_38
v_mov_b32 v7, s56
v_accvgpr_write_b32 a127, 1
s_mov_b64 exec, 1
buffer_atomic_add a127, v7, s[4:7], 0 offen sc0
s_mov_b64 exec, -1
tt_38:
v_and_b32 v1, 31, v0
v_lshrrev_b32 v2, 5, v0
v_lshrrev_b32 v3, 4, v1
v_lshlrev_b32 v3, 12, v3
v_and_b32 v4, 15, v1
v_lshl_add_u32 v3, v4, 4, v3
v_lshl_add_u32 v12, v2, 8, v3
s_mul_i32 s24, s17, 524288
s_mul_i32 s25, s18, 64
s_lshr_b32 s26, s25, 7
s_lshl_b32 s26, s26, 13
s_and_b32 s25, s25, 127
s_lshl_b32 s25, s25, 5
s_add_u32 s24, s24, s25
s_add_u32 s24, s24, s26
s_add_u32 s33, s33, s24
v_accvgpr_read_b32 v32, a0
v_accvgpr_read_b32 v33, a1
v_accvgpr_read_b32 v34, a2
v_accvgpr_read_b32 v35, a3
v_accvgpr_read_b32 v36, a4
v_accvgpr_read_b32 v37, a5
v_accvgpr_read_b32 v38, a6
v_accvgpr_read_b32 v39, a7
v_accvgpr_read_b32 v40, a8
v_accvgpr_read_b32 v41, a9
v_accvgpr_read_b32 v42, a10
v_accvgpr_read_b32 v43, a11
v_accvgpr_read_b32 v44, a12
v_accvgpr_read_b32 v45, a13
v_accvgpr_read_b32 v46, a14
v_accvgpr_read_b32 v47, a15
v_cvt_pk_bf16_f32 v48, v32, v33
v_cvt_pk_bf16_f32 v49, v34, v35
v_cvt_pk_bf16_f32 v50, v36, v37
v_cvt_pk_bf16_f32 v51, v38, v39
v_cvt_pk_bf16_f32 v52, v40, v41
v_cvt_pk_bf16_f32 v53, v42, v43
v_cvt_pk_bf16_f32 v54, v44, v45
v_cvt_pk_bf16_f32 v55, v46, v47
v_permlane32_swap_b32 v48, v50
v_permlane32_swap_b32 v49, v51
v_permlane32_swap_b32 v52, v54
v_permlane32_swap_b32 v53, v55
s_add_u32 s24, s33, 0
buffer_store_dwordx4 v[48:51], v12, s[4:7], s24 offen sc1
s_add_u32 s24, s33, 512
buffer_store_dwordx4 v[52:55], v12, s[4:7], s24 offen sc1
s_nop 1
v_accvgpr_read_b32 v32, a16
v_accvgpr_read_b32 v33, a17
v_accvgpr_read_b32 v34, a18
v_accvgpr_read_b32 v35, a19
v_accvgpr_read_b32 v36, a20
v_accvgpr_read_b32 v37, a21
v_accvgpr_read_b32 v38, a22
v_accvgpr_read_b32 v39, a23
v_accvgpr_read_b32 v40, a24
v_accvgpr_read_b32 v41, a25
v_accvgpr_read_b32 v42, a26
v_accvgpr_read_b32 v43, a27
v_accvgpr_read_b32 v44, a28
v_accvgpr_read_b32 v45, a29
v_accvgpr_read_b32 v46, a30
v_accvgpr_read_b32 v47, a31
v_cvt_pk_bf16_f32 v48, v32, v33
v_cvt_pk_bf16_f32 v49, v34, v35
v_cvt_pk_bf16_f32 v50, v36, v37
v_cvt_pk_bf16_f32 v51, v38, v39
v_cvt_pk_bf16_f32 v52, v40, v41
v_cvt_pk_bf16_f32 v53, v42, v43
v_cvt_pk_bf16_f32 v54, v44, v45
v_cvt_pk_bf16_f32 v55, v46, v47
v_permlane32_swap_b32 v48, v50
v_permlane32_swap_b32 v49, v51
v_permlane32_swap_b32 v52, v54
v_permlane32_swap_b32 v53, v55
s_add_u32 s24, s33, 1024
buffer_store_dwordx4 v[48:51], v12, s[4:7], s24 offen sc1
s_add_u32 s24, s33, 1536
buffer_store_dwordx4 v[52:55], v12, s[4:7], s24 offen sc1
s_nop 1
v_accvgpr_read_b32 v32, a32
v_accvgpr_read_b32 v33, a33
v_accvgpr_read_b32 v34, a34
v_accvgpr_read_b32 v35, a35
v_accvgpr_read_b32 v36, a36
v_accvgpr_read_b32 v37, a37
v_accvgpr_read_b32 v38, a38
v_accvgpr_read_b32 v39, a39
v_accvgpr_read_b32 v40, a40
v_accvgpr_read_b32 v41, a41
v_accvgpr_read_b32 v42, a42
v_accvgpr_read_b32 v43, a43
v_accvgpr_read_b32 v44, a44
v_accvgpr_read_b32 v45, a45
v_accvgpr_read_b32 v46, a46
v_accvgpr_read_b32 v47, a47
v_cvt_pk_bf16_f32 v48, v32, v33
v_cvt_pk_bf16_f32 v49, v34, v35
v_cvt_pk_bf16_f32 v50, v36, v37
v_cvt_pk_bf16_f32 v51, v38, v39
v_cvt_pk_bf16_f32 v52, v40, v41
v_cvt_pk_bf16_f32 v53, v42, v43
v_cvt_pk_bf16_f32 v54, v44, v45
v_cvt_pk_bf16_f32 v55, v46, v47
v_permlane32_swap_b32 v48, v50
v_permlane32_swap_b32 v49, v51
v_permlane32_swap_b32 v52, v54
v_permlane32_swap_b32 v53, v55
s_add_u32 s24, s33, 262144
buffer_store_dwordx4 v[48:51], v12, s[4:7], s24 offen sc1
s_add_u32 s24, s33, 262656
buffer_store_dwordx4 v[52:55], v12, s[4:7], s24 offen sc1
s_nop 1
v_accvgpr_read_b32 v32, a48
v_accvgpr_read_b32 v33, a49
v_accvgpr_read_b32 v34, a50
v_accvgpr_read_b32 v35, a51
v_accvgpr_read_b32 v36, a52
v_accvgpr_read_b32 v37, a53
v_accvgpr_read_b32 v38, a54
v_accvgpr_read_b32 v39, a55
v_accvgpr_read_b32 v40, a56
v_accvgpr_read_b32 v41, a57
v_accvgpr_read_b32 v42, a58
v_accvgpr_read_b32 v43, a59
v_accvgpr_read_b32 v44, a60
v_accvgpr_read_b32 v45, a61
v_accvgpr_read_b32 v46, a62
v_accvgpr_read_b32 v47, a63
v_cvt_pk_bf16_f32 v48, v32, v33
v_cvt_pk_bf16_f32 v49, v34, v35
v_cvt_pk_bf16_f32 v50, v36, v37
v_cvt_pk_bf16_f32 v51, v38, v39
v_cvt_pk_bf16_f32 v52, v40, v41
v_cvt_pk_bf16_f32 v53, v42, v43
v_cvt_pk_bf16_f32 v54, v44, v45
v_cvt_pk_bf16_f32 v55, v46, v47
v_permlane32_swap_b32 v48, v50
v_permlane32_swap_b32 v49, v51
v_permlane32_swap_b32 v52, v54
v_permlane32_swap_b32 v53, v55
s_add_u32 s24, s33, 263168
buffer_store_dwordx4 v[48:51], v12, s[4:7], s24 offen sc1
s_add_u32 s24, s33, 263680
buffer_store_dwordx4 v[52:55], v12, s[4:7], s24 offen sc1
s_nop 1
s_branch p1s_37
vt_36:
s_add_u32 m0, s22, 0
s_add_u32 s24, s19, 0
buffer_load_dwordx4 v8, s[4:7], s24 offen lds
s_add_u32 m0, s22, 1024
s_add_u32 s24, s19, 16384
buffer_load_dwordx4 v9, s[4:7], s24 offen lds
s_add_u32 m0, s23, 0
s_add_u32 s25, s20, 0
buffer_load_dwordx4 v10, s[8:11], s25 offen lds
s_add_u32 m0, s23, 1024
s_add_u32 s25, s20, 16384
buffer_load_dwordx4 v11, s[8:11], s25 offen lds
s_add_u32 m0, s23, 2048
s_add_u32 s25, s20, 32768
buffer_load_dwordx4 v10, s[8:11], s25 offen lds
s_add_u32 m0, s23, 3072
s_add_u32 s25, s20, 49152
buffer_load_dwordx4 v11, s[8:11], s25 offen lds
s_add_u32 m0, s22, 49152
s_add_u32 s24, s19, 128
buffer_load_dwordx4 v8, s[4:7], s24 offen lds
s_add_u32 m0, s22, 50176
s_add_u32 s24, s19, 16512
buffer_load_dwordx4 v9, s[4:7], s24 offen lds
s_add_u32 m0, s23, 49152
s_add_u32 s25, s20, 524288
buffer_load_dwordx4 v10, s[8:11], s25 offen lds
s_add_u32 m0, s23, 50176
s_add_u32 s25, s20, 540672
buffer_load_dwordx4 v11, s[8:11], s25 offen lds
s_add_u32 m0, s23, 51200
s_add_u32 s25, s20, 557056
buffer_load_dwordx4 v10, s[8:11], s25 offen lds
s_add_u32 m0, s23, 52224
s_add_u32 s25, s20, 573440
buffer_load_dwordx4 v11, s[8:11], s25 offen lds
v_accvgpr_write_b32 a0, 0
v_accvgpr_write_b32 a1, 0
v_accvgpr_write_b32 a2, 0
v_accvgpr_write_b32 a3, 0
v_accvgpr_write_b32 a4, 0
v_accvgpr_write_b32 a5, 0
v_accvgpr_write_b32 a6, 0
v_accvgpr_write_b32 a7, 0
v_accvgpr_write_b32 a8, 0
v_accvgpr_write_b32 a9, 0
v_accvgpr_write_b32 a10, 0
v_accvgpr_write_b32 a11, 0
v_accvgpr_write_b32 a12, 0
v_accvgpr_write_b32 a13, 0
v_accvgpr_write_b32 a14, 0
v_accvgpr_write_b32 a15, 0
v_accvgpr_write_b32 a16, 0
v_accvgpr_write_b32 a17, 0
v_accvgpr_write_b32 a18, 0
v_accvgpr_write_b32 a19, 0
v_accvgpr_write_b32 a20, 0
v_accvgpr_write_b32 a21, 0
v_accvgpr_write_b32 a22, 0
v_accvgpr_write_b32 a23, 0
v_accvgpr_write_b32 a24, 0
v_accvgpr_write_b32 a25, 0
v_accvgpr_write_b32 a26, 0
v_accvgpr_write_b32 a27, 0
v_accvgpr_write_b32 a28, 0
v_accvgpr_write_b32 a29, 0
v_accvgpr_write_b32 a30, 0
v_accvgpr_write_b32 a31, 0
v_accvgpr_write_b32 a32, 0
v_accvgpr_write_b32 a33, 0
v_accvgpr_write_b32 a34, 0
v_accvgpr_write_b32 a35, 0
v_accvgpr_write_b32 a36, 0
v_accvgpr_write_b32 a37, 0
v_accvgpr_write_b32 a38, 0
v_accvgpr_write_b32 a39, 0
v_accvgpr_write_b32 a40, 0
v_accvgpr_write_b32 a41, 0
v_accvgpr_write_b32 a42, 0
v_accvgpr_write_b32 a43, 0
v_accvgpr_write_b32 a44, 0
v_accvgpr_write_b32 a45, 0
v_accvgpr_write_b32 a46, 0
v_accvgpr_write_b32 a47, 0
v_accvgpr_write_b32 a48, 0
v_accvgpr_write_b32 a49, 0
v_accvgpr_write_b32 a50, 0
v_accvgpr_write_b32 a51, 0
v_accvgpr_write_b32 a52, 0
v_accvgpr_write_b32 a53, 0
v_accvgpr_write_b32 a54, 0
v_accvgpr_write_b32 a55, 0
v_accvgpr_write_b32 a56, 0
v_accvgpr_write_b32 a57, 0
v_accvgpr_write_b32 a58, 0
v_accvgpr_write_b32 a59, 0
v_accvgpr_write_b32 a60, 0
v_accvgpr_write_b32 a61, 0
v_accvgpr_write_b32 a62, 0
v_accvgpr_write_b32 a63, 0
s_waitcnt vmcnt(6)
s_barrier
RB 32,13,0
RB 36,13,4096
RT 40,17,0
RT 42,17,2048
RT 44,18,0
RT 46,18,2048
RB 48,14,0
RB 52,14,4096
RT 56,17,8192
RT 58,17,10240
RT 60,18,8192
RT 62,18,10240
RB 64,15,0
RB 68,15,4096
RT 72,17,16384
RT 74,17,18432
RT 76,18,16384
RT 78,18,18432
s_waitcnt lgkmcnt(12)
MM 0,32,40
RB 80,16,0
RB 84,16,4096
RT 88,17,24576
MM 16,32,44
RT 90,17,26624
RT 92,18,24576
RT 94,18,26624
MM 32,36,40
s_add_u32 m0, s22, 98304
s_add_u32 s24, s19, 256
buffer_load_dwordx4 v8, s[4:7], s24 offen lds
s_add_u32 m0, s22, 99328
s_add_u32 s24, s19, 16640
buffer_load_dwordx4 v9, s[4:7], s24 offen lds
s_add_u32 m0, s23, 98304
s_add_u32 s25, s20, 1048576
buffer_load_dwordx4 v10, s[8:11], s25 offen lds
MM 48,36,44
s_add_u32 m0, s23, 99328
s_add_u32 s25, s20, 1064960
buffer_load_dwordx4 v11, s[8:11], s25 offen lds
s_add_u32 m0, s23, 100352
s_add_u32 s25, s20, 1081344
buffer_load_dwordx4 v10, s[8:11], s25 offen lds
s_add_u32 m0, s23, 101376
s_add_u32 s25, s20, 1097728
buffer_load_dwordx4 v11, s[8:11], s25 offen lds
s_waitcnt lgkmcnt(0) vmcnt(6)
s_barrier
MM 0,48,56
RB 32,19,0
RB 36,19,4096
MM 16,48,60
RT 40,23,0
RT 42,23,2048
MM 32,52,56
RT 44,24,0
RT 46,24,2048
MM 48,52,60
s_add_u32 m0, s22, 0
s_add_u32 s24, s19, 384
buffer_load_dwordx4 v8, s[4:7], s24 offen lds
s_waitcnt lgkmcnt(12)
MM 0,64,72
RB 48,20,0
RB 52,20,4096
MM 16,64,76
RT 56,23,8192
RT 58,23,10240
MM 32,68,72
RT 60,24,8192
RT 62,24,10240
MM 48,68,76
s_add_u32 m0, s22, 1024
s_add_u32 s24, s19, 16768
buffer_load_dwordx4 v9, s[4:7], s24 offen lds
s_add_u32 m0, s23, 0
s_add_u32 s25, s20, 1572864
buffer_load_dwordx4 v10, s[8:11], s25 offen lds
s_waitcnt lgkmcnt(12)
MM 0,80,88
RB 64,21,0
RB 68,21,4096
MM 16,80,92
RT 72,23,16384
RT 74,23,18432
MM 32,84,88
RT 76,24,16384
RT 78,24,18432
MM 48,84,92
s_add_u32 m0, s23, 1024
s_add_u32 s25, s20, 1589248
buffer_load_dwordx4 v11, s[8:11], s25 offen lds
s_waitcnt lgkmcnt(12)
MM 0,32,40
RB 80,22,0
RB 84,22,4096
MM 16,32,44
RT 88,23,24576
RT 90,23,26624
MM 32,36,40
RT 92,24,24576
RT 94,24,26624
MM 48,36,44
s_add_u32 m0, s23, 2048
s_add_u32 s25, s20, 1605632
buffer_load_dwordx4 v10, s[8:11], s25 offen lds
s_add_u32 m0, s23, 3072
s_add_u32 s25, s20, 1622016
buffer_load_dwordx4 v11, s[8:11], s25 offen lds
s_waitcnt lgkmcnt(0) vmcnt(6)
s_barrier
MM 0,48,56
RB 32,25,0
RB 36,25,4096
MM 16,48,60
RT 40,29,0
RT 42,29,2048
MM 32,52,56
RT 44,30,0
RT 46,30,2048
MM 48,52,60
s_add_u32 m0, s22, 49152
s_add_u32 s24, s19, 512
buffer_load_dwordx4 v8, s[4:7], s24 offen lds
s_waitcnt lgkmcnt(12)
MM 0,64,72
RB 48,26,0
RB 52,26,4096
MM 16,64,76
RT 56,29,8192
RT 58,29,10240
MM 32,68,72
RT 60,30,8192
RT 62,30,10240
MM 48,68,76
s_add_u32 m0, s22, 50176
s_add_u32 s24, s19, 16896
buffer_load_dwordx4 v9, s[4:7], s24 offen lds
s_add_u32 m0, s23, 49152
s_add_u32 s25, s20, 2097152
buffer_load_dwordx4 v10, s[8:11], s25 offen lds
s_waitcnt lgkmcnt(12)
MM 0,80,88
RB 64,27,0
RB 68,27,4096
MM 16,80,92
RT 72,29,16384
RT 74,29,18432
MM 32,84,88
RT 76,30,16384
RT 78,30,18432
MM 48,84,92
s_add_u32 m0, s23, 50176
s_add_u32 s25, s20, 2113536
buffer_load_dwordx4 v11, s[8:11], s25 offen lds
s_waitcnt lgkmcnt(12)
MM 0,32,40
RB 80,28,0
RB 84,28,4096
MM 16,32,44
RT 88,29,24576
RT 90,29,26624
MM 32,36,40
RT 92,30,24576
RT 94,30,26624
MM 48,36,44
s_add_u32 m0, s23, 51200
s_add_u32 s25, s20, 2129920
buffer_load_dwordx4 v10, s[8:11], s25 offen lds
s_add_u32 m0, s23, 52224
s_add_u32 s25, s20, 2146304
buffer_load_dwordx4 v11, s[8:11], s25 offen lds
s_waitcnt lgkmcnt(0) vmcnt(6)
s_barrier
MM 0,48,56
RB 32,13,0
RB 36,13,4096
MM 16,48,60
RT 40,17,0
RT 42,17,2048
MM 32,52,56
RT 44,18,0
RT 46,18,2048
MM 48,52,60
s_add_u32 m0, s22, 98304
s_add_u32 s24, s19, 640
buffer_load_dwordx4 v8, s[4:7], s24 offen lds
s_waitcnt lgkmcnt(12)
MM 0,64,72
RB 48,14,0
RB 52,14,4096
MM 16,64,76
RT 56,17,8192
RT 58,17,10240
MM 32,68,72
RT 60,18,8192
RT 62,18,10240
MM 48,68,76
s_add_u32 m0, s22, 99328
s_add_u32 s24, s19, 17024
buffer_load_dwordx4 v9, s[4:7], s24 offen lds
s_add_u32 m0, s23, 98304
s_add_u32 s25, s20, 2621440
buffer_load_dwordx4 v10, s[8:11], s25 offen lds
s_waitcnt lgkmcnt(12)
MM 0,80,88
RB 64,15,0
RB 68,15,4096
MM 16,80,92
RT 72,17,16384
RT 74,17,18432
MM 32,84,88
RT 76,18,16384
RT 78,18,18432
MM 48,84,92
s_add_u32 m0, s23, 99328
s_add_u32 s25, s20, 2637824
buffer_load_dwordx4 v11, s[8:11], s25 offen lds
s_waitcnt lgkmcnt(12)
MM 0,32,40
RB 80,16,0
RB 84,16,4096
MM 16,32,44
RT 88,17,24576
RT 90,17,26624
MM 32,36,40
RT 92,18,24576
RT 94,18,26624
MM 48,36,44
s_add_u32 m0, s23, 100352
s_add_u32 s25, s20, 2654208
buffer_load_dwordx4 v10, s[8:11], s25 offen lds
s_add_u32 m0, s23, 101376
s_add_u32 s25, s20, 2670592
buffer_load_dwordx4 v11, s[8:11], s25 offen lds
s_waitcnt lgkmcnt(0) vmcnt(6)
s_barrier
MM 0,48,56
RB 32,19,0
RB 36,19,4096
MM 16,48,60
RT 40,23,0
RT 42,23,2048
MM 32,52,56
RT 44,24,0
RT 46,24,2048
MM 48,52,60
s_add_u32 m0, s22, 0
s_add_u32 s24, s19, 768
buffer_load_dwordx4 v8, s[4:7], s24 offen lds
s_waitcnt lgkmcnt(12)
MM 0,64,72
RB 48,20,0
RB 52,20,4096
MM 16,64,76
RT 56,23,8192
RT 58,23,10240
MM 32,68,72
RT 60,24,8192
RT 62,24,10240
MM 48,68,76
s_add_u32 m0, s22, 1024
s_add_u32 s24, s19, 17152
buffer_load_dwordx4 v9, s[4:7], s24 offen lds
s_add_u32 m0, s23, 0
s_add_u32 s25, s20, 3145728
buffer_load_dwordx4 v10, s[8:11], s25 offen lds
s_waitcnt lgkmcnt(12)
MM 0,80,88
RB 64,21,0
RB 68,21,4096
MM 16,80,92
RT 72,23,16384
RT 74,23,18432
MM 32,84,88
RT 76,24,16384
RT 78,24,18432
MM 48,84,92
s_add_u32 m0, s23, 1024
s_add_u32 s25, s20, 3162112
buffer_load_dwordx4 v11, s[8:11], s25 offen lds
s_waitcnt lgkmcnt(12)
MM 0,32,40
RB 80,22,0
RB 84,22,4096
MM 16,32,44
RT 88,23,24576
RT 90,23,26624
MM 32,36,40
RT 92,24,24576
RT 94,24,26624
MM 48,36,44
s_add_u32 m0, s23, 2048
s_add_u32 s25, s20, 3178496
buffer_load_dwordx4 v10, s[8:11], s25 offen lds
s_add_u32 m0, s23, 3072
s_add_u32 s25, s20, 3194880
buffer_load_dwordx4 v11, s[8:11], s25 offen lds
s_waitcnt lgkmcnt(0) vmcnt(6)
s_barrier
MM 0,48,56
RB 32,25,0
RB 36,25,4096
MM 16,48,60
RT 40,29,0
RT 42,29,2048
MM 32,52,56
RT 44,30,0
RT 46,30,2048
MM 48,52,60
s_add_u32 m0, s22, 49152
s_add_u32 s24, s19, 896
buffer_load_dwordx4 v8, s[4:7], s24 offen lds
s_waitcnt lgkmcnt(12)
MM 0,64,72
RB 48,26,0
RB 52,26,4096
MM 16,64,76
RT 56,29,8192
RT 58,29,10240
MM 32,68,72
RT 60,30,8192
RT 62,30,10240
MM 48,68,76
s_add_u32 m0, s22, 50176
s_add_u32 s24, s19, 17280
buffer_load_dwordx4 v9, s[4:7], s24 offen lds
s_add_u32 m0, s23, 49152
s_add_u32 s25, s20, 3670016
buffer_load_dwordx4 v10, s[8:11], s25 offen lds
s_waitcnt lgkmcnt(12)
MM 0,80,88
RB 64,27,0
RB 68,27,4096
MM 16,80,92
RT 72,29,16384
RT 74,29,18432
MM 32,84,88
RT 76,30,16384
RT 78,30,18432
MM 48,84,92
s_add_u32 m0, s23, 50176
s_add_u32 s25, s20, 3686400
buffer_load_dwordx4 v11, s[8:11], s25 offen lds
s_waitcnt lgkmcnt(12)
MM 0,32,40
RB 80,28,0
RB 84,28,4096
MM 16,32,44
RT 88,29,24576
RT 90,29,26624
MM 32,36,40
RT 92,30,24576
RT 94,30,26624
MM 48,36,44
s_add_u32 m0, s23, 51200
s_add_u32 s25, s20, 3702784
buffer_load_dwordx4 v10, s[8:11], s25 offen lds
s_add_u32 m0, s23, 52224
s_add_u32 s25, s20, 3719168
buffer_load_dwordx4 v11, s[8:11], s25 offen lds
s_waitcnt lgkmcnt(0) vmcnt(6)
s_barrier
MM 0,48,56
RB 32,13,0
RB 36,13,4096
MM 16,48,60
RT 40,17,0
RT 42,17,2048
MM 32,52,56
RT 44,18,0
RT 46,18,2048
MM 48,52,60
s_add_u32 m0, s22, 98304
s_add_u32 s24, s19, 1024
buffer_load_dwordx4 v8, s[4:7], s24 offen lds
s_waitcnt lgkmcnt(12)
MM 0,64,72
RB 48,14,0
RB 52,14,4096
MM 16,64,76
RT 56,17,8192
RT 58,17,10240
MM 32,68,72
RT 60,18,8192
RT 62,18,10240
MM 48,68,76
s_add_u32 m0, s22, 99328
s_add_u32 s24, s19, 17408
buffer_load_dwordx4 v9, s[4:7], s24 offen lds
s_add_u32 m0, s23, 98304
s_add_u32 s25, s20, 4194304
buffer_load_dwordx4 v10, s[8:11], s25 offen lds
s_waitcnt lgkmcnt(12)
MM 0,80,88
RB 64,15,0
RB 68,15,4096
MM 16,80,92
RT 72,17,16384
RT 74,17,18432
MM 32,84,88
RT 76,18,16384
RT 78,18,18432
MM 48,84,92
s_add_u32 m0, s23, 99328
s_add_u32 s25, s20, 4210688
buffer_load_dwordx4 v11, s[8:11], s25 offen lds
s_waitcnt lgkmcnt(12)
MM 0,32,40
RB 80,16,0
RB 84,16,4096
MM 16,32,44
RT 88,17,24576
RT 90,17,26624
MM 32,36,40
RT 92,18,24576
RT 94,18,26624
MM 48,36,44
s_add_u32 m0, s23, 100352
s_add_u32 s25, s20, 4227072
buffer_load_dwordx4 v10, s[8:11], s25 offen lds
s_add_u32 m0, s23, 101376
s_add_u32 s25, s20, 4243456
buffer_load_dwordx4 v11, s[8:11], s25 offen lds
s_waitcnt lgkmcnt(0) vmcnt(6)
s_barrier
MM 0,48,56
RB 32,19,0
RB 36,19,4096
MM 16,48,60
RT 40,23,0
RT 42,23,2048
MM 32,52,56
RT 44,24,0
RT 46,24,2048
MM 48,52,60
s_add_u32 m0, s22, 0
s_add_u32 s24, s19, 1152
buffer_load_dwordx4 v8, s[4:7], s24 offen lds
s_waitcnt lgkmcnt(12)
MM 0,64,72
RB 48,20,0
RB 52,20,4096
MM 16,64,76
RT 56,23,8192
RT 58,23,10240
MM 32,68,72
RT 60,24,8192
RT 62,24,10240
MM 48,68,76
s_add_u32 m0, s22, 1024
s_add_u32 s24, s19, 17536
buffer_load_dwordx4 v9, s[4:7], s24 offen lds
s_add_u32 m0, s23, 0
s_add_u32 s25, s20, 4718592
buffer_load_dwordx4 v10, s[8:11], s25 offen lds
s_waitcnt lgkmcnt(12)
MM 0,80,88
RB 64,21,0
RB 68,21,4096
MM 16,80,92
RT 72,23,16384
RT 74,23,18432
MM 32,84,88
RT 76,24,16384
RT 78,24,18432
MM 48,84,92
s_add_u32 m0, s23, 1024
s_add_u32 s25, s20, 4734976
buffer_load_dwordx4 v11, s[8:11], s25 offen lds
s_waitcnt lgkmcnt(12)
MM 0,32,40
RB 80,22,0
RB 84,22,4096
MM 16,32,44
RT 88,23,24576
RT 90,23,26624
MM 32,36,40
RT 92,24,24576
RT 94,24,26624
MM 48,36,44
s_add_u32 m0, s23, 2048
s_add_u32 s25, s20, 4751360
buffer_load_dwordx4 v10, s[8:11], s25 offen lds
s_add_u32 m0, s23, 3072
s_add_u32 s25, s20, 4767744
buffer_load_dwordx4 v11, s[8:11], s25 offen lds
s_waitcnt lgkmcnt(0) vmcnt(6)
s_barrier
MM 0,48,56
RB 32,25,0
RB 36,25,4096
MM 16,48,60
RT 40,29,0
RT 42,29,2048
MM 32,52,56
RT 44,30,0
RT 46,30,2048
MM 48,52,60
s_add_u32 m0, s22, 49152
s_add_u32 s24, s19, 1280
buffer_load_dwordx4 v8, s[4:7], s24 offen lds
s_waitcnt lgkmcnt(12)
MM 0,64,72
RB 48,26,0
RB 52,26,4096
MM 16,64,76
RT 56,29,8192
RT 58,29,10240
MM 32,68,72
RT 60,30,8192
RT 62,30,10240
MM 48,68,76
s_add_u32 m0, s22, 50176
s_add_u32 s24, s19, 17664
buffer_load_dwordx4 v9, s[4:7], s24 offen lds
s_add_u32 m0, s23, 49152
s_add_u32 s25, s20, 5242880
buffer_load_dwordx4 v10, s[8:11], s25 offen lds
s_waitcnt lgkmcnt(12)
MM 0,80,88
RB 64,27,0
RB 68,27,4096
MM 16,80,92
RT 72,29,16384
RT 74,29,18432
MM 32,84,88
RT 76,30,16384
RT 78,30,18432
MM 48,84,92
s_add_u32 m0, s23, 50176
s_add_u32 s25, s20, 5259264
buffer_load_dwordx4 v11, s[8:11], s25 offen lds
s_waitcnt lgkmcnt(12)
MM 0,32,40
RB 80,28,0
RB 84,28,4096
MM 16,32,44
RT 88,29,24576
RT 90,29,26624
MM 32,36,40
RT 92,30,24576
RT 94,30,26624
MM 48,36,44
s_add_u32 m0, s23, 51200
s_add_u32 s25, s20, 5275648
buffer_load_dwordx4 v10, s[8:11], s25 offen lds
s_add_u32 m0, s23, 52224
s_add_u32 s25, s20, 5292032
buffer_load_dwordx4 v11, s[8:11], s25 offen lds
s_waitcnt lgkmcnt(0) vmcnt(6)
s_barrier
MM 0,48,56
RB 32,13,0
RB 36,13,4096
MM 16,48,60
RT 40,17,0
RT 42,17,2048
MM 32,52,56
RT 44,18,0
RT 46,18,2048
MM 48,52,60
s_add_u32 m0, s22, 98304
s_add_u32 s24, s19, 1408
buffer_load_dwordx4 v8, s[4:7], s24 offen lds
s_waitcnt lgkmcnt(12)
MM 0,64,72
RB 48,14,0
RB 52,14,4096
MM 16,64,76
RT 56,17,8192
RT 58,17,10240
MM 32,68,72
RT 60,18,8192
RT 62,18,10240
MM 48,68,76
s_add_u32 m0, s22, 99328
s_add_u32 s24, s19, 17792
buffer_load_dwordx4 v9, s[4:7], s24 offen lds
s_add_u32 m0, s23, 98304
s_add_u32 s25, s20, 5767168
buffer_load_dwordx4 v10, s[8:11], s25 offen lds
s_waitcnt lgkmcnt(12)
MM 0,80,88
RB 64,15,0
RB 68,15,4096
MM 16,80,92
RT 72,17,16384
RT 74,17,18432
MM 32,84,88
RT 76,18,16384
RT 78,18,18432
MM 48,84,92
s_add_u32 m0, s23, 99328
s_add_u32 s25, s20, 5783552
buffer_load_dwordx4 v11, s[8:11], s25 offen lds
s_waitcnt lgkmcnt(12)
MM 0,32,40
RB 80,16,0
RB 84,16,4096
MM 16,32,44
RT 88,17,24576
RT 90,17,26624
MM 32,36,40
RT 92,18,24576
RT 94,18,26624
MM 48,36,44
s_add_u32 m0, s23, 100352
s_add_u32 s25, s20, 5799936
buffer_load_dwordx4 v10, s[8:11], s25 offen lds
s_add_u32 m0, s23, 101376
s_add_u32 s25, s20, 5816320
buffer_load_dwordx4 v11, s[8:11], s25 offen lds
s_waitcnt lgkmcnt(0) vmcnt(6)
s_barrier
MM 0,48,56
RB 32,19,0
RB 36,19,4096
MM 16,48,60
RT 40,23,0
RT 42,23,2048
MM 32,52,56
RT 44,24,0
RT 46,24,2048
MM 48,52,60
s_add_u32 m0, s22, 0
s_add_u32 s24, s19, 1536
buffer_load_dwordx4 v8, s[4:7], s24 offen lds
s_waitcnt lgkmcnt(12)
MM 0,64,72
RB 48,20,0
RB 52,20,4096
MM 16,64,76
RT 56,23,8192
RT 58,23,10240
MM 32,68,72
RT 60,24,8192
RT 62,24,10240
MM 48,68,76
s_add_u32 m0, s22, 1024
s_add_u32 s24, s19, 17920
buffer_load_dwordx4 v9, s[4:7], s24 offen lds
s_add_u32 m0, s23, 0
s_add_u32 s25, s20, 6291456
buffer_load_dwordx4 v10, s[8:11], s25 offen lds
s_waitcnt lgkmcnt(12)
MM 0,80,88
RB 64,21,0
RB 68,21,4096
MM 16,80,92
RT 72,23,16384
RT 74,23,18432
MM 32,84,88
RT 76,24,16384
RT 78,24,18432
MM 48,84,92
s_add_u32 m0, s23, 1024
s_add_u32 s25, s20, 6307840
buffer_load_dwordx4 v11, s[8:11], s25 offen lds
s_waitcnt lgkmcnt(12)
MM 0,32,40
RB 80,22,0
RB 84,22,4096
MM 16,32,44
RT 88,23,24576
RT 90,23,26624
MM 32,36,40
RT 92,24,24576
RT 94,24,26624
MM 48,36,44
s_add_u32 m0, s23, 2048
s_add_u32 s25, s20, 6324224
buffer_load_dwordx4 v10, s[8:11], s25 offen lds
s_add_u32 m0, s23, 3072
s_add_u32 s25, s20, 6340608
buffer_load_dwordx4 v11, s[8:11], s25 offen lds
s_waitcnt lgkmcnt(0) vmcnt(6)
s_barrier
MM 0,48,56
RB 32,25,0
RB 36,25,4096
MM 16,48,60
RT 40,29,0
RT 42,29,2048
MM 32,52,56
RT 44,30,0
RT 46,30,2048
MM 48,52,60
s_add_u32 m0, s22, 49152
s_add_u32 s24, s19, 1664
buffer_load_dwordx4 v8, s[4:7], s24 offen lds
s_waitcnt lgkmcnt(12)
MM 0,64,72
RB 48,26,0
RB 52,26,4096
MM 16,64,76
RT 56,29,8192
RT 58,29,10240
MM 32,68,72
RT 60,30,8192
RT 62,30,10240
MM 48,68,76
s_add_u32 m0, s22, 50176
s_add_u32 s24, s19, 18048
buffer_load_dwordx4 v9, s[4:7], s24 offen lds
s_add_u32 m0, s23, 49152
s_add_u32 s25, s20, 6815744
buffer_load_dwordx4 v10, s[8:11], s25 offen lds
s_waitcnt lgkmcnt(12)
MM 0,80,88
RB 64,27,0
RB 68,27,4096
MM 16,80,92
RT 72,29,16384
RT 74,29,18432
MM 32,84,88
RT 76,30,16384
RT 78,30,18432
MM 48,84,92
s_add_u32 m0, s23, 50176
s_add_u32 s25, s20, 6832128
buffer_load_dwordx4 v11, s[8:11], s25 offen lds
s_waitcnt lgkmcnt(12)
MM 0,32,40
RB 80,28,0
RB 84,28,4096
MM 16,32,44
RT 88,29,24576
RT 90,29,26624
MM 32,36,40
RT 92,30,24576
RT 94,30,26624
MM 48,36,44
s_add_u32 m0, s23, 51200
s_add_u32 s25, s20, 6848512
buffer_load_dwordx4 v10, s[8:11], s25 offen lds
s_add_u32 m0, s23, 52224
s_add_u32 s25, s20, 6864896
buffer_load_dwordx4 v11, s[8:11], s25 offen lds
s_waitcnt lgkmcnt(0) vmcnt(6)
s_barrier
MM 0,48,56
RB 32,13,0
RB 36,13,4096
MM 16,48,60
RT 40,17,0
RT 42,17,2048
MM 32,52,56
RT 44,18,0
RT 46,18,2048
MM 48,52,60
s_add_u32 m0, s22, 98304
s_add_u32 s24, s19, 1792
buffer_load_dwordx4 v8, s[4:7], s24 offen lds
s_waitcnt lgkmcnt(12)
MM 0,64,72
RB 48,14,0
RB 52,14,4096
MM 16,64,76
RT 56,17,8192
RT 58,17,10240
MM 32,68,72
RT 60,18,8192
RT 62,18,10240
MM 48,68,76
s_add_u32 m0, s22, 99328
s_add_u32 s24, s19, 18176
buffer_load_dwordx4 v9, s[4:7], s24 offen lds
s_add_u32 m0, s23, 98304
s_add_u32 s25, s20, 7340032
buffer_load_dwordx4 v10, s[8:11], s25 offen lds
s_waitcnt lgkmcnt(12)
MM 0,80,88
RB 64,15,0
RB 68,15,4096
MM 16,80,92
RT 72,17,16384
RT 74,17,18432
MM 32,84,88
RT 76,18,16384
RT 78,18,18432
MM 48,84,92
s_add_u32 m0, s23, 99328
s_add_u32 s25, s20, 7356416
buffer_load_dwordx4 v11, s[8:11], s25 offen lds
s_waitcnt lgkmcnt(12)
MM 0,32,40
RB 80,16,0
RB 84,16,4096
MM 16,32,44
RT 88,17,24576
RT 90,17,26624
MM 32,36,40
RT 92,18,24576
RT 94,18,26624
MM 48,36,44
s_add_u32 m0, s23, 100352
s_add_u32 s25, s20, 7372800
buffer_load_dwordx4 v10, s[8:11], s25 offen lds
s_add_u32 m0, s23, 101376
s_add_u32 s25, s20, 7389184
buffer_load_dwordx4 v11, s[8:11], s25 offen lds
s_waitcnt lgkmcnt(0) vmcnt(6)
s_barrier
MM 0,48,56
RB 32,19,0
RB 36,19,4096
MM 16,48,60
RT 40,23,0
RT 42,23,2048
MM 32,52,56
RT 44,24,0
RT 46,24,2048
MM 48,52,60
s_add_u32 m0, s22, 0
s_add_u32 s24, s19, 1920
buffer_load_dwordx4 v8, s[4:7], s24 offen lds
s_waitcnt lgkmcnt(12)
MM 0,64,72
RB 48,20,0
RB 52,20,4096
MM 16,64,76
RT 56,23,8192
RT 58,23,10240
MM 32,68,72
RT 60,24,8192
RT 62,24,10240
MM 48,68,76
s_add_u32 m0, s22, 1024
s_add_u32 s24, s19, 18304
buffer_load_dwordx4 v9, s[4:7], s24 offen lds
s_add_u32 m0, s23, 0
s_add_u32 s25, s20, 7864320
buffer_load_dwordx4 v10, s[8:11], s25 offen lds
s_waitcnt lgkmcnt(12)
MM 0,80,88
RB 64,21,0
RB 68,21,4096
MM 16,80,92
RT 72,23,16384
RT 74,23,18432
MM 32,84,88
RT 76,24,16384
RT 78,24,18432
MM 48,84,92
s_add_u32 m0, s23, 1024
s_add_u32 s25, s20, 7880704
buffer_load_dwordx4 v11, s[8:11], s25 offen lds
s_waitcnt lgkmcnt(12)
MM 0,32,40
RB 80,22,0
RB 84,22,4096
MM 16,32,44
RT 88,23,24576
RT 90,23,26624
MM 32,36,40
RT 92,24,24576
RT 94,24,26624
MM 48,36,44
s_add_u32 m0, s23, 2048
s_add_u32 s25, s20, 7897088
buffer_load_dwordx4 v10, s[8:11], s25 offen lds
s_add_u32 m0, s23, 3072
s_add_u32 s25, s20, 7913472
buffer_load_dwordx4 v11, s[8:11], s25 offen lds
s_waitcnt lgkmcnt(0) vmcnt(6)
s_barrier
MM 0,48,56
RB 32,25,0
RB 36,25,4096
MM 16,48,60
RT 40,29,0
MM 32,52,56
RT 42,29,2048
RT 44,30,0
MM 48,52,60
RT 46,30,2048
s_waitcnt lgkmcnt(12)
MM 0,64,72
RB 48,26,0
RB 52,26,4096
MM 16,64,76
RT 56,29,8192
MM 32,68,72
RT 58,29,10240
RT 60,30,8192
MM 48,68,76
RT 62,30,10240
s_waitcnt lgkmcnt(12)
MM 0,80,88
RB 64,27,0
RB 68,27,4096
MM 16,80,92
RT 72,29,16384
MM 32,84,88
RT 74,29,18432
RT 76,30,16384
MM 48,84,92
RT 78,30,18432
s_waitcnt lgkmcnt(12)
MM 0,32,40
RB 80,28,0
RB 84,28,4096
MM 16,32,44
RT 88,29,24576
MM 32,36,40
RT 90,29,26624
RT 92,30,24576
MM 48,36,44
RT 94,30,26624
s_waitcnt lgkmcnt(0) vmcnt(0)
s_barrier
MM 0,48,56
RB 32,13,0
RB 36,13,4096
MM 16,48,60
RT 40,17,0
MM 32,52,56
RT 42,17,2048
RT 44,18,0
MM 48,52,60
RT 46,18,2048
s_waitcnt lgkmcnt(12)
MM 0,64,72
RB 48,14,0
RB 52,14,4096
MM 16,64,76
RT 56,17,8192
MM 32,68,72
RT 58,17,10240
RT 60,18,8192
MM 48,68,76
RT 62,18,10240
s_waitcnt lgkmcnt(12)
MM 0,80,88
RB 64,15,0
RB 68,15,4096
MM 16,80,92
RT 72,17,16384
MM 32,84,88
RT 74,17,18432
RT 76,18,16384
MM 48,84,92
RT 78,18,18432
s_waitcnt lgkmcnt(12)
MM 0,32,40
RB 80,16,0
RB 84,16,4096
MM 16,32,44
RT 88,17,24576
MM 32,36,40
RT 90,17,26624
RT 92,18,24576
MM 48,36,44
RT 94,18,26624
s_waitcnt lgkmcnt(0)
MM 0,48,56
MM 16,48,60
MM 32,52,56
MM 48,52,60
s_waitcnt lgkmcnt(0)
MM 0,64,72
MM 16,64,76
MM 32,68,72
MM 48,68,76
s_waitcnt lgkmcnt(0)
MM 0,80,88
MM 16,80,92
MM 32,84,88
MM 48,84,92
s_barrier
s_cmp_lg_u32 s16, 0
s_cbranch_scc1 tt_39
v_mov_b32 v7, s56
v_accvgpr_write_b32 a127, 1
s_mov_b64 exec, 1
buffer_atomic_add a127, v7, s[4:7], 0 offen sc0
s_mov_b64 exec, -1
tt_39:
v_and_b32 v1, 31, v0
v_lshrrev_b32 v2, 5, v0
v_lshrrev_b32 v3, 4, v1
v_lshlrev_b32 v3, 10, v3
v_and_b32 v4, 15, v1
v_lshl_add_u32 v3, v4, 4, v3
v_lshl_add_u32 v12, v2, 8, v3
s_mul_i32 s24, s17, 524288
s_mul_i32 s25, s18, 64
s_lshr_b32 s26, s25, 7
s_lshl_b32 s26, s26, 13
s_and_b32 s25, s25, 127
s_lshl_b32 s25, s25, 6
s_add_u32 s24, s24, s25
s_add_u32 s24, s24, s26
s_add_u32 s33, s33, s24
v_accvgpr_read_b32 v32, a0
v_accvgpr_read_b32 v33, a1
v_accvgpr_read_b32 v34, a2
v_accvgpr_read_b32 v35, a3
v_accvgpr_read_b32 v36, a4
v_accvgpr_read_b32 v37, a5
v_accvgpr_read_b32 v38, a6
v_accvgpr_read_b32 v39, a7
v_accvgpr_read_b32 v40, a8
v_accvgpr_read_b32 v41, a9
v_accvgpr_read_b32 v42, a10
v_accvgpr_read_b32 v43, a11
v_accvgpr_read_b32 v44, a12
v_accvgpr_read_b32 v45, a13
v_accvgpr_read_b32 v46, a14
v_accvgpr_read_b32 v47, a15
v_cvt_pk_bf16_f32 v48, v32, v33
v_cvt_pk_bf16_f32 v49, v34, v35
v_cvt_pk_bf16_f32 v50, v40, v41
v_cvt_pk_bf16_f32 v51, v42, v43
v_cvt_pk_bf16_f32 v52, v36, v37
v_cvt_pk_bf16_f32 v53, v38, v39
v_cvt_pk_bf16_f32 v54, v44, v45
v_cvt_pk_bf16_f32 v55, v46, v47
s_add_u32 s24, s33, 0
buffer_store_dwordx4 v[48:51], v12, s[4:7], s24 offen sc1
s_add_u32 s24, s33, 512
buffer_store_dwordx4 v[52:55], v12, s[4:7], s24 offen sc1
s_nop 1
v_accvgpr_read_b32 v32, a16
v_accvgpr_read_b32 v33, a17
v_accvgpr_read_b32 v34, a18
v_accvgpr_read_b32 v35, a19
v_accvgpr_read_b32 v36, a20
v_accvgpr_read_b32 v37, a21
v_accvgpr_read_b32 v38, a22
v_accvgpr_read_b32 v39, a23
v_accvgpr_read_b32 v40, a24
v_accvgpr_read_b32 v41, a25
v_accvgpr_read_b32 v42, a26
v_accvgpr_read_b32 v43, a27
v_accvgpr_read_b32 v44, a28
v_accvgpr_read_b32 v45, a29
v_accvgpr_read_b32 v46, a30
v_accvgpr_read_b32 v47, a31
v_cvt_pk_bf16_f32 v48, v32, v33
v_cvt_pk_bf16_f32 v49, v34, v35
v_cvt_pk_bf16_f32 v50, v40, v41
v_cvt_pk_bf16_f32 v51, v42, v43
v_cvt_pk_bf16_f32 v52, v36, v37
v_cvt_pk_bf16_f32 v53, v38, v39
v_cvt_pk_bf16_f32 v54, v44, v45
v_cvt_pk_bf16_f32 v55, v46, v47
s_add_u32 s24, s33, 2048
buffer_store_dwordx4 v[48:51], v12, s[4:7], s24 offen sc1
s_add_u32 s24, s33, 2560
buffer_store_dwordx4 v[52:55], v12, s[4:7], s24 offen sc1
s_nop 1
v_accvgpr_read_b32 v32, a32
v_accvgpr_read_b32 v33, a33
v_accvgpr_read_b32 v34, a34
v_accvgpr_read_b32 v35, a35
v_accvgpr_read_b32 v36, a36
v_accvgpr_read_b32 v37, a37
v_accvgpr_read_b32 v38, a38
v_accvgpr_read_b32 v39, a39
v_accvgpr_read_b32 v40, a40
v_accvgpr_read_b32 v41, a41
v_accvgpr_read_b32 v42, a42
v_accvgpr_read_b32 v43, a43
v_accvgpr_read_b32 v44, a44
v_accvgpr_read_b32 v45, a45
v_accvgpr_read_b32 v46, a46
v_accvgpr_read_b32 v47, a47
v_cvt_pk_bf16_f32 v48, v32, v33
v_cvt_pk_bf16_f32 v49, v34, v35
v_cvt_pk_bf16_f32 v50, v40, v41
v_cvt_pk_bf16_f32 v51, v42, v43
v_cvt_pk_bf16_f32 v52, v36, v37
v_cvt_pk_bf16_f32 v53, v38, v39
v_cvt_pk_bf16_f32 v54, v44, v45
v_cvt_pk_bf16_f32 v55, v46, v47
s_add_u32 s24, s33, 262144
buffer_store_dwordx4 v[48:51], v12, s[4:7], s24 offen sc1
s_add_u32 s24, s33, 262656
buffer_store_dwordx4 v[52:55], v12, s[4:7], s24 offen sc1
s_nop 1
v_accvgpr_read_b32 v32, a48
v_accvgpr_read_b32 v33, a49
v_accvgpr_read_b32 v34, a50
v_accvgpr_read_b32 v35, a51
v_accvgpr_read_b32 v36, a52
v_accvgpr_read_b32 v37, a53
v_accvgpr_read_b32 v38, a54
v_accvgpr_read_b32 v39, a55
v_accvgpr_read_b32 v40, a56
v_accvgpr_read_b32 v41, a57
v_accvgpr_read_b32 v42, a58
v_accvgpr_read_b32 v43, a59
v_accvgpr_read_b32 v44, a60
v_accvgpr_read_b32 v45, a61
v_accvgpr_read_b32 v46, a62
v_accvgpr_read_b32 v47, a63
v_cvt_pk_bf16_f32 v48, v32, v33
v_cvt_pk_bf16_f32 v49, v34, v35
v_cvt_pk_bf16_f32 v50, v40, v41
v_cvt_pk_bf16_f32 v51, v42, v43
v_cvt_pk_bf16_f32 v52, v36, v37
v_cvt_pk_bf16_f32 v53, v38, v39
v_cvt_pk_bf16_f32 v54, v44, v45
v_cvt_pk_bf16_f32 v55, v46, v47
s_add_u32 s24, s33, 264192
buffer_store_dwordx4 v[48:51], v12, s[4:7], s24 offen sc1
s_add_u32 s24, s33, 264704
buffer_store_dwordx4 v[52:55], v12, s[4:7], s24 offen sc1
s_nop 1
p1s_37:
s_cmp_eq_u32 s74, 0
s_cbranch_scc1 sq_40
s_waitcnt vmcnt(0)
s_barrier
s_cmp_lg_u32 s16, 0
s_cbranch_scc1 sig_42
v_mov_b32 v1, s76
v_mov_b32 v2, 4
s_mov_b64 exec, 1
buffer_atomic_add v2, v1, s[4:7], 0 offen
s_mov_b64 exec, -1
sig_42:
s_branch sqe_41
sq_40:
s_waitcnt vmcnt(0)
s_barrier
s_cmp_lg_u32 s16, 0
s_cbranch_scc1 sig_43
v_mov_b32 v1, s76
v_mov_b32 v2, 1
s_mov_b64 exec, 1
buffer_atomic_add v2, v1, s[4:7], 0 offen
s_mov_b64 exec, -1
sig_43:
sqe_41:
s_branch mega_kernel_wloop
mega_kernel_t16:
s_lshr_b32 s74, s79, 3
s_add_u32 s74, s74, 1
s_lshr_b32 s17, s16, 1
s_and_b32 s18, s16, 1
v_lshrrev_b32 v1, 3, v0
s_mov_b32 s24, 2048
v_mul_lo_u32 v1, v1, s24
v_lshrrev_b32 v2, 4, v0
v_and_b32 v3, 7, v0
s_mov_b32 s25, 0
s_xor_b32 s26, s25, 0
v_add_u32 v4, s26, v2
v_xor_b32 v4, v4, v3
v_lshl_add_u32 v8, v4, 4, v1
s_xor_b32 s26, s25, 4
v_add_u32 v4, s26, v2
v_xor_b32 v4, v4, v3
v_lshl_add_u32 v9, v4, 4, v1
v_lshrrev_b32 v1, 3, v0
v_and_b32 v3, 7, v0
s_mov_b32 s24, 8192
v_mul_lo_u32 v2, v1, s24
v_bfe_u32 v4, v1, 1, 1
v_lshlrev_b32 v4, 2, v4
v_xor_b32 v4, v4, v3
v_lshl_add_u32 v10, v4, 4, v2
v_bfe_u32 v4, v1, 1, 1
v_lshlrev_b32 v4, 2, v4
v_xor_b32 v4, v4, v3
v_lshl_add_u32 v11, v4, 4, v2
v_and_b32 v1, 31, v0
v_lshrrev_b32 v2, 5, v0
v_bfe_u32 v3, v1, 1, 3
s_mul_i32 s24, s17, 4096
v_lshlrev_b32 v4, 7, v1
v_add_u32 v4, s24, v4
v_add_u32 v5, 0, v2
v_xor_b32 v5, v5, v3
v_lshl_add_u32 v13, v5, 4, v4
v_add_u32 v5, 2, v2
v_xor_b32 v5, v5, v3
v_lshl_add_u32 v14, v5, 4, v4
v_add_u32 v5, 4, v2
v_xor_b32 v5, v5, v3
v_lshl_add_u32 v15, v5, 4, v4
v_add_u32 v5, 6, v2
v_xor_b32 v5, v5, v3
v_lshl_add_u32 v16, v5, 4, v4
v_and_b32 v1, 15, v0
v_lshrrev_b32 v2, 2, v1
v_lshrrev_b32 v3, 5, v0
v_lshl_add_u32 v3, v3, 3, v2
v_mul_u32_u24 v3, 128, v3
v_and_b32 v4, 3, v1
v_lshl_add_u32 v3, v4, 3, v3
v_bfe_u32 v4, v0, 4, 1
v_lshl_add_u32 v3, v4, 5, v3
v_add_u32 v3, 16384, v3
s_mul_i32 s24, s18, 1
s_add_u32 s24, s24, 0
v_bfe_u32 v4, v2, 1, 1
v_xor_b32 v4, s24, v4
v_lshl_add_u32 v17, v4, 6, v3
v_add_u32 v18, 49152, v13
v_add_u32 v19, 49152, v14
v_add_u32 v20, 49152, v15
v_add_u32 v21, 49152, v16
v_add_u32 v22, 49152, v17
v_add_u32 v23, 98304, v13
v_add_u32 v24, 98304, v14
v_add_u32 v25, 98304, v15
v_add_u32 v26, 98304, v16
v_add_u32 v27, 98304, v17
s_mul_i32 s22, s16, 2048
s_mul_i32 s23, s16, 1024
s_add_u32 s23, s23, 16384
s_mov_b64 s[36:37], s[66:67]
s_cmp_eq_u32 s74, 2
s_cselect_b32 s36, s68, s36
s_cselect_b32 s37, s69, s37
s_mov_b32 s8, s36
s_and_b32 s9, s37, 0xffff
s_mov_b32 s10, 0x800000
s_mov_b32 s11, 0x00020000
s_lshl_b32 s28, s77, 7
s_lshl_b32 s29, s60, 9
s_and_b32 s24, s79, 7
s_lshl_b32 s24, s24, 6
s_add_u32 s29, s29, s24
s_mul_i32 s24, s16, 16
s_add_u32 s24, s24, s28
s_mul_i32 s19, s24, 2048
s_add_u32 s19, s19, 2097152
s_mul_i32 s20, s16, 65536
s_lshl_b32 s24, s29, 1
s_add_u32 s20, s20, s24
s_mov_b32 s33, 23068672
s_cmp_eq_u32 s74, 2
s_cselect_b32 s33, 39845888, s33
s_lshl_b32 s24, s28, 13
s_add_u32 s33, s33, s24
s_lshr_b32 s24, s29, 7
s_lshl_b32 s24, s24, 13
s_add_u32 s33, s33, s24
s_and_b32 s24, s29, 127
s_lshl_b32 s76, s60, 4
s_add_u32 s76, s76, s77
s_lshl_b32 s76, s76, 7
s_add_u32 s76, s76, 8192
s_cmp_eq_u32 s74, 2
s_cbranch_scc1 vtf_44
s_lshl_b32 s24, s24, 5
s_add_u32 s33, s33, s24
s_add_u32 m0, s22, 0
s_add_u32 s24, s19, 0
buffer_load_dwordx4 v8, s[4:7], s24 offen lds
s_add_u32 m0, s22, 1024
s_add_u32 s24, s19, 16384
buffer_load_dwordx4 v9, s[4:7], s24 offen lds
s_add_u32 m0, s23, 0
s_add_u32 s25, s20, 0
buffer_load_dwordx4 v10, s[8:11], s25 offen lds
s_add_u32 m0, s22, 24576
s_add_u32 s24, s19, 128
buffer_load_dwordx4 v8, s[4:7], s24 offen lds
s_add_u32 m0, s22, 25600
s_add_u32 s24, s19, 16512
buffer_load_dwordx4 v9, s[4:7], s24 offen lds
s_add_u32 m0, s23, 24576
s_add_u32 s25, s20, 524288
buffer_load_dwordx4 v10, s[8:11], s25 offen lds
v_accvgpr_write_b32 a0, 0
v_accvgpr_write_b32 a1, 0
v_accvgpr_write_b32 a2, 0
v_accvgpr_write_b32 a3, 0
v_accvgpr_write_b32 a4, 0
v_accvgpr_write_b32 a5, 0
v_accvgpr_write_b32 a6, 0
v_accvgpr_write_b32 a7, 0
v_accvgpr_write_b32 a8, 0
v_accvgpr_write_b32 a9, 0
v_accvgpr_write_b32 a10, 0
v_accvgpr_write_b32 a11, 0
v_accvgpr_write_b32 a12, 0
v_accvgpr_write_b32 a13, 0
v_accvgpr_write_b32 a14, 0
v_accvgpr_write_b32 a15, 0
s_waitcnt vmcnt(3)
s_barrier
RB 32,13,0
RT 36,17,0
RT 38,17,512
RB 40,14,0
RT 44,17,2048
RT 46,17,2560
RB 48,15,0
RT 52,17,4096
RT 54,17,4608
s_waitcnt lgkmcnt(6)
MM 0,36,32
RB 56,16,0
RT 60,17,6144
RT 62,17,6656
s_add_u32 m0, s22, 49152
s_add_u32 s24, s19, 256
buffer_load_dwordx4 v8, s[4:7], s24 offen lds
s_add_u32 m0, s22, 50176
s_add_u32 s24, s19, 16640
buffer_load_dwordx4 v9, s[4:7], s24 offen lds
s_add_u32 m0, s23, 49152
s_add_u32 s25, s20, 1048576
buffer_load_dwordx4 v10, s[8:11], s25 offen lds
s_waitcnt lgkmcnt(6) vmcnt(3)
s_barrier
MM 0,44,40
RB 32,13,24576
RT 36,17,24576
RT 38,17,25088
s_add_u32 m0, s22, 73728
s_add_u32 s24, s19, 384
buffer_load_dwordx4 v8, s[4:7], s24 offen lds
s_waitcnt lgkmcnt(6)
MM 0,52,48
RB 40,14,24576
RT 44,17,26624
RT 46,17,27136
s_add_u32 m0, s22, 74752
s_add_u32 s24, s19, 16768
buffer_load_dwordx4 v9, s[4:7], s24 offen lds
s_add_u32 m0, s23, 73728
s_add_u32 s25, s20, 1572864
buffer_load_dwordx4 v10, s[8:11], s25 offen lds
s_waitcnt lgkmcnt(6)
MM 0,60,56
RB 48,15,24576
RT 52,17,28672
RT 54,17,29184
s_add_u32 m0, s22, 98304
s_add_u32 s24, s19, 512
buffer_load_dwordx4 v8, s[4:7], s24 offen lds
s_waitcnt lgkmcnt(6)
MM 0,36,32
RB 56,16,24576
RT 60,17,30720
RT 62,17,31232
s_add_u32 m0, s22, 99328
s_add_u32 s24, s19, 16896
buffer_load_dwordx4 v9, s[4:7], s24 offen lds
s_add_u32 m0, s23, 98304
s_add_u32 s25, s20, 2097152
buffer_load_dwordx4 v10, s[8:11], s25 offen lds
s_waitcnt lgkmcnt(6) vmcnt(6)
s_barrier
MM 0,44,40
RB 32,18,0
RT 36,22,0
RT 38,22,512
s_add_u32 m0, s22, 122880
s_add_u32 s24, s19, 640
buffer_load_dwordx4 v8, s[4:7], s24 offen lds
s_waitcnt lgkmcnt(6)
MM 0,52,48
RB 40,19,0
RT 44,22,2048
RT 46,22,2560
s_add_u32 m0, s22, 123904
s_add_u32 s24, s19, 17024
buffer_load_dwordx4 v9, s[4:7], s24 offen lds
s_add_u32 m0, s23, 122880
s_add_u32 s25, s20, 2621440
buffer_load_dwordx4 v10, s[8:11], s25 offen lds
s_waitcnt lgkmcnt(6)
MM 0,60,56
RB 48,20,0
RT 52,22,4096
RT 54,22,4608
s_add_u32 m0, s22, 0
s_add_u32 s24, s19, 768
buffer_load_dwordx4 v8, s[4:7], s24 offen lds
s_waitcnt lgkmcnt(6)
MM 0,36,32
RB 56,21,0
RT 60,22,6144
RT 62,22,6656
s_add_u32 m0, s22, 1024
s_add_u32 s24, s19, 17152
buffer_load_dwordx4 v9, s[4:7], s24 offen lds
s_add_u32 m0, s23, 0
s_add_u32 s25, s20, 3145728
buffer_load_dwordx4 v10, s[8:11], s25 offen lds
s_waitcnt lgkmcnt(6) vmcnt(9)
s_barrier
MM 0,44,40
RB 32,18,24576
RT 36,22,24576
RT 38,22,25088
s_waitcnt lgkmcnt(6)
MM 0,52,48
RB 40,19,24576
RT 44,22,26624
RT 46,22,27136
s_add_u32 m0, s22, 24576
s_add_u32 s24, s19, 896
buffer_load_dwordx4 v8, s[4:7], s24 offen lds
s_waitcnt lgkmcnt(6)
MM 0,60,56
RB 48,20,24576
RT 52,22,28672
RT 54,22,29184
s_add_u32 m0, s22, 25600
s_add_u32 s24, s19, 17280
buffer_load_dwordx4 v9, s[4:7], s24 offen lds
s_waitcnt lgkmcnt(6)
MM 0,36,32
RB 56,21,24576
RT 60,22,30720
RT 62,22,31232
s_add_u32 m0, s23, 24576
s_add_u32 s25, s20, 3670016
buffer_load_dwordx4 v10, s[8:11], s25 offen lds
s_waitcnt lgkmcnt(6) vmcnt(9)
s_barrier
MM 0,44,40
RB 32,23,0
RT 36,27,0
RT 38,27,512
s_waitcnt lgkmcnt(6)
MM 0,52,48
RB 40,24,0
RT 44,27,2048
RT 46,27,2560
s_add_u32 m0, s22, 49152
s_add_u32 s24, s19, 1024
buffer_load_dwordx4 v8, s[4:7], s24 offen lds
s_waitcnt lgkmcnt(6)
MM 0,60,56
RB 48,25,0
RT 52,27,4096
RT 54,27,4608
s_add_u32 m0, s22, 50176
s_add_u32 s24, s19, 17408
buffer_load_dwordx4 v9, s[4:7], s24 offen lds
s_waitcnt lgkmcnt(6)
MM 0,36,32
RB 56,26,0
RT 60,27,6144
RT 62,27,6656
s_add_u32 m0, s23, 49152
s_add_u32 s25, s20, 4194304
buffer_load_dwordx4 v10, s[8:11], s25 offen lds
s_waitcnt lgkmcnt(6) vmcnt(9)
s_barrier
MM 0,44,40
RB 32,23,24576
RT 36,27,24576
RT 38,27,25088
s_waitcnt lgkmcnt(6)
MM 0,52,48
RB 40,24,24576
RT 44,27,26624
RT 46,27,27136
s_add_u32 m0, s22, 73728
s_add_u32 s24, s19, 1152
buffer_load_dwordx4 v8, s[4:7], s24 offen lds
s_waitcnt lgkmcnt(6)
MM 0,60,56
RB 48,25,24576
RT 52,27,28672
RT 54,27,29184
s_add_u32 m0, s22, 74752
s_add_u32 s24, s19, 17536
buffer_load_dwordx4 v9, s[4:7], s24 offen lds
s_waitcnt lgkmcnt(6)
MM 0,36,32
RB 56,26,24576
RT 60,27,30720
RT 62,27,31232
s_add_u32 m0, s23, 73728
s_add_u32 s25, s20, 4718592
buffer_load_dwordx4 v10, s[8:11], s25 offen lds
s_waitcnt lgkmcnt(6) vmcnt(9)
s_barrier
MM 0,44,40
RB 32,13,0
RT 36,17,0
RT 38,17,512
s_waitcnt lgkmcnt(6)
MM 0,52,48
RB 40,14,0
RT 44,17,2048
RT 46,17,2560
s_add_u32 m0, s22, 98304
s_add_u32 s24, s19, 1280
buffer_load_dwordx4 v8, s[4:7], s24 offen lds
s_waitcnt lgkmcnt(6)
MM 0,60,56
RB 48,15,0
RT 52,17,4096
RT 54,17,4608
s_add_u32 m0, s22, 99328
s_add_u32 s24, s19, 17664
buffer_load_dwordx4 v9, s[4:7], s24 offen lds
s_waitcnt lgkmcnt(6)
MM 0,36,32
RB 56,16,0
RT 60,17,6144
RT 62,17,6656
s_add_u32 m0, s23, 98304
s_add_u32 s25, s20, 5242880
buffer_load_dwordx4 v10, s[8:11], s25 offen lds
s_waitcnt lgkmcnt(6) vmcnt(9)
s_barrier
MM 0,44,40
RB 32,13,24576
RT 36,17,24576
RT 38,17,25088
s_waitcnt lgkmcnt(6)
MM 0,52,48
RB 40,14,24576
RT 44,17,26624
RT 46,17,27136
s_add_u32 m0, s22, 122880
s_add_u32 s24, s19, 1408
buffer_load_dwordx4 v8, s[4:7], s24 offen lds
s_waitcnt lgkmcnt(6)
MM 0,60,56
RB 48,15,24576
RT 52,17,28672
RT 54,17,29184
s_add_u32 m0, s22, 123904
s_add_u32 s24, s19, 17792
buffer_load_dwordx4 v9, s[4:7], s24 offen lds
s_waitcnt lgkmcnt(6)
MM 0,36,32
RB 56,16,24576
RT 60,17,30720
RT 62,17,31232
s_add_u32 m0, s23, 122880
s_add_u32 s25, s20, 5767168
buffer_load_dwordx4 v10, s[8:11], s25 offen lds
s_waitcnt lgkmcnt(6) vmcnt(9)
s_barrier
MM 0,44,40
RB 32,18,0
RT 36,22,0
RT 38,22,512
s_waitcnt lgkmcnt(6)
MM 0,52,48
RB 40,19,0
RT 44,22,2048
RT 46,22,2560
s_add_u32 m0, s22, 0
s_add_u32 s24, s19, 1536
buffer_load_dwordx4 v8, s[4:7], s24 offen lds
s_waitcnt lgkmcnt(6)
MM 0,60,56
RB 48,20,0
RT 52,22,4096
RT 54,22,4608
s_add_u32 m0, s22, 1024
s_add_u32 s24, s19, 17920
buffer_load_dwordx4 v9, s[4:7], s24 offen lds
s_waitcnt lgkmcnt(6)
MM 0,36,32
RB 56,21,0
RT 60,22,6144
RT 62,22,6656
s_add_u32 m0, s23, 0
s_add_u32 s25, s20, 6291456
buffer_load_dwordx4 v10, s[8:11], s25 offen lds
s_waitcnt lgkmcnt(6) vmcnt(9)
s_barrier
MM 0,44,40
RB 32,18,24576
RT 36,22,24576
RT 38,22,25088
s_waitcnt lgkmcnt(6)
MM 0,52,48
RB 40,19,24576
RT 44,22,26624
RT 46,22,27136
s_add_u32 m0, s22, 24576
s_add_u32 s24, s19, 1664
buffer_load_dwordx4 v8, s[4:7], s24 offen lds
s_waitcnt lgkmcnt(6)
MM 0,60,56
RB 48,20,24576
RT 52,22,28672
RT 54,22,29184
s_add_u32 m0, s22, 25600
s_add_u32 s24, s19, 18048
buffer_load_dwordx4 v9, s[4:7], s24 offen lds
s_waitcnt lgkmcnt(6)
MM 0,36,32
RB 56,21,24576
RT 60,22,30720
RT 62,22,31232
s_add_u32 m0, s23, 24576
s_add_u32 s25, s20, 6815744
buffer_load_dwordx4 v10, s[8:11], s25 offen lds
s_waitcnt lgkmcnt(6) vmcnt(9)
s_barrier
MM 0,44,40
RB 32,23,0
RT 36,27,0
RT 38,27,512
s_waitcnt lgkmcnt(6)
MM 0,52,48
RB 40,24,0
RT 44,27,2048
RT 46,27,2560
s_add_u32 m0, s22, 49152
s_add_u32 s24, s19, 1792
buffer_load_dwordx4 v8, s[4:7], s24 offen lds
s_waitcnt lgkmcnt(6)
MM 0,60,56
RB 48,25,0
RT 52,27,4096
RT 54,27,4608
s_add_u32 m0, s22, 50176
s_add_u32 s24, s19, 18176
buffer_load_dwordx4 v9, s[4:7], s24 offen lds
s_waitcnt lgkmcnt(6)
MM 0,36,32
RB 56,26,0
RT 60,27,6144
RT 62,27,6656
s_add_u32 m0, s23, 49152
s_add_u32 s25, s20, 7340032
buffer_load_dwordx4 v10, s[8:11], s25 offen lds
s_waitcnt lgkmcnt(6) vmcnt(9)
s_barrier
MM 0,44,40
RB 32,23,24576
RT 36,27,24576
RT 38,27,25088
s_waitcnt lgkmcnt(6)
MM 0,52,48
RB 40,24,24576
RT 44,27,26624
RT 46,27,27136
s_add_u32 m0, s22, 73728
s_add_u32 s24, s19, 1920
buffer_load_dwordx4 v8, s[4:7], s24 offen lds
s_waitcnt lgkmcnt(6)
MM 0,60,56
RB 48,25,24576
RT 52,27,28672
RT 54,27,29184
s_add_u32 m0, s22, 74752
s_add_u32 s24, s19, 18304
buffer_load_dwordx4 v9, s[4:7], s24 offen lds
s_waitcnt lgkmcnt(6)
MM 0,36,32
RB 56,26,24576
RT 60,27,30720
RT 62,27,31232
s_add_u32 m0, s23, 73728
s_add_u32 s25, s20, 7864320
buffer_load_dwordx4 v10, s[8:11], s25 offen lds
s_waitcnt lgkmcnt(6) vmcnt(9)
s_barrier
MM 0,44,40
RB 32,13,0
RT 36,17,0
RT 38,17,512
s_waitcnt lgkmcnt(6)
MM 0,52,48
RB 40,14,0
RT 44,17,2048
RT 46,17,2560
s_waitcnt lgkmcnt(6)
MM 0,60,56
RB 48,15,0
RT 52,17,4096
RT 54,17,4608
s_waitcnt lgkmcnt(6)
MM 0,36,32
RB 56,16,0
RT 60,17,6144
RT 62,17,6656
s_waitcnt lgkmcnt(6) vmcnt(6)
s_barrier
MM 0,44,40
RB 32,13,24576
RT 36,17,24576
RT 38,17,25088
s_waitcnt lgkmcnt(6)
MM 0,52,48
RB 40,14,24576
RT 44,17,26624
RT 46,17,27136
s_waitcnt lgkmcnt(6)
MM 0,60,56
RB 48,15,24576
RT 52,17,28672
RT 54,17,29184
s_waitcnt lgkmcnt(6)
MM 0,36,32
RB 56,16,24576
RT 60,17,30720
RT 62,17,31232
s_waitcnt lgkmcnt(6) vmcnt(3)
s_barrier
MM 0,44,40
RB 32,18,0
RT 36,22,0
RT 38,22,512
s_waitcnt lgkmcnt(6)
MM 0,52,48
RB 40,19,0
RT 44,22,2048
RT 46,22,2560
s_waitcnt lgkmcnt(6)
MM 0,60,56
RB 48,20,0
RT 52,22,4096
RT 54,22,4608
s_waitcnt lgkmcnt(6)
MM 0,36,32
RB 56,21,0
RT 60,22,6144
RT 62,22,6656
s_waitcnt lgkmcnt(6) vmcnt(0)
s_barrier
MM 0,44,40
RB 32,18,24576
RT 36,22,24576
RT 38,22,25088
s_waitcnt lgkmcnt(6)
MM 0,52,48
RB 40,19,24576
RT 44,22,26624
RT 46,22,27136
s_waitcnt lgkmcnt(6)
MM 0,60,56
RB 48,20,24576
RT 52,22,28672
RT 54,22,29184
s_waitcnt lgkmcnt(6)
MM 0,36,32
RB 56,21,24576
RT 60,22,30720
RT 62,22,31232
s_waitcnt lgkmcnt(0)
MM 0,44,40
s_waitcnt lgkmcnt(0)
MM 0,52,48
s_waitcnt lgkmcnt(0)
MM 0,60,56
s_barrier
s_cmp_lg_u32 s16, 0
s_cbranch_scc1 tt_46
v_mov_b32 v7, s56
v_accvgpr_write_b32 a127, 1
s_mov_b64 exec, 1
buffer_atomic_add a127, v7, s[4:7], 0 offen sc0
s_mov_b64 exec, -1
tt_46:
v_and_b32 v1, 31, v0
v_lshrrev_b32 v2, 5, v0
v_lshrrev_b32 v3, 4, v1
v_lshlrev_b32 v3, 12, v3
v_and_b32 v4, 15, v1
v_lshl_add_u32 v3, v4, 4, v3
v_lshl_add_u32 v12, v2, 8, v3
s_mul_i32 s24, s17, 262144
s_mul_i32 s25, s18, 32
s_lshr_b32 s26, s25, 7
s_lshl_b32 s26, s26, 13
s_and_b32 s25, s25, 127
s_lshl_b32 s25, s25, 5
s_add_u32 s24, s24, s25
s_add_u32 s24, s24, s26
s_add_u32 s33, s33, s24
v_accvgpr_read_b32 v32, a0
v_accvgpr_read_b32 v33, a1
v_accvgpr_read_b32 v34, a2
v_accvgpr_read_b32 v35, a3
v_accvgpr_read_b32 v36, a4
v_accvgpr_read_b32 v37, a5
v_accvgpr_read_b32 v38, a6
v_accvgpr_read_b32 v39, a7
v_accvgpr_read_b32 v40, a8
v_accvgpr_read_b32 v41, a9
v_accvgpr_read_b32 v42, a10
v_accvgpr_read_b32 v43, a11
v_accvgpr_read_b32 v44, a12
v_accvgpr_read_b32 v45, a13
v_accvgpr_read_b32 v46, a14
v_accvgpr_read_b32 v47, a15
v_cvt_pk_bf16_f32 v48, v32, v33
v_cvt_pk_bf16_f32 v49, v34, v35
v_cvt_pk_bf16_f32 v50, v36, v37
v_cvt_pk_bf16_f32 v51, v38, v39
v_cvt_pk_bf16_f32 v52, v40, v41
v_cvt_pk_bf16_f32 v53, v42, v43
v_cvt_pk_bf16_f32 v54, v44, v45
v_cvt_pk_bf16_f32 v55, v46, v47
v_permlane32_swap_b32 v48, v50
v_permlane32_swap_b32 v49, v51
v_permlane32_swap_b32 v52, v54
v_permlane32_swap_b32 v53, v55
s_add_u32 s24, s33, 0
buffer_store_dwordx4 v[48:51], v12, s[4:7], s24 offen sc1
s_add_u32 s24, s33, 512
buffer_store_dwordx4 v[52:55], v12, s[4:7], s24 offen sc1
s_nop 1
s_branch p1sf_45
vtf_44:
s_lshl_b32 s24, s24, 6
s_add_u32 s33, s33, s24
s_add_u32 m0, s22, 0
s_add_u32 s24, s19, 0
buffer_load_dwordx4 v8, s[4:7], s24 offen lds
s_add_u32 m0, s22, 1024
s_add_u32 s24, s19, 16384
buffer_load_dwordx4 v9, s[4:7], s24 offen lds
s_add_u32 m0, s23, 0
s_add_u32 s25, s20, 0
buffer_load_dwordx4 v10, s[8:11], s25 offen lds
s_add_u32 m0, s22, 24576
s_add_u32 s24, s19, 128
buffer_load_dwordx4 v8, s[4:7], s24 offen lds
s_add_u32 m0, s22, 25600
s_add_u32 s24, s19, 16512
buffer_load_dwordx4 v9, s[4:7], s24 offen lds
s_add_u32 m0, s23, 24576
s_add_u32 s25, s20, 524288
buffer_load_dwordx4 v10, s[8:11], s25 offen lds
v_accvgpr_write_b32 a0, 0
v_accvgpr_write_b32 a1, 0
v_accvgpr_write_b32 a2, 0
v_accvgpr_write_b32 a3, 0
v_accvgpr_write_b32 a4, 0
v_accvgpr_write_b32 a5, 0
v_accvgpr_write_b32 a6, 0
v_accvgpr_write_b32 a7, 0
v_accvgpr_write_b32 a8, 0
v_accvgpr_write_b32 a9, 0
v_accvgpr_write_b32 a10, 0
v_accvgpr_write_b32 a11, 0
v_accvgpr_write_b32 a12, 0
v_accvgpr_write_b32 a13, 0
v_accvgpr_write_b32 a14, 0
v_accvgpr_write_b32 a15, 0
s_waitcnt vmcnt(3)
s_barrier
RB 32,13,0
RT 36,17,0
RT 38,17,512
RB 40,14,0
RT 44,17,2048
RT 46,17,2560
RB 48,15,0
RT 52,17,4096
RT 54,17,4608
s_waitcnt lgkmcnt(6)
MM 0,32,36
RB 56,16,0
RT 60,17,6144
RT 62,17,6656
s_add_u32 m0, s22, 49152
s_add_u32 s24, s19, 256
buffer_load_dwordx4 v8, s[4:7], s24 offen lds
s_add_u32 m0, s22, 50176
s_add_u32 s24, s19, 16640
buffer_load_dwordx4 v9, s[4:7], s24 offen lds
s_add_u32 m0, s23, 49152
s_add_u32 s25, s20, 1048576
buffer_load_dwordx4 v10, s[8:11], s25 offen lds
s_waitcnt lgkmcnt(6) vmcnt(3)
s_barrier
MM 0,40,44
RB 32,13,24576
RT 36,17,24576
RT 38,17,25088
s_add_u32 m0, s22, 73728
s_add_u32 s24, s19, 384
buffer_load_dwordx4 v8, s[4:7], s24 offen lds
s_waitcnt lgkmcnt(6)
MM 0,48,52
RB 40,14,24576
RT 44,17,26624
RT 46,17,27136
s_add_u32 m0, s22, 74752
s_add_u32 s24, s19, 16768
buffer_load_dwordx4 v9, s[4:7], s24 offen lds
s_add_u32 m0, s23, 73728
s_add_u32 s25, s20, 1572864
buffer_load_dwordx4 v10, s[8:11], s25 offen lds
s_waitcnt lgkmcnt(6)
MM 0,56,60
RB 48,15,24576
RT 52,17,28672
RT 54,17,29184
s_add_u32 m0, s22, 98304
s_add_u32 s24, s19, 512
buffer_load_dwordx4 v8, s[4:7], s24 offen lds
s_waitcnt lgkmcnt(6)
MM 0,32,36
RB 56,16,24576
RT 60,17,30720
RT 62,17,31232
s_add_u32 m0, s22, 99328
s_add_u32 s24, s19, 16896
buffer_load_dwordx4 v9, s[4:7], s24 offen lds
s_add_u32 m0, s23, 98304
s_add_u32 s25, s20, 2097152
buffer_load_dwordx4 v10, s[8:11], s25 offen lds
s_waitcnt lgkmcnt(6) vmcnt(6)
s_barrier
MM 0,40,44
RB 32,18,0
RT 36,22,0
RT 38,22,512
s_add_u32 m0, s22, 122880
s_add_u32 s24, s19, 640
buffer_load_dwordx4 v8, s[4:7], s24 offen lds
s_waitcnt lgkmcnt(6)
MM 0,48,52
RB 40,19,0
RT 44,22,2048
RT 46,22,2560
s_add_u32 m0, s22, 123904
s_add_u32 s24, s19, 17024
buffer_load_dwordx4 v9, s[4:7], s24 offen lds
s_add_u32 m0, s23, 122880
s_add_u32 s25, s20, 2621440
buffer_load_dwordx4 v10, s[8:11], s25 offen lds
s_waitcnt lgkmcnt(6)
MM 0,56,60
RB 48,20,0
RT 52,22,4096
RT 54,22,4608
s_add_u32 m0, s22, 0
s_add_u32 s24, s19, 768
buffer_load_dwordx4 v8, s[4:7], s24 offen lds
s_waitcnt lgkmcnt(6)
MM 0,32,36
RB 56,21,0
RT 60,22,6144
RT 62,22,6656
s_add_u32 m0, s22, 1024
s_add_u32 s24, s19, 17152
buffer_load_dwordx4 v9, s[4:7], s24 offen lds
s_add_u32 m0, s23, 0
s_add_u32 s25, s20, 3145728
buffer_load_dwordx4 v10, s[8:11], s25 offen lds
s_waitcnt lgkmcnt(6) vmcnt(9)
s_barrier
MM 0,40,44
RB 32,18,24576
RT 36,22,24576
RT 38,22,25088
s_waitcnt lgkmcnt(6)
MM 0,48,52
RB 40,19,24576
RT 44,22,26624
RT 46,22,27136
s_add_u32 m0, s22, 24576
s_add_u32 s24, s19, 896
buffer_load_dwordx4 v8, s[4:7], s24 offen lds
s_waitcnt lgkmcnt(6)
MM 0,56,60
RB 48,20,24576
RT 52,22,28672
RT 54,22,29184
s_add_u32 m0, s22, 25600
s_add_u32 s24, s19, 17280
buffer_load_dwordx4 v9, s[4:7], s24 offen lds
s_waitcnt lgkmcnt(6)
MM 0,32,36
RB 56,21,24576
RT 60,22,30720
RT 62,22,31232
s_add_u32 m0, s23, 24576
s_add_u32 s25, s20, 3670016
buffer_load_dwordx4 v10, s[8:11], s25 offen lds
s_waitcnt lgkmcnt(6) vmcnt(9)
s_barrier
MM 0,40,44
RB 32,23,0
RT 36,27,0
RT 38,27,512
s_waitcnt lgkmcnt(6)
MM 0,48,52
RB 40,24,0
RT 44,27,2048
RT 46,27,2560
s_add_u32 m0, s22, 49152
s_add_u32 s24, s19, 1024
buffer_load_dwordx4 v8, s[4:7], s24 offen lds
s_waitcnt lgkmcnt(6)
MM 0,56,60
RB 48,25,0
RT 52,27,4096
RT 54,27,4608
s_add_u32 m0, s22, 50176
s_add_u32 s24, s19, 17408
buffer_load_dwordx4 v9, s[4:7], s24 offen lds
s_waitcnt lgkmcnt(6)
MM 0,32,36
RB 56,26,0
RT 60,27,6144
RT 62,27,6656
s_add_u32 m0, s23, 49152
s_add_u32 s25, s20, 4194304
buffer_load_dwordx4 v10, s[8:11], s25 offen lds
s_waitcnt lgkmcnt(6) vmcnt(9)
s_barrier
MM 0,40,44
RB 32,23,24576
RT 36,27,24576
RT 38,27,25088
s_waitcnt lgkmcnt(6)
MM 0,48,52
RB 40,24,24576
RT 44,27,26624
RT 46,27,27136
s_add_u32 m0, s22, 73728
s_add_u32 s24, s19, 1152
buffer_load_dwordx4 v8, s[4:7], s24 offen lds
s_waitcnt lgkmcnt(6)
MM 0,56,60
RB 48,25,24576
RT 52,27,28672
RT 54,27,29184
s_add_u32 m0, s22, 74752
s_add_u32 s24, s19, 17536
buffer_load_dwordx4 v9, s[4:7], s24 offen lds
s_waitcnt lgkmcnt(6)
MM 0,32,36
RB 56,26,24576
RT 60,27,30720
RT 62,27,31232
s_add_u32 m0, s23, 73728
s_add_u32 s25, s20, 4718592
buffer_load_dwordx4 v10, s[8:11], s25 offen lds
s_waitcnt lgkmcnt(6) vmcnt(9)
s_barrier
MM 0,40,44
RB 32,13,0
RT 36,17,0
RT 38,17,512
s_waitcnt lgkmcnt(6)
MM 0,48,52
RB 40,14,0
RT 44,17,2048
RT 46,17,2560
s_add_u32 m0, s22, 98304
s_add_u32 s24, s19, 1280
buffer_load_dwordx4 v8, s[4:7], s24 offen lds
s_waitcnt lgkmcnt(6)
MM 0,56,60
RB 48,15,0
RT 52,17,4096
RT 54,17,4608
s_add_u32 m0, s22, 99328
s_add_u32 s24, s19, 17664
buffer_load_dwordx4 v9, s[4:7], s24 offen lds
s_waitcnt lgkmcnt(6)
MM 0,32,36
RB 56,16,0
RT 60,17,6144
RT 62,17,6656
s_add_u32 m0, s23, 98304
s_add_u32 s25, s20, 5242880
buffer_load_dwordx4 v10, s[8:11], s25 offen lds
s_waitcnt lgkmcnt(6) vmcnt(9)
s_barrier
MM 0,40,44
RB 32,13,24576
RT 36,17,24576
RT 38,17,25088
s_waitcnt lgkmcnt(6)
MM 0,48,52
RB 40,14,24576
RT 44,17,26624
RT 46,17,27136
s_add_u32 m0, s22, 122880
s_add_u32 s24, s19, 1408
buffer_load_dwordx4 v8, s[4:7], s24 offen lds
s_waitcnt lgkmcnt(6)
MM 0,56,60
RB 48,15,24576
RT 52,17,28672
RT 54,17,29184
s_add_u32 m0, s22, 123904
s_add_u32 s24, s19, 17792
buffer_load_dwordx4 v9, s[4:7], s24 offen lds
s_waitcnt lgkmcnt(6)
MM 0,32,36
RB 56,16,24576
RT 60,17,30720
RT 62,17,31232
s_add_u32 m0, s23, 122880
s_add_u32 s25, s20, 5767168
buffer_load_dwordx4 v10, s[8:11], s25 offen lds
s_waitcnt lgkmcnt(6) vmcnt(9)
s_barrier
MM 0,40,44
RB 32,18,0
RT 36,22,0
RT 38,22,512
s_waitcnt lgkmcnt(6)
MM 0,48,52
RB 40,19,0
RT 44,22,2048
RT 46,22,2560
s_add_u32 m0, s22, 0
s_add_u32 s24, s19, 1536
buffer_load_dwordx4 v8, s[4:7], s24 offen lds
s_waitcnt lgkmcnt(6)
MM 0,56,60
RB 48,20,0
RT 52,22,4096
RT 54,22,4608
s_add_u32 m0, s22, 1024
s_add_u32 s24, s19, 17920
buffer_load_dwordx4 v9, s[4:7], s24 offen lds
s_waitcnt lgkmcnt(6)
MM 0,32,36
RB 56,21,0
RT 60,22,6144
RT 62,22,6656
s_add_u32 m0, s23, 0
s_add_u32 s25, s20, 6291456
buffer_load_dwordx4 v10, s[8:11], s25 offen lds
s_waitcnt lgkmcnt(6) vmcnt(9)
s_barrier
MM 0,40,44
RB 32,18,24576
RT 36,22,24576
RT 38,22,25088
s_waitcnt lgkmcnt(6)
MM 0,48,52
RB 40,19,24576
RT 44,22,26624
RT 46,22,27136
s_add_u32 m0, s22, 24576
s_add_u32 s24, s19, 1664
buffer_load_dwordx4 v8, s[4:7], s24 offen lds
s_waitcnt lgkmcnt(6)
MM 0,56,60
RB 48,20,24576
RT 52,22,28672
RT 54,22,29184
s_add_u32 m0, s22, 25600
s_add_u32 s24, s19, 18048
buffer_load_dwordx4 v9, s[4:7], s24 offen lds
s_waitcnt lgkmcnt(6)
MM 0,32,36
RB 56,21,24576
RT 60,22,30720
RT 62,22,31232
s_add_u32 m0, s23, 24576
s_add_u32 s25, s20, 6815744
buffer_load_dwordx4 v10, s[8:11], s25 offen lds
s_waitcnt lgkmcnt(6) vmcnt(9)
s_barrier
MM 0,40,44
RB 32,23,0
RT 36,27,0
RT 38,27,512
s_waitcnt lgkmcnt(6)
MM 0,48,52
RB 40,24,0
RT 44,27,2048
RT 46,27,2560
s_add_u32 m0, s22, 49152
s_add_u32 s24, s19, 1792
buffer_load_dwordx4 v8, s[4:7], s24 offen lds
s_waitcnt lgkmcnt(6)
MM 0,56,60
RB 48,25,0
RT 52,27,4096
RT 54,27,4608
s_add_u32 m0, s22, 50176
s_add_u32 s24, s19, 18176
buffer_load_dwordx4 v9, s[4:7], s24 offen lds
s_waitcnt lgkmcnt(6)
MM 0,32,36
RB 56,26,0
RT 60,27,6144
RT 62,27,6656
s_add_u32 m0, s23, 49152
s_add_u32 s25, s20, 7340032
buffer_load_dwordx4 v10, s[8:11], s25 offen lds
s_waitcnt lgkmcnt(6) vmcnt(9)
s_barrier
MM 0,40,44
RB 32,23,24576
RT 36,27,24576
RT 38,27,25088
s_waitcnt lgkmcnt(6)
MM 0,48,52
RB 40,24,24576
RT 44,27,26624
RT 46,27,27136
s_add_u32 m0, s22, 73728
s_add_u32 s24, s19, 1920
buffer_load_dwordx4 v8, s[4:7], s24 offen lds
s_waitcnt lgkmcnt(6)
MM 0,56,60
RB 48,25,24576
RT 52,27,28672
RT 54,27,29184
s_add_u32 m0, s22, 74752
s_add_u32 s24, s19, 18304
buffer_load_dwordx4 v9, s[4:7], s24 offen lds
s_waitcnt lgkmcnt(6)
MM 0,32,36
RB 56,26,24576
RT 60,27,30720
RT 62,27,31232
s_add_u32 m0, s23, 73728
s_add_u32 s25, s20, 7864320
buffer_load_dwordx4 v10, s[8:11], s25 offen lds
s_waitcnt lgkmcnt(6) vmcnt(9)
s_barrier
MM 0,40,44
RB 32,13,0
RT 36,17,0
RT 38,17,512
s_waitcnt lgkmcnt(6)
MM 0,48,52
RB 40,14,0
RT 44,17,2048
RT 46,17,2560
s_waitcnt lgkmcnt(6)
MM 0,56,60
RB 48,15,0
RT 52,17,4096
RT 54,17,4608
s_waitcnt lgkmcnt(6)
MM 0,32,36
RB 56,16,0
RT 60,17,6144
RT 62,17,6656
s_waitcnt lgkmcnt(6) vmcnt(6)
s_barrier
MM 0,40,44
RB 32,13,24576
RT 36,17,24576
RT 38,17,25088
s_waitcnt lgkmcnt(6)
MM 0,48,52
RB 40,14,24576
RT 44,17,26624
RT 46,17,27136
s_waitcnt lgkmcnt(6)
MM 0,56,60
RB 48,15,24576
RT 52,17,28672
RT 54,17,29184
s_waitcnt lgkmcnt(6)
MM 0,32,36
RB 56,16,24576
RT 60,17,30720
RT 62,17,31232
s_waitcnt lgkmcnt(6) vmcnt(3)
s_barrier
MM 0,40,44
RB 32,18,0
RT 36,22,0
RT 38,22,512
s_waitcnt lgkmcnt(6)
MM 0,48,52
RB 40,19,0
RT 44,22,2048
RT 46,22,2560
s_waitcnt lgkmcnt(6)
MM 0,56,60
RB 48,20,0
RT 52,22,4096
RT 54,22,4608
s_waitcnt lgkmcnt(6)
MM 0,32,36
RB 56,21,0
RT 60,22,6144
RT 62,22,6656
s_waitcnt lgkmcnt(6) vmcnt(0)
s_barrier
MM 0,40,44
RB 32,18,24576
RT 36,22,24576
RT 38,22,25088
s_waitcnt lgkmcnt(6)
MM 0,48,52
RB 40,19,24576
RT 44,22,26624
RT 46,22,27136
s_waitcnt lgkmcnt(6)
MM 0,56,60
RB 48,20,24576
RT 52,22,28672
RT 54,22,29184
s_waitcnt lgkmcnt(6)
MM 0,32,36
RB 56,21,24576
RT 60,22,30720
RT 62,22,31232
s_waitcnt lgkmcnt(0)
MM 0,40,44
s_waitcnt lgkmcnt(0)
MM 0,48,52
s_waitcnt lgkmcnt(0)
MM 0,56,60
s_barrier
s_cmp_lg_u32 s16, 0
s_cbranch_scc1 tt_47
v_mov_b32 v7, s56
v_accvgpr_write_b32 a127, 1
s_mov_b64 exec, 1
buffer_atomic_add a127, v7, s[4:7], 0 offen sc0
s_mov_b64 exec, -1
tt_47:
v_and_b32 v1, 31, v0
v_lshrrev_b32 v2, 5, v0
v_lshrrev_b32 v3, 4, v1
v_lshlrev_b32 v3, 10, v3
v_and_b32 v4, 15, v1
v_lshl_add_u32 v3, v4, 4, v3
v_lshl_add_u32 v12, v2, 8, v3
s_mul_i32 s24, s17, 262144
s_mul_i32 s25, s18, 32
s_lshr_b32 s26, s25, 7
s_lshl_b32 s26, s26, 13
s_and_b32 s25, s25, 127
s_lshl_b32 s25, s25, 6
s_add_u32 s24, s24, s25
s_add_u32 s24, s24, s26
s_add_u32 s33, s33, s24
v_accvgpr_read_b32 v32, a0
v_accvgpr_read_b32 v33, a1
v_accvgpr_read_b32 v34, a2
v_accvgpr_read_b32 v35, a3
v_accvgpr_read_b32 v36, a4
v_accvgpr_read_b32 v37, a5
v_accvgpr_read_b32 v38, a6
v_accvgpr_read_b32 v39, a7
v_accvgpr_read_b32 v40, a8
v_accvgpr_read_b32 v41, a9
v_accvgpr_read_b32 v42, a10
v_accvgpr_read_b32 v43, a11
v_accvgpr_read_b32 v44, a12
v_accvgpr_read_b32 v45, a13
v_accvgpr_read_b32 v46, a14
v_accvgpr_read_b32 v47, a15
v_cvt_pk_bf16_f32 v48, v32, v33
v_cvt_pk_bf16_f32 v49, v34, v35
v_cvt_pk_bf16_f32 v50, v40, v41
v_cvt_pk_bf16_f32 v51, v42, v43
v_cvt_pk_bf16_f32 v52, v36, v37
v_cvt_pk_bf16_f32 v53, v38, v39
v_cvt_pk_bf16_f32 v54, v44, v45
v_cvt_pk_bf16_f32 v55, v46, v47
s_add_u32 s24, s33, 0
buffer_store_dwordx4 v[48:51], v12, s[4:7], s24 offen sc1
s_add_u32 s24, s33, 512
buffer_store_dwordx4 v[52:55], v12, s[4:7], s24 offen sc1
s_nop 1
p1sf_45:
s_waitcnt vmcnt(0)
s_barrier
s_cmp_lg_u32 s16, 0
s_cbranch_scc1 sig_48
v_mov_b32 v1, s76
v_mov_b32 v2, 1
s_mov_b64 exec, 1
buffer_atomic_add v2, v1, s[4:7], 0 offen
s_mov_b64 exec, -1
sig_48:
s_branch mega_kernel_wloop
mega_kernel_t2:
s_lshl_b32 s74, s77, 2
s_lshl_b32 s24, s79, 1
s_add_u32 s74, s74, s24
s_lshl_b32 s24, s60, 4
s_add_u32 s24, s24, s77
s_lshl_b32 s24, s24, 7
s_add_u32 s24, s24, 8192
s_lshl_b32 s25, s60, 4
s_add_u32 s25, s25, s77
s_lshl_b32 s25, s25, 7
s_add_u32 s25, s25, 24576
s_add_u32 s75, s74, 2
s_lshl_b32 s75, s75, 4
s_cmp_lg_u32 s16, 0
s_cbranch_scc1 wf_49
v_mov_b32 v1, 0
v_mov_b32 v2, 0
v_writelane_b32 v1, s24, 0
s_mov_b32 s27, 16
v_writelane_b32 v2, s27, 0
v_writelane_b32 v1, s25, 1
s_mov_b32 s27, 2
v_writelane_b32 v2, s27, 1
s_mov_b64 exec, 3
wfp_50:
s_add_u32 s63, s63, 1
s_cmp_gt_u32 s63, 262144
s_cbranch_scc0 go_51
s_endpgm
go_51:
buffer_load_dword v3, v1, s[4:7], 0 offen sc1
s_waitcnt vmcnt(0)
v_cmp_lt_u32 vcc, v3, v2
s_nop 0
s_cbranch_vccz wfd_52
v_sub_u32 v4, v2, v3
s_nop 0
v_readlane_b32 s27, v4, 0
s_nop 0
s_cmp_lt_i32 s27, 2
s_cbranch_scc1 lv_53
s_sleep 40
s_branch wfp_50
lv_53:
s_cmp_lt_i32 s27, 1
s_cbranch_scc1 lv_54
s_sleep 12
s_branch wfp_50
lv_54:
s_sleep 8
s_branch wfp_50
wfd_52:
s_mov_b64 exec, -1
wf_49:
s_barrier
s_lshr_b32 s72, s74, 2
s_sub_u32 s24, s74, 60
s_lshr_b32 s24, s24, 1
s_add_u32 s24, s24, 15
s_cmp_ge_u32 s74, 60
s_cselect_b32 s72, s24, s72
s_lshl_b32 s76, s60, 5
s_add_u32 s76, s76, s72
s_lshl_b32 s76, s76, 7
s_add_u32 s76, s76, 98304
s_and_b32 s73, s16, 3
s_lshl_b32 s26, s60, 2
s_add_u32 s73, s73, s26
s_lshr_b32 s34, s16, 2
s_add_u32 s34, s34, s74
s_cmp_lg_u32 s16, 0
s_cbranch_scc1 tt_55
v_mov_b32 v7, s56
v_accvgpr_write_b32 a127, 1
s_mov_b64 exec, 1
buffer_atomic_add a127, v7, s[4:7], 0 offen sc0
s_mov_b64 exec, -1
tt_55:
v_and_b32 v1, 15, v0
v_lshrrev_b32 v2, 4, v0
v_lshlrev_b32 v3, 4, v0
s_lshl_b32 s24, s34, 18
s_lshl_b32 s25, s73, 13
s_add_u32 s24, s24, s25
s_add_u32 s25, s24, 6291456
buffer_load_dwordx4 a[96:99], v3, s[4:7], s25 offen offset:0 sc1
buffer_load_dwordx4 a[100:103], v3, s[4:7], s25 offen offset:1024 sc1
buffer_load_dwordx4 a[104:107], v3, s[4:7], s25 offen offset:2048 sc1
buffer_load_dwordx4 a[108:111], v3, s[4:7], s25 offen offset:3072 sc1
s_add_u32 s25, s24, 23068672
buffer_load_dwordx4 a[0:3], v3, s[4:7], s25 offen offset:0 sc1
buffer_load_dwordx4 a[4:7], v3, s[4:7], s25 offen offset:1024 sc1
buffer_load_dwordx4 a[8:11], v3, s[4:7], s25 offen offset:2048 sc1
buffer_load_dwordx4 a[12:15], v3, s[4:7], s25 offen offset:3072 sc1
s_add_u32 s25, s25, 4096
buffer_load_dwordx4 a[16:19], v3, s[4:7], s25 offen offset:0 sc1
buffer_load_dwordx4 a[20:23], v3, s[4:7], s25 offen offset:1024 sc1
buffer_load_dwordx4 a[24:27], v3, s[4:7], s25 offen offset:2048 sc1
buffer_load_dwordx4 a[28:31], v3, s[4:7], s25 offen offset:3072 sc1
s_add_u32 s25, s24, 39845888
buffer_load_dwordx4 a[32:35], v3, s[4:7], s25 offen offset:0 sc1
buffer_load_dwordx4 a[36:39], v3, s[4:7], s25 offen offset:1024 sc1
buffer_load_dwordx4 a[40:43], v3, s[4:7], s25 offen offset:2048 sc1
buffer_load_dwordx4 a[44:47], v3, s[4:7], s25 offen offset:3072 sc1
s_add_u32 s25, s25, 4096
buffer_load_dwordx4 a[48:51], v3, s[4:7], s25 offen offset:0 sc1
buffer_load_dwordx4 a[52:55], v3, s[4:7], s25 offen offset:1024 sc1
buffer_load_dwordx4 a[56:59], v3, s[4:7], s25 offen offset:2048 sc1
buffer_load_dwordx4 a[60:63], v3, s[4:7], s25 offen offset:3072 sc1
s_add_u32 s25, s24, 6295552
buffer_load_dwordx4 v[16:19], v3, s[4:7], s25 offen offset:0 sc1
buffer_load_dwordx4 v[20:23], v3, s[4:7], s25 offen offset:1024 sc1
buffer_load_dwordx4 v[24:27], v3, s[4:7], s25 offen offset:2048 sc1
buffer_load_dwordx4 v[28:31], v3, s[4:7], s25 offen offset:3072 sc1
v_mov_b32 v6, 0xff800000
v_mov_b32 v7, 0
v_mov_b32 v88, 0x3f803f80
v_lshl_add_u32 v4, v2, 2, 0
v_cmp_gt_u32 vcc, v4, v1
s_nop 1
v_cndmask_b32 v92, v7, v6, vcc
v_mov_b32 v89, 0x3f803f80
v_lshl_add_u32 v4, v2, 2, 1
v_cmp_gt_u32 vcc, v4, v1
s_nop 1
v_cndmask_b32 v93, v7, v6, vcc
v_mov_b32 v90, 0x3f803f80
v_lshl_add_u32 v4, v2, 2, 2
v_cmp_gt_u32 vcc, v4, v1
s_nop 1
v_cndmask_b32 v94, v7, v6, vcc
v_mov_b32 v91, 0x3f803f80
v_lshl_add_u32 v4, v2, 2, 3
v_cmp_gt_u32 vcc, v4, v1
s_nop 1
v_cndmask_b32 v95, v7, v6, vcc
v_cmp_lt_u32 vcc, 1, v2
s_nop 1
v_cndmask_b32 v96, v7, v6, vcc
v_cndmask_b32 v97, v7, v6, vcc
v_cndmask_b32 v98, v7, v6, vcc
v_cndmask_b32 v99, v7, v6, vcc
s_lshl_b32 s26, s60, 7
s_add_u32 s26, s26, 4096
s_cmp_lg_u32 s16, 0
s_cbranch_scc1 wf_56
v_mov_b32 v112, 0
v_mov_b32 v113, 0
v_writelane_b32 v112, s26, 0
v_writelane_b32 v113, s75, 0
s_mov_b64 exec, 1
wfp_57:
s_add_u32 s63, s63, 1
s_cmp_gt_u32 s63, 262144
s_cbranch_scc0 go_58
s_endpgm
go_58:
buffer_load_dword v114, v112, s[4:7], 0 offen sc1
s_waitcnt vmcnt(0)
v_cmp_lt_u32 vcc, v114, v113
s_nop 0
s_cbranch_vccz wfd_59
v_sub_u32 v115, v113, v114
s_nop 0
v_readlane_b32 s27, v115, 0
s_nop 0
s_cmp_lt_i32 s27, 49
s_cbranch_scc1 lv_60
s_sleep 127
s_sleep 127
s_branch wfp_57
lv_60:
s_cmp_lt_i32 s27, 33
s_cbranch_scc1 lv_61
s_sleep 100
s_branch wfp_57
lv_61:
s_cmp_lt_i32 s27, 17
s_cbranch_scc1 lv_62
s_sleep 40
s_branch wfp_57
lv_62:
s_cmp_lt_i32 s27, 1
s_cbranch_scc1 lv_63
s_sleep 6
s_branch wfp_57
lv_63:
s_sleep 8
s_branch wfp_57
wfd_59:
s_mov_b64 exec, -1
wf_56:
s_barrier
s_lshl_b32 s24, s34, 16
s_lshl_b32 s25, s73, 11
s_add_u32 s24, s24, s25
v_and_b32 v4, 7, v1
v_lshlrev_b32 v4, 8, v4
v_lshl_add_u32 v4, v2, 4, v4
s_add_u32 s25, s24, 56623104
buffer_load_dwordx4 a[64:67], v4, s[4:7], s25 offen offset:0 sc1
buffer_load_dwordx4 a[68:71], v4, s[4:7], s25 offen offset:64 sc1
buffer_load_dwordx4 a[72:75], v4, s[4:7], s25 offen offset:128 sc1
buffer_load_dwordx4 a[76:79], v4, s[4:7], s25 offen offset:192 sc1
v_and_b32 v5, 1, v2
v_lshlrev_b32 v5, 3, v5
v_lshl_add_u32 v5, v1, 4, v5
s_add_u32 s25, s24, 60817408
buffer_load_dwordx2 a[80:81], v5, s[4:7], s25 offen offset:0 sc1
buffer_load_dwordx2 a[82:83], v5, s[4:7], s25 offen offset:256 sc1
buffer_load_dwordx2 a[84:85], v5, s[4:7], s25 offen offset:512 sc1
buffer_load_dwordx2 a[86:87], v5, s[4:7], s25 offen offset:768 sc1
buffer_load_dwordx2 a[88:89], v5, s[4:7], s25 offen offset:1024 sc1
buffer_load_dwordx2 a[90:91], v5, s[4:7], s25 offen offset:1280 sc1
buffer_load_dwordx2 a[92:93], v5, s[4:7], s25 offen offset:1536 sc1
buffer_load_dwordx2 a[94:95], v5, s[4:7], s25 offen offset:1792 sc1
v_lshlrev_b32 v4, 13, v1
v_and_b32 v5, 1, v2
v_lshl_add_u32 v4, v5, 5, v4
v_lshrrev_b32 v5, 1, v2
v_lshl_add_u32 v4, v5, 4, v4
s_lshl_b32 s24, s34, 18
s_lshl_b32 s25, s73, 8
s_add_u32 s24, s24, s25
s_add_u32 s24, s24, 65011712
s_waitcnt vmcnt(0)
v_mfma_f32_16x16x32_bf16 v[32:35], a[64:67], a[96:99], v[96:99]
v_mfma_f32_16x16x32_bf16 v[36:39], a[0:3], a[96:99], v[92:95]
v_mfma_f32_16x16x32_bf16 v[32:35], a[68:71], a[100:103], v[32:35]
v_mfma_f32_16x16x32_bf16 v[36:39], a[4:7], a[100:103], v[36:39]
v_mfma_f32_16x16x32_bf16 v[32:35], a[72:75], a[104:107], v[32:35]
v_mfma_f32_16x16x32_bf16 v[36:39], a[8:11], a[104:107], v[36:39]
v_mfma_f32_16x16x32_bf16 v[32:35], a[76:79], a[108:111], v[32:35]
v_mfma_f32_16x16x32_bf16 v[36:39], a[12:15], a[108:111], v[36:39]
s_nop 6
v_max3_f32 v100, v32, v33, v34
v_max3_f32 v100, v100, v35, v36
v_max3_f32 v100, v100, v37, v38
v_max_f32 v100, v100, v39
v_mov_b32 v101, v100
s_nop 1
v_permlane32_swap_b32 v100, v101
v_max_f32 v100, v100, v101
v_mov_b32 v101, v100
s_nop 1
v_permlane16_swap_b32 v100, v101
v_max_f32 v100, v100, v101
v_mul_f32 v100, s78, v100
v_fma_f32 v32, v32, s78, -v100
v_fma_f32 v33, v33, s78, -v100
v_fma_f32 v34, v34, s78, -v100
v_fma_f32 v35, v35, s78, -v100
v_fma_f32 v36, v36, s78, -v100
v_fma_f32 v37, v37, s78, -v100
v_fma_f32 v38, v38, s78, -v100
v_fma_f32 v39, v39, s78, -v100
v_exp_f32 v32, v32
v_exp_f32 v33, v33
v_exp_f32 v34, v34
v_exp_f32 v35, v35
v_exp_f32 v36, v36
v_exp_f32 v37, v37
v_exp_f32 v38, v38
v_exp_f32 v39, v39
v_cvt_pk_bf16_f32 v44, v32, v33
v_cvt_pk_bf16_f32 v45, v34, v35
v_cvt_pk_bf16_f32 v46, v36, v37
v_cvt_pk_bf16_f32 v47, v38, v39
v_mov_b32 v48, 0
v_mov_b32 v49, 0
v_mfma_f32_16x16x16_bf16 v[52:55], v[88:89], v[44:45], 0
v_mfma_f32_16x16x16_bf16 v[56:59], a[80:81], v[44:45], 0
v_mfma_f32_16x16x16_bf16 v[60:63], a[82:83], v[44:45], 0
v_mfma_f32_16x16x16_bf16 v[64:67], a[84:85], v[44:45], 0
v_mfma_f32_16x16x16_bf16 v[68:71], a[86:87], v[44:45], 0
v_mfma_f32_16x16x16_bf16 v[72:75], a[88:89], v[44:45], 0
v_mfma_f32_16x16x16_bf16 v[76:79], a[90:91], v[44:45], 0
v_mfma_f32_16x16x16_bf16 v[80:83], a[92:93], v[44:45], 0
v_mfma_f32_16x16x16_bf16 v[84:87], a[94:95], v[44:45], 0
v_mfma_f32_16x16x32_bf16 v[52:55], v[88:91], v[46:49], v[52:55]
v_mfma_f32_16x16x32_bf16 v[56:59], a[32:35], v[46:49], v[56:59]
v_mfma_f32_16x16x32_bf16 v[60:63], a[36:39], v[46:49], v[60:63]
v_mfma_f32_16x16x32_bf16 v[64:67], a[40:43], v[46:49], v[64:67]
v_mfma_f32_16x16x32_bf16 v[68:71], a[44:47], v[46:49], v[68:71]
v_mfma_f32_16x16x32_bf16 v[72:75], a[48:51], v[46:49], v[72:75]
v_mfma_f32_16x16x32_bf16 v[76:79], a[52:55], v[46:49], v[76:79]
v_mfma_f32_16x16x32_bf16 v[80:83], a[56:59], v[46:49], v[80:83]
v_mfma_f32_16x16x32_bf16 v[84:87], a[60:63], v[46:49], v[84:87]
v_rcp_f32 v100, v52
s_nop 0
v_mul_f32 v56, v56, v100
v_mul_f32 v60, v60, v100
v_mul_f32 v57, v57, v100
v_mul_f32 v61, v61, v100
v_mul_f32 v58, v58, v100
v_mul_f32 v62, v62, v100
v_mul_f32 v59, v59, v100
v_mul_f32 v63, v63, v100
v_cvt_pk_bf16_f32 v104, v56, v57
v_cvt_pk_bf16_f32 v105, v58, v59
v_cvt_pk_bf16_f32 v106, v60, v61
v_cvt_pk_bf16_f32 v107, v62, v63
s_nop 0
v_permlane16_swap_b32 v104, v106
v_permlane16_swap_b32 v105, v107
s_add_u32 s25, s24, 0
buffer_store_dwordx4 v[104:107], v4, s[4:7], s25 offen offset:0 sc1
v_mul_f32 v64, v64, v100
v_mul_f32 v68, v68, v100
v_mul_f32 v65, v65, v100
v_mul_f32 v69, v69, v100
v_mul_f32 v66, v66, v100
v_mul_f32 v70, v70, v100
v_mul_f32 v67, v67, v100
v_mul_f32 v71, v71, v100
v_cvt_pk_bf16_f32 v108, v64, v65
v_cvt_pk_bf16_f32 v109, v66, v67
v_cvt_pk_bf16_f32 v110, v68, v69
v_cvt_pk_bf16_f32 v111, v70, v71
s_nop 0
v_permlane16_swap_b32 v108, v110
v_permlane16_swap_b32 v109, v111
s_add_u32 s25, s24, 0
buffer_store_dwordx4 v[108:111], v4, s[4:7], s25 offen offset:64 sc1
v_mul_f32 v72, v72, v100
v_mul_f32 v76, v76, v100
v_mul_f32 v73, v73, v100
v_mul_f32 v77, v77, v100
v_mul_f32 v74, v74, v100
v_mul_f32 v78, v78, v100
v_mul_f32 v75, v75, v100
v_mul_f32 v79, v79, v100
v_cvt_pk_bf16_f32 v112, v72, v73
v_cvt_pk_bf16_f32 v113, v74, v75
v_cvt_pk_bf16_f32 v114, v76, v77
v_cvt_pk_bf16_f32 v115, v78, v79
s_nop 0
v_permlane16_swap_b32 v112, v114
v_permlane16_swap_b32 v113, v115
s_add_u32 s25, s24, 0
buffer_store_dwordx4 v[112:115], v4, s[4:7], s25 offen offset:128 sc1
v_mul_f32 v80, v80, v100
v_mul_f32 v84, v84, v100
v_mul_f32 v81, v81, v100
v_mul_f32 v85, v85, v100
v_mul_f32 v82, v82, v100
v_mul_f32 v86, v86, v100
v_mul_f32 v83, v83, v100
v_mul_f32 v87, v87, v100
v_cvt_pk_bf16_f32 v116, v80, v81
v_cvt_pk_bf16_f32 v117, v82, v83
v_cvt_pk_bf16_f32 v118, v84, v85
v_cvt_pk_bf16_f32 v119, v86, v87
s_nop 0
v_permlane16_swap_b32 v116, v118
v_permlane16_swap_b32 v117, v119
s_add_u32 s25, s24, 0
buffer_store_dwordx4 v[116:119], v4, s[4:7], s25 offen offset:192 sc1
s_nop 1
v_mfma_f32_16x16x32_bf16 v[32:35], a[64:67], v[16:19], v[96:99]
v_mfma_f32_16x16x32_bf16 v[36:39], a[0:3], v[16:19], 0
v_mfma_f32_16x16x32_bf16 v[40:43], a[16:19], v[16:19], v[92:95]
v_mfma_f32_16x16x32_bf16 v[32:35], a[68:71], v[20:23], v[32:35]
v_mfma_f32_16x16x32_bf16 v[36:39], a[4:7], v[20:23], v[36:39]
v_mfma_f32_16x16x32_bf16 v[40:43], a[20:23], v[20:23], v[40:43]
v_mfma_f32_16x16x32_bf16 v[32:35], a[72:75], v[24:27], v[32:35]
v_mfma_f32_16x16x32_bf16 v[36:39], a[8:11], v[24:27], v[36:39]
v_mfma_f32_16x16x32_bf16 v[40:43], a[24:27], v[24:27], v[40:43]
v_mfma_f32_16x16x32_bf16 v[32:35], a[76:79], v[28:31], v[32:35]
v_mfma_f32_16x16x32_bf16 v[36:39], a[12:15], v[28:31], v[36:39]
v_mfma_f32_16x16x32_bf16 v[40:43], a[28:31], v[28:31], v[40:43]
s_nop 5
v_max3_f32 v100, v32, v33, v34
v_max3_f32 v100, v100, v35, v36
v_max3_f32 v100, v100, v37, v38
v_max3_f32 v100, v100, v39, v40
v_max3_f32 v100, v100, v41, v42
v_max_f32 v100, v100, v43
v_mov_b32 v101, v100
s_nop 1
v_permlane32_swap_b32 v100, v101
v_max_f32 v100, v100, v101
v_mov_b32 v101, v100
s_nop 1
v_permlane16_swap_b32 v100, v101
v_max_f32 v100, v100, v101
v_mul_f32 v100, s78, v100
v_fma_f32 v32, v32, s78, -v100
v_fma_f32 v33, v33, s78, -v100
v_fma_f32 v34, v34, s78, -v100
v_fma_f32 v35, v35, s78, -v100
v_fma_f32 v36, v36, s78, -v100
v_fma_f32 v37, v37, s78, -v100
v_fma_f32 v38, v38, s78, -v100
v_fma_f32 v39, v39, s78, -v100
v_fma_f32 v40, v40, s78, -v100
v_fma_f32 v41, v41, s78, -v100
v_fma_f32 v42, v42, s78, -v100
v_fma_f32 v43, v43, s78, -v100
v_exp_f32 v32, v32
v_exp_f32 v33, v33
v_exp_f32 v34, v34
v_exp_f32 v35, v35
v_exp_f32 v36, v36
v_exp_f32 v37, v37
v_exp_f32 v38, v38
v_exp_f32 v39, v39
v_exp_f32 v40, v40
v_exp_f32 v41, v41
v_exp_f32 v42, v42
v_exp_f32 v43, v43
v_cvt_pk_bf16_f32 v44, v32, v33
v_cvt_pk_bf16_f32 v45, v34, v35
v_cvt_pk_bf16_f32 v46, v36, v37
v_cvt_pk_bf16_f32 v47, v38, v39
v_cvt_pk_bf16_f32 v48, v40, v41
v_cvt_pk_bf16_f32 v49, v42, v43
v_mfma_f32_16x16x16_bf16 v[52:55], v[88:89], v[44:45], 0
v_mfma_f32_16x16x16_bf16 v[56:59], a[80:81], v[44:45], 0
v_mfma_f32_16x16x16_bf16 v[60:63], a[82:83], v[44:45], 0
v_mfma_f32_16x16x16_bf16 v[64:67], a[84:85], v[44:45], 0
v_mfma_f32_16x16x16_bf16 v[68:71], a[86:87], v[44:45], 0
v_mfma_f32_16x16x16_bf16 v[72:75], a[88:89], v[44:45], 0
v_mfma_f32_16x16x16_bf16 v[76:79], a[90:91], v[44:45], 0
v_mfma_f32_16x16x16_bf16 v[80:83], a[92:93], v[44:45], 0
v_mfma_f32_16x16x16_bf16 v[84:87], a[94:95], v[44:45], 0
v_mfma_f32_16x16x32_bf16 v[52:55], v[88:91], v[46:49], v[52:55]
v_mfma_f32_16x16x32_bf16 v[56:59], a[32:35], v[46:49], v[56:59]
v_mfma_f32_16x16x32_bf16 v[60:63], a[36:39], v[46:49], v[60:63]
v_mfma_f32_16x16x32_bf16 v[64:67], a[40:43], v[46:49], v[64:67]
v_mfma_f32_16x16x32_bf16 v[68:71], a[44:47], v[46:49], v[68:71]
v_mfma_f32_16x16x32_bf16 v[72:75], a[48:51], v[46:49], v[72:75]
v_mfma_f32_16x16x32_bf16 v[76:79], a[52:55], v[46:49], v[76:79]
v_mfma_f32_16x16x32_bf16 v[80:83], a[56:59], v[46:49], v[80:83]
v_mfma_f32_16x16x32_bf16 v[84:87], a[60:63], v[46:49], v[84:87]
v_rcp_f32 v100, v52
s_nop 0
v_mul_f32 v56, v56, v100
v_mul_f32 v60, v60, v100
v_mul_f32 v57, v57, v100
v_mul_f32 v61, v61, v100
v_mul_f32 v58, v58, v100
v_mul_f32 v62, v62, v100
v_mul_f32 v59, v59, v100
v_mul_f32 v63, v63, v100
v_cvt_pk_bf16_f32 v104, v56, v57
v_cvt_pk_bf16_f32 v105, v58, v59
v_cvt_pk_bf16_f32 v106, v60, v61
v_cvt_pk_bf16_f32 v107, v62, v63
s_nop 0
v_permlane16_swap_b32 v104, v106
v_permlane16_swap_b32 v105, v107
s_add_u32 s25, s24, 131072
buffer_store_dwordx4 v[104:107], v4, s[4:7], s25 offen offset:0 sc1
v_mul_f32 v64, v64, v100
v_mul_f32 v68, v68, v100
v_mul_f32 v65, v65, v100
v_mul_f32 v69, v69, v100
v_mul_f32 v66, v66, v100
v_mul_f32 v70, v70, v100
v_mul_f32 v67, v67, v100
v_mul_f32 v71, v71, v100
v_cvt_pk_bf16_f32 v108, v64, v65
v_cvt_pk_bf16_f32 v109, v66, v67
v_cvt_pk_bf16_f32 v110, v68, v69
v_cvt_pk_bf16_f32 v111, v70, v71
s_nop 0
v_permlane16_swap_b32 v108, v110
v_permlane16_swap_b32 v109, v111
s_add_u32 s25, s24, 131072
buffer_store_dwordx4 v[108:111], v4, s[4:7], s25 offen offset:64 sc1
v_mul_f32 v72, v72, v100
v_mul_f32 v76, v76, v100
v_mul_f32 v73, v73, v100
v_mul_f32 v77, v77, v100
v_mul_f32 v74, v74, v100
v_mul_f32 v78, v78, v100
v_mul_f32 v75, v75, v100
v_mul_f32 v79, v79, v100
v_cvt_pk_bf16_f32 v112, v72, v73
v_cvt_pk_bf16_f32 v113, v74, v75
v_cvt_pk_bf16_f32 v114, v76, v77
v_cvt_pk_bf16_f32 v115, v78, v79
s_nop 0
v_permlane16_swap_b32 v112, v114
v_permlane16_swap_b32 v113, v115
s_add_u32 s25, s24, 131072
buffer_store_dwordx4 v[112:115], v4, s[4:7], s25 offen offset:128 sc1
v_mul_f32 v80, v80, v100
v_mul_f32 v84, v84, v100
v_mul_f32 v81, v81, v100
v_mul_f32 v85, v85, v100
v_mul_f32 v82, v82, v100
v_mul_f32 v86, v86, v100
v_mul_f32 v83, v83, v100
v_mul_f32 v87, v87, v100
v_cvt_pk_bf16_f32 v116, v80, v81
v_cvt_pk_bf16_f32 v117, v82, v83
v_cvt_pk_bf16_f32 v118, v84, v85
v_cvt_pk_bf16_f32 v119, v86, v87
s_nop 0
v_permlane16_swap_b32 v116, v118
v_permlane16_swap_b32 v117, v119
s_add_u32 s25, s24, 131072
buffer_store_dwordx4 v[116:119], v4, s[4:7], s25 offen offset:192 sc1
s_cmp_ge_u32 s74, 60
s_cbranch_scc1 a2_64
s_waitcnt vmcnt(0)
s_barrier
s_cmp_lg_u32 s16, 0
s_cbranch_scc1 sig_66
v_mov_b32 v1, s76
v_mov_b32 v2, 2
s_mov_b64 exec, 1
buffer_atomic_add v2, v1, s[4:7], 0 offen
s_mov_b64 exec, -1
sig_66:
s_branch a3_65
a2_64:
s_waitcnt vmcnt(0)
s_barrier
s_cmp_lg_u32 s16, 0
s_cbranch_scc1 sig_67
v_mov_b32 v1, s76
v_mov_b32 v2, 4
s_mov_b64 exec, 1
buffer_atomic_add v2, v1, s[4:7], 0 offen
s_mov_b64 exec, -1
sig_67:
a3_65:
s_branch mega_kernel_wloop
mega_kernel_t3:
s_lshr_b32 s17, s16, 2
s_and_b32 s18, s16, 3
v_lshrrev_b32 v1, 3, v0
s_mov_b32 s24, 8192
v_mul_lo_u32 v1, v1, s24
v_lshrrev_b32 v2, 4, v0
v_and_b32 v3, 7, v0
s_mov_b32 s25, 0
s_xor_b32 s26, s25, 0
v_add_u32 v4, s26, v2
v_xor_b32 v4, v4, v3
v_lshl_add_u32 v8, v4, 4, v1
s_xor_b32 s26, s25, 4
v_add_u32 v4, s26, v2
v_xor_b32 v4, v4, v3
v_lshl_add_u32 v9, v4, 4, v1
v_lshrrev_b32 v1, 5, v0
v_and_b32 v3, 31, v0
s_mov_b32 s24, 2048
v_mul_lo_u32 v2, v1, s24
v_add_u32 v4, 0, v1
v_and_b32 v4, 3, v4
v_lshlrev_b32 v4, 2, v4
v_xor_b32 v4, v4, v3
v_lshl_add_u32 v10, v4, 4, v2
v_add_u32 v4, 2, v1
v_and_b32 v4, 3, v4
v_lshlrev_b32 v4, 2, v4
v_xor_b32 v4, v4, v3
v_lshl_add_u32 v11, v4, 4, v2
v_and_b32 v1, 31, v0
v_lshrrev_b32 v2, 5, v0
v_bfe_u32 v3, v1, 1, 3
s_mul_i32 s24, s17, 8192
v_lshlrev_b32 v4, 7, v1
v_add_u32 v4, s24, v4
v_add_u32 v5, 0, v2
v_xor_b32 v5, v5, v3
v_lshl_add_u32 v13, v5, 4, v4
v_add_u32 v5, 2, v2
v_xor_b32 v5, v5, v3
v_lshl_add_u32 v14, v5, 4, v4
v_add_u32 v5, 4, v2
v_xor_b32 v5, v5, v3
v_lshl_add_u32 v15, v5, 4, v4
v_add_u32 v5, 6, v2
v_xor_b32 v5, v5, v3
v_lshl_add_u32 v16, v5, 4, v4
v_and_b32 v1, 15, v0
v_lshrrev_b32 v2, 2, v1
v_lshrrev_b32 v3, 5, v0
v_lshl_add_u32 v3, v3, 3, v2
v_mul_u32_u24 v3, 512, v3
v_and_b32 v4, 3, v1
v_lshl_add_u32 v3, v4, 3, v3
v_bfe_u32 v4, v0, 4, 1
v_lshl_add_u32 v3, v4, 5, v3
v_add_u32 v3, 16384, v3
s_mul_i32 s24, s18, 2
s_add_u32 s24, s24, 0
v_xor_b32 v4, s24, v2
v_lshl_add_u32 v17, v4, 6, v3
s_mul_i32 s24, s18, 2
s_add_u32 s24, s24, 1
v_xor_b32 v4, s24, v2
v_lshl_add_u32 v18, v4, 6, v3
v_add_u32 v19, 49152, v13
v_add_u32 v20, 49152, v14
v_add_u32 v21, 49152, v15
v_add_u32 v22, 49152, v16
v_add_u32 v23, 49152, v17
v_add_u32 v24, 49152, v18
v_add_u32 v25, 98304, v13
v_add_u32 v26, 98304, v14
v_add_u32 v27, 98304, v15
v_add_u32 v28, 98304, v16
v_add_u32 v29, 98304, v17
v_add_u32 v30, 98304, v18
s_mul_i32 s22, s16, 2048
s_mul_i32 s23, s16, 4096
s_add_u32 s23, s23, 16384
s_mov_b32 s8, s70
s_and_b32 s9, s71, 0xffff
s_mov_b32 s10, 0x800000
s_mov_b32 s11, 0x00020000
s_lshl_b32 s28, s77, 7
s_lshl_b32 s52, s77, 6
s_add_u32 s52, s52, 960
s_cmp_ge_u32 s77, 15
s_cselect_b32 s28, s52, s28
s_lshl_b32 s29, s79, 8
s_mul_i32 s24, s16, 16
s_add_u32 s24, s24, s28
s_mul_i32 s19, s24, 8192
s_add_u32 s19, s19, 65011712
s_mul_i32 s20, s16, 16384
s_lshl_b32 s24, s29, 1
s_add_u32 s20, s20, s24
s_lshl_b32 s24, s60, 10
s_add_u32 s19, s19, s24
s_lshl_b32 s24, s60, 20
s_add_u32 s20, s20, s24
s_lshl_b32 s33, s60, 22
s_add_u32 s33, s33, 121643008
s_lshl_b32 s24, s28, 11
s_add_u32 s33, s33, s24
s_lshl_b32 s24, s29, 1
s_add_u32 s33, s33, s24
s_lshl_b32 s76, s60, 5
s_add_u32 s76, s76, s77
s_lshl_b32 s76, s76, 7
s_add_u32 s76, s76, 98304
s_cmp_lg_u32 s16, 0
s_cbranch_scc1 wf_68
v_mov_b32 v1, 0
v_mov_b32 v2, 0
v_writelane_b32 v1, s76, 0
s_mov_b32 s27, 4
v_writelane_b32 v2, s27, 0
s_mov_b64 exec, 1
wfp_69:
s_add_u32 s63, s63, 1
s_cmp_gt_u32 s63, 262144
s_cbranch_scc0 go_70
s_endpgm
go_70:
buffer_load_dword v3, v1, s[4:7], 0 offen sc1
s_waitcnt vmcnt(0)
v_cmp_lt_u32 vcc, v3, v2
s_nop 0
s_cbranch_vccz wfd_71
s_cmp_lt_u32 s77, 13
s_cbranch_scc1 urg_72
s_sleep 2
s_branch wfp_69
urg_72:
v_sub_u32 v4, v2, v3
s_nop 0
v_readlane_b32 s27, v4, 0
s_nop 0
s_cmp_lt_i32 s27, 2
s_cbranch_scc1 lv_73
s_sleep 40
s_branch wfp_69
lv_73:
s_cmp_lt_i32 s27, 1
s_cbranch_scc1 lv_74
s_sleep 12
s_branch wfp_69
lv_74:
s_sleep 8
s_branch wfp_69
wfd_71:
s_mov_b64 exec, -1
wf_68:
s_barrier
s_add_u32 m0, s22, 0
s_add_u32 s24, s19, 0
buffer_load_dwordx4 v8, s[4:7], s24 offen sc1 lds
s_add_u32 m0, s22, 1024
s_add_u32 s24, s19, 65536
buffer_load_dwordx4 v9, s[4:7], s24 offen sc1 lds
s_add_u32 m0, s23, 0
s_add_u32 s25, s20, 0
buffer_load_dwordx4 v10, s[8:11], s25 offen lds
s_add_u32 m0, s23, 1024
s_add_u32 s25, s20, 4096
buffer_load_dwordx4 v11, s[8:11], s25 offen lds
s_add_u32 m0, s23, 2048
s_add_u32 s25, s20, 8192
buffer_load_dwordx4 v10, s[8:11], s25 offen lds
s_add_u32 m0, s23, 3072
s_add_u32 s25, s20, 12288
buffer_load_dwordx4 v11, s[8:11], s25 offen lds
s_add_u32 m0, s22, 49152
s_add_u32 s24, s19, 128
buffer_load_dwordx4 v8, s[4:7], s24 offen sc1 lds
s_add_u32 m0, s22, 50176
s_add_u32 s24, s19, 65664
buffer_load_dwordx4 v9, s[4:7], s24 offen sc1 lds
s_add_u32 m0, s23, 49152
s_add_u32 s25, s20, 131072
buffer_load_dwordx4 v10, s[8:11], s25 offen lds
s_add_u32 m0, s23, 50176
s_add_u32 s25, s20, 135168
buffer_load_dwordx4 v11, s[8:11], s25 offen lds
s_add_u32 m0, s23, 51200
s_add_u32 s25, s20, 139264
buffer_load_dwordx4 v10, s[8:11], s25 offen lds
s_add_u32 m0, s23, 52224
s_add_u32 s25, s20, 143360
buffer_load_dwordx4 v11, s[8:11], s25 offen lds
v_accvgpr_write_b32 a0, 0
v_accvgpr_write_b32 a1, 0
v_accvgpr_write_b32 a2, 0
v_accvgpr_write_b32 a3, 0
v_accvgpr_write_b32 a4, 0
v_accvgpr_write_b32 a5, 0
v_accvgpr_write_b32 a6, 0
v_accvgpr_write_b32 a7, 0
v_accvgpr_write_b32 a8, 0
v_accvgpr_write_b32 a9, 0
v_accvgpr_write_b32 a10, 0
v_accvgpr_write_b32 a11, 0
v_accvgpr_write_b32 a12, 0
v_accvgpr_write_b32 a13, 0
v_accvgpr_write_b32 a14, 0
v_accvgpr_write_b32 a15, 0
v_accvgpr_write_b32 a16, 0
v_accvgpr_write_b32 a17, 0
v_accvgpr_write_b32 a18, 0
v_accvgpr_write_b32 a19, 0
v_accvgpr_write_b32 a20, 0
v_accvgpr_write_b32 a21, 0
v_accvgpr_write_b32 a22, 0
v_accvgpr_write_b32 a23, 0
v_accvgpr_write_b32 a24, 0
v_accvgpr_write_b32 a25, 0
v_accvgpr_write_b32 a26, 0
v_accvgpr_write_b32 a27, 0
v_accvgpr_write_b32 a28, 0
v_accvgpr_write_b32 a29, 0
v_accvgpr_write_b32 a30, 0
v_accvgpr_write_b32 a31, 0
v_accvgpr_write_b32 a32, 0
v_accvgpr_write_b32 a33, 0
v_accvgpr_write_b32 a34, 0
v_accvgpr_write_b32 a35, 0
v_accvgpr_write_b32 a36, 0
v_accvgpr_write_b32 a37, 0
v_accvgpr_write_b32 a38, 0
v_accvgpr_write_b32 a39, 0
v_accvgpr_write_b32 a40, 0
v_accvgpr_write_b32 a41, 0
v_accvgpr_write_b32 a42, 0
v_accvgpr_write_b32 a43, 0
v_accvgpr_write_b32 a44, 0
v_accvgpr_write_b32 a45, 0
v_accvgpr_write_b32 a46, 0
v_accvgpr_write_b32 a47, 0
v_accvgpr_write_b32 a48, 0
v_accvgpr_write_b32 a49, 0
v_accvgpr_write_b32 a50, 0
v_accvgpr_write_b32 a51, 0
v_accvgpr_write_b32 a52, 0
v_accvgpr_write_b32 a53, 0
v_accvgpr_write_b32 a54, 0
v_accvgpr_write_b32 a55, 0
v_accvgpr_write_b32 a56, 0
v_accvgpr_write_b32 a57, 0
v_accvgpr_write_b32 a58, 0
v_accvgpr_write_b32 a59, 0
v_accvgpr_write_b32 a60, 0
v_accvgpr_write_b32 a61, 0
v_accvgpr_write_b32 a62, 0
v_accvgpr_write_b32 a63, 0
s_waitcnt vmcnt(6)
s_barrier
RB 32,13,0
RB 36,13,4096
RT 40,17,0
RT 42,17,2048
RT 44,18,0
RT 46,18,2048
RB 48,14,0
RB 52,14,4096
RT 56,17,8192
RT 58,17,10240
RT 60,18,8192
RT 62,18,10240
RB 64,15,0
RB 68,15,4096
RT 72,17,16384
RT 74,17,18432
RT 76,18,16384
RT 78,18,18432
s_waitcnt lgkmcnt(12)
MM 0,40,32
RB 80,16,0
RB 84,16,4096
RT 88,17,24576
MM 16,44,32
RT 90,17,26624
RT 92,18,24576
RT 94,18,26624
MM 32,40,36
s_add_u32 m0, s22, 98304
s_add_u32 s24, s19, 256
buffer_load_dwordx4 v8, s[4:7], s24 offen sc1 lds
s_add_u32 m0, s22, 99328
s_add_u32 s24, s19, 65792
buffer_load_dwordx4 v9, s[4:7], s24 offen sc1 lds
s_add_u32 m0, s23, 98304
s_add_u32 s25, s20, 262144
buffer_load_dwordx4 v10, s[8:11], s25 offen lds
MM 48,44,36
s_add_u32 m0, s23, 99328
s_add_u32 s25, s20, 266240
buffer_load_dwordx4 v11, s[8:11], s25 offen lds
s_add_u32 m0, s23, 100352
s_add_u32 s25, s20, 270336
buffer_load_dwordx4 v10, s[8:11], s25 offen lds
s_add_u32 m0, s23, 101376
s_add_u32 s25, s20, 274432
buffer_load_dwordx4 v11, s[8:11], s25 offen lds
s_waitcnt lgkmcnt(0) vmcnt(6)
s_barrier
MM 0,56,48
RB 32,19,0
RB 36,19,4096
MM 16,60,48
RT 40,23,0
RT 42,23,2048
MM 32,56,52
RT 44,24,0
RT 46,24,2048
MM 48,60,52
s_add_u32 m0, s22, 0
s_add_u32 s24, s19, 384
buffer_load_dwordx4 v8, s[4:7], s24 offen sc1 lds
s_waitcnt lgkmcnt(12)
MM 0,72,64
RB 48,20,0
RB 52,20,4096
MM 16,76,64
RT 56,23,8192
RT 58,23,10240
MM 32,72,68
RT 60,24,8192
RT 62,24,10240
MM 48,76,68
s_add_u32 m0, s22, 1024
s_add_u32 s24, s19, 65920
buffer_load_dwordx4 v9, s[4:7], s24 offen sc1 lds
s_add_u32 m0, s23, 0
s_add_u32 s25, s20, 393216
buffer_load_dwordx4 v10, s[8:11], s25 offen lds
s_waitcnt lgkmcnt(12)
MM 0,88,80
RB 64,21,0
RB 68,21,4096
MM 16,92,80
RT 72,23,16384
RT 74,23,18432
MM 32,88,84
RT 76,24,16384
RT 78,24,18432
MM 48,92,84
s_add_u32 m0, s23, 1024
s_add_u32 s25, s20, 397312
buffer_load_dwordx4 v11, s[8:11], s25 offen lds
s_waitcnt lgkmcnt(12)
MM 0,40,32
RB 80,22,0
RB 84,22,4096
MM 16,44,32
RT 88,23,24576
RT 90,23,26624
MM 32,40,36
RT 92,24,24576
RT 94,24,26624
MM 48,44,36
s_add_u32 m0, s23, 2048
s_add_u32 s25, s20, 401408
buffer_load_dwordx4 v10, s[8:11], s25 offen lds
s_add_u32 m0, s23, 3072
s_add_u32 s25, s20, 405504
buffer_load_dwordx4 v11, s[8:11], s25 offen lds
s_waitcnt lgkmcnt(0) vmcnt(6)
s_barrier
MM 0,56,48
RB 32,25,0
RB 36,25,4096
MM 16,60,48
RT 40,29,0
RT 42,29,2048
MM 32,56,52
RT 44,30,0
RT 46,30,2048
MM 48,60,52
s_add_u32 m0, s22, 49152
s_add_u32 s24, s19, 512
buffer_load_dwordx4 v8, s[4:7], s24 offen sc1 lds
s_waitcnt lgkmcnt(12)
MM 0,72,64
RB 48,26,0
RB 52,26,4096
MM 16,76,64
RT 56,29,8192
RT 58,29,10240
MM 32,72,68
RT 60,30,8192
RT 62,30,10240
MM 48,76,68
s_add_u32 m0, s22, 50176
s_add_u32 s24, s19, 66048
buffer_load_dwordx4 v9, s[4:7], s24 offen sc1 lds
s_add_u32 m0, s23, 49152
s_add_u32 s25, s20, 524288
buffer_load_dwordx4 v10, s[8:11], s25 offen lds
s_waitcnt lgkmcnt(12)
MM 0,88,80
RB 64,27,0
RB 68,27,4096
MM 16,92,80
RT 72,29,16384
RT 74,29,18432
MM 32,88,84
RT 76,30,16384
RT 78,30,18432
MM 48,92,84
s_add_u32 m0, s23, 50176
s_add_u32 s25, s20, 528384
buffer_load_dwordx4 v11, s[8:11], s25 offen lds
s_waitcnt lgkmcnt(12)
MM 0,40,32
RB 80,28,0
RB 84,28,4096
MM 16,44,32
RT 88,29,24576
RT 90,29,26624
MM 32,40,36
RT 92,30,24576
RT 94,30,26624
MM 48,44,36
s_add_u32 m0, s23, 51200
s_add_u32 s25, s20, 532480
buffer_load_dwordx4 v10, s[8:11], s25 offen lds
s_add_u32 m0, s23, 52224
s_add_u32 s25, s20, 536576
buffer_load_dwordx4 v11, s[8:11], s25 offen lds
s_waitcnt lgkmcnt(0) vmcnt(6)
s_barrier
MM 0,56,48
RB 32,13,0
RB 36,13,4096
MM 16,60,48
RT 40,17,0
RT 42,17,2048
MM 32,56,52
RT 44,18,0
RT 46,18,2048
MM 48,60,52
s_add_u32 m0, s22, 98304
s_add_u32 s24, s19, 640
buffer_load_dwordx4 v8, s[4:7], s24 offen sc1 lds
s_waitcnt lgkmcnt(12)
MM 0,72,64
RB 48,14,0
RB 52,14,4096
MM 16,76,64
RT 56,17,8192
RT 58,17,10240
MM 32,72,68
RT 60,18,8192
RT 62,18,10240
MM 48,76,68
s_add_u32 m0, s22, 99328
s_add_u32 s24, s19, 66176
buffer_load_dwordx4 v9, s[4:7], s24 offen sc1 lds
s_add_u32 m0, s23, 98304
s_add_u32 s25, s20, 655360
buffer_load_dwordx4 v10, s[8:11], s25 offen lds
s_waitcnt lgkmcnt(12)
MM 0,88,80
RB 64,15,0
RB 68,15,4096
MM 16,92,80
RT 72,17,16384
RT 74,17,18432
MM 32,88,84
RT 76,18,16384
RT 78,18,18432
MM 48,92,84
s_add_u32 m0, s23, 99328
s_add_u32 s25, s20, 659456
buffer_load_dwordx4 v11, s[8:11], s25 offen lds
s_waitcnt lgkmcnt(12)
MM 0,40,32
RB 80,16,0
RB 84,16,4096
MM 16,44,32
RT 88,17,24576
RT 90,17,26624
MM 32,40,36
RT 92,18,24576
RT 94,18,26624
MM 48,44,36
s_add_u32 m0, s23, 100352
s_add_u32 s25, s20, 663552
buffer_load_dwordx4 v10, s[8:11], s25 offen lds
s_add_u32 m0, s23, 101376
s_add_u32 s25, s20, 667648
buffer_load_dwordx4 v11, s[8:11], s25 offen lds
s_waitcnt lgkmcnt(0) vmcnt(6)
s_barrier
MM 0,56,48
RB 32,19,0
RB 36,19,4096
MM 16,60,48
RT 40,23,0
RT 42,23,2048
MM 32,56,52
RT 44,24,0
RT 46,24,2048
MM 48,60,52
s_add_u32 m0, s22, 0
s_add_u32 s24, s19, 768
buffer_load_dwordx4 v8, s[4:7], s24 offen sc1 lds
s_waitcnt lgkmcnt(12)
MM 0,72,64
RB 48,20,0
RB 52,20,4096
MM 16,76,64
RT 56,23,8192
RT 58,23,10240
MM 32,72,68
RT 60,24,8192
RT 62,24,10240
MM 48,76,68
s_add_u32 m0, s22, 1024
s_add_u32 s24, s19, 66304
buffer_load_dwordx4 v9, s[4:7], s24 offen sc1 lds
s_add_u32 m0, s23, 0
s_add_u32 s25, s20, 786432
buffer_load_dwordx4 v10, s[8:11], s25 offen lds
s_waitcnt lgkmcnt(12)
MM 0,88,80
RB 64,21,0
RB 68,21,4096
MM 16,92,80
RT 72,23,16384
RT 74,23,18432
MM 32,88,84
RT 76,24,16384
RT 78,24,18432
MM 48,92,84
s_add_u32 m0, s23, 1024
s_add_u32 s25, s20, 790528
buffer_load_dwordx4 v11, s[8:11], s25 offen lds
s_waitcnt lgkmcnt(12)
MM 0,40,32
RB 80,22,0
RB 84,22,4096
MM 16,44,32
RT 88,23,24576
RT 90,23,26624
MM 32,40,36
RT 92,24,24576
RT 94,24,26624
MM 48,44,36
s_add_u32 m0, s23, 2048
s_add_u32 s25, s20, 794624
buffer_load_dwordx4 v10, s[8:11], s25 offen lds
s_add_u32 m0, s23, 3072
s_add_u32 s25, s20, 798720
buffer_load_dwordx4 v11, s[8:11], s25 offen lds
s_waitcnt lgkmcnt(0) vmcnt(6)
s_barrier
MM 0,56,48
RB 32,25,0
RB 36,25,4096
MM 16,60,48
RT 40,29,0
RT 42,29,2048
MM 32,56,52
RT 44,30,0
RT 46,30,2048
MM 48,60,52
s_add_u32 m0, s22, 49152
s_add_u32 s24, s19, 896
buffer_load_dwordx4 v8, s[4:7], s24 offen sc1 lds
s_waitcnt lgkmcnt(12)
MM 0,72,64
RB 48,26,0
RB 52,26,4096
MM 16,76,64
RT 56,29,8192
RT 58,29,10240
MM 32,72,68
RT 60,30,8192
RT 62,30,10240
MM 48,76,68
s_add_u32 m0, s22, 50176
s_add_u32 s24, s19, 66432
buffer_load_dwordx4 v9, s[4:7], s24 offen sc1 lds
s_add_u32 m0, s23, 49152
s_add_u32 s25, s20, 917504
buffer_load_dwordx4 v10, s[8:11], s25 offen lds
s_waitcnt lgkmcnt(12)
MM 0,88,80
RB 64,27,0
RB 68,27,4096
MM 16,92,80
RT 72,29,16384
RT 74,29,18432
MM 32,88,84
RT 76,30,16384
RT 78,30,18432
MM 48,92,84
s_add_u32 m0, s23, 50176
s_add_u32 s25, s20, 921600
buffer_load_dwordx4 v11, s[8:11], s25 offen lds
s_waitcnt lgkmcnt(12)
MM 0,40,32
RB 80,28,0
RB 84,28,4096
MM 16,44,32
RT 88,29,24576
RT 90,29,26624
MM 32,40,36
RT 92,30,24576
RT 94,30,26624
MM 48,44,36
s_add_u32 m0, s23, 51200
s_add_u32 s25, s20, 925696
buffer_load_dwordx4 v10, s[8:11], s25 offen lds
s_add_u32 m0, s23, 52224
s_add_u32 s25, s20, 929792
buffer_load_dwordx4 v11, s[8:11], s25 offen lds
s_waitcnt lgkmcnt(0) vmcnt(6)
s_barrier
MM 0,56,48
RB 32,13,0
RB 36,13,4096
MM 16,60,48
RT 40,17,0
MM 32,56,52
RT 42,17,2048
RT 44,18,0
MM 48,60,52
RT 46,18,2048
s_waitcnt lgkmcnt(12)
MM 0,72,64
RB 48,14,0
RB 52,14,4096
MM 16,76,64
RT 56,17,8192
MM 32,72,68
RT 58,17,10240
RT 60,18,8192
MM 48,76,68
RT 62,18,10240
s_waitcnt lgkmcnt(12)
MM 0,88,80
RB 64,15,0
RB 68,15,4096
MM 16,92,80
RT 72,17,16384
MM 32,88,84
RT 74,17,18432
RT 76,18,16384
MM 48,92,84
RT 78,18,18432
s_waitcnt lgkmcnt(12)
MM 0,40,32
RB 80,16,0
RB 84,16,4096
MM 16,44,32
RT 88,17,24576
MM 32,40,36
RT 90,17,26624
RT 92,18,24576
MM 48,44,36
RT 94,18,26624
s_waitcnt lgkmcnt(0) vmcnt(0)
s_barrier
MM 0,56,48
RB 32,19,0
RB 36,19,4096
MM 16,60,48
RT 40,23,0
MM 32,56,52
RT 42,23,2048
RT 44,24,0
MM 48,60,52
RT 46,24,2048
s_waitcnt lgkmcnt(12)
MM 0,72,64
RB 48,20,0
RB 52,20,4096
MM 16,76,64
RT 56,23,8192
MM 32,72,68
RT 58,23,10240
RT 60,24,8192
MM 48,76,68
RT 62,24,10240
s_waitcnt lgkmcnt(12)
MM 0,88,80
RB 64,21,0
RB 68,21,4096
MM 16,92,80
RT 72,23,16384
MM 32,88,84
RT 74,23,18432
RT 76,24,16384
MM 48,92,84
RT 78,24,18432
s_waitcnt lgkmcnt(12)
MM 0,40,32
RB 80,22,0
RB 84,22,4096
MM 16,44,32
RT 88,23,24576
MM 32,40,36
RT 90,23,26624
RT 92,24,24576
MM 48,44,36
RT 94,24,26624
s_waitcnt lgkmcnt(0)
MM 0,56,48
MM 16,60,48
MM 32,56,52
MM 48,60,52
s_waitcnt lgkmcnt(0)
MM 0,72,64
MM 16,76,64
MM 32,72,68
MM 48,76,68
s_waitcnt lgkmcnt(0)
MM 0,88,80
MM 16,92,80
MM 32,88,84
MM 48,92,84
s_barrier
s_cmp_lg_u32 s16, 0
s_cbranch_scc1 tt_75
v_mov_b32 v7, s56
v_accvgpr_write_b32 a127, 1
s_mov_b64 exec, 1
buffer_atomic_add a127, v7, s[4:7], 0 offen sc0
s_mov_b64 exec, -1
tt_75:
v_and_b32 v1, 31, v0
v_lshrrev_b32 v2, 5, v0
s_mul_i32 s24, s17, 33792
s_mul_i32 s25, s18, 128
s_add_u32 s24, s24, s25
v_mul_u32_u24 v3, 528, v1
v_lshl_add_u32 v3, v2, 4, v3
v_add_u32 v3, s24, v3
v_lshrrev_b32 v4, 5, v0
v_and_b32 v5, 31, v0
s_mul_i32 s24, s16, 16
v_add_u32 v4, s24, v4
v_mul_u32_u24 v6, 528, v4
v_lshl_add_u32 v6, v5, 4, v6
s_mov_b32 s24, 2048
v_mul_lo_u32 v12, v4, s24
v_lshl_add_u32 v12, v5, 4, v12
v_accvgpr_read_b32 v32, a0
v_accvgpr_read_b32 v33, a1
v_accvgpr_read_b32 v34, a2
v_accvgpr_read_b32 v35, a3
v_accvgpr_read_b32 v36, a4
v_accvgpr_read_b32 v37, a5
v_accvgpr_read_b32 v38, a6
v_accvgpr_read_b32 v39, a7
v_accvgpr_read_b32 v40, a8
v_accvgpr_read_b32 v41, a9
v_accvgpr_read_b32 v42, a10
v_accvgpr_read_b32 v43, a11
v_accvgpr_read_b32 v44, a12
v_accvgpr_read_b32 v45, a13
v_accvgpr_read_b32 v46, a14
v_accvgpr_read_b32 v47, a15
v_cvt_pk_bf16_f32 v48, v32, v33
v_cvt_pk_bf16_f32 v49, v34, v35
v_cvt_pk_bf16_f32 v50, v36, v37
v_cvt_pk_bf16_f32 v51, v38, v39
v_cvt_pk_bf16_f32 v52, v40, v41
v_cvt_pk_bf16_f32 v53, v42, v43
v_cvt_pk_bf16_f32 v54, v44, v45
v_cvt_pk_bf16_f32 v55, v46, v47
v_permlane32_swap_b32 v48, v50
v_permlane32_swap_b32 v49, v51
v_permlane32_swap_b32 v52, v54
v_permlane32_swap_b32 v53, v55
ds_write_b128 v3, v[48:51] offset:0
ds_write_b128 v3, v[52:55] offset:32
v_accvgpr_read_b32 v32, a16
v_accvgpr_read_b32 v33, a17
v_accvgpr_read_b32 v34, a18
v_accvgpr_read_b32 v35, a19
v_accvgpr_read_b32 v36, a20
v_accvgpr_read_b32 v37, a21
v_accvgpr_read_b32 v38, a22
v_accvgpr_read_b32 v39, a23
v_accvgpr_read_b32 v40, a24
v_accvgpr_read_b32 v41, a25
v_accvgpr_read_b32 v42, a26
v_accvgpr_read_b32 v43, a27
v_accvgpr_read_b32 v44, a28
v_accvgpr_read_b32 v45, a29
v_accvgpr_read_b32 v46, a30
v_accvgpr_read_b32 v47, a31
v_cvt_pk_bf16_f32 v56, v32, v33
v_cvt_pk_bf16_f32 v57, v34, v35
v_cvt_pk_bf16_f32 v58, v36, v37
v_cvt_pk_bf16_f32 v59, v38, v39
v_cvt_pk_bf16_f32 v60, v40, v41
v_cvt_pk_bf16_f32 v61, v42, v43
v_cvt_pk_bf16_f32 v62, v44, v45
v_cvt_pk_bf16_f32 v63, v46, v47
v_permlane32_swap_b32 v56, v58
v_permlane32_swap_b32 v57, v59
v_permlane32_swap_b32 v60, v62
v_permlane32_swap_b32 v61, v63
ds_write_b128 v3, v[56:59] offset:64
ds_write_b128 v3, v[60:63] offset:96
v_accvgpr_read_b32 v32, a32
v_accvgpr_read_b32 v33, a33
v_accvgpr_read_b32 v34, a34
v_accvgpr_read_b32 v35, a35
v_accvgpr_read_b32 v36, a36
v_accvgpr_read_b32 v37, a37
v_accvgpr_read_b32 v38, a38
v_accvgpr_read_b32 v39, a39
v_accvgpr_read_b32 v40, a40
v_accvgpr_read_b32 v41, a41
v_accvgpr_read_b32 v42, a42
v_accvgpr_read_b32 v43, a43
v_accvgpr_read_b32 v44, a44
v_accvgpr_read_b32 v45, a45
v_accvgpr_read_b32 v46, a46
v_accvgpr_read_b32 v47, a47
v_cvt_pk_bf16_f32 v48, v32, v33
v_cvt_pk_bf16_f32 v49, v34, v35
v_cvt_pk_bf16_f32 v50, v36, v37
v_cvt_pk_bf16_f32 v51, v38, v39
v_cvt_pk_bf16_f32 v52, v40, v41
v_cvt_pk_bf16_f32 v53, v42, v43
v_cvt_pk_bf16_f32 v54, v44, v45
v_cvt_pk_bf16_f32 v55, v46, v47
v_permlane32_swap_b32 v48, v50
v_permlane32_swap_b32 v49, v51
v_permlane32_swap_b32 v52, v54
v_permlane32_swap_b32 v53, v55
ds_write_b128 v3, v[48:51] offset:16896
ds_write_b128 v3, v[52:55] offset:16928
v_accvgpr_read_b32 v32, a48
v_accvgpr_read_b32 v33, a49
v_accvgpr_read_b32 v34, a50
v_accvgpr_read_b32 v35, a51
v_accvgpr_read_b32 v36, a52
v_accvgpr_read_b32 v37, a53
v_accvgpr_read_b32 v38, a54
v_accvgpr_read_b32 v39, a55
v_accvgpr_read_b32 v40, a56
v_accvgpr_read_b32 v41, a57
v_accvgpr_read_b32 v42, a58
v_accvgpr_read_b32 v43, a59
v_accvgpr_read_b32 v44, a60
v_accvgpr_read_b32 v45, a61
v_accvgpr_read_b32 v46, a62
v_accvgpr_read_b32 v47, a63
v_cvt_pk_bf16_f32 v56, v32, v33
v_cvt_pk_bf16_f32 v57, v34, v35
v_cvt_pk_bf16_f32 v58, v36, v37
v_cvt_pk_bf16_f32 v59, v38, v39
v_cvt_pk_bf16_f32 v60, v40, v41
v_cvt_pk_bf16_f32 v61, v42, v43
v_cvt_pk_bf16_f32 v62, v44, v45
v_cvt_pk_bf16_f32 v63, v46, v47
v_permlane32_swap_b32 v56, v58
v_permlane32_swap_b32 v57, v59
v_permlane32_swap_b32 v60, v62
v_permlane32_swap_b32 v61, v63
ds_write_b128 v3, v[56:59] offset:16960
ds_write_b128 v3, v[60:63] offset:16992
s_waitcnt lgkmcnt(0)
s_barrier
RB 32,6,0
RB 36,6,1056
RB 40,6,2112
RB 44,6,3168
RB 48,6,4224
RB 52,6,5280
RB 56,6,6336
RB 60,6,7392
s_waitcnt lgkmcnt(7)
s_add_u32 s24, s33, 0
buffer_store_dwordx4 v[32:35], v12, s[4:7], s24 offen sc1
s_waitcnt lgkmcnt(6)
s_add_u32 s24, s33, 4096
buffer_store_dwordx4 v[36:39], v12, s[4:7], s24 offen sc1
s_waitcnt lgkmcnt(5)
s_add_u32 s24, s33, 8192
buffer_store_dwordx4 v[40:43], v12, s[4:7], s24 offen sc1
s_waitcnt lgkmcnt(4)
s_add_u32 s24, s33, 12288
buffer_store_dwordx4 v[44:47], v12, s[4:7], s24 offen sc1
s_waitcnt lgkmcnt(3)
s_add_u32 s24, s33, 16384
buffer_store_dwordx4 v[48:51], v12, s[4:7], s24 offen sc1
s_waitcnt lgkmcnt(2)
s_add_u32 s24, s33, 20480
buffer_store_dwordx4 v[52:55], v12, s[4:7], s24 offen sc1
s_waitcnt lgkmcnt(1)
s_add_u32 s24, s33, 24576
buffer_store_dwordx4 v[56:59], v12, s[4:7], s24 offen sc1
s_waitcnt lgkmcnt(0)
s_add_u32 s24, s33, 28672
buffer_store_dwordx4 v[60:63], v12, s[4:7], s24 offen sc1
s_lshl_b32 s76, s77, 3
s_add_u32 s76, s76, s60
s_lshl_b32 s76, s76, 7
s_add_u32 s76, s76, 131072
s_waitcnt vmcnt(0)
s_barrier
s_cmp_lg_u32 s16, 0
s_cbranch_scc1 sig_76
v_mov_b32 v1, s76
v_mov_b32 v2, 4
s_mov_b64 exec, 1
buffer_atomic_add v2, v1, s[4:7], 0 offen
s_mov_b64 exec, -1
sig_76:
s_branch mega_kernel_wloop
mega_kernel_t11:
s_lshr_b32 s17, s16, 2
s_and_b32 s18, s16, 3
v_lshrrev_b32 v1, 3, v0
s_mov_b32 s24, 8192
v_mul_lo_u32 v1, v1, s24
v_lshrrev_b32 v2, 4, v0
v_and_b32 v3, 7, v0
s_mov_b32 s25, 0
s_xor_b32 s26, s25, 0
v_add_u32 v4, s26, v2
v_xor_b32 v4, v4, v3
v_lshl_add_u32 v8, v4, 4, v1
s_xor_b32 s26, s25, 4
v_add_u32 v4, s26, v2
v_xor_b32 v4, v4, v3
v_lshl_add_u32 v9, v4, 4, v1
v_lshrrev_b32 v1, 4, v0
v_and_b32 v3, 15, v0
s_mov_b32 s24, 2048
v_mul_lo_u32 v2, v1, s24
v_add_u32 v4, 0, v1
v_and_b32 v4, 3, v4
v_lshlrev_b32 v4, 2, v4
v_xor_b32 v4, v4, v3
v_lshl_add_u32 v10, v4, 4, v2
v_add_u32 v4, 0, v1
v_and_b32 v4, 3, v4
v_lshlrev_b32 v4, 2, v4
v_xor_b32 v4, v4, v3
v_lshl_add_u32 v11, v4, 4, v2
v_and_b32 v1, 31, v0
v_lshrrev_b32 v2, 5, v0
v_bfe_u32 v3, v1, 1, 3
s_mul_i32 s24, s17, 8192
v_lshlrev_b32 v4, 7, v1
v_add_u32 v4, s24, v4
v_add_u32 v5, 0, v2
v_xor_b32 v5, v5, v3
v_lshl_add_u32 v13, v5, 4, v4
v_add_u32 v5, 2, v2
v_xor_b32 v5, v5, v3
v_lshl_add_u32 v14, v5, 4, v4
v_add_u32 v5, 4, v2
v_xor_b32 v5, v5, v3
v_lshl_add_u32 v15, v5, 4, v4
v_add_u32 v5, 6, v2
v_xor_b32 v5, v5, v3
v_lshl_add_u32 v16, v5, 4, v4
v_and_b32 v1, 15, v0
v_lshrrev_b32 v2, 2, v1
v_lshrrev_b32 v3, 5, v0
v_lshl_add_u32 v3, v3, 3, v2
v_mul_u32_u24 v3, 256, v3
v_and_b32 v4, 3, v1
v_lshl_add_u32 v3, v4, 3, v3
v_bfe_u32 v4, v0, 4, 1
v_lshl_add_u32 v3, v4, 5, v3
v_add_u32 v3, 16384, v3
s_mul_i32 s24, s18, 1
s_add_u32 s24, s24, 0
v_xor_b32 v4, s24, v2
v_lshl_add_u32 v17, v4, 6, v3
v_add_u32 v18, 65536, v13
v_add_u32 v19, 65536, v14
v_add_u32 v20, 65536, v15
v_add_u32 v21, 65536, v16
v_add_u32 v22, 65536, v17
v_add_u32 v23, 131072, v13
v_add_u32 v24, 131072, v14
v_add_u32 v25, 131072, v15
v_add_u32 v26, 131072, v16
v_add_u32 v27, 131072, v17
s_mul_i32 s22, s16, 2048
s_mul_i32 s23, s16, 2048
s_add_u32 s23, s23, 16384
s_mov_b32 s8, s70
s_and_b32 s9, s71, 0xffff
s_mov_b32 s10, 0x800000
s_mov_b32 s11, 0x00020000
s_lshl_b32 s28, s77, 7
s_lshl_b32 s52, s77, 6
s_add_u32 s52, s52, 960
s_cmp_ge_u32 s77, 15
s_cselect_b32 s28, s52, s28
s_lshl_b32 s29, s79, 7
s_mul_i32 s24, s16, 16
s_add_u32 s24, s24, s28
s_mul_i32 s19, s24, 8192
s_add_u32 s19, s19, 65011712
s_mul_i32 s20, s16, 16384
s_lshl_b32 s24, s29, 1
s_add_u32 s20, s20, s24
s_lshl_b32 s24, s60, 10
s_add_u32 s19, s19, s24
s_lshl_b32 s24, s60, 20
s_add_u32 s20, s20, s24
s_lshl_b32 s33, s60, 22
s_add_u32 s33, s33, 121643008
s_lshl_b32 s24, s28, 11
s_add_u32 s33, s33, s24
s_lshl_b32 s24, s29, 1
s_add_u32 s33, s33, s24
s_lshl_b32 s76, s60, 5
s_add_u32 s76, s76, s77
s_lshl_b32 s76, s76, 7
s_add_u32 s76, s76, 98304
s_cmp_lg_u32 s16, 0
s_cbranch_scc1 wf_77
v_mov_b32 v1, 0
v_mov_b32 v2, 0
v_writelane_b32 v1, s76, 0
s_mov_b32 s27, 4
v_writelane_b32 v2, s27, 0
s_mov_b64 exec, 1
wfp_78:
s_add_u32 s63, s63, 1
s_cmp_gt_u32 s63, 262144
s_cbranch_scc0 go_79
s_endpgm
go_79:
buffer_load_dword v3, v1, s[4:7], 0 offen sc1
s_waitcnt vmcnt(0)
v_cmp_lt_u32 vcc, v3, v2
s_nop 0
s_cbranch_vccz wfd_80
s_cmp_lt_u32 s77, 13
s_cbranch_scc1 urg_81
s_sleep 2
s_branch wfp_78
urg_81:
v_sub_u32 v4, v2, v3
s_nop 0
v_readlane_b32 s27, v4, 0
s_nop 0
s_cmp_lt_i32 s27, 2
s_cbranch_scc1 lv_82
s_sleep 40
s_branch wfp_78
lv_82:
s_cmp_lt_i32 s27, 1
s_cbranch_scc1 lv_83
s_sleep 12
s_branch wfp_78
lv_83:
s_sleep 8
s_branch wfp_78
wfd_80:
s_mov_b64 exec, -1
wf_77:
s_barrier
s_add_u32 m0, s22, 0
s_add_u32 s24, s19, 0
buffer_load_dwordx4 v8, s[4:7], s24 offen sc1 lds
s_add_u32 m0, s22, 1024
s_add_u32 s24, s19, 65536
buffer_load_dwordx4 v9, s[4:7], s24 offen sc1 lds
s_add_u32 m0, s23, 0
s_add_u32 s25, s20, 0
buffer_load_dwordx4 v10, s[8:11], s25 offen lds
s_add_u32 m0, s23, 1024
s_add_u32 s25, s20, 8192
buffer_load_dwordx4 v11, s[8:11], s25 offen lds
s_add_u32 m0, s22, 32768
s_add_u32 s24, s19, 128
buffer_load_dwordx4 v8, s[4:7], s24 offen sc1 lds
s_add_u32 m0, s22, 33792
s_add_u32 s24, s19, 65664
buffer_load_dwordx4 v9, s[4:7], s24 offen sc1 lds
s_add_u32 m0, s23, 32768
s_add_u32 s25, s20, 131072
buffer_load_dwordx4 v10, s[8:11], s25 offen lds
s_add_u32 m0, s23, 33792
s_add_u32 s25, s20, 139264
buffer_load_dwordx4 v11, s[8:11], s25 offen lds
v_accvgpr_write_b32 a0, 0
v_accvgpr_write_b32 a1, 0
v_accvgpr_write_b32 a2, 0
v_accvgpr_write_b32 a3, 0
v_accvgpr_write_b32 a4, 0
v_accvgpr_write_b32 a5, 0
v_accvgpr_write_b32 a6, 0
v_accvgpr_write_b32 a7, 0
v_accvgpr_write_b32 a8, 0
v_accvgpr_write_b32 a9, 0
v_accvgpr_write_b32 a10, 0
v_accvgpr_write_b32 a11, 0
v_accvgpr_write_b32 a12, 0
v_accvgpr_write_b32 a13, 0
v_accvgpr_write_b32 a14, 0
v_accvgpr_write_b32 a15, 0
v_accvgpr_write_b32 a16, 0
v_accvgpr_write_b32 a17, 0
v_accvgpr_write_b32 a18, 0
v_accvgpr_write_b32 a19, 0
v_accvgpr_write_b32 a20, 0
v_accvgpr_write_b32 a21, 0
v_accvgpr_write_b32 a22, 0
v_accvgpr_write_b32 a23, 0
v_accvgpr_write_b32 a24, 0
v_accvgpr_write_b32 a25, 0
v_accvgpr_write_b32 a26, 0
v_accvgpr_write_b32 a27, 0
v_accvgpr_write_b32 a28, 0
v_accvgpr_write_b32 a29, 0
v_accvgpr_write_b32 a30, 0
v_accvgpr_write_b32 a31, 0
s_waitcnt vmcnt(4)
s_barrier
RB 32,13,0
RB 36,13,4096
RT 40,17,0
RT 42,17,1024
RB 44,14,0
RB 48,14,4096
RT 52,17,4096
RT 54,17,5120
RB 56,15,0
RB 60,15,4096
RT 64,17,8192
RT 66,17,9216
s_waitcnt lgkmcnt(8)
MM 0,40,32
RB 68,16,0
RB 72,16,4096
RT 76,17,12288
RT 78,17,13312
MM 16,40,36
s_add_u32 m0, s22, 65536
s_add_u32 s24, s19, 256
buffer_load_dwordx4 v8, s[4:7], s24 offen sc1 lds
s_add_u32 m0, s22, 66560
s_add_u32 s24, s19, 65792
buffer_load_dwordx4 v9, s[4:7], s24 offen sc1 lds
s_add_u32 m0, s23, 65536
s_add_u32 s25, s20, 262144
buffer_load_dwordx4 v10, s[8:11], s25 offen lds
s_add_u32 m0, s23, 66560
s_add_u32 s25, s20, 270336
buffer_load_dwordx4 v11, s[8:11], s25 offen lds
s_waitcnt lgkmcnt(8) vmcnt(4)
s_barrier
MM 0,52,44
RB 32,13,32768
RB 36,13,36864
RT 40,17,32768
MM 16,52,48
RT 42,17,33792
s_add_u32 m0, s22, 98304
s_add_u32 s24, s19, 384
buffer_load_dwordx4 v8, s[4:7], s24 offen sc1 lds
s_add_u32 m0, s22, 99328
s_add_u32 s24, s19, 65920
buffer_load_dwordx4 v9, s[4:7], s24 offen sc1 lds
s_waitcnt lgkmcnt(8)
MM 0,64,56
RB 44,14,32768
RB 48,14,36864
RT 52,17,36864
MM 16,64,60
RT 54,17,37888
s_add_u32 m0, s23, 98304
s_add_u32 s25, s20, 393216
buffer_load_dwordx4 v10, s[8:11], s25 offen lds
s_add_u32 m0, s23, 99328
s_add_u32 s25, s20, 401408
buffer_load_dwordx4 v11, s[8:11], s25 offen lds
s_waitcnt lgkmcnt(8)
MM 0,76,68
RB 56,15,32768
RB 60,15,36864
RT 64,17,40960
MM 16,76,72
RT 66,17,41984
s_add_u32 m0, s22, 131072
s_add_u32 s24, s19, 512
buffer_load_dwordx4 v8, s[4:7], s24 offen sc1 lds
s_add_u32 m0, s22, 132096
s_add_u32 s24, s19, 66048
buffer_load_dwordx4 v9, s[4:7], s24 offen sc1 lds
s_waitcnt lgkmcnt(8)
MM 0,40,32
RB 68,16,32768
RB 72,16,36864
RT 76,17,45056
MM 16,40,36
RT 78,17,46080
s_add_u32 m0, s23, 131072
s_add_u32 s25, s20, 524288
buffer_load_dwordx4 v10, s[8:11], s25 offen lds
s_add_u32 m0, s23, 132096
s_add_u32 s25, s20, 532480
buffer_load_dwordx4 v11, s[8:11], s25 offen lds
s_waitcnt lgkmcnt(8) vmcnt(8)
s_barrier
MM 0,52,44
RB 32,18,0
RB 36,18,4096
RT 40,22,0
MM 16,52,48
RT 42,22,1024
s_add_u32 m0, s22, 0
s_add_u32 s24, s19, 640
buffer_load_dwordx4 v8, s[4:7], s24 offen sc1 lds
s_waitcnt lgkmcnt(8)
MM 0,64,56
RB 44,19,0
RB 48,19,4096
RT 52,22,4096
MM 16,64,60
RT 54,22,5120
s_add_u32 m0, s22, 1024
s_add_u32 s24, s19, 66176
buffer_load_dwordx4 v9, s[4:7], s24 offen sc1 lds
s_waitcnt lgkmcnt(8)
MM 0,76,68
RB 56,20,0
RB 60,20,4096
RT 64,22,8192
MM 16,76,72
RT 66,22,9216
s_add_u32 m0, s23, 0
s_add_u32 s25, s20, 655360
buffer_load_dwordx4 v10, s[8:11], s25 offen lds
s_waitcnt lgkmcnt(8)
MM 0,40,32
RB 68,21,0
RB 72,21,4096
RT 76,22,12288
MM 16,40,36
RT 78,22,13312
s_add_u32 m0, s23, 1024
s_add_u32 s25, s20, 663552
buffer_load_dwordx4 v11, s[8:11], s25 offen lds
s_waitcnt lgkmcnt(8) vmcnt(8)
s_barrier
MM 0,52,44
RB 32,18,32768
RB 36,18,36864
RT 40,22,32768
MM 16,52,48
RT 42,22,33792
s_add_u32 m0, s22, 32768
s_add_u32 s24, s19, 768
buffer_load_dwordx4 v8, s[4:7], s24 offen sc1 lds
s_waitcnt lgkmcnt(8)
MM 0,64,56
RB 44,19,32768
RB 48,19,36864
RT 52,22,36864
MM 16,64,60
RT 54,22,37888
s_add_u32 m0, s22, 33792
s_add_u32 s24, s19, 66304
buffer_load_dwordx4 v9, s[4:7], s24 offen sc1 lds
s_waitcnt lgkmcnt(8)
MM 0,76,68
RB 56,20,32768
RB 60,20,36864
RT 64,22,40960
MM 16,76,72
RT 66,22,41984
s_add_u32 m0, s23, 32768
s_add_u32 s25, s20, 786432
buffer_load_dwordx4 v10, s[8:11], s25 offen lds
s_waitcnt lgkmcnt(8)
MM 0,40,32
RB 68,21,32768
RB 72,21,36864
RT 76,22,45056
MM 16,40,36
RT 78,22,46080
s_add_u32 m0, s23, 33792
s_add_u32 s25, s20, 794624
buffer_load_dwordx4 v11, s[8:11], s25 offen lds
s_waitcnt lgkmcnt(8) vmcnt(8)
s_barrier
MM 0,52,44
RB 32,23,0
RB 36,23,4096
RT 40,27,0
MM 16,52,48
RT 42,27,1024
s_add_u32 m0, s22, 65536
s_add_u32 s24, s19, 896
buffer_load_dwordx4 v8, s[4:7], s24 offen sc1 lds
s_waitcnt lgkmcnt(8)
MM 0,64,56
RB 44,24,0
RB 48,24,4096
RT 52,27,4096
MM 16,64,60
RT 54,27,5120
s_add_u32 m0, s22, 66560
s_add_u32 s24, s19, 66432
buffer_load_dwordx4 v9, s[4:7], s24 offen sc1 lds
s_waitcnt lgkmcnt(8)
MM 0,76,68
RB 56,25,0
RB 60,25,4096
RT 64,27,8192
MM 16,76,72
RT 66,27,9216
s_add_u32 m0, s23, 65536
s_add_u32 s25, s20, 917504
buffer_load_dwordx4 v10, s[8:11], s25 offen lds
s_waitcnt lgkmcnt(8)
MM 0,40,32
RB 68,26,0
RB 72,26,4096
RT 76,27,12288
MM 16,40,36
RT 78,27,13312
s_add_u32 m0, s23, 66560
s_add_u32 s25, s20, 925696
buffer_load_dwordx4 v11, s[8:11], s25 offen lds
s_waitcnt lgkmcnt(8) vmcnt(8)
s_barrier
MM 0,52,44
RB 32,13,0
RB 36,13,4096
MM 16,52,48
RT 40,17,0
RT 42,17,1024
s_waitcnt lgkmcnt(8)
MM 0,64,56
RB 44,14,0
RB 48,14,4096
MM 16,64,60
RT 52,17,4096
RT 54,17,5120
s_waitcnt lgkmcnt(8)
MM 0,76,68
RB 56,15,0
RB 60,15,4096
MM 16,76,72
RT 64,17,8192
RT 66,17,9216
s_waitcnt lgkmcnt(8)
MM 0,40,32
RB 68,16,0
RB 72,16,4096
MM 16,40,36
RT 76,17,12288
RT 78,17,13312
s_waitcnt lgkmcnt(8) vmcnt(4)
s_barrier
MM 0,52,44
RB 32,13,32768
RB 36,13,36864
MM 16,52,48
RT 40,17,32768
RT 42,17,33792
s_waitcnt lgkmcnt(8)
MM 0,64,56
RB 44,14,32768
RB 48,14,36864
MM 16,64,60
RT 52,17,36864
RT 54,17,37888
s_waitcnt lgkmcnt(8)
MM 0,76,68
RB 56,15,32768
RB 60,15,36864
MM 16,76,72
RT 64,17,40960
RT 66,17,41984
s_waitcnt lgkmcnt(8)
MM 0,40,32
RB 68,16,32768
RB 72,16,36864
MM 16,40,36
RT 76,17,45056
RT 78,17,46080
s_waitcnt lgkmcnt(8) vmcnt(0)
s_barrier
MM 0,52,44
RB 32,18,0
RB 36,18,4096
MM 16,52,48
RT 40,22,0
RT 42,22,1024
s_waitcnt lgkmcnt(8)
MM 0,64,56
RB 44,19,0
RB 48,19,4096
MM 16,64,60
RT 52,22,4096
RT 54,22,5120
s_waitcnt lgkmcnt(8)
MM 0,76,68
RB 56,20,0
RB 60,20,4096
MM 16,76,72
RT 64,22,8192
RT 66,22,9216
s_waitcnt lgkmcnt(8)
MM 0,40,32
RB 68,21,0
RB 72,21,4096
MM 16,40,36
RT 76,22,12288
RT 78,22,13312
s_waitcnt lgkmcnt(0)
MM 0,52,44
MM 16,52,48
s_waitcnt lgkmcnt(0)
MM 0,64,56
MM 16,64,60
s_waitcnt lgkmcnt(0)
MM 0,76,68
MM 16,76,72
s_barrier
s_cmp_lg_u32 s16, 0
s_cbranch_scc1 tt_84
v_mov_b32 v7, s56
v_accvgpr_write_b32 a127, 1
s_mov_b64 exec, 1
buffer_atomic_add a127, v7, s[4:7], 0 offen sc0
s_mov_b64 exec, -1
tt_84:
v_and_b32 v1, 31, v0
v_lshrrev_b32 v2, 5, v0
s_mul_i32 s24, s17, 17408
s_mul_i32 s25, s18, 64
s_add_u32 s24, s24, s25
v_mul_u32_u24 v3, 272, v1
v_lshl_add_u32 v3, v2, 4, v3
v_add_u32 v3, s24, v3
v_lshrrev_b32 v4, 4, v0
v_and_b32 v5, 15, v0
s_mul_i32 s24, s16, 16
v_add_u32 v4, s24, v4
v_mul_u32_u24 v6, 272, v4
v_lshl_add_u32 v6, v5, 4, v6
s_mov_b32 s24, 2048
v_mul_lo_u32 v12, v4, s24
v_lshl_add_u32 v12, v5, 4, v12
v_accvgpr_read_b32 v32, a0
v_accvgpr_read_b32 v33, a1
v_accvgpr_read_b32 v34, a2
v_accvgpr_read_b32 v35, a3
v_accvgpr_read_b32 v36, a4
v_accvgpr_read_b32 v37, a5
v_accvgpr_read_b32 v38, a6
v_accvgpr_read_b32 v39, a7
v_accvgpr_read_b32 v40, a8
v_accvgpr_read_b32 v41, a9
v_accvgpr_read_b32 v42, a10
v_accvgpr_read_b32 v43, a11
v_accvgpr_read_b32 v44, a12
v_accvgpr_read_b32 v45, a13
v_accvgpr_read_b32 v46, a14
v_accvgpr_read_b32 v47, a15
v_cvt_pk_bf16_f32 v48, v32, v33
v_cvt_pk_bf16_f32 v49, v34, v35
v_cvt_pk_bf16_f32 v50, v36, v37
v_cvt_pk_bf16_f32 v51, v38, v39
v_cvt_pk_bf16_f32 v52, v40, v41
v_cvt_pk_bf16_f32 v53, v42, v43
v_cvt_pk_bf16_f32 v54, v44, v45
v_cvt_pk_bf16_f32 v55, v46, v47
v_permlane32_swap_b32 v48, v50
v_permlane32_swap_b32 v49, v51
v_permlane32_swap_b32 v52, v54
v_permlane32_swap_b32 v53, v55
ds_write_b128 v3, v[48:51] offset:0
ds_write_b128 v3, v[52:55] offset:32
v_accvgpr_read_b32 v32, a16
v_accvgpr_read_b32 v33, a17
v_accvgpr_read_b32 v34, a18
v_accvgpr_read_b32 v35, a19
v_accvgpr_read_b32 v36, a20
v_accvgpr_read_b32 v37, a21
v_accvgpr_read_b32 v38, a22
v_accvgpr_read_b32 v39, a23
v_accvgpr_read_b32 v40, a24
v_accvgpr_read_b32 v41, a25
v_accvgpr_read_b32 v42, a26
v_accvgpr_read_b32 v43, a27
v_accvgpr_read_b32 v44, a28
v_accvgpr_read_b32 v45, a29
v_accvgpr_read_b32 v46, a30
v_accvgpr_read_b32 v47, a31
v_cvt_pk_bf16_f32 v56, v32, v33
v_cvt_pk_bf16_f32 v57, v34, v35
v_cvt_pk_bf16_f32 v58, v36, v37
v_cvt_pk_bf16_f32 v59, v38, v39
v_cvt_pk_bf16_f32 v60, v40, v41
v_cvt_pk_bf16_f32 v61, v42, v43
v_cvt_pk_bf16_f32 v62, v44, v45
v_cvt_pk_bf16_f32 v63, v46, v47
v_permlane32_swap_b32 v56, v58
v_permlane32_swap_b32 v57, v59
v_permlane32_swap_b32 v60, v62
v_permlane32_swap_b32 v61, v63
ds_write_b128 v3, v[56:59] offset:8704
ds_write_b128 v3, v[60:63] offset:8736
s_waitcnt lgkmcnt(0)
s_barrier
RB 32,6,0
RB 36,6,1088
RB 40,6,2176
RB 44,6,3264
s_waitcnt lgkmcnt(3)
s_add_u32 s24, s33, 0
buffer_store_dwordx4 v[32:35], v12, s[4:7], s24 offen sc1
s_waitcnt lgkmcnt(2)
s_add_u32 s24, s33, 8192
buffer_store_dwordx4 v[36:39], v12, s[4:7], s24 offen sc1
s_waitcnt lgkmcnt(1)
s_add_u32 s24, s33, 16384
buffer_store_dwordx4 v[40:43], v12, s[4:7], s24 offen sc1
s_waitcnt lgkmcnt(0)
s_add_u32 s24, s33, 24576
buffer_store_dwordx4 v[44:47], v12, s[4:7], s24 offen sc1
s_lshl_b32 s76, s77, 3
s_add_u32 s76, s76, s60
s_lshl_b32 s76, s76, 7
s_add_u32 s76, s76, 131072
s_waitcnt vmcnt(0)
s_barrier
s_cmp_lg_u32 s16, 0
s_cbranch_scc1 sig_85
v_mov_b32 v1, s76
v_mov_b32 v2, 2
s_mov_b64 exec, 1
buffer_atomic_add v2, v1, s[4:7], 0 offen
s_mov_b64 exec, -1
sig_85:
s_branch mega_kernel_wloop
mega_kernel_t18:
s_bfe_u32 s17, s16, 65537
s_and_b32 s18, s16, 1
s_lshr_b32 s52, s16, 2
v_lshrrev_b32 v1, 3, v0
s_mov_b32 s24, 8192
v_mul_lo_u32 v1, v1, s24
v_lshrrev_b32 v2, 4, v0
v_and_b32 v3, 7, v0
s_and_b32 s25, s16, 1
s_lshl_b32 s25, s25, 2
v_add_u32 v4, s25, v2
v_xor_b32 v4, v4, v3
v_lshl_add_u32 v8, v4, 4, v1
v_lshrrev_b32 v1, 3, v0
v_and_b32 v3, 7, v0
s_mov_b32 s24, 2048
v_mul_lo_u32 v2, v1, s24
v_bfe_u32 v4, v1, 1, 1
v_lshlrev_b32 v4, 2, v4
v_xor_b32 v4, v4, v3
v_lshl_add_u32 v10, v4, 4, v2
v_and_b32 v1, 31, v0
v_lshrrev_b32 v2, 5, v0
v_bfe_u32 v3, v1, 1, 3
s_mul_i32 s24, s17, 4096
v_lshlrev_b32 v4, 7, v1
v_add_u32 v4, s24, v4
s_lshl_b32 s25, s52, 2
s_add_u32 s26, s25, 0
v_add_u32 v5, s26, v2
v_xor_b32 v5, v5, v3
v_lshl_add_u32 v13, v5, 4, v4
s_add_u32 s26, s25, 2
v_add_u32 v5, s26, v2
v_xor_b32 v5, v5, v3
v_lshl_add_u32 v14, v5, 4, v4
v_and_b32 v1, 15, v0
v_lshrrev_b32 v2, 2, v1
v_lshrrev_b32 v3, 5, v0
v_lshl_add_u32 v3, v3, 3, v2
s_lshl_b32 s24, s52, 5
v_add_u32 v3, s24, v3
v_lshlrev_b32 v3, 7, v3
v_and_b32 v4, 3, v1
v_lshl_add_u32 v3, v4, 3, v3
v_bfe_u32 v4, v0, 4, 1
v_lshl_add_u32 v3, v4, 5, v3
v_add_u32 v3, 8192, v3
v_bfe_u32 v4, v2, 1, 1
v_xor_b32 v4, s18, v4
v_lshl_add_u32 v15, v4, 6, v3
v_add_u32 v16, 65536, v13
v_add_u32 v17, 65536, v14
v_add_u32 v18, 65536, v15
s_lshl_b32 s22, s16, 10
s_add_u32 s23, s22, 8192
s_mov_b32 s8, s70
s_and_b32 s9, s71, 0xffff
s_mov_b32 s10, 0x800000
s_mov_b32 s11, 0x00020000
s_lshl_b32 s28, s77, 7
s_lshl_b32 s52, s77, 6
s_add_u32 s52, s52, 960
s_cmp_ge_u32 s77, 15
s_cselect_b32 s28, s52, s28
s_lshl_b32 s29, s79, 6
s_mul_i32 s24, s16, 8
s_add_u32 s24, s24, s28
s_mul_i32 s19, s24, 8192
s_add_u32 s19, s19, 65011712
s_mul_i32 s20, s16, 16384
s_lshl_b32 s24, s29, 1
s_add_u32 s20, s20, s24
s_lshl_b32 s24, s60, 10
s_add_u32 s19, s19, s24
s_lshl_b32 s24, s60, 20
s_add_u32 s20, s20, s24
s_lshl_b32 s33, s60, 22
s_add_u32 s33, s33, 121643008
s_lshl_b32 s24, s28, 11
s_add_u32 s33, s33, s24
s_lshl_b32 s24, s29, 1
s_add_u32 s33, s33, s24
s_lshl_b32 s76, s60, 5
s_add_u32 s76, s76, s77
s_lshl_b32 s76, s76, 7
s_add_u32 s76, s76, 98304
s_cmp_lg_u32 s16, 0
s_cbranch_scc1 wf_86
v_mov_b32 v1, 0
v_mov_b32 v2, 0
v_writelane_b32 v1, s76, 0
s_mov_b32 s27, 4
v_writelane_b32 v2, s27, 0
s_mov_b64 exec, 1
wfp_87:
s_add_u32 s63, s63, 1
s_cmp_gt_u32 s63, 262144
s_cbranch_scc0 go_88
s_endpgm
go_88:
buffer_load_dword v3, v1, s[4:7], 0 offen sc1
s_waitcnt vmcnt(0)
v_cmp_lt_u32 vcc, v3, v2
s_nop 0
s_cbranch_vccz wfd_89
s_cmp_lt_u32 s77, 13
s_cbranch_scc1 urg_90
s_sleep 2
s_branch wfp_87
urg_90:
v_sub_u32 v4, v2, v3
s_nop 0
v_readlane_b32 s27, v4, 0
s_nop 0
s_cmp_lt_i32 s27, 2
s_cbranch_scc1 lv_91
s_sleep 40
s_branch wfp_87
lv_91:
s_cmp_lt_i32 s27, 1
s_cbranch_scc1 lv_92
s_sleep 12
s_branch wfp_87
lv_92:
s_sleep 8
s_branch wfp_87
wfd_89:
s_mov_b64 exec, -1
wf_86:
s_barrier
s_add_u32 m0, s22, 0
s_add_u32 s24, s19, 0
buffer_load_dwordx4 v8, s[4:7], s24 offen sc1 lds
s_add_u32 m0, s23, 0
s_add_u32 s25, s20, 0
buffer_load_dwordx4 v10, s[8:11], s25 offen lds
s_add_u32 m0, s22, 16384
s_add_u32 s24, s19, 128
buffer_load_dwordx4 v8, s[4:7], s24 offen sc1 lds
s_add_u32 m0, s23, 16384
s_add_u32 s25, s20, 131072
buffer_load_dwordx4 v10, s[8:11], s25 offen lds
s_add_u32 m0, s22, 32768
s_add_u32 s24, s19, 256
buffer_load_dwordx4 v8, s[4:7], s24 offen sc1 lds
s_add_u32 m0, s23, 32768
s_add_u32 s25, s20, 262144
buffer_load_dwordx4 v10, s[8:11], s25 offen lds
v_accvgpr_write_b32 a0, 0
v_accvgpr_write_b32 a1, 0
v_accvgpr_write_b32 a2, 0
v_accvgpr_write_b32 a3, 0
v_accvgpr_write_b32 a4, 0
v_accvgpr_write_b32 a5, 0
v_accvgpr_write_b32 a6, 0
v_accvgpr_write_b32 a7, 0
v_accvgpr_write_b32 a8, 0
v_accvgpr_write_b32 a9, 0
v_accvgpr_write_b32 a10, 0
v_accvgpr_write_b32 a11, 0
v_accvgpr_write_b32 a12, 0
v_accvgpr_write_b32 a13, 0
v_accvgpr_write_b32 a14, 0
v_accvgpr_write_b32 a15, 0
s_waitcnt vmcnt(4)
s_barrier
RB 32,13,0
RT 36,15,0
RT 38,15,512
RB 40,14,0
RT 44,15,2048
RT 46,15,2560
s_waitcnt vmcnt(2)
s_barrier
RB 48,13,16384
RT 52,15,16384
RT 54,15,16896
RB 56,14,16384
RT 60,15,18432
RT 62,15,18944
s_waitcnt lgkmcnt(6)
MM 0,36,32
MM 0,44,40
s_add_u32 m0, s22, 49152
s_add_u32 s24, s19, 384
buffer_load_dwordx4 v8, s[4:7], s24 offen sc1 lds
s_add_u32 m0, s23, 49152
s_add_u32 s25, s20, 393216
buffer_load_dwordx4 v10, s[8:11], s25 offen lds
s_add_u32 m0, s22, 65536
s_add_u32 s24, s19, 512
buffer_load_dwordx4 v8, s[4:7], s24 offen sc1 lds
s_add_u32 m0, s23, 65536
s_add_u32 s25, s20, 524288
buffer_load_dwordx4 v10, s[8:11], s25 offen lds
s_waitcnt vmcnt(4)
s_barrier
RB 32,13,32768
RT 36,15,32768
RT 38,15,33280
RB 40,14,32768
RT 44,15,34816
RT 46,15,35328
s_waitcnt lgkmcnt(6)
MM 0,52,48
MM 0,60,56
s_add_u32 m0, s22, 81920
s_add_u32 s24, s19, 640
buffer_load_dwordx4 v8, s[4:7], s24 offen sc1 lds
s_add_u32 m0, s23, 81920
s_add_u32 s25, s20, 655360
buffer_load_dwordx4 v10, s[8:11], s25 offen lds
s_add_u32 m0, s22, 0
s_add_u32 s24, s19, 768
buffer_load_dwordx4 v8, s[4:7], s24 offen sc1 lds
s_add_u32 m0, s23, 0
s_add_u32 s25, s20, 786432
buffer_load_dwordx4 v10, s[8:11], s25 offen lds
s_waitcnt vmcnt(6)
s_barrier
RB 48,13,49152
RT 52,15,49152
RT 54,15,49664
RB 56,14,49152
RT 60,15,51200
RT 62,15,51712
s_waitcnt lgkmcnt(6)
MM 0,36,32
MM 0,44,40
s_add_u32 m0, s22, 16384
s_add_u32 s24, s19, 896
buffer_load_dwordx4 v8, s[4:7], s24 offen sc1 lds
s_add_u32 m0, s23, 16384
s_add_u32 s25, s20, 917504
buffer_load_dwordx4 v10, s[8:11], s25 offen lds
s_waitcnt vmcnt(6)
s_barrier
RB 32,16,0
RT 36,18,0
RT 38,18,512
RB 40,17,0
RT 44,18,2048
RT 46,18,2560
s_waitcnt lgkmcnt(6)
MM 0,52,48
MM 0,60,56
s_waitcnt vmcnt(4)
s_barrier
RB 48,16,16384
RT 52,18,16384
RT 54,18,16896
RB 56,17,16384
RT 60,18,18432
RT 62,18,18944
s_waitcnt lgkmcnt(6)
MM 0,36,32
MM 0,44,40
s_waitcnt vmcnt(2)
s_barrier
RB 32,13,0
RT 36,15,0
RT 38,15,512
RB 40,14,0
RT 44,15,2048
RT 46,15,2560
s_waitcnt lgkmcnt(6)
MM 0,52,48
MM 0,60,56
s_waitcnt vmcnt(0)
s_barrier
RB 48,13,16384
RT 52,15,16384
RT 54,15,16896
RB 56,14,16384
RT 60,15,18432
RT 62,15,18944
s_waitcnt lgkmcnt(6)
MM 0,36,32
MM 0,44,40
s_waitcnt lgkmcnt(0)
MM 0,52,48
MM 0,60,56
s_barrier
s_and_b32 s24, s16, 3
s_lshl_b32 s24, s24, 12
v_lshlrev_b32 v1, 4, v0
v_add_u32 v1, s24, v1
v_add_u32 v1, 65536, v1
s_cmp_lt_u32 s16, 4
s_cbranch_scc1 ksr_93
s_nop 3
ds_write_b128 v1, a[0:3] offset:0
ds_write_b128 v1, a[4:7] offset:1024
ds_write_b128 v1, a[8:11] offset:2048
ds_write_b128 v1, a[12:15] offset:3072
s_waitcnt lgkmcnt(0)
ksr_93:
s_barrier
s_cmp_ge_u32 s16, 4
s_cbranch_scc1 kse_94
RB 32,1,0
RB 36,1,1024
RB 40,1,2048
RB 44,1,3072
v_accvgpr_read_b32 v48, a0
v_accvgpr_read_b32 v49, a1
v_accvgpr_read_b32 v50, a2
v_accvgpr_read_b32 v51, a3
v_accvgpr_read_b32 v52, a4
v_accvgpr_read_b32 v53, a5
v_accvgpr_read_b32 v54, a6
v_accvgpr_read_b32 v55, a7
v_accvgpr_read_b32 v56, a8
v_accvgpr_read_b32 v57, a9
v_accvgpr_read_b32 v58, a10
v_accvgpr_read_b32 v59, a11
v_accvgpr_read_b32 v60, a12
v_accvgpr_read_b32 v61, a13
v_accvgpr_read_b32 v62, a14
v_accvgpr_read_b32 v63, a15
s_waitcnt lgkmcnt(0)
v_add_f32 v48, v48, v32
v_add_f32 v49, v49, v33
v_add_f32 v50, v50, v34
v_add_f32 v51, v51, v35
v_add_f32 v52, v52, v36
v_add_f32 v53, v53, v37
v_add_f32 v54, v54, v38
v_add_f32 v55, v55, v39
v_add_f32 v56, v56, v40
v_add_f32 v57, v57, v41
v_add_f32 v58, v58, v42
v_add_f32 v59, v59, v43
v_add_f32 v60, v60, v44
v_add_f32 v61, v61, v45
v_add_f32 v62, v62, v46
v_add_f32 v63, v63, v47
v_accvgpr_write_b32 a0, v48
v_accvgpr_write_b32 a1, v49
v_accvgpr_write_b32 a2, v50
v_accvgpr_write_b32 a3, v51
v_accvgpr_write_b32 a4, v52
v_accvgpr_write_b32 a5, v53
v_accvgpr_write_b32 a6, v54
v_accvgpr_write_b32 a7, v55
v_accvgpr_write_b32 a8, v56
v_accvgpr_write_b32 a9, v57
v_accvgpr_write_b32 a10, v58
v_accvgpr_write_b32 a11, v59
v_accvgpr_write_b32 a12, v60
v_accvgpr_write_b32 a13, v61
v_accvgpr_write_b32 a14, v62
v_accvgpr_write_b32 a15, v63
kse_94:
s_cmp_lg_u32 s16, 0
s_cbranch_scc1 tt_95
v_mov_b32 v7, s56
v_accvgpr_write_b32 a127, 1
s_mov_b64 exec, 1
buffer_atomic_add a127, v7, s[4:7], 0 offen sc0
s_mov_b64 exec, -1
tt_95:
v_and_b32 v1, 31, v0
v_lshrrev_b32 v2, 5, v0
s_mul_i32 s24, s17, 4608
s_mul_i32 s25, s18, 64
s_add_u32 s24, s24, s25
v_mul_u32_u24 v3, 144, v1
v_lshl_add_u32 v3, v2, 4, v3
v_add_u32 v3, s24, v3
v_lshrrev_b32 v4, 3, v0
v_and_b32 v5, 7, v0
s_mul_i32 s24, s16, 8
v_add_u32 v4, s24, v4
v_mul_u32_u24 v6, 144, v4
v_lshl_add_u32 v6, v5, 4, v6
s_mov_b32 s24, 2048
v_mul_lo_u32 v12, v4, s24
v_lshl_add_u32 v12, v5, 4, v12
s_cmp_ge_u32 s16, 4
s_cbranch_scc1 epw_96
v_accvgpr_read_b32 v32, a0
v_accvgpr_read_b32 v33, a1
v_accvgpr_read_b32 v34, a2
v_accvgpr_read_b32 v35, a3
v_accvgpr_read_b32 v36, a4
v_accvgpr_read_b32 v37, a5
v_accvgpr_read_b32 v38, a6
v_accvgpr_read_b32 v39, a7
v_accvgpr_read_b32 v40, a8
v_accvgpr_read_b32 v41, a9
v_accvgpr_read_b32 v42, a10
v_accvgpr_read_b32 v43, a11
v_accvgpr_read_b32 v44, a12
v_accvgpr_read_b32 v45, a13
v_accvgpr_read_b32 v46, a14
v_accvgpr_read_b32 v47, a15
v_cvt_pk_bf16_f32 v48, v32, v33
v_cvt_pk_bf16_f32 v49, v34, v35
v_cvt_pk_bf16_f32 v50, v36, v37
v_cvt_pk_bf16_f32 v51, v38, v39
v_cvt_pk_bf16_f32 v52, v40, v41
v_cvt_pk_bf16_f32 v53, v42, v43
v_cvt_pk_bf16_f32 v54, v44, v45
v_cvt_pk_bf16_f32 v55, v46, v47
v_permlane32_swap_b32 v48, v50
v_permlane32_swap_b32 v49, v51
v_permlane32_swap_b32 v52, v54
v_permlane32_swap_b32 v53, v55
ds_write_b128 v3, v[48:51] offset:0
ds_write_b128 v3, v[52:55] offset:32
epw_96:
s_waitcnt lgkmcnt(0)
s_barrier
RB 32,6,0
s_waitcnt lgkmcnt(0)
s_add_u32 s24, s33, 0
buffer_store_dwordx4 v[32:35], v12, s[4:7], s24 offen sc1
s_lshl_b32 s76, s77, 3
s_add_u32 s76, s76, s60
s_lshl_b32 s76, s76, 7
s_add_u32 s76, s76, 131072
s_waitcnt vmcnt(0)
s_barrier
s_cmp_lg_u32 s16, 0
s_cbranch_scc1 sig_97
v_mov_b32 v1, s76
v_mov_b32 v2, 1
s_mov_b64 exec, 1
buffer_atomic_add v2, v1, s[4:7], 0 offen
s_mov_b64 exec, -1
sig_97:
s_branch mega_kernel_wloop
mega_kernel_t4:
s_lshl_b32 s76, s77, 10
s_add_u32 s76, s76, 131072
s_cmp_lg_u32 s16, 0
s_cbranch_scc1 ws_98
v_lshlrev_b32 v1, 7, v0
v_add_u32 v1, s76, v1
s_mov_b64 exec, 0xff
wsp_99:
s_add_u32 s63, s63, 1
s_cmp_gt_u32 s63, 262144
s_cbranch_scc0 go_101
s_endpgm
go_101:
buffer_load_dword v3, v1, s[4:7], 0 offen sc1
s_waitcnt vmcnt(0)
s_mov_b32 s26, 0
v_readlane_b32 s27, v3, 0
s_nop 0
s_add_u32 s26, s26, s27
v_readlane_b32 s27, v3, 1
s_nop 0
s_add_u32 s26, s26, s27
v_readlane_b32 s27, v3, 2
s_nop 0
s_add_u32 s26, s26, s27
v_readlane_b32 s27, v3, 3
s_nop 0
s_add_u32 s26, s26, s27
v_readlane_b32 s27, v3, 4
s_nop 0
s_add_u32 s26, s26, s27
v_readlane_b32 s27, v3, 5
s_nop 0
s_add_u32 s26, s26, s27
v_readlane_b32 s27, v3, 6
s_nop 0
s_add_u32 s26, s26, s27
v_readlane_b32 s27, v3, 7
s_nop 0
s_add_u32 s26, s26, s27
s_sub_i32 s26, 128, s26
s_cmp_lt_i32 s26, 1
s_cbranch_scc1 wsd_100
s_cmp_lt_u32 s77, 13
s_cbranch_scc1 urg_102
s_sleep 2
s_branch wsp_99
urg_102:
s_cmp_lt_i32 s26, 3
s_cbranch_scc1 lv_103
s_sleep 40
s_branch wsp_99
lv_103:
s_cmp_lt_i32 s26, 1
s_cbranch_scc1 lv_104
s_sleep 12
s_branch wsp_99
lv_104:
s_sleep 8
s_branch wsp_99
wsd_100:
s_mov_b64 exec, -1
ws_98:
s_barrier
s_cmp_lg_u32 s16, 0
s_cbranch_scc1 tt_105
v_mov_b32 v7, s56
v_accvgpr_write_b32 a127, 1
s_mov_b64 exec, 1
buffer_atomic_add a127, v7, s[4:7], 0 offen sc0
s_mov_b64 exec, -1
tt_105:
s_lshl_b32 s24, s77, 7
s_lshl_b32 s52, s77, 6
s_add_u32 s52, s52, 960
s_cmp_ge_u32 s77, 15
s_cselect_b32 s24, s52, s24
s_lshl_b32 s25, s60, 4
s_lshl_b32 s26, s79, 3
s_add_u32 s25, s25, s26
s_lshl_b32 s26, s60, 3
s_cmp_ge_u32 s77, 15
s_cselect_b32 s25, s26, s25
s_add_u32 s24, s24, s25
s_add_u32 s24, s24, s16
s_lshl_b32 s24, s24, 11
v_lshl_add_u32 v2, v0, 4, s24
s_mov_b32 s12, s88
s_and_b32 s13, s89, 0xffff
s_mov_b32 s14, 0x400000
s_mov_b32 s15, 0x00020000
buffer_load_dwordx4 v[4:7], v2, s[12:15], 0 offen
buffer_load_dwordx4 v[8:11], v2, s[12:15], 0 offen offset:1024
s_mov_b32 s26, 121643008
buffer_load_dwordx4 v[48:51], v2, s[4:7], s26 offen sc1
buffer_load_dwordx4 v[52:55], v2, s[4:7], s26 offen offset:1024 sc1
s_mov_b32 s26, 125837312
buffer_load_dwordx4 v[56:59], v2, s[4:7], s26 offen sc1
buffer_load_dwordx4 v[60:63], v2, s[4:7], s26 offen offset:1024 sc1
s_mov_b32 s26, 130031616
buffer_load_dwordx4 v[64:67], v2, s[4:7], s26 offen sc1
buffer_load_dwordx4 v[68:71], v2, s[4:7], s26 offen offset:1024 sc1
s_mov_b32 s26, 134225920
buffer_load_dwordx4 v[72:75], v2, s[4:7], s26 offen sc1
buffer_load_dwordx4 v[76:79], v2, s[4:7], s26 offen offset:1024 sc1
s_mov_b32 s26, 138420224
buffer_load_dwordx4 v[80:83], v2, s[4:7], s26 offen sc1
buffer_load_dwordx4 v[84:87], v2, s[4:7], s26 offen offset:1024 sc1
s_mov_b32 s26, 142614528
buffer_load_dwordx4 v[88:91], v2, s[4:7], s26 offen sc1
buffer_load_dwordx4 v[92:95], v2, s[4:7], s26 offen offset:1024 sc1
s_mov_b32 s26, 146808832
buffer_load_dwordx4 v[96:99], v2, s[4:7], s26 offen sc1
buffer_load_dwordx4 v[100:103], v2, s[4:7], s26 offen offset:1024 sc1
s_mov_b32 s26, 151003136
buffer_load_dwordx4 v[104:107], v2, s[4:7], s26 offen sc1
buffer_load_dwordx4 v[108:111], v2, s[4:7], s26 offen offset:1024 sc1
s_waitcnt vmcnt(0)
v_lshlrev_b32 v12, 16, v48
v_and_b32 v13, 0xffff0000, v48
v_lshlrev_b32 v14, 16, v49
v_and_b32 v15, 0xffff0000, v49
v_lshlrev_b32 v16, 16, v50
v_and_b32 v17, 0xffff0000, v50
v_lshlrev_b32 v18, 16, v51
v_and_b32 v19, 0xffff0000, v51
v_lshlrev_b32 v20, 16, v52
v_and_b32 v21, 0xffff0000, v52
v_lshlrev_b32 v22, 16, v53
v_and_b32 v23, 0xffff0000, v53
v_lshlrev_b32 v24, 16, v54
v_and_b32 v25, 0xffff0000, v54
v_lshlrev_b32 v26, 16, v55
v_and_b32 v27, 0xffff0000, v55
v_lshlrev_b32 v28, 16, v56
v_and_b32 v29, 0xffff0000, v56
v_pk_add_f32 v[12:13], v[12:13], v[28:29]
v_lshlrev_b32 v30, 16, v57
v_and_b32 v31, 0xffff0000, v57
v_pk_add_f32 v[14:15], v[14:15], v[30:31]
v_lshlrev_b32 v28, 16, v58
v_and_b32 v29, 0xffff0000, v58
v_pk_add_f32 v[16:17], v[16:17], v[28:29]
v_lshlrev_b32 v30, 16, v59
v_and_b32 v31, 0xffff0000, v59
v_pk_add_f32 v[18:19], v[18:19], v[30:31]
v_lshlrev_b32 v28, 16, v60
v_and_b32 v29, 0xffff0000, v60
v_pk_add_f32 v[20:21], v[20:21], v[28:29]
v_lshlrev_b32 v30, 16, v61
v_and_b32 v31, 0xffff0000, v61
v_pk_add_f32 v[22:23], v[22:23], v[30:31]
v_lshlrev_b32 v28, 16, v62
v_and_b32 v29, 0xffff0000, v62
v_pk_add_f32 v[24:25], v[24:25], v[28:29]
v_lshlrev_b32 v30, 16, v63
v_and_b32 v31, 0xffff0000, v63
v_pk_add_f32 v[26:27], v[26:27], v[30:31]
v_lshlrev_b32 v28, 16, v64
v_and_b32 v29, 0xffff0000, v64
v_pk_add_f32 v[12:13], v[12:13], v[28:29]
v_lshlrev_b32 v30, 16, v65
v_and_b32 v31, 0xffff0000, v65
v_pk_add_f32 v[14:15], v[14:15], v[30:31]
v_lshlrev_b32 v28, 16, v66
v_and_b32 v29, 0xffff0000, v66
v_pk_add_f32 v[16:17], v[16:17], v[28:29]
v_lshlrev_b32 v30, 16, v67
v_and_b32 v31, 0xffff0000, v67
v_pk_add_f32 v[18:19], v[18:19], v[30:31]
v_lshlrev_b32 v28, 16, v68
v_and_b32 v29, 0xffff0000, v68
v_pk_add_f32 v[20:21], v[20:21], v[28:29]
v_lshlrev_b32 v30, 16, v69
v_and_b32 v31, 0xffff0000, v69
v_pk_add_f32 v[22:23], v[22:23], v[30:31]
v_lshlrev_b32 v28, 16, v70
v_and_b32 v29, 0xffff0000, v70
v_pk_add_f32 v[24:25], v[24:25], v[28:29]
v_lshlrev_b32 v30, 16, v71
v_and_b32 v31, 0xffff0000, v71
v_pk_add_f32 v[26:27], v[26:27], v[30:31]
v_lshlrev_b32 v28, 16, v72
v_and_b32 v29, 0xffff0000, v72
v_pk_add_f32 v[12:13], v[12:13], v[28:29]
v_lshlrev_b32 v30, 16, v73
v_and_b32 v31, 0xffff0000, v73
v_pk_add_f32 v[14:15], v[14:15], v[30:31]
v_lshlrev_b32 v28, 16, v74
v_and_b32 v29, 0xffff0000, v74
v_pk_add_f32 v[16:17], v[16:17], v[28:29]
v_lshlrev_b32 v30, 16, v75
v_and_b32 v31, 0xffff0000, v75
v_pk_add_f32 v[18:19], v[18:19], v[30:31]
v_lshlrev_b32 v28, 16, v76
v_and_b32 v29, 0xffff0000, v76
v_pk_add_f32 v[20:21], v[20:21], v[28:29]
v_lshlrev_b32 v30, 16, v77
v_and_b32 v31, 0xffff0000, v77
v_pk_add_f32 v[22:23], v[22:23], v[30:31]
v_lshlrev_b32 v28, 16, v78
v_and_b32 v29, 0xffff0000, v78
v_pk_add_f32 v[24:25], v[24:25], v[28:29]
v_lshlrev_b32 v30, 16, v79
v_and_b32 v31, 0xffff0000, v79
v_pk_add_f32 v[26:27], v[26:27], v[30:31]
v_lshlrev_b32 v28, 16, v80
v_and_b32 v29, 0xffff0000, v80
v_pk_add_f32 v[12:13], v[12:13], v[28:29]
v_lshlrev_b32 v30, 16, v81
v_and_b32 v31, 0xffff0000, v81
v_pk_add_f32 v[14:15], v[14:15], v[30:31]
v_lshlrev_b32 v28, 16, v82
v_and_b32 v29, 0xffff0000, v82
v_pk_add_f32 v[16:17], v[16:17], v[28:29]
v_lshlrev_b32 v30, 16, v83
v_and_b32 v31, 0xffff0000, v83
v_pk_add_f32 v[18:19], v[18:19], v[30:31]
v_lshlrev_b32 v28, 16, v84
v_and_b32 v29, 0xffff0000, v84
v_pk_add_f32 v[20:21], v[20:21], v[28:29]
v_lshlrev_b32 v30, 16, v85
v_and_b32 v31, 0xffff0000, v85
v_pk_add_f32 v[22:23], v[22:23], v[30:31]
v_lshlrev_b32 v28, 16, v86
v_and_b32 v29, 0xffff0000, v86
v_pk_add_f32 v[24:25], v[24:25], v[28:29]
v_lshlrev_b32 v30, 16, v87
v_and_b32 v31, 0xffff0000, v87
v_pk_add_f32 v[26:27], v[26:27], v[30:31]
v_lshlrev_b32 v28, 16, v88
v_and_b32 v29, 0xffff0000, v88
v_pk_add_f32 v[12:13], v[12:13], v[28:29]
v_lshlrev_b32 v30, 16, v89
v_and_b32 v31, 0xffff0000, v89
v_pk_add_f32 v[14:15], v[14:15], v[30:31]
v_lshlrev_b32 v28, 16, v90
v_and_b32 v29, 0xffff0000, v90
v_pk_add_f32 v[16:17], v[16:17], v[28:29]
v_lshlrev_b32 v30, 16, v91
v_and_b32 v31, 0xffff0000, v91
v_pk_add_f32 v[18:19], v[18:19], v[30:31]
v_lshlrev_b32 v28, 16, v92
v_and_b32 v29, 0xffff0000, v92
v_pk_add_f32 v[20:21], v[20:21], v[28:29]
v_lshlrev_b32 v30, 16, v93
v_and_b32 v31, 0xffff0000, v93
v_pk_add_f32 v[22:23], v[22:23], v[30:31]
v_lshlrev_b32 v28, 16, v94
v_and_b32 v29, 0xffff0000, v94
v_pk_add_f32 v[24:25], v[24:25], v[28:29]
v_lshlrev_b32 v30, 16, v95
v_and_b32 v31, 0xffff0000, v95
v_pk_add_f32 v[26:27], v[26:27], v[30:31]
v_lshlrev_b32 v28, 16, v96
v_and_b32 v29, 0xffff0000, v96
v_pk_add_f32 v[12:13], v[12:13], v[28:29]
v_lshlrev_b32 v30, 16, v97
v_and_b32 v31, 0xffff0000, v97
v_pk_add_f32 v[14:15], v[14:15], v[30:31]
v_lshlrev_b32 v28, 16, v98
v_and_b32 v29, 0xffff0000, v98
v_pk_add_f32 v[16:17], v[16:17], v[28:29]
v_lshlrev_b32 v30, 16, v99
v_and_b32 v31, 0xffff0000, v99
v_pk_add_f32 v[18:19], v[18:19], v[30:31]
v_lshlrev_b32 v28, 16, v100
v_and_b32 v29, 0xffff0000, v100
v_pk_add_f32 v[20:21], v[20:21], v[28:29]
v_lshlrev_b32 v30, 16, v101
v_and_b32 v31, 0xffff0000, v101
v_pk_add_f32 v[22:23], v[22:23], v[30:31]
v_lshlrev_b32 v28, 16, v102
v_and_b32 v29, 0xffff0000, v102
v_pk_add_f32 v[24:25], v[24:25], v[28:29]
v_lshlrev_b32 v30, 16, v103
v_and_b32 v31, 0xffff0000, v103
v_pk_add_f32 v[26:27], v[26:27], v[30:31]
v_lshlrev_b32 v28, 16, v104
v_and_b32 v29, 0xffff0000, v104
v_pk_add_f32 v[12:13], v[12:13], v[28:29]
v_lshlrev_b32 v30, 16, v105
v_and_b32 v31, 0xffff0000, v105
v_pk_add_f32 v[14:15], v[14:15], v[30:31]
v_lshlrev_b32 v28, 16, v106
v_and_b32 v29, 0xffff0000, v106
v_pk_add_f32 v[16:17], v[16:17], v[28:29]
v_lshlrev_b32 v30, 16, v107
v_and_b32 v31, 0xffff0000, v107
v_pk_add_f32 v[18:19], v[18:19], v[30:31]
v_lshlrev_b32 v28, 16, v108
v_and_b32 v29, 0xffff0000, v108
v_pk_add_f32 v[20:21], v[20:21], v[28:29]
v_lshlrev_b32 v30, 16, v109
v_and_b32 v31, 0xffff0000, v109
v_pk_add_f32 v[22:23], v[22:23], v[30:31]
v_lshlrev_b32 v28, 16, v110
v_and_b32 v29, 0xffff0000, v110
v_pk_add_f32 v[24:25], v[24:25], v[28:29]
v_lshlrev_b32 v30, 16, v111
v_and_b32 v31, 0xffff0000, v111
v_pk_add_f32 v[26:27], v[26:27], v[30:31]
v_cvt_pk_bf16_f32 v32, v12, v13
v_cvt_pk_bf16_f32 v33, v14, v15
v_cvt_pk_bf16_f32 v34, v16, v17
v_cvt_pk_bf16_f32 v35, v18, v19
v_cvt_pk_bf16_f32 v36, v20, v21
v_cvt_pk_bf16_f32 v37, v22, v23
v_cvt_pk_bf16_f32 v38, v24, v25
v_cvt_pk_bf16_f32 v39, v26, v27
v_lshlrev_b32 v12, 16, v32
v_and_b32 v13, 0xffff0000, v32
v_lshlrev_b32 v28, 16, v4
v_and_b32 v29, 0xffff0000, v4
v_pk_add_f32 v[12:13], v[12:13], v[28:29]
v_lshlrev_b32 v14, 16, v33
v_and_b32 v15, 0xffff0000, v33
v_lshlrev_b32 v28, 16, v5
v_and_b32 v29, 0xffff0000, v5
v_pk_add_f32 v[14:15], v[14:15], v[28:29]
v_lshlrev_b32 v16, 16, v34
v_and_b32 v17, 0xffff0000, v34
v_lshlrev_b32 v28, 16, v6
v_and_b32 v29, 0xffff0000, v6
v_pk_add_f32 v[16:17], v[16:17], v[28:29]
v_lshlrev_b32 v18, 16, v35
v_and_b32 v19, 0xffff0000, v35
v_lshlrev_b32 v28, 16, v7
v_and_b32 v29, 0xffff0000, v7
v_pk_add_f32 v[18:19], v[18:19], v[28:29]
v_lshlrev_b32 v20, 16, v36
v_and_b32 v21, 0xffff0000, v36
v_lshlrev_b32 v28, 16, v8
v_and_b32 v29, 0xffff0000, v8
v_pk_add_f32 v[20:21], v[20:21], v[28:29]
v_lshlrev_b32 v22, 16, v37
v_and_b32 v23, 0xffff0000, v37
v_lshlrev_b32 v28, 16, v9
v_and_b32 v29, 0xffff0000, v9
v_pk_add_f32 v[22:23], v[22:23], v[28:29]
v_lshlrev_b32 v24, 16, v38
v_and_b32 v25, 0xffff0000, v38
v_lshlrev_b32 v28, 16, v10
v_and_b32 v29, 0xffff0000, v10
v_pk_add_f32 v[24:25], v[24:25], v[28:29]
v_lshlrev_b32 v26, 16, v39
v_and_b32 v27, 0xffff0000, v39
v_lshlrev_b32 v28, 16, v11
v_and_b32 v29, 0xffff0000, v11
v_pk_add_f32 v[26:27], v[26:27], v[28:29]
v_cvt_pk_bf16_f32 v32, v12, v13
v_cvt_pk_bf16_f32 v33, v14, v15
v_cvt_pk_bf16_f32 v34, v16, v17
v_cvt_pk_bf16_f32 v35, v18, v19
v_cvt_pk_bf16_f32 v36, v20, v21
v_cvt_pk_bf16_f32 v37, v22, v23
v_cvt_pk_bf16_f32 v38, v24, v25
v_cvt_pk_bf16_f32 v39, v26, v27
s_mov_b32 s26, 81788928
buffer_store_dwordx4 v[32:35], v2, s[4:7], s26 offen sc1
buffer_store_dwordx4 v[36:39], v2, s[4:7], s26 offen offset:1024 sc1
v_lshlrev_b32 v12, 16, v32
v_and_b32 v13, 0xffff0000, v32
v_lshlrev_b32 v14, 16, v33
v_and_b32 v15, 0xffff0000, v33
v_lshlrev_b32 v16, 16, v34
v_and_b32 v17, 0xffff0000, v34
v_lshlrev_b32 v18, 16, v35
v_and_b32 v19, 0xffff0000, v35
v_lshlrev_b32 v20, 16, v36
v_and_b32 v21, 0xffff0000, v36
v_lshlrev_b32 v22, 16, v37
v_and_b32 v23, 0xffff0000, v37
v_lshlrev_b32 v24, 16, v38
v_and_b32 v25, 0xffff0000, v38
v_lshlrev_b32 v26, 16, v39
v_and_b32 v27, 0xffff0000, v39
v_pk_add_f32 v[28:29], v[12:13], v[14:15]
v_pk_add_f32 v[28:29], v[28:29], v[16:17]
v_pk_add_f32 v[28:29], v[28:29], v[18:19]
v_pk_add_f32 v[28:29], v[28:29], v[20:21]
v_pk_add_f32 v[28:29], v[28:29], v[22:23]
v_pk_add_f32 v[28:29], v[28:29], v[24:25]
v_pk_add_f32 v[28:29], v[28:29], v[26:27]
v_add_f32 v28, v28, v29
s_nop 1
v_add_f32_dpp v28, v28, v28 row_ror:8 row_mask:0xf bank_mask:0xf
s_nop 1
v_add_f32_dpp v28, v28, v28 row_ror:4 row_mask:0xf bank_mask:0xf
s_nop 1
v_add_f32_dpp v28, v28, v28 row_ror:2 row_mask:0xf bank_mask:0xf
s_nop 1
v_add_f32_dpp v28, v28, v28 row_ror:1 row_mask:0xf bank_mask:0xf
v_mov_b32 v29, v28
s_nop 1
v_permlane16_swap_b32 v28, v29
v_add_f32 v28, v28, v29
v_mov_b32 v29, v28
s_nop 1
v_permlane32_swap_b32 v28, v29
v_add_f32 v28, v28, v29
v_mul_f32 v28, 0xba800000, v28
v_mov_b32 v29, v28
v_pk_add_f32 v[12:13], v[12:13], v[28:29]
v_pk_add_f32 v[14:15], v[14:15], v[28:29]
v_pk_add_f32 v[16:17], v[16:17], v[28:29]
v_pk_add_f32 v[18:19], v[18:19], v[28:29]
v_pk_add_f32 v[20:21], v[20:21], v[28:29]
v_pk_add_f32 v[22:23], v[22:23], v[28:29]
v_pk_add_f32 v[24:25], v[24:25], v[28:29]
v_pk_add_f32 v[26:27], v[26:27], v[28:29]
v_pk_mul_f32 v[30:31], v[12:13], v[12:13]
v_pk_fma_f32 v[30:31], v[14:15], v[14:15], v[30:31]
v_pk_fma_f32 v[30:31], v[16:17], v[16:17], v[30:31]
v_pk_fma_f32 v[30:31], v[18:19], v[18:19], v[30:31]
v_pk_fma_f32 v[30:31], v[20:21], v[20:21], v[30:31]
v_pk_fma_f32 v[30:31], v[22:23], v[22:23], v[30:31]
v_pk_fma_f32 v[30:31], v[24:25], v[24:25], v[30:31]
v_pk_fma_f32 v[30:31], v[26:27], v[26:27], v[30:31]
v_add_f32 v30, v30, v31
s_nop 1
v_add_f32_dpp v30, v30, v30 row_ror:8 row_mask:0xf bank_mask:0xf
s_nop 1
v_add_f32_dpp v30, v30, v30 row_ror:4 row_mask:0xf bank_mask:0xf
s_nop 1
v_add_f32_dpp v30, v30, v30 row_ror:2 row_mask:0xf bank_mask:0xf
s_nop 1
v_add_f32_dpp v30, v30, v30 row_ror:1 row_mask:0xf bank_mask:0xf
v_mov_b32 v31, v30
s_nop 1
v_permlane16_swap_b32 v30, v31
v_add_f32 v30, v30, v31
v_mov_b32 v31, v30
s_nop 1
v_permlane32_swap_b32 v30, v31
v_add_f32 v30, v30, v31
v_mov_b32 v31, 0x3727c5ac
v_fmac_f32 v31, 0x3a800000, v30
v_rsq_f32 v31, v31
s_nop 0
v_mov_b32 v30, v31
v_pk_mul_f32 v[12:13], v[12:13], v[30:31]
v_pk_mul_f32 v[14:15], v[14:15], v[30:31]
v_pk_mul_f32 v[16:17], v[16:17], v[30:31]
v_pk_mul_f32 v[18:19], v[18:19], v[30:31]
v_pk_mul_f32 v[20:21], v[20:21], v[30:31]
v_pk_mul_f32 v[22:23], v[22:23], v[30:31]
v_pk_mul_f32 v[24:25], v[24:25], v[30:31]
v_pk_mul_f32 v[26:27], v[26:27], v[30:31]
v_cvt_pk_bf16_f32 v4, v12, v13
v_cvt_pk_bf16_f32 v5, v14, v15
v_cvt_pk_bf16_f32 v6, v16, v17
v_cvt_pk_bf16_f32 v7, v18, v19
v_cvt_pk_bf16_f32 v8, v20, v21
v_cvt_pk_bf16_f32 v9, v22, v23
v_cvt_pk_bf16_f32 v10, v24, v25
v_cvt_pk_bf16_f32 v11, v26, v27
s_mov_b32 s26, 85983232
buffer_store_dwordx4 v[4:7], v2, s[4:7], s26 offen sc1
buffer_store_dwordx4 v[8:11], v2, s[4:7], s26 offen offset:1024 sc1
v_lshlrev_b32 v12, 16, v4
v_and_b32 v13, 0xffff0000, v4
v_lshlrev_b32 v14, 16, v5
v_and_b32 v15, 0xffff0000, v5
v_lshlrev_b32 v16, 16, v6
v_and_b32 v17, 0xffff0000, v6
v_lshlrev_b32 v18, 16, v7
v_and_b32 v19, 0xffff0000, v7
v_lshlrev_b32 v20, 16, v8
v_and_b32 v21, 0xffff0000, v8
v_lshlrev_b32 v22, 16, v9
v_and_b32 v23, 0xffff0000, v9
v_lshlrev_b32 v24, 16, v10
v_and_b32 v25, 0xffff0000, v10
v_lshlrev_b32 v26, 16, v11
v_and_b32 v27, 0xffff0000, v11
v_pk_add_f32 v[28:29], v[12:13], v[14:15]
v_pk_add_f32 v[28:29], v[28:29], v[16:17]
v_pk_add_f32 v[28:29], v[28:29], v[18:19]
v_pk_add_f32 v[28:29], v[28:29], v[20:21]
v_pk_add_f32 v[28:29], v[28:29], v[22:23]
v_pk_add_f32 v[28:29], v[28:29], v[24:25]
v_pk_add_f32 v[28:29], v[28:29], v[26:27]
v_add_f32 v28, v28, v29
s_nop 1
v_add_f32_dpp v28, v28, v28 row_ror:8 row_mask:0xf bank_mask:0xf
s_nop 1
v_add_f32_dpp v28, v28, v28 row_ror:4 row_mask:0xf bank_mask:0xf
s_nop 1
v_add_f32_dpp v28, v28, v28 row_ror:2 row_mask:0xf bank_mask:0xf
s_nop 1
v_add_f32_dpp v28, v28, v28 row_ror:1 row_mask:0xf bank_mask:0xf
v_mov_b32 v29, v28
s_nop 1
v_permlane16_swap_b32 v28, v29
v_add_f32 v28, v28, v29
v_mov_b32 v29, v28
s_nop 1
v_permlane32_swap_b32 v28, v29
v_add_f32 v28, v28, v29
v_mul_f32 v28, 0xba800000, v28
v_mov_b32 v29, v28
v_pk_add_f32 v[12:13], v[12:13], v[28:29]
v_pk_add_f32 v[14:15], v[14:15], v[28:29]
v_pk_add_f32 v[16:17], v[16:17], v[28:29]
v_pk_add_f32 v[18:19], v[18:19], v[28:29]
v_pk_add_f32 v[20:21], v[20:21], v[28:29]
v_pk_add_f32 v[22:23], v[22:23], v[28:29]
v_pk_add_f32 v[24:25], v[24:25], v[28:29]
v_pk_add_f32 v[26:27], v[26:27], v[28:29]
v_pk_mul_f32 v[30:31], v[12:13], v[12:13]
v_pk_fma_f32 v[30:31], v[14:15], v[14:15], v[30:31]
v_pk_fma_f32 v[30:31], v[16:17], v[16:17], v[30:31]
v_pk_fma_f32 v[30:31], v[18:19], v[18:19], v[30:31]
v_pk_fma_f32 v[30:31], v[20:21], v[20:21], v[30:31]
v_pk_fma_f32 v[30:31], v[22:23], v[22:23], v[30:31]
v_pk_fma_f32 v[30:31], v[24:25], v[24:25], v[30:31]
v_pk_fma_f32 v[30:31], v[26:27], v[26:27], v[30:31]
v_add_f32 v30, v30, v31
s_nop 1
v_add_f32_dpp v30, v30, v30 row_ror:8 row_mask:0xf bank_mask:0xf
s_nop 1
v_add_f32_dpp v30, v30, v30 row_ror:4 row_mask:0xf bank_mask:0xf
s_nop 1
v_add_f32_dpp v30, v30, v30 row_ror:2 row_mask:0xf bank_mask:0xf
s_nop 1
v_add_f32_dpp v30, v30, v30 row_ror:1 row_mask:0xf bank_mask:0xf
v_mov_b32 v31, v30
s_nop 1
v_permlane16_swap_b32 v30, v31
v_add_f32 v30, v30, v31
v_mov_b32 v31, v30
s_nop 1
v_permlane32_swap_b32 v30, v31
v_add_f32 v30, v30, v31
v_mov_b32 v31, 0x3727c5ac
v_fmac_f32 v31, 0x3a800000, v30
v_rsq_f32 v31, v31
s_nop 0
v_mov_b32 v30, v31
v_pk_mul_f32 v[12:13], v[12:13], v[30:31]
v_pk_mul_f32 v[14:15], v[14:15], v[30:31]
v_pk_mul_f32 v[16:17], v[16:17], v[30:31]
v_pk_mul_f32 v[18:19], v[18:19], v[30:31]
v_pk_mul_f32 v[20:21], v[20:21], v[30:31]
v_pk_mul_f32 v[22:23], v[22:23], v[30:31]
v_pk_mul_f32 v[24:25], v[24:25], v[30:31]
v_pk_mul_f32 v[26:27], v[26:27], v[30:31]
v_cvt_pk_bf16_f32 v40, v12, v13
v_cvt_pk_bf16_f32 v41, v14, v15
v_cvt_pk_bf16_f32 v42, v16, v17
v_cvt_pk_bf16_f32 v43, v18, v19
v_cvt_pk_bf16_f32 v44, v20, v21
v_cvt_pk_bf16_f32 v45, v22, v23
v_cvt_pk_bf16_f32 v46, v24, v25
v_cvt_pk_bf16_f32 v47, v26, v27
s_mov_b32 s26, 90177536
buffer_store_dwordx4 v[40:43], v2, s[4:7], s26 offen sc1
buffer_store_dwordx4 v[44:47], v2, s[4:7], s26 offen offset:1024 sc1
s_lshl_b32 s76, s77, 7
s_add_u32 s76, s76, 45056
s_cmp_ge_u32 s77, 15
s_cbranch_scc1 r2_106
s_waitcnt vmcnt(0)
s_barrier
s_cmp_lg_u32 s16, 0
s_cbranch_scc1 sig_108
v_mov_b32 v1, s76
v_mov_b32 v2, 1
s_mov_b64 exec, 1
buffer_atomic_add v2, v1, s[4:7], 0 offen
s_mov_b64 exec, -1
sig_108:
s_branch r3_107
r2_106:
s_waitcnt vmcnt(0)
s_barrier
s_cmp_lg_u32 s16, 0
s_cbranch_scc1 sig_109
v_mov_b32 v1, s76
v_mov_b32 v2, 2
s_mov_b64 exec, 1
buffer_atomic_add v2, v1, s[4:7], 0 offen
s_mov_b64 exec, -1
sig_109:
r3_107:
s_branch mega_kernel_wloop
mega_kernel_t7:
s_lshl_b32 s76, s77, 7
s_add_u32 s76, s76, 53248
s_cmp_lg_u32 s16, 0
s_cbranch_scc1 wf_110
v_mov_b32 v1, 0
v_mov_b32 v2, 0
v_writelane_b32 v1, s76, 0
s_mov_b32 s27, 16
v_writelane_b32 v2, s27, 0
s_mov_b64 exec, 1
wfp_111:
s_add_u32 s63, s63, 1
s_cmp_gt_u32 s63, 262144
s_cbranch_scc0 go_112
s_endpgm
go_112:
buffer_load_dword v3, v1, s[4:7], 0 offen sc1
s_waitcnt vmcnt(0)
v_cmp_lt_u32 vcc, v3, v2
s_nop 0
s_cbranch_vccz wfd_113
s_cmp_lt_u32 s77, 13
s_cbranch_scc1 urg_114
s_sleep 2
s_branch wfp_111
urg_114:
v_sub_u32 v4, v2, v3
s_nop 0
v_readlane_b32 s27, v4, 0
s_nop 0
s_cmp_lt_i32 s27, 2
s_cbranch_scc1 lv_115
s_sleep 40
s_branch wfp_111
lv_115:
s_cmp_lt_i32 s27, 1
s_cbranch_scc1 lv_116
s_sleep 12
s_branch wfp_111
lv_116:
s_sleep 8
s_branch wfp_111
wfd_113:
s_mov_b64 exec, -1
wf_110:
s_barrier
s_cmp_lg_u32 s16, 0
s_cbranch_scc1 tt_117
v_mov_b32 v7, s56
v_accvgpr_write_b32 a127, 1
s_mov_b64 exec, 1
buffer_atomic_add a127, v7, s[4:7], 0 offen sc0
s_mov_b64 exec, -1
tt_117:
s_lshl_b32 s24, s77, 7
s_lshl_b32 s52, s77, 6
s_add_u32 s52, s52, 960
s_cmp_ge_u32 s77, 15
s_cselect_b32 s24, s52, s24
s_lshl_b32 s25, s60, 4
s_lshl_b32 s26, s79, 3
s_add_u32 s25, s25, s26
s_lshl_b32 s26, s60, 3
s_cmp_ge_u32 s77, 15
s_cselect_b32 s25, s26, s25
s_add_u32 s24, s24, s25
s_add_u32 s24, s24, s16
s_lshl_b32 s24, s24, 11
v_lshl_add_u32 v2, v0, 4, s24
s_mov_b32 s26, 98574336
buffer_load_dwordx4 v[4:7], v2, s[4:7], s26 offen sc1
buffer_load_dwordx4 v[8:11], v2, s[4:7], s26 offen offset:1024 sc1
s_waitcnt vmcnt(0)
v_lshlrev_b32 v12, 16, v4
v_and_b32 v13, 0xffff0000, v4
v_lshlrev_b32 v14, 16, v5
v_and_b32 v15, 0xffff0000, v5
v_lshlrev_b32 v16, 16, v6
v_and_b32 v17, 0xffff0000, v6
v_lshlrev_b32 v18, 16, v7
v_and_b32 v19, 0xffff0000, v7
v_lshlrev_b32 v20, 16, v8
v_and_b32 v21, 0xffff0000, v8
v_lshlrev_b32 v22, 16, v9
v_and_b32 v23, 0xffff0000, v9
v_lshlrev_b32 v24, 16, v10
v_and_b32 v25, 0xffff0000, v10
v_lshlrev_b32 v26, 16, v11
v_and_b32 v27, 0xffff0000, v11
v_pk_add_f32 v[28:29], v[12:13], v[14:15]
v_pk_add_f32 v[28:29], v[28:29], v[16:17]
v_pk_add_f32 v[28:29], v[28:29], v[18:19]
v_pk_add_f32 v[28:29], v[28:29], v[20:21]
v_pk_add_f32 v[28:29], v[28:29], v[22:23]
v_pk_add_f32 v[28:29], v[28:29], v[24:25]
v_pk_add_f32 v[28:29], v[28:29], v[26:27]
v_add_f32 v28, v28, v29
s_nop 1
v_add_f32_dpp v28, v28, v28 row_ror:8 row_mask:0xf bank_mask:0xf
s_nop 1
v_add_f32_dpp v28, v28, v28 row_ror:4 row_mask:0xf bank_mask:0xf
s_nop 1
v_add_f32_dpp v28, v28, v28 row_ror:2 row_mask:0xf bank_mask:0xf
s_nop 1
v_add_f32_dpp v28, v28, v28 row_ror:1 row_mask:0xf bank_mask:0xf
v_mov_b32 v29, v28
s_nop 1
v_permlane16_swap_b32 v28, v29
v_add_f32 v28, v28, v29
v_mov_b32 v29, v28
s_nop 1
v_permlane32_swap_b32 v28, v29
v_add_f32 v28, v28, v29
v_mul_f32 v28, 0xba800000, v28
v_mov_b32 v29, v28
v_pk_add_f32 v[12:13], v[12:13], v[28:29]
v_pk_add_f32 v[14:15], v[14:15], v[28:29]
v_pk_add_f32 v[16:17], v[16:17], v[28:29]
v_pk_add_f32 v[18:19], v[18:19], v[28:29]
v_pk_add_f32 v[20:21], v[20:21], v[28:29]
v_pk_add_f32 v[22:23], v[22:23], v[28:29]
v_pk_add_f32 v[24:25], v[24:25], v[28:29]
v_pk_add_f32 v[26:27], v[26:27], v[28:29]
v_pk_mul_f32 v[30:31], v[12:13], v[12:13]
v_pk_fma_f32 v[30:31], v[14:15], v[14:15], v[30:31]
v_pk_fma_f32 v[30:31], v[16:17], v[16:17], v[30:31]
v_pk_fma_f32 v[30:31], v[18:19], v[18:19], v[30:31]
v_pk_fma_f32 v[30:31], v[20:21], v[20:21], v[30:31]
v_pk_fma_f32 v[30:31], v[22:23], v[22:23], v[30:31]
v_pk_fma_f32 v[30:31], v[24:25], v[24:25], v[30:31]
v_pk_fma_f32 v[30:31], v[26:27], v[26:27], v[30:31]
v_add_f32 v30, v30, v31
s_nop 1
v_add_f32_dpp v30, v30, v30 row_ror:8 row_mask:0xf bank_mask:0xf
s_nop 1
v_add_f32_dpp v30, v30, v30 row_ror:4 row_mask:0xf bank_mask:0xf
s_nop 1
v_add_f32_dpp v30, v30, v30 row_ror:2 row_mask:0xf bank_mask:0xf
s_nop 1
v_add_f32_dpp v30, v30, v30 row_ror:1 row_mask:0xf bank_mask:0xf
v_mov_b32 v31, v30
s_nop 1
v_permlane16_swap_b32 v30, v31
v_add_f32 v30, v30, v31
v_mov_b32 v31, v30
s_nop 1
v_permlane32_swap_b32 v30, v31
v_add_f32 v30, v30, v31
v_mov_b32 v31, 0x3727c5ac
v_fmac_f32 v31, 0x3a800000, v30
v_rsq_f32 v31, v31
s_nop 0
v_mov_b32 v30, v31
v_pk_mul_f32 v[12:13], v[12:13], v[30:31]
v_pk_mul_f32 v[14:15], v[14:15], v[30:31]
v_pk_mul_f32 v[16:17], v[16:17], v[30:31]
v_pk_mul_f32 v[18:19], v[18:19], v[30:31]
v_pk_mul_f32 v[20:21], v[20:21], v[30:31]
v_pk_mul_f32 v[22:23], v[22:23], v[30:31]
v_pk_mul_f32 v[24:25], v[24:25], v[30:31]
v_pk_mul_f32 v[26:27], v[26:27], v[30:31]
v_cvt_pk_bf16_f32 v4, v12, v13
v_cvt_pk_bf16_f32 v5, v14, v15
v_cvt_pk_bf16_f32 v6, v16, v17
v_cvt_pk_bf16_f32 v7, v18, v19
v_cvt_pk_bf16_f32 v8, v20, v21
v_cvt_pk_bf16_f32 v9, v22, v23
v_cvt_pk_bf16_f32 v10, v24, v25
v_cvt_pk_bf16_f32 v11, v26, v27
s_mov_b32 s26, 102768640
buffer_store_dwordx4 v[4:7], v2, s[4:7], s26 offen sc1
buffer_store_dwordx4 v[8:11], v2, s[4:7], s26 offen offset:1024 sc1
s_lshl_b32 s76, s77, 7
s_add_u32 s76, s76, 57344
s_cmp_ge_u32 s77, 15
s_cbranch_scc1 r2_118
s_waitcnt vmcnt(0)
s_barrier
s_cmp_lg_u32 s16, 0
s_cbranch_scc1 sig_120
v_mov_b32 v1, s76
v_mov_b32 v2, 1
s_mov_b64 exec, 1
buffer_atomic_add v2, v1, s[4:7], 0 offen
s_mov_b64 exec, -1
sig_120:
s_branch r3_119
r2_118:
s_waitcnt vmcnt(0)
s_barrier
s_cmp_lg_u32 s16, 0
s_cbranch_scc1 sig_121
v_mov_b32 v1, s76
v_mov_b32 v2, 2
s_mov_b64 exec, 1
buffer_atomic_add v2, v1, s[4:7], 0 offen
s_mov_b64 exec, -1
sig_121:
r3_119:
s_branch mega_kernel_wloop
mega_kernel_t10:
s_lshl_b32 s76, s77, 10
s_add_u32 s76, s76, 196608
s_cmp_lg_u32 s16, 0
s_cbranch_scc1 ws_122
v_lshlrev_b32 v1, 7, v0
v_add_u32 v1, s76, v1
s_mov_b64 exec, 0xff
wsp_123:
s_add_u32 s63, s63, 1
s_cmp_gt_u32 s63, 262144
s_cbranch_scc0 go_125
s_endpgm
go_125:
buffer_load_dword v3, v1, s[4:7], 0 offen sc1
s_waitcnt vmcnt(0)
s_mov_b32 s26, 0
v_readlane_b32 s27, v3, 0
s_nop 0
s_add_u32 s26, s26, s27
v_readlane_b32 s27, v3, 1
s_nop 0
s_add_u32 s26, s26, s27
v_readlane_b32 s27, v3, 2
s_nop 0
s_add_u32 s26, s26, s27
v_readlane_b32 s27, v3, 3
s_nop 0
s_add_u32 s26, s26, s27
v_readlane_b32 s27, v3, 4
s_nop 0
s_add_u32 s26, s26, s27
v_readlane_b32 s27, v3, 5
s_nop 0
s_add_u32 s26, s26, s27
v_readlane_b32 s27, v3, 6
s_nop 0
s_add_u32 s26, s26, s27
v_readlane_b32 s27, v3, 7
s_nop 0
s_add_u32 s26, s26, s27
s_sub_i32 s26, 64, s26
s_cmp_lt_i32 s26, 1
s_cbranch_scc1 wsd_124
s_cmp_lt_u32 s77, 13
s_cbranch_scc1 urg_126
s_sleep 2
s_branch wsp_123
urg_126:
s_cmp_lt_i32 s26, 3
s_cbranch_scc1 lv_127
s_sleep 40
s_branch wsp_123
lv_127:
s_cmp_lt_i32 s26, 1
s_cbranch_scc1 lv_128
s_sleep 12
s_branch wsp_123
lv_128:
s_sleep 8
s_branch wsp_123
wsd_124:
s_mov_b64 exec, -1
ws_122:
s_barrier
s_cmp_lg_u32 s16, 0
s_cbranch_scc1 tt_129
v_mov_b32 v7, s56
v_accvgpr_write_b32 a127, 1
s_mov_b64 exec, 1
buffer_atomic_add a127, v7, s[4:7], 0 offen sc0
s_mov_b64 exec, -1
tt_129:
s_lshl_b32 s24, s77, 7
s_lshl_b32 s52, s77, 6
s_add_u32 s52, s52, 960
s_cmp_ge_u32 s77, 15
s_cselect_b32 s24, s52, s24
s_lshl_b32 s25, s60, 4
s_lshl_b32 s26, s79, 3
s_add_u32 s25, s25, s26
s_lshl_b32 s26, s60, 3
s_cmp_ge_u32 s77, 15
s_cselect_b32 s25, s26, s25
s_add_u32 s24, s24, s25
s_add_u32 s24, s24, s16
s_lshl_b32 s24, s24, 11
v_lshl_add_u32 v2, v0, 4, s24
s_mov_b32 s12, s90
s_and_b32 s13, s91, 0xffff
s_mov_b32 s14, 0x400000
s_mov_b32 s15, 0x00020000
v_lshlrev_b32 v4, 4, v0
v_sub_u32 v5, v2, v4
v_lshl_add_u32 v3, v5, 1, v4
v_lshrrev_b32 v4, 1, v4
v_add_u32 v2, v5, v4
s_mov_b32 s26, 98574336
buffer_load_dwordx2 v[4:5], v2, s[4:7], s26 offen offset:0 sc1
buffer_load_dwordx2 v[6:7], v2, s[4:7], s26 offen offset:512 sc1
buffer_load_dwordx2 v[8:9], v2, s[4:7], s26 offen offset:1024 sc1
buffer_load_dwordx2 v[10:11], v2, s[4:7], s26 offen offset:1536 sc1
s_mov_b32 s26, 81788928
buffer_load_dwordx2 v[32:33], v2, s[4:7], s26 offen offset:0 sc1
buffer_load_dwordx2 v[34:35], v2, s[4:7], s26 offen offset:512 sc1
buffer_load_dwordx2 v[36:37], v2, s[4:7], s26 offen offset:1024 sc1
buffer_load_dwordx2 v[38:39], v2, s[4:7], s26 offen offset:1536 sc1
s_mov_b32 s26, 155197440
buffer_load_dwordx4 v[48:51], v3, s[4:7], s26 offen offset:0 sc1
buffer_load_dwordx4 v[52:55], v3, s[4:7], s26 offen offset:1024 sc1
buffer_load_dwordx4 v[56:59], v3, s[4:7], s26 offen offset:2048 sc1
buffer_load_dwordx4 v[60:63], v3, s[4:7], s26 offen offset:3072 sc1
s_mov_b32 s26, 163586048
buffer_load_dwordx4 v[64:67], v3, s[4:7], s26 offen offset:0 sc1
buffer_load_dwordx4 v[68:71], v3, s[4:7], s26 offen offset:1024 sc1
buffer_load_dwordx4 v[72:75], v3, s[4:7], s26 offen offset:2048 sc1
buffer_load_dwordx4 v[76:79], v3, s[4:7], s26 offen offset:3072 sc1
s_mov_b32 s26, 171974656
buffer_load_dwordx4 v[80:83], v3, s[4:7], s26 offen offset:0 sc1
buffer_load_dwordx4 v[84:87], v3, s[4:7], s26 offen offset:1024 sc1
buffer_load_dwordx4 v[88:91], v3, s[4:7], s26 offen offset:2048 sc1
buffer_load_dwordx4 v[92:95], v3, s[4:7], s26 offen offset:3072 sc1
s_mov_b32 s26, 180363264
buffer_load_dwordx4 v[96:99], v3, s[4:7], s26 offen offset:0 sc1
buffer_load_dwordx4 v[100:103], v3, s[4:7], s26 offen offset:1024 sc1
buffer_load_dwordx4 v[104:107], v3, s[4:7], s26 offen offset:2048 sc1
buffer_load_dwordx4 v[108:111], v3, s[4:7], s26 offen offset:3072 sc1
s_waitcnt vmcnt(0)
v_pk_add_f32 v[48:49], v[48:49], v[64:65]
v_pk_add_f32 v[80:81], v[80:81], v[96:97]
v_pk_add_f32 v[50:51], v[50:51], v[66:67]
v_pk_add_f32 v[82:83], v[82:83], v[98:99]
v_pk_add_f32 v[52:53], v[52:53], v[68:69]
v_pk_add_f32 v[84:85], v[84:85], v[100:101]
v_pk_add_f32 v[54:55], v[54:55], v[70:71]
v_pk_add_f32 v[86:87], v[86:87], v[102:103]
v_pk_add_f32 v[56:57], v[56:57], v[72:73]
v_pk_add_f32 v[88:89], v[88:89], v[104:105]
v_pk_add_f32 v[58:59], v[58:59], v[74:75]
v_pk_add_f32 v[90:91], v[90:91], v[106:107]
v_pk_add_f32 v[60:61], v[60:61], v[76:77]
v_pk_add_f32 v[92:93], v[92:93], v[108:109]
v_pk_add_f32 v[62:63], v[62:63], v[78:79]
v_pk_add_f32 v[94:95], v[94:95], v[110:111]
v_pk_add_f32 v[48:49], v[48:49], v[80:81]
v_pk_add_f32 v[50:51], v[50:51], v[82:83]
v_pk_add_f32 v[52:53], v[52:53], v[84:85]
v_pk_add_f32 v[54:55], v[54:55], v[86:87]
v_pk_add_f32 v[56:57], v[56:57], v[88:89]
v_pk_add_f32 v[58:59], v[58:59], v[90:91]
v_pk_add_f32 v[60:61], v[60:61], v[92:93]
v_pk_add_f32 v[62:63], v[62:63], v[94:95]
v_cvt_pk_bf16_f32 v12, v48, v49
v_lshlrev_b32 v14, 16, v12
v_and_b32 v15, 0xffff0000, v12
v_lshlrev_b32 v16, 16, v4
v_and_b32 v17, 0xffff0000, v4
v_pk_add_f32 v[14:15], v[14:15], v[16:17]
v_cvt_pk_bf16_f32 v12, v14, v15
v_lshlrev_b32 v14, 16, v12
v_and_b32 v15, 0xffff0000, v12
v_lshlrev_b32 v16, 16, v32
v_and_b32 v17, 0xffff0000, v32
v_pk_add_f32 v[14:15], v[14:15], v[16:17]
v_cvt_pk_bf16_f32 v12, v14, v15
v_mov_b32 v20, v12
v_cvt_pk_bf16_f32 v12, v50, v51
v_lshlrev_b32 v14, 16, v12
v_and_b32 v15, 0xffff0000, v12
v_lshlrev_b32 v16, 16, v5
v_and_b32 v17, 0xffff0000, v5
v_pk_add_f32 v[14:15], v[14:15], v[16:17]
v_cvt_pk_bf16_f32 v12, v14, v15
v_lshlrev_b32 v14, 16, v12
v_and_b32 v15, 0xffff0000, v12
v_lshlrev_b32 v16, 16, v33
v_and_b32 v17, 0xffff0000, v33
v_pk_add_f32 v[14:15], v[14:15], v[16:17]
v_cvt_pk_bf16_f32 v12, v14, v15
v_mov_b32 v21, v12
v_cvt_pk_bf16_f32 v12, v52, v53
v_lshlrev_b32 v14, 16, v12
v_and_b32 v15, 0xffff0000, v12
v_lshlrev_b32 v16, 16, v6
v_and_b32 v17, 0xffff0000, v6
v_pk_add_f32 v[14:15], v[14:15], v[16:17]
v_cvt_pk_bf16_f32 v12, v14, v15
v_lshlrev_b32 v14, 16, v12
v_and_b32 v15, 0xffff0000, v12
v_lshlrev_b32 v16, 16, v34
v_and_b32 v17, 0xffff0000, v34
v_pk_add_f32 v[14:15], v[14:15], v[16:17]
v_cvt_pk_bf16_f32 v12, v14, v15
v_mov_b32 v22, v12
v_cvt_pk_bf16_f32 v12, v54, v55
v_lshlrev_b32 v14, 16, v12
v_and_b32 v15, 0xffff0000, v12
v_lshlrev_b32 v16, 16, v7
v_and_b32 v17, 0xffff0000, v7
v_pk_add_f32 v[14:15], v[14:15], v[16:17]
v_cvt_pk_bf16_f32 v12, v14, v15
v_lshlrev_b32 v14, 16, v12
v_and_b32 v15, 0xffff0000, v12
v_lshlrev_b32 v16, 16, v35
v_and_b32 v17, 0xffff0000, v35
v_pk_add_f32 v[14:15], v[14:15], v[16:17]
v_cvt_pk_bf16_f32 v12, v14, v15
v_mov_b32 v23, v12
v_cvt_pk_bf16_f32 v12, v56, v57
v_lshlrev_b32 v14, 16, v12
v_and_b32 v15, 0xffff0000, v12
v_lshlrev_b32 v16, 16, v8
v_and_b32 v17, 0xffff0000, v8
v_pk_add_f32 v[14:15], v[14:15], v[16:17]
v_cvt_pk_bf16_f32 v12, v14, v15
v_lshlrev_b32 v14, 16, v12
v_and_b32 v15, 0xffff0000, v12
v_lshlrev_b32 v16, 16, v36
v_and_b32 v17, 0xffff0000, v36
v_pk_add_f32 v[14:15], v[14:15], v[16:17]
v_cvt_pk_bf16_f32 v12, v14, v15
v_mov_b32 v24, v12
v_cvt_pk_bf16_f32 v12, v58, v59
v_lshlrev_b32 v14, 16, v12
v_and_b32 v15, 0xffff0000, v12
v_lshlrev_b32 v16, 16, v9
v_and_b32 v17, 0xffff0000, v9
v_pk_add_f32 v[14:15], v[14:15], v[16:17]
v_cvt_pk_bf16_f32 v12, v14, v15
v_lshlrev_b32 v14, 16, v12
v_and_b32 v15, 0xffff0000, v12
v_lshlrev_b32 v16, 16, v37
v_and_b32 v17, 0xffff0000, v37
v_pk_add_f32 v[14:15], v[14:15], v[16:17]
v_cvt_pk_bf16_f32 v12, v14, v15
v_mov_b32 v25, v12
v_cvt_pk_bf16_f32 v12, v60, v61
v_lshlrev_b32 v14, 16, v12
v_and_b32 v15, 0xffff0000, v12
v_lshlrev_b32 v16, 16, v10
v_and_b32 v17, 0xffff0000, v10
v_pk_add_f32 v[14:15], v[14:15], v[16:17]
v_cvt_pk_bf16_f32 v12, v14, v15
v_lshlrev_b32 v14, 16, v12
v_and_b32 v15, 0xffff0000, v12
v_lshlrev_b32 v16, 16, v38
v_and_b32 v17, 0xffff0000, v38
v_pk_add_f32 v[14:15], v[14:15], v[16:17]
v_cvt_pk_bf16_f32 v12, v14, v15
v_mov_b32 v26, v12
v_cvt_pk_bf16_f32 v12, v62, v63
v_lshlrev_b32 v14, 16, v12
v_and_b32 v15, 0xffff0000, v12
v_lshlrev_b32 v16, 16, v11
v_and_b32 v17, 0xffff0000, v11
v_pk_add_f32 v[14:15], v[14:15], v[16:17]
v_cvt_pk_bf16_f32 v12, v14, v15
v_lshlrev_b32 v14, 16, v12
v_and_b32 v15, 0xffff0000, v12
v_lshlrev_b32 v16, 16, v39
v_and_b32 v17, 0xffff0000, v39
v_pk_add_f32 v[14:15], v[14:15], v[16:17]
v_cvt_pk_bf16_f32 v12, v14, v15
v_mov_b32 v27, v12
buffer_store_dwordx2 v[20:21], v2, s[12:15], 0 offen offset:0
buffer_store_dwordx2 v[22:23], v2, s[12:15], 0 offen offset:512
buffer_store_dwordx2 v[24:25], v2, s[12:15], 0 offen offset:1024
buffer_store_dwordx2 v[26:27], v2, s[12:15], 0 offen offset:1536
s_branch mega_kernel_wloop
mega_kernel_worker:
s_mov_b32 s60, s24
s_mov_b32 s16, s26
s_mov_b32 s63, 0
s_load_dwordx2 s[64:65], s[0:1], 16
s_load_dwordx2 s[66:67], s[0:1], 24
s_load_dwordx2 s[68:69], s[0:1], 32
s_load_dwordx2 s[70:71], s[0:1], 40
s_load_dwordx2 s[80:81], s[0:1], 64
s_load_dwordx2 s[82:83], s[0:1], 72
s_load_dwordx2 s[84:85], s[0:1], 80
s_load_dwordx2 s[86:87], s[0:1], 88
s_load_dwordx2 s[88:89], s[0:1], 0
s_load_dwordx2 s[90:91], s[0:1], 96
s_mov_b32 s78, 0x3e0293ee
s_getpc_b64 s[92:93]
mega_kernel_pc:
s_add_u32 s92, s92, mega_kernel_table-mega_kernel_pc
s_addc_u32 s93, s93, 0
s_waitcnt lgkmcnt(0)
s_cmp_ge_u32 s25, 16
s_cbranch_scc1 q1_31
s_mul_i32 s55, s60, 1
s_add_u32 s55, s55, 4088
s_lshl_b32 s56, s60, 7
s_add_u32 s56, s56, 7168
s_mov_b32 s57, 0
s_branch q2_32
q1_31:
s_mul_i32 s55, s60, 511
s_lshl_b32 s56, s60, 7
s_add_u32 s56, s56, 6144
s_mov_b32 s57, 510
q2_32:
s_cmp_lg_u32 s16, 0
s_cbranch_scc1 tt_33
v_mov_b32 v7, s56
v_accvgpr_write_b32 a127, 1
s_mov_b64 exec, 1
buffer_atomic_add a127, v7, s[4:7], 0 offen sc0
s_mov_b64 exec, -1
tt_33:
mega_kernel_wloop:
s_cmp_lg_u32 s16, 0
s_cbranch_scc1 tk_34
s_waitcnt vmcnt(0)
v_accvgpr_read_b32 v6, a127
v_mov_b32 v5, 0
s_mov_b64 exec, 1
ds_write_b32 v5, v6
s_mov_b64 exec, -1
s_waitcnt lgkmcnt(0)
tk_34:
s_barrier
v_mov_b32 v5, 0
ds_read_b32 v6, v5
s_waitcnt lgkmcnt(0)
v_readfirstlane_b32 s61, v6
s_barrier
s_min_u32 s61, s61, s57
s_add_u32 s24, s55, s61
s_lshl_b32 s24, s24, 2
s_load_dword s62, s[92:93], s24
s_waitcnt lgkmcnt(0)
s_and_b32 s72, s62, 31
s_bfe_u32 s77, s62, 327685
s_bfe_u32 s79, s62, 393226
s_cmp_eq_u32 s72, 31
s_cbranch_scc1 mega_kernel_wend_tramp
s_cmp_eq_u32 s72, 0
s_cbranch_scc1 mega_kernel_t0_tramp
s_cmp_eq_u32 s72, 1
s_cbranch_scc1 mega_kernel_t1_tramp
s_cmp_eq_u32 s72, 2
s_cbranch_scc1 mega_kernel_t2_tramp
s_cmp_eq_u32 s72, 3
s_cbranch_scc1 mega_kernel_t3_tramp
s_cmp_eq_u32 s72, 4
s_cbranch_scc1 mega_kernel_t4_tramp
s_cmp_eq_u32 s72, 5
s_cbranch_scc1 mega_kernel_t5_tramp
s_cmp_eq_u32 s72, 6
s_cbranch_scc1 mega_kernel_t6_tramp
s_cmp_eq_u32 s72, 7
s_cbranch_scc1 mega_kernel_t7_tramp
s_cmp_eq_u32 s72, 8
s_cbranch_scc1 mega_kernel_t8_tramp
s_cmp_eq_u32 s72, 9
s_cbranch_scc1 mega_kernel_t9_tramp
s_cmp_eq_u32 s72, 11
s_cbranch_scc1 mega_kernel_t11_tramp
s_cmp_eq_u32 s72, 12
s_cbranch_scc1 mega_kernel_t12_tramp
s_cmp_eq_u32 s72, 13
s_cbranch_scc1 mega_kernel_t13_tramp
s_cmp_eq_u32 s72, 14
s_cbranch_scc1 mega_kernel_t14_tramp
s_cmp_eq_u32 s72, 15
s_cbranch_scc1 mega_kernel_t15_tramp
s_cmp_eq_u32 s72, 16
s_cbranch_scc1 mega_kernel_t16_tramp
s_cmp_eq_u32 s72, 17
s_cbranch_scc1 mega_kernel_t17_tramp
s_cmp_eq_u32 s72, 18
s_cbranch_scc1 mega_kernel_t18_tramp
s_cmp_eq_u32 s72, 19
s_cbranch_scc1 mega_kernel_t19_tramp
s_cmp_eq_u32 s72, 20
s_cbranch_scc1 mega_kernel_t20_tramp
s_cmp_eq_u32 s72, 21
s_cbranch_scc1 mega_kernel_t21_tramp
s_cmp_eq_u32 s72, 22
s_cbranch_scc1 mega_kernel_t22_tramp
s_branch mega_kernel_t10
mega_kernel_t0_tramp:
s_branch mega_kernel_t0
mega_kernel_t1_tramp:
s_branch mega_kernel_t0
mega_kernel_t2_tramp:
s_branch mega_kernel_t2
mega_kernel_t3_tramp:
s_branch mega_kernel_t3
mega_kernel_t4_tramp:
s_branch mega_kernel_t4
mega_kernel_t5_tramp:
s_branch mega_kernel_t5
mega_kernel_t6_tramp:
s_branch mega_kernel_t6
mega_kernel_t7_tramp:
s_branch mega_kernel_t7
mega_kernel_t8_tramp:
s_branch mega_kernel_t8
mega_kernel_t9_tramp:
s_branch mega_kernel_t9
mega_kernel_t11_tramp:
s_branch mega_kernel_t11
mega_kernel_t12_tramp:
s_branch mega_kernel_t12
mega_kernel_t13_tramp:
s_branch mega_kernel_t13
mega_kernel_t14_tramp:
s_branch mega_kernel_t14
mega_kernel_t15_tramp:
s_branch mega_kernel_t15
mega_kernel_t16_tramp:
s_branch mega_kernel_t16
mega_kernel_t17_tramp:
s_branch mega_kernel_t17
mega_kernel_t18_tramp:
s_branch mega_kernel_t18
mega_kernel_t19_tramp:
s_branch mega_kernel_t19
mega_kernel_t20_tramp:
s_branch mega_kernel_t20
mega_kernel_t21_tramp:
s_branch mega_kernel_t21
mega_kernel_t22_tramp:
s_branch mega_kernel_t22
mega_kernel_wend_tramp:
s_cmp_lt_u32 s55, 4088
s_cbranch_scc1 mega_kernel_wend_t2
s_mul_i32 s55, s60, 511
s_lshl_b32 s56, s60, 7
s_add_u32 s56, s56, 6144
s_mov_b32 s57, 510
s_cmp_lg_u32 s16, 0
s_cbranch_scc1 tt_35
v_mov_b32 v7, s56
v_accvgpr_write_b32 a127, 1
s_mov_b64 exec, 1
buffer_atomic_add a127, v7, s[4:7], 0 offen sc0
s_mov_b64 exec, -1
tt_35:
s_branch mega_kernel_wloop
mega_kernel_wend_t2:
s_branch mega_kernel_wend
mega_kernel_t5:
s_lshr_b32 s17, s16, 2
s_and_b32 s18, s16, 3
v_lshrrev_b32 v1, 3, v0
s_mov_b32 s24, 2048
v_mul_lo_u32 v1, v1, s24
v_lshrrev_b32 v2, 4, v0
v_and_b32 v3, 7, v0
s_mov_b32 s25, 0
s_xor_b32 s26, s25, 0
v_add_u32 v4, s26, v2
v_xor_b32 v4, v4, v3
v_lshl_add_u32 v8, v4, 4, v1
s_xor_b32 s26, s25, 4
v_add_u32 v4, s26, v2
v_xor_b32 v4, v4, v3
v_lshl_add_u32 v9, v4, 4, v1
v_lshrrev_b32 v1, 5, v0
v_and_b32 v3, 31, v0
s_mov_b32 s24, 2048
v_mul_lo_u32 v2, v1, s24
v_add_u32 v4, 0, v1
v_and_b32 v4, 3, v4
v_lshlrev_b32 v4, 2, v4
v_xor_b32 v4, v4, v3
v_lshl_add_u32 v10, v4, 4, v2
v_add_u32 v4, 2, v1
v_and_b32 v4, 3, v4
v_lshlrev_b32 v4, 2, v4
v_xor_b32 v4, v4, v3
v_lshl_add_u32 v11, v4, 4, v2
v_and_b32 v1, 31, v0
v_lshrrev_b32 v2, 5, v0
v_bfe_u32 v3, v1, 1, 3
s_mul_i32 s24, s17, 8192
v_lshlrev_b32 v4, 7, v1
v_add_u32 v4, s24, v4
v_add_u32 v5, 0, v2
v_xor_b32 v5, v5, v3
v_lshl_add_u32 v13, v5, 4, v4
v_add_u32 v5, 2, v2
v_xor_b32 v5, v5, v3
v_lshl_add_u32 v14, v5, 4, v4
v_add_u32 v5, 4, v2
v_xor_b32 v5, v5, v3
v_lshl_add_u32 v15, v5, 4, v4
v_add_u32 v5, 6, v2
v_xor_b32 v5, v5, v3
v_lshl_add_u32 v16, v5, 4, v4
v_and_b32 v1, 15, v0
v_lshrrev_b32 v2, 2, v1
v_lshrrev_b32 v3, 5, v0
v_lshl_add_u32 v3, v3, 3, v2
v_mul_u32_u24 v3, 512, v3
v_and_b32 v4, 3, v1
v_lshl_add_u32 v3, v4, 3, v3
v_bfe_u32 v4, v0, 4, 1
v_lshl_add_u32 v3, v4, 5, v3
v_add_u32 v3, 16384, v3
s_mul_i32 s24, s18, 2
s_add_u32 s24, s24, 0
v_xor_b32 v4, s24, v2
v_lshl_add_u32 v17, v4, 6, v3
s_mul_i32 s24, s18, 2
s_add_u32 s24, s24, 1
v_xor_b32 v4, s24, v2
v_lshl_add_u32 v18, v4, 6, v3
v_add_u32 v19, 49152, v13
v_add_u32 v20, 49152, v14
v_add_u32 v21, 49152, v15
v_add_u32 v22, 49152, v16
v_add_u32 v23, 49152, v17
v_add_u32 v24, 49152, v18
v_add_u32 v25, 98304, v13
v_add_u32 v26, 98304, v14
v_add_u32 v27, 98304, v15
v_add_u32 v28, 98304, v16
v_add_u32 v29, 98304, v17
v_add_u32 v30, 98304, v18
s_mul_i32 s22, s16, 2048
s_mul_i32 s23, s16, 4096
s_add_u32 s23, s23, 16384
s_mov_b32 s8, s80
s_and_b32 s9, s81, 0xffff
s_mov_b32 s10, 0x200000
s_mov_b32 s11, 0x00020000
s_lshl_b32 s28, s77, 7
s_lshl_b32 s52, s77, 6
s_add_u32 s52, s52, 960
s_cmp_ge_u32 s77, 15
s_cselect_b32 s28, s52, s28
s_and_b32 s29, s79, 3
s_lshl_b32 s29, s29, 8
s_mul_i32 s24, s16, 16
s_add_u32 s24, s24, s28
s_mul_i32 s19, s24, 2048
s_add_u32 s19, s19, 90177536
s_mul_i32 s20, s16, 16384
s_lshl_b32 s24, s29, 1
s_add_u32 s20, s20, s24
s_mul_i32 s24, s28, 2048
s_mul_i32 s25, s29, 2
s_add_u32 s24, s24, s25
s_add_u32 s33, s24, 94375936
s_add_u32 s34, s24, 0
s_mov_b32 s35, 0
s_lshl_b32 s76, s77, 7
s_add_u32 s76, s76, 45056
s_cmp_lg_u32 s16, 0
s_cbranch_scc1 wf_130
v_mov_b32 v1, 0
v_mov_b32 v2, 0
v_writelane_b32 v1, s76, 0
s_mov_b32 s27, 16
v_writelane_b32 v2, s27, 0
s_mov_b64 exec, 1
wfp_131:
s_add_u32 s63, s63, 1
s_cmp_gt_u32 s63, 262144
s_cbranch_scc0 go_132
s_endpgm
go_132:
buffer_load_dword v3, v1, s[4:7], 0 offen sc1
s_waitcnt vmcnt(0)
v_cmp_lt_u32 vcc, v3, v2
s_nop 0
s_cbranch_vccz wfd_133
s_cmp_lt_u32 s77, 13
s_cbranch_scc1 urg_134
s_sleep 2
s_branch wfp_131
urg_134:
v_sub_u32 v4, v2, v3
s_nop 0
v_readlane_b32 s27, v4, 0
s_nop 0
s_cmp_lt_i32 s27, 2
s_cbranch_scc1 lv_135
s_sleep 40
s_branch wfp_131
lv_135:
s_cmp_lt_i32 s27, 1
s_cbranch_scc1 lv_136
s_sleep 12
s_branch wfp_131
lv_136:
s_sleep 8
s_branch wfp_131
wfd_133:
s_mov_b64 exec, -1
wf_130:
s_barrier
s_add_u32 m0, s22, 0
s_add_u32 s24, s19, 0
buffer_load_dwordx4 v8, s[4:7], s24 offen sc1 lds
s_add_u32 m0, s22, 1024
s_add_u32 s24, s19, 16384
buffer_load_dwordx4 v9, s[4:7], s24 offen sc1 lds
s_add_u32 m0, s23, 0
s_add_u32 s25, s20, 0
buffer_load_dwordx4 v10, s[8:11], s25 offen lds
s_add_u32 m0, s23, 1024
s_add_u32 s25, s20, 4096
buffer_load_dwordx4 v11, s[8:11], s25 offen lds
s_add_u32 m0, s23, 2048
s_add_u32 s25, s20, 8192
buffer_load_dwordx4 v10, s[8:11], s25 offen lds
s_add_u32 m0, s23, 3072
s_add_u32 s25, s20, 12288
buffer_load_dwordx4 v11, s[8:11], s25 offen lds
s_add_u32 m0, s22, 49152
s_add_u32 s24, s19, 128
buffer_load_dwordx4 v8, s[4:7], s24 offen sc1 lds
s_add_u32 m0, s22, 50176
s_add_u32 s24, s19, 16512
buffer_load_dwordx4 v9, s[4:7], s24 offen sc1 lds
s_add_u32 m0, s23, 49152
s_add_u32 s25, s20, 131072
buffer_load_dwordx4 v10, s[8:11], s25 offen lds
s_add_u32 m0, s23, 50176
s_add_u32 s25, s20, 135168
buffer_load_dwordx4 v11, s[8:11], s25 offen lds
s_add_u32 m0, s23, 51200
s_add_u32 s25, s20, 139264
buffer_load_dwordx4 v10, s[8:11], s25 offen lds
s_add_u32 m0, s23, 52224
s_add_u32 s25, s20, 143360
buffer_load_dwordx4 v11, s[8:11], s25 offen lds
v_accvgpr_write_b32 a0, 0
v_accvgpr_write_b32 a1, 0
v_accvgpr_write_b32 a2, 0
v_accvgpr_write_b32 a3, 0
v_accvgpr_write_b32 a4, 0
v_accvgpr_write_b32 a5, 0
v_accvgpr_write_b32 a6, 0
v_accvgpr_write_b32 a7, 0
v_accvgpr_write_b32 a8, 0
v_accvgpr_write_b32 a9, 0
v_accvgpr_write_b32 a10, 0
v_accvgpr_write_b32 a11, 0
v_accvgpr_write_b32 a12, 0
v_accvgpr_write_b32 a13, 0
v_accvgpr_write_b32 a14, 0
v_accvgpr_write_b32 a15, 0
v_accvgpr_write_b32 a16, 0
v_accvgpr_write_b32 a17, 0
v_accvgpr_write_b32 a18, 0
v_accvgpr_write_b32 a19, 0
v_accvgpr_write_b32 a20, 0
v_accvgpr_write_b32 a21, 0
v_accvgpr_write_b32 a22, 0
v_accvgpr_write_b32 a23, 0
v_accvgpr_write_b32 a24, 0
v_accvgpr_write_b32 a25, 0
v_accvgpr_write_b32 a26, 0
v_accvgpr_write_b32 a27, 0
v_accvgpr_write_b32 a28, 0
v_accvgpr_write_b32 a29, 0
v_accvgpr_write_b32 a30, 0
v_accvgpr_write_b32 a31, 0
v_accvgpr_write_b32 a32, 0
v_accvgpr_write_b32 a33, 0
v_accvgpr_write_b32 a34, 0
v_accvgpr_write_b32 a35, 0
v_accvgpr_write_b32 a36, 0
v_accvgpr_write_b32 a37, 0
v_accvgpr_write_b32 a38, 0
v_accvgpr_write_b32 a39, 0
v_accvgpr_write_b32 a40, 0
v_accvgpr_write_b32 a41, 0
v_accvgpr_write_b32 a42, 0
v_accvgpr_write_b32 a43, 0
v_accvgpr_write_b32 a44, 0
v_accvgpr_write_b32 a45, 0
v_accvgpr_write_b32 a46, 0
v_accvgpr_write_b32 a47, 0
v_accvgpr_write_b32 a48, 0
v_accvgpr_write_b32 a49, 0
v_accvgpr_write_b32 a50, 0
v_accvgpr_write_b32 a51, 0
v_accvgpr_write_b32 a52, 0
v_accvgpr_write_b32 a53, 0
v_accvgpr_write_b32 a54, 0
v_accvgpr_write_b32 a55, 0
v_accvgpr_write_b32 a56, 0
v_accvgpr_write_b32 a57, 0
v_accvgpr_write_b32 a58, 0
v_accvgpr_write_b32 a59, 0
v_accvgpr_write_b32 a60, 0
v_accvgpr_write_b32 a61, 0
v_accvgpr_write_b32 a62, 0
v_accvgpr_write_b32 a63, 0
s_waitcnt vmcnt(6)
s_barrier
RB 32,13,0
RB 36,13,4096
RT 40,17,0
RT 42,17,2048
RT 44,18,0
RT 46,18,2048
RB 48,14,0
RB 52,14,4096
RT 56,17,8192
RT 58,17,10240
RT 60,18,8192
RT 62,18,10240
RB 64,15,0
RB 68,15,4096
RT 72,17,16384
RT 74,17,18432
RT 76,18,16384
RT 78,18,18432
s_waitcnt lgkmcnt(12)
MM 0,40,32
RB 80,16,0
RB 84,16,4096
RT 88,17,24576
MM 16,44,32
RT 90,17,26624
RT 92,18,24576
RT 94,18,26624
MM 32,40,36
s_add_u32 m0, s22, 98304
s_add_u32 s24, s19, 256
buffer_load_dwordx4 v8, s[4:7], s24 offen sc1 lds
s_add_u32 m0, s22, 99328
s_add_u32 s24, s19, 16640
buffer_load_dwordx4 v9, s[4:7], s24 offen sc1 lds
s_add_u32 m0, s23, 98304
s_add_u32 s25, s20, 262144
buffer_load_dwordx4 v10, s[8:11], s25 offen lds
MM 48,44,36
s_add_u32 m0, s23, 99328
s_add_u32 s25, s20, 266240
buffer_load_dwordx4 v11, s[8:11], s25 offen lds
s_add_u32 m0, s23, 100352
s_add_u32 s25, s20, 270336
buffer_load_dwordx4 v10, s[8:11], s25 offen lds
s_add_u32 m0, s23, 101376
s_add_u32 s25, s20, 274432
buffer_load_dwordx4 v11, s[8:11], s25 offen lds
s_waitcnt lgkmcnt(0) vmcnt(6)
s_barrier
MM 0,56,48
RB 32,19,0
RB 36,19,4096
MM 16,60,48
RT 40,23,0
RT 42,23,2048
MM 32,56,52
RT 44,24,0
RT 46,24,2048
MM 48,60,52
s_add_u32 m0, s22, 0
s_add_u32 s24, s19, 384
buffer_load_dwordx4 v8, s[4:7], s24 offen sc1 lds
s_waitcnt lgkmcnt(12)
MM 0,72,64
RB 48,20,0
RB 52,20,4096
MM 16,76,64
RT 56,23,8192
RT 58,23,10240
MM 32,72,68
RT 60,24,8192
RT 62,24,10240
MM 48,76,68
s_add_u32 m0, s22, 1024
s_add_u32 s24, s19, 16768
buffer_load_dwordx4 v9, s[4:7], s24 offen sc1 lds
s_add_u32 m0, s23, 0
s_add_u32 s25, s20, 393216
buffer_load_dwordx4 v10, s[8:11], s25 offen lds
s_waitcnt lgkmcnt(12)
MM 0,88,80
RB 64,21,0
RB 68,21,4096
MM 16,92,80
RT 72,23,16384
RT 74,23,18432
MM 32,88,84
RT 76,24,16384
RT 78,24,18432
MM 48,92,84
s_add_u32 m0, s23, 1024
s_add_u32 s25, s20, 397312
buffer_load_dwordx4 v11, s[8:11], s25 offen lds
s_waitcnt lgkmcnt(12)
MM 0,40,32
RB 80,22,0
RB 84,22,4096
MM 16,44,32
RT 88,23,24576
RT 90,23,26624
MM 32,40,36
RT 92,24,24576
RT 94,24,26624
MM 48,44,36
s_add_u32 m0, s23, 2048
s_add_u32 s25, s20, 401408
buffer_load_dwordx4 v10, s[8:11], s25 offen lds
s_add_u32 m0, s23, 3072
s_add_u32 s25, s20, 405504
buffer_load_dwordx4 v11, s[8:11], s25 offen lds
s_waitcnt lgkmcnt(0) vmcnt(6)
s_barrier
MM 0,56,48
RB 32,25,0
RB 36,25,4096
MM 16,60,48
RT 40,29,0
RT 42,29,2048
MM 32,56,52
RT 44,30,0
RT 46,30,2048
MM 48,60,52
s_add_u32 m0, s22, 49152
s_add_u32 s24, s19, 512
buffer_load_dwordx4 v8, s[4:7], s24 offen sc1 lds
s_waitcnt lgkmcnt(12)
MM 0,72,64
RB 48,26,0
RB 52,26,4096
MM 16,76,64
RT 56,29,8192
RT 58,29,10240
MM 32,72,68
RT 60,30,8192
RT 62,30,10240
MM 48,76,68
s_add_u32 m0, s22, 50176
s_add_u32 s24, s19, 16896
buffer_load_dwordx4 v9, s[4:7], s24 offen sc1 lds
s_add_u32 m0, s23, 49152
s_add_u32 s25, s20, 524288
buffer_load_dwordx4 v10, s[8:11], s25 offen lds
s_waitcnt lgkmcnt(12)
MM 0,88,80
RB 64,27,0
RB 68,27,4096
MM 16,92,80
RT 72,29,16384
RT 74,29,18432
MM 32,88,84
RT 76,30,16384
RT 78,30,18432
MM 48,92,84
s_add_u32 m0, s23, 50176
s_add_u32 s25, s20, 528384
buffer_load_dwordx4 v11, s[8:11], s25 offen lds
s_waitcnt lgkmcnt(12)
MM 0,40,32
RB 80,28,0
RB 84,28,4096
MM 16,44,32
RT 88,29,24576
RT 90,29,26624
MM 32,40,36
RT 92,30,24576
RT 94,30,26624
MM 48,44,36
s_add_u32 m0, s23, 51200
s_add_u32 s25, s20, 532480
buffer_load_dwordx4 v10, s[8:11], s25 offen lds
s_add_u32 m0, s23, 52224
s_add_u32 s25, s20, 536576
buffer_load_dwordx4 v11, s[8:11], s25 offen lds
s_waitcnt lgkmcnt(0) vmcnt(6)
s_barrier
MM 0,56,48
RB 32,13,0
RB 36,13,4096
MM 16,60,48
RT 40,17,0
RT 42,17,2048
MM 32,56,52
RT 44,18,0
RT 46,18,2048
MM 48,60,52
s_add_u32 m0, s22, 98304
s_add_u32 s24, s19, 640
buffer_load_dwordx4 v8, s[4:7], s24 offen sc1 lds
s_waitcnt lgkmcnt(12)
MM 0,72,64
RB 48,14,0
RB 52,14,4096
MM 16,76,64
RT 56,17,8192
RT 58,17,10240
MM 32,72,68
RT 60,18,8192
RT 62,18,10240
MM 48,76,68
s_add_u32 m0, s22, 99328
s_add_u32 s24, s19, 17024
buffer_load_dwordx4 v9, s[4:7], s24 offen sc1 lds
s_add_u32 m0, s23, 98304
s_add_u32 s25, s20, 655360
buffer_load_dwordx4 v10, s[8:11], s25 offen lds
s_waitcnt lgkmcnt(12)
MM 0,88,80
RB 64,15,0
RB 68,15,4096
MM 16,92,80
RT 72,17,16384
RT 74,17,18432
MM 32,88,84
RT 76,18,16384
RT 78,18,18432
MM 48,92,84
s_add_u32 m0, s23, 99328
s_add_u32 s25, s20, 659456
buffer_load_dwordx4 v11, s[8:11], s25 offen lds
s_waitcnt lgkmcnt(12)
MM 0,40,32
RB 80,16,0
RB 84,16,4096
MM 16,44,32
RT 88,17,24576
RT 90,17,26624
MM 32,40,36
RT 92,18,24576
RT 94,18,26624
MM 48,44,36
s_add_u32 m0, s23, 100352
s_add_u32 s25, s20, 663552
buffer_load_dwordx4 v10, s[8:11], s25 offen lds
s_add_u32 m0, s23, 101376
s_add_u32 s25, s20, 667648
buffer_load_dwordx4 v11, s[8:11], s25 offen lds
s_waitcnt lgkmcnt(0) vmcnt(6)
s_barrier
MM 0,56,48
RB 32,19,0
RB 36,19,4096
MM 16,60,48
RT 40,23,0
RT 42,23,2048
MM 32,56,52
RT 44,24,0
RT 46,24,2048
MM 48,60,52
s_add_u32 m0, s22, 0
s_add_u32 s24, s19, 768
buffer_load_dwordx4 v8, s[4:7], s24 offen sc1 lds
s_waitcnt lgkmcnt(12)
MM 0,72,64
RB 48,20,0
RB 52,20,4096
MM 16,76,64
RT 56,23,8192
RT 58,23,10240
MM 32,72,68
RT 60,24,8192
RT 62,24,10240
MM 48,76,68
s_add_u32 m0, s22, 1024
s_add_u32 s24, s19, 17152
buffer_load_dwordx4 v9, s[4:7], s24 offen sc1 lds
s_add_u32 m0, s23, 0
s_add_u32 s25, s20, 786432
buffer_load_dwordx4 v10, s[8:11], s25 offen lds
s_waitcnt lgkmcnt(12)
MM 0,88,80
RB 64,21,0
RB 68,21,4096
MM 16,92,80
RT 72,23,16384
RT 74,23,18432
MM 32,88,84
RT 76,24,16384
RT 78,24,18432
MM 48,92,84
s_add_u32 m0, s23, 1024
s_add_u32 s25, s20, 790528
buffer_load_dwordx4 v11, s[8:11], s25 offen lds
s_waitcnt lgkmcnt(12)
MM 0,40,32
RB 80,22,0
RB 84,22,4096
MM 16,44,32
RT 88,23,24576
RT 90,23,26624
MM 32,40,36
RT 92,24,24576
RT 94,24,26624
MM 48,44,36
s_add_u32 m0, s23, 2048
s_add_u32 s25, s20, 794624
buffer_load_dwordx4 v10, s[8:11], s25 offen lds
s_add_u32 m0, s23, 3072
s_add_u32 s25, s20, 798720
buffer_load_dwordx4 v11, s[8:11], s25 offen lds
s_waitcnt lgkmcnt(0) vmcnt(6)
s_barrier
MM 0,56,48
RB 32,25,0
RB 36,25,4096
MM 16,60,48
RT 40,29,0
RT 42,29,2048
MM 32,56,52
RT 44,30,0
RT 46,30,2048
MM 48,60,52
s_add_u32 m0, s22, 49152
s_add_u32 s24, s19, 896
buffer_load_dwordx4 v8, s[4:7], s24 offen sc1 lds
s_waitcnt lgkmcnt(12)
MM 0,72,64
RB 48,26,0
RB 52,26,4096
MM 16,76,64
RT 56,29,8192
RT 58,29,10240
MM 32,72,68
RT 60,30,8192
RT 62,30,10240
MM 48,76,68
s_add_u32 m0, s22, 50176
s_add_u32 s24, s19, 17280
buffer_load_dwordx4 v9, s[4:7], s24 offen sc1 lds
s_add_u32 m0, s23, 49152
s_add_u32 s25, s20, 917504
buffer_load_dwordx4 v10, s[8:11], s25 offen lds
s_waitcnt lgkmcnt(12)
MM 0,88,80
RB 64,27,0
RB 68,27,4096
MM 16,92,80
RT 72,29,16384
RT 74,29,18432
MM 32,88,84
RT 76,30,16384
RT 78,30,18432
MM 48,92,84
s_add_u32 m0, s23, 50176
s_add_u32 s25, s20, 921600
buffer_load_dwordx4 v11, s[8:11], s25 offen lds
s_waitcnt lgkmcnt(12)
MM 0,40,32
RB 80,28,0
RB 84,28,4096
MM 16,44,32
RT 88,29,24576
RT 90,29,26624
MM 32,40,36
RT 92,30,24576
RT 94,30,26624
MM 48,44,36
s_add_u32 m0, s23, 51200
s_add_u32 s25, s20, 925696
buffer_load_dwordx4 v10, s[8:11], s25 offen lds
s_add_u32 m0, s23, 52224
s_add_u32 s25, s20, 929792
buffer_load_dwordx4 v11, s[8:11], s25 offen lds
s_waitcnt lgkmcnt(0) vmcnt(6)
s_barrier
MM 0,56,48
RB 32,13,0
RB 36,13,4096
MM 16,60,48
RT 40,17,0
RT 42,17,2048
MM 32,56,52
RT 44,18,0
RT 46,18,2048
MM 48,60,52
s_add_u32 m0, s22, 98304
s_add_u32 s24, s19, 1024
buffer_load_dwordx4 v8, s[4:7], s24 offen sc1 lds
s_waitcnt lgkmcnt(12)
MM 0,72,64
RB 48,14,0
RB 52,14,4096
MM 16,76,64
RT 56,17,8192
RT 58,17,10240
MM 32,72,68
RT 60,18,8192
RT 62,18,10240
MM 48,76,68
s_add_u32 m0, s22, 99328
s_add_u32 s24, s19, 17408
buffer_load_dwordx4 v9, s[4:7], s24 offen sc1 lds
s_add_u32 m0, s23, 98304
s_add_u32 s25, s20, 1048576
buffer_load_dwordx4 v10, s[8:11], s25 offen lds
s_waitcnt lgkmcnt(12)
MM 0,88,80
RB 64,15,0
RB 68,15,4096
MM 16,92,80
RT 72,17,16384
RT 74,17,18432
MM 32,88,84
RT 76,18,16384
RT 78,18,18432
MM 48,92,84
s_add_u32 m0, s23, 99328
s_add_u32 s25, s20, 1052672
buffer_load_dwordx4 v11, s[8:11], s25 offen lds
s_waitcnt lgkmcnt(12)
MM 0,40,32
RB 80,16,0
RB 84,16,4096
MM 16,44,32
RT 88,17,24576
RT 90,17,26624
MM 32,40,36
RT 92,18,24576
RT 94,18,26624
MM 48,44,36
s_add_u32 m0, s23, 100352
s_add_u32 s25, s20, 1056768
buffer_load_dwordx4 v10, s[8:11], s25 offen lds
s_add_u32 m0, s23, 101376
s_add_u32 s25, s20, 1060864
buffer_load_dwordx4 v11, s[8:11], s25 offen lds
s_waitcnt lgkmcnt(0) vmcnt(6)
s_barrier
MM 0,56,48
RB 32,19,0
RB 36,19,4096
MM 16,60,48
RT 40,23,0
RT 42,23,2048
MM 32,56,52
RT 44,24,0
RT 46,24,2048
MM 48,60,52
s_add_u32 m0, s22, 0
s_add_u32 s24, s19, 1152
buffer_load_dwordx4 v8, s[4:7], s24 offen sc1 lds
s_waitcnt lgkmcnt(12)
MM 0,72,64
RB 48,20,0
RB 52,20,4096
MM 16,76,64
RT 56,23,8192
RT 58,23,10240
MM 32,72,68
RT 60,24,8192
RT 62,24,10240
MM 48,76,68
s_add_u32 m0, s22, 1024
s_add_u32 s24, s19, 17536
buffer_load_dwordx4 v9, s[4:7], s24 offen sc1 lds
s_add_u32 m0, s23, 0
s_add_u32 s25, s20, 1179648
buffer_load_dwordx4 v10, s[8:11], s25 offen lds
s_waitcnt lgkmcnt(12)
MM 0,88,80
RB 64,21,0
RB 68,21,4096
MM 16,92,80
RT 72,23,16384
RT 74,23,18432
MM 32,88,84
RT 76,24,16384
RT 78,24,18432
MM 48,92,84
s_add_u32 m0, s23, 1024
s_add_u32 s25, s20, 1183744
buffer_load_dwordx4 v11, s[8:11], s25 offen lds
s_waitcnt lgkmcnt(12)
MM 0,40,32
RB 80,22,0
RB 84,22,4096
MM 16,44,32
RT 88,23,24576
RT 90,23,26624
MM 32,40,36
RT 92,24,24576
RT 94,24,26624
MM 48,44,36
s_add_u32 m0, s23, 2048
s_add_u32 s25, s20, 1187840
buffer_load_dwordx4 v10, s[8:11], s25 offen lds
s_add_u32 m0, s23, 3072
s_add_u32 s25, s20, 1191936
buffer_load_dwordx4 v11, s[8:11], s25 offen lds
s_waitcnt lgkmcnt(0) vmcnt(6)
s_barrier
MM 0,56,48
RB 32,25,0
RB 36,25,4096
MM 16,60,48
RT 40,29,0
RT 42,29,2048
MM 32,56,52
RT 44,30,0
RT 46,30,2048
MM 48,60,52
s_add_u32 m0, s22, 49152
s_add_u32 s24, s19, 1280
buffer_load_dwordx4 v8, s[4:7], s24 offen sc1 lds
s_waitcnt lgkmcnt(12)
MM 0,72,64
RB 48,26,0
RB 52,26,4096
MM 16,76,64
RT 56,29,8192
RT 58,29,10240
MM 32,72,68
RT 60,30,8192
RT 62,30,10240
MM 48,76,68
s_add_u32 m0, s22, 50176
s_add_u32 s24, s19, 17664
buffer_load_dwordx4 v9, s[4:7], s24 offen sc1 lds
s_add_u32 m0, s23, 49152
s_add_u32 s25, s20, 1310720
buffer_load_dwordx4 v10, s[8:11], s25 offen lds
s_waitcnt lgkmcnt(12)
MM 0,88,80
RB 64,27,0
RB 68,27,4096
MM 16,92,80
RT 72,29,16384
RT 74,29,18432
MM 32,88,84
RT 76,30,16384
RT 78,30,18432
MM 48,92,84
s_add_u32 m0, s23, 50176
s_add_u32 s25, s20, 1314816
buffer_load_dwordx4 v11, s[8:11], s25 offen lds
s_waitcnt lgkmcnt(12)
MM 0,40,32
RB 80,28,0
RB 84,28,4096
MM 16,44,32
RT 88,29,24576
RT 90,29,26624
MM 32,40,36
RT 92,30,24576
RT 94,30,26624
MM 48,44,36
s_add_u32 m0, s23, 51200
s_add_u32 s25, s20, 1318912
buffer_load_dwordx4 v10, s[8:11], s25 offen lds
s_add_u32 m0, s23, 52224
s_add_u32 s25, s20, 1323008
buffer_load_dwordx4 v11, s[8:11], s25 offen lds
s_waitcnt lgkmcnt(0) vmcnt(6)
s_barrier
MM 0,56,48
RB 32,13,0
RB 36,13,4096
MM 16,60,48
RT 40,17,0
RT 42,17,2048
MM 32,56,52
RT 44,18,0
RT 46,18,2048
MM 48,60,52
s_add_u32 m0, s22, 98304
s_add_u32 s24, s19, 1408
buffer_load_dwordx4 v8, s[4:7], s24 offen sc1 lds
s_waitcnt lgkmcnt(12)
MM 0,72,64
RB 48,14,0
RB 52,14,4096
MM 16,76,64
RT 56,17,8192
RT 58,17,10240
MM 32,72,68
RT 60,18,8192
RT 62,18,10240
MM 48,76,68
s_add_u32 m0, s22, 99328
s_add_u32 s24, s19, 17792
buffer_load_dwordx4 v9, s[4:7], s24 offen sc1 lds
s_add_u32 m0, s23, 98304
s_add_u32 s25, s20, 1441792
buffer_load_dwordx4 v10, s[8:11], s25 offen lds
s_waitcnt lgkmcnt(12)
MM 0,88,80
RB 64,15,0
RB 68,15,4096
MM 16,92,80
RT 72,17,16384
RT 74,17,18432
MM 32,88,84
RT 76,18,16384
RT 78,18,18432
MM 48,92,84
s_add_u32 m0, s23, 99328
s_add_u32 s25, s20, 1445888
buffer_load_dwordx4 v11, s[8:11], s25 offen lds
s_waitcnt lgkmcnt(12)
MM 0,40,32
RB 80,16,0
RB 84,16,4096
MM 16,44,32
RT 88,17,24576
RT 90,17,26624
MM 32,40,36
RT 92,18,24576
RT 94,18,26624
MM 48,44,36
s_add_u32 m0, s23, 100352
s_add_u32 s25, s20, 1449984
buffer_load_dwordx4 v10, s[8:11], s25 offen lds
s_add_u32 m0, s23, 101376
s_add_u32 s25, s20, 1454080
buffer_load_dwordx4 v11, s[8:11], s25 offen lds
s_waitcnt lgkmcnt(0) vmcnt(6)
s_barrier
MM 0,56,48
RB 32,19,0
RB 36,19,4096
MM 16,60,48
RT 40,23,0
RT 42,23,2048
MM 32,56,52
RT 44,24,0
RT 46,24,2048
MM 48,60,52
s_add_u32 m0, s22, 0
s_add_u32 s24, s19, 1536
buffer_load_dwordx4 v8, s[4:7], s24 offen sc1 lds
s_waitcnt lgkmcnt(12)
MM 0,72,64
RB 48,20,0
RB 52,20,4096
MM 16,76,64
RT 56,23,8192
RT 58,23,10240
MM 32,72,68
RT 60,24,8192
RT 62,24,10240
MM 48,76,68
s_add_u32 m0, s22, 1024
s_add_u32 s24, s19, 17920
buffer_load_dwordx4 v9, s[4:7], s24 offen sc1 lds
s_add_u32 m0, s23, 0
s_add_u32 s25, s20, 1572864
buffer_load_dwordx4 v10, s[8:11], s25 offen lds
s_waitcnt lgkmcnt(12)
MM 0,88,80
RB 64,21,0
RB 68,21,4096
MM 16,92,80
RT 72,23,16384
RT 74,23,18432
MM 32,88,84
RT 76,24,16384
RT 78,24,18432
MM 48,92,84
s_add_u32 m0, s23, 1024
s_add_u32 s25, s20, 1576960
buffer_load_dwordx4 v11, s[8:11], s25 offen lds
s_waitcnt lgkmcnt(12)
MM 0,40,32
RB 80,22,0
RB 84,22,4096
MM 16,44,32
RT 88,23,24576
RT 90,23,26624
MM 32,40,36
RT 92,24,24576
RT 94,24,26624
MM 48,44,36
s_add_u32 m0, s23, 2048
s_add_u32 s25, s20, 1581056
buffer_load_dwordx4 v10, s[8:11], s25 offen lds
s_add_u32 m0, s23, 3072
s_add_u32 s25, s20, 1585152
buffer_load_dwordx4 v11, s[8:11], s25 offen lds
s_waitcnt lgkmcnt(0) vmcnt(6)
s_barrier
MM 0,56,48
RB 32,25,0
RB 36,25,4096
MM 16,60,48
RT 40,29,0
RT 42,29,2048
MM 32,56,52
RT 44,30,0
RT 46,30,2048
MM 48,60,52
s_add_u32 m0, s22, 49152
s_add_u32 s24, s19, 1664
buffer_load_dwordx4 v8, s[4:7], s24 offen sc1 lds
s_waitcnt lgkmcnt(12)
MM 0,72,64
RB 48,26,0
RB 52,26,4096
MM 16,76,64
RT 56,29,8192
RT 58,29,10240
MM 32,72,68
RT 60,30,8192
RT 62,30,10240
MM 48,76,68
s_add_u32 m0, s22, 50176
s_add_u32 s24, s19, 18048
buffer_load_dwordx4 v9, s[4:7], s24 offen sc1 lds
s_add_u32 m0, s23, 49152
s_add_u32 s25, s20, 1703936
buffer_load_dwordx4 v10, s[8:11], s25 offen lds
s_waitcnt lgkmcnt(12)
MM 0,88,80
RB 64,27,0
RB 68,27,4096
MM 16,92,80
RT 72,29,16384
RT 74,29,18432
MM 32,88,84
RT 76,30,16384
RT 78,30,18432
MM 48,92,84
s_add_u32 m0, s23, 50176
s_add_u32 s25, s20, 1708032
buffer_load_dwordx4 v11, s[8:11], s25 offen lds
s_waitcnt lgkmcnt(12)
MM 0,40,32
RB 80,28,0
RB 84,28,4096
MM 16,44,32
RT 88,29,24576
RT 90,29,26624
MM 32,40,36
RT 92,30,24576
RT 94,30,26624
MM 48,44,36
s_add_u32 m0, s23, 51200
s_add_u32 s25, s20, 1712128
buffer_load_dwordx4 v10, s[8:11], s25 offen lds
s_add_u32 m0, s23, 52224
s_add_u32 s25, s20, 1716224
buffer_load_dwordx4 v11, s[8:11], s25 offen lds
s_waitcnt lgkmcnt(0) vmcnt(6)
s_barrier
MM 0,56,48
RB 32,13,0
RB 36,13,4096
MM 16,60,48
RT 40,17,0
RT 42,17,2048
MM 32,56,52
RT 44,18,0
RT 46,18,2048
MM 48,60,52
s_add_u32 m0, s22, 98304
s_add_u32 s24, s19, 1792
buffer_load_dwordx4 v8, s[4:7], s24 offen sc1 lds
s_waitcnt lgkmcnt(12)
MM 0,72,64
RB 48,14,0
RB 52,14,4096
MM 16,76,64
RT 56,17,8192
RT 58,17,10240
MM 32,72,68
RT 60,18,8192
RT 62,18,10240
MM 48,76,68
s_add_u32 m0, s22, 99328
s_add_u32 s24, s19, 18176
buffer_load_dwordx4 v9, s[4:7], s24 offen sc1 lds
s_add_u32 m0, s23, 98304
s_add_u32 s25, s20, 1835008
buffer_load_dwordx4 v10, s[8:11], s25 offen lds
s_waitcnt lgkmcnt(12)
MM 0,88,80
RB 64,15,0
RB 68,15,4096
MM 16,92,80
RT 72,17,16384
RT 74,17,18432
MM 32,88,84
RT 76,18,16384
RT 78,18,18432
MM 48,92,84
s_add_u32 m0, s23, 99328
s_add_u32 s25, s20, 1839104
buffer_load_dwordx4 v11, s[8:11], s25 offen lds
s_waitcnt lgkmcnt(12)
MM 0,40,32
RB 80,16,0
RB 84,16,4096
MM 16,44,32
RT 88,17,24576
RT 90,17,26624
MM 32,40,36
RT 92,18,24576
RT 94,18,26624
MM 48,44,36
s_add_u32 m0, s23, 100352
s_add_u32 s25, s20, 1843200
buffer_load_dwordx4 v10, s[8:11], s25 offen lds
s_add_u32 m0, s23, 101376
s_add_u32 s25, s20, 1847296
buffer_load_dwordx4 v11, s[8:11], s25 offen lds
s_waitcnt lgkmcnt(0) vmcnt(6)
s_barrier
MM 0,56,48
RB 32,19,0
RB 36,19,4096
MM 16,60,48
RT 40,23,0
RT 42,23,2048
MM 32,56,52
RT 44,24,0
RT 46,24,2048
MM 48,60,52
s_add_u32 m0, s22, 0
s_add_u32 s24, s19, 1920
buffer_load_dwordx4 v8, s[4:7], s24 offen sc1 lds
s_waitcnt lgkmcnt(12)
MM 0,72,64
RB 48,20,0
RB 52,20,4096
MM 16,76,64
RT 56,23,8192
RT 58,23,10240
MM 32,72,68
RT 60,24,8192
RT 62,24,10240
MM 48,76,68
s_add_u32 m0, s22, 1024
s_add_u32 s24, s19, 18304
buffer_load_dwordx4 v9, s[4:7], s24 offen sc1 lds
s_add_u32 m0, s23, 0
s_add_u32 s25, s20, 1966080
buffer_load_dwordx4 v10, s[8:11], s25 offen lds
s_waitcnt lgkmcnt(12)
MM 0,88,80
RB 64,21,0
RB 68,21,4096
MM 16,92,80
RT 72,23,16384
RT 74,23,18432
MM 32,88,84
RT 76,24,16384
RT 78,24,18432
MM 48,92,84
s_add_u32 m0, s23, 1024
s_add_u32 s25, s20, 1970176
buffer_load_dwordx4 v11, s[8:11], s25 offen lds
s_waitcnt lgkmcnt(12)
MM 0,40,32
RB 80,22,0
RB 84,22,4096
MM 16,44,32
RT 88,23,24576
RT 90,23,26624
MM 32,40,36
RT 92,24,24576
RT 94,24,26624
MM 48,44,36
s_add_u32 m0, s23, 2048
s_add_u32 s25, s20, 1974272
buffer_load_dwordx4 v10, s[8:11], s25 offen lds
s_add_u32 m0, s23, 3072
s_add_u32 s25, s20, 1978368
buffer_load_dwordx4 v11, s[8:11], s25 offen lds
s_waitcnt lgkmcnt(0) vmcnt(6)
s_barrier
MM 0,56,48
RB 32,25,0
RB 36,25,4096
MM 16,60,48
RT 40,29,0
MM 32,56,52
RT 42,29,2048
RT 44,30,0
MM 48,60,52
RT 46,30,2048
s_waitcnt lgkmcnt(12)
MM 0,72,64
RB 48,26,0
RB 52,26,4096
MM 16,76,64
RT 56,29,8192
MM 32,72,68
RT 58,29,10240
RT 60,30,8192
MM 48,76,68
RT 62,30,10240
s_waitcnt lgkmcnt(12)
MM 0,88,80
RB 64,27,0
RB 68,27,4096
MM 16,92,80
RT 72,29,16384
MM 32,88,84
RT 74,29,18432
RT 76,30,16384
MM 48,92,84
RT 78,30,18432
s_waitcnt lgkmcnt(12)
MM 0,40,32
RB 80,28,0
RB 84,28,4096
MM 16,44,32
RT 88,29,24576
MM 32,40,36
RT 90,29,26624
RT 92,30,24576
MM 48,44,36
RT 94,30,26624
s_waitcnt lgkmcnt(0) vmcnt(0)
s_barrier
MM 0,56,48
RB 32,13,0
RB 36,13,4096
MM 16,60,48
RT 40,17,0
MM 32,56,52
RT 42,17,2048
RT 44,18,0
MM 48,60,52
RT 46,18,2048
s_waitcnt lgkmcnt(12)
MM 0,72,64
RB 48,14,0
RB 52,14,4096
MM 16,76,64
RT 56,17,8192
MM 32,72,68
RT 58,17,10240
RT 60,18,8192
MM 48,76,68
RT 62,18,10240
s_waitcnt lgkmcnt(12)
MM 0,88,80
RB 64,15,0
RB 68,15,4096
MM 16,92,80
RT 72,17,16384
MM 32,88,84
RT 74,17,18432
RT 76,18,16384
MM 48,92,84
RT 78,18,18432
s_waitcnt lgkmcnt(12)
MM 0,40,32
RB 80,16,0
RB 84,16,4096
MM 16,44,32
RT 88,17,24576
MM 32,40,36
RT 90,17,26624
RT 92,18,24576
MM 48,44,36
RT 94,18,26624
s_waitcnt lgkmcnt(0)
MM 0,56,48
MM 16,60,48
MM 32,56,52
MM 48,60,52
s_waitcnt lgkmcnt(0)
MM 0,72,64
MM 16,76,64
MM 32,72,68
MM 48,76,68
s_waitcnt lgkmcnt(0)
MM 0,88,80
MM 16,92,80
MM 32,88,84
MM 48,92,84
s_barrier
s_cmp_lg_u32 s16, 0
s_cbranch_scc1 tt_137
v_mov_b32 v7, s56
v_accvgpr_write_b32 a127, 1
s_mov_b64 exec, 1
buffer_atomic_add a127, v7, s[4:7], 0 offen sc0
s_mov_b64 exec, -1
tt_137:
v_and_b32 v1, 31, v0
v_lshrrev_b32 v2, 5, v0
s_mul_i32 s24, s17, 33792
s_mul_i32 s25, s18, 128
s_add_u32 s24, s24, s25
v_mul_u32_u24 v3, 528, v1
v_lshl_add_u32 v3, v2, 4, v3
v_add_u32 v3, s24, v3
v_mov_b32 v72, 0xc0135761
v_mov_b32 v74, 0xbdd2d3e8
v_mov_b32 v76, 1.0
v_mov_b32 v73, 0xc0135761
v_mov_b32 v75, 0xbdd2d3e8
v_mov_b32 v77, 1.0
v_lshrrev_b32 v4, 5, v0
v_and_b32 v5, 31, v0
s_mul_i32 s24, s16, 16
v_add_u32 v4, s24, v4
v_mul_u32_u24 v6, 528, v4
v_lshl_add_u32 v6, v5, 4, v6
s_mov_b32 s24, 2048
v_mul_lo_u32 v12, v4, s24
v_lshl_add_u32 v12, v5, 4, v12
v_accvgpr_read_b32 v32, a0
v_accvgpr_read_b32 v33, a1
v_accvgpr_read_b32 v34, a2
v_accvgpr_read_b32 v35, a3
v_accvgpr_read_b32 v36, a4
v_accvgpr_read_b32 v37, a5
v_accvgpr_read_b32 v38, a6
v_accvgpr_read_b32 v39, a7
v_accvgpr_read_b32 v40, a8
v_accvgpr_read_b32 v41, a9
v_accvgpr_read_b32 v42, a10
v_accvgpr_read_b32 v43, a11
v_accvgpr_read_b32 v44, a12
v_accvgpr_read_b32 v45, a13
v_accvgpr_read_b32 v46, a14
v_accvgpr_read_b32 v47, a15
v_pk_mul_f32 v[64:65], v[32:33], v[32:33]
v_pk_mul_f32 v[66:67], v[34:35], v[34:35]
v_pk_fma_f32 v[64:65], v[64:65], v[74:75], v[72:73]
v_pk_fma_f32 v[66:67], v[66:67], v[74:75], v[72:73]
v_pk_mul_f32 v[64:65], v[64:65], v[32:33]
v_pk_mul_f32 v[66:67], v[66:67], v[34:35]
v_exp_f32 v64, v64
v_exp_f32 v66, v66
v_exp_f32 v65, v65
v_exp_f32 v67, v67
v_pk_add_f32 v[64:65], v[64:65], v[76:77]
v_pk_add_f32 v[66:67], v[66:67], v[76:77]
v_rcp_f32 v64, v64
v_rcp_f32 v66, v66
v_rcp_f32 v65, v65
v_rcp_f32 v67, v67
v_pk_mul_f32 v[32:33], v[32:33], v[64:65]
v_pk_mul_f32 v[34:35], v[34:35], v[66:67]
v_pk_mul_f32 v[64:65], v[36:37], v[36:37]
v_pk_mul_f32 v[66:67], v[38:39], v[38:39]
v_pk_fma_f32 v[64:65], v[64:65], v[74:75], v[72:73]
v_pk_fma_f32 v[66:67], v[66:67], v[74:75], v[72:73]
v_pk_mul_f32 v[64:65], v[64:65], v[36:37]
v_pk_mul_f32 v[66:67], v[66:67], v[38:39]
v_exp_f32 v64, v64
v_exp_f32 v66, v66
v_exp_f32 v65, v65
v_exp_f32 v67, v67
v_pk_add_f32 v[64:65], v[64:65], v[76:77]
v_pk_add_f32 v[66:67], v[66:67], v[76:77]
v_rcp_f32 v64, v64
v_rcp_f32 v66, v66
v_rcp_f32 v65, v65
v_rcp_f32 v67, v67
v_pk_mul_f32 v[36:37], v[36:37], v[64:65]
v_pk_mul_f32 v[38:39], v[38:39], v[66:67]
v_pk_mul_f32 v[64:65], v[40:41], v[40:41]
v_pk_mul_f32 v[66:67], v[42:43], v[42:43]
v_pk_fma_f32 v[64:65], v[64:65], v[74:75], v[72:73]
v_pk_fma_f32 v[66:67], v[66:67], v[74:75], v[72:73]
v_pk_mul_f32 v[64:65], v[64:65], v[40:41]
v_pk_mul_f32 v[66:67], v[66:67], v[42:43]
v_exp_f32 v64, v64
v_exp_f32 v66, v66
v_exp_f32 v65, v65
v_exp_f32 v67, v67
v_pk_add_f32 v[64:65], v[64:65], v[76:77]
v_pk_add_f32 v[66:67], v[66:67], v[76:77]
v_rcp_f32 v64, v64
v_rcp_f32 v66, v66
v_rcp_f32 v65, v65
v_rcp_f32 v67, v67
v_pk_mul_f32 v[40:41], v[40:41], v[64:65]
v_pk_mul_f32 v[42:43], v[42:43], v[66:67]
v_pk_mul_f32 v[64:65], v[44:45], v[44:45]
v_pk_mul_f32 v[66:67], v[46:47], v[46:47]
v_pk_fma_f32 v[64:65], v[64:65], v[74:75], v[72:73]
v_pk_fma_f32 v[66:67], v[66:67], v[74:75], v[72:73]
v_pk_mul_f32 v[64:65], v[64:65], v[44:45]
v_pk_mul_f32 v[66:67], v[66:67], v[46:47]
v_exp_f32 v64, v64
v_exp_f32 v66, v66
v_exp_f32 v65, v65
v_exp_f32 v67, v67
v_pk_add_f32 v[64:65], v[64:65], v[76:77]
v_pk_add_f32 v[66:67], v[66:67], v[76:77]
v_rcp_f32 v64, v64
v_rcp_f32 v66, v66
v_rcp_f32 v65, v65
v_rcp_f32 v67, v67
v_pk_mul_f32 v[44:45], v[44:45], v[64:65]
v_pk_mul_f32 v[46:47], v[46:47], v[66:67]
v_cvt_pk_bf16_f32 v48, v32, v33
v_cvt_pk_bf16_f32 v49, v34, v35
v_cvt_pk_bf16_f32 v50, v36, v37
v_cvt_pk_bf16_f32 v51, v38, v39
v_cvt_pk_bf16_f32 v52, v40, v41
v_cvt_pk_bf16_f32 v53, v42, v43
v_cvt_pk_bf16_f32 v54, v44, v45
v_cvt_pk_bf16_f32 v55, v46, v47
v_permlane32_swap_b32 v48, v50
v_permlane32_swap_b32 v49, v51
v_permlane32_swap_b32 v52, v54
v_permlane32_swap_b32 v53, v55
ds_write_b128 v3, v[48:51] offset:0
ds_write_b128 v3, v[52:55] offset:32
v_accvgpr_read_b32 v32, a16
v_accvgpr_read_b32 v33, a17
v_accvgpr_read_b32 v34, a18
v_accvgpr_read_b32 v35, a19
v_accvgpr_read_b32 v36, a20
v_accvgpr_read_b32 v37, a21
v_accvgpr_read_b32 v38, a22
v_accvgpr_read_b32 v39, a23
v_accvgpr_read_b32 v40, a24
v_accvgpr_read_b32 v41, a25
v_accvgpr_read_b32 v42, a26
v_accvgpr_read_b32 v43, a27
v_accvgpr_read_b32 v44, a28
v_accvgpr_read_b32 v45, a29
v_accvgpr_read_b32 v46, a30
v_accvgpr_read_b32 v47, a31
v_pk_mul_f32 v[64:65], v[32:33], v[32:33]
v_pk_mul_f32 v[66:67], v[34:35], v[34:35]
v_pk_fma_f32 v[64:65], v[64:65], v[74:75], v[72:73]
v_pk_fma_f32 v[66:67], v[66:67], v[74:75], v[72:73]
v_pk_mul_f32 v[64:65], v[64:65], v[32:33]
v_pk_mul_f32 v[66:67], v[66:67], v[34:35]
v_exp_f32 v64, v64
v_exp_f32 v66, v66
v_exp_f32 v65, v65
v_exp_f32 v67, v67
v_pk_add_f32 v[64:65], v[64:65], v[76:77]
v_pk_add_f32 v[66:67], v[66:67], v[76:77]
v_rcp_f32 v64, v64
v_rcp_f32 v66, v66
v_rcp_f32 v65, v65
v_rcp_f32 v67, v67
v_pk_mul_f32 v[32:33], v[32:33], v[64:65]
v_pk_mul_f32 v[34:35], v[34:35], v[66:67]
v_pk_mul_f32 v[64:65], v[36:37], v[36:37]
v_pk_mul_f32 v[66:67], v[38:39], v[38:39]
v_pk_fma_f32 v[64:65], v[64:65], v[74:75], v[72:73]
v_pk_fma_f32 v[66:67], v[66:67], v[74:75], v[72:73]
v_pk_mul_f32 v[64:65], v[64:65], v[36:37]
v_pk_mul_f32 v[66:67], v[66:67], v[38:39]
v_exp_f32 v64, v64
v_exp_f32 v66, v66
v_exp_f32 v65, v65
v_exp_f32 v67, v67
v_pk_add_f32 v[64:65], v[64:65], v[76:77]
v_pk_add_f32 v[66:67], v[66:67], v[76:77]
v_rcp_f32 v64, v64
v_rcp_f32 v66, v66
v_rcp_f32 v65, v65
v_rcp_f32 v67, v67
v_pk_mul_f32 v[36:37], v[36:37], v[64:65]
v_pk_mul_f32 v[38:39], v[38:39], v[66:67]
v_pk_mul_f32 v[64:65], v[40:41], v[40:41]
v_pk_mul_f32 v[66:67], v[42:43], v[42:43]
v_pk_fma_f32 v[64:65], v[64:65], v[74:75], v[72:73]
v_pk_fma_f32 v[66:67], v[66:67], v[74:75], v[72:73]
v_pk_mul_f32 v[64:65], v[64:65], v[40:41]
v_pk_mul_f32 v[66:67], v[66:67], v[42:43]
v_exp_f32 v64, v64
v_exp_f32 v66, v66
v_exp_f32 v65, v65
v_exp_f32 v67, v67
v_pk_add_f32 v[64:65], v[64:65], v[76:77]
v_pk_add_f32 v[66:67], v[66:67], v[76:77]
v_rcp_f32 v64, v64
v_rcp_f32 v66, v66
v_rcp_f32 v65, v65
v_rcp_f32 v67, v67
v_pk_mul_f32 v[40:41], v[40:41], v[64:65]
v_pk_mul_f32 v[42:43], v[42:43], v[66:67]
v_pk_mul_f32 v[64:65], v[44:45], v[44:45]
v_pk_mul_f32 v[66:67], v[46:47], v[46:47]
v_pk_fma_f32 v[64:65], v[64:65], v[74:75], v[72:73]
v_pk_fma_f32 v[66:67], v[66:67], v[74:75], v[72:73]
v_pk_mul_f32 v[64:65], v[64:65], v[44:45]
v_pk_mul_f32 v[66:67], v[66:67], v[46:47]
v_exp_f32 v64, v64
v_exp_f32 v66, v66
v_exp_f32 v65, v65
v_exp_f32 v67, v67
v_pk_add_f32 v[64:65], v[64:65], v[76:77]
v_pk_add_f32 v[66:67], v[66:67], v[76:77]
v_rcp_f32 v64, v64
v_rcp_f32 v66, v66
v_rcp_f32 v65, v65
v_rcp_f32 v67, v67
v_pk_mul_f32 v[44:45], v[44:45], v[64:65]
v_pk_mul_f32 v[46:47], v[46:47], v[66:67]
v_cvt_pk_bf16_f32 v56, v32, v33
v_cvt_pk_bf16_f32 v57, v34, v35
v_cvt_pk_bf16_f32 v58, v36, v37
v_cvt_pk_bf16_f32 v59, v38, v39
v_cvt_pk_bf16_f32 v60, v40, v41
v_cvt_pk_bf16_f32 v61, v42, v43
v_cvt_pk_bf16_f32 v62, v44, v45
v_cvt_pk_bf16_f32 v63, v46, v47
v_permlane32_swap_b32 v56, v58
v_permlane32_swap_b32 v57, v59
v_permlane32_swap_b32 v60, v62
v_permlane32_swap_b32 v61, v63
ds_write_b128 v3, v[56:59] offset:64
ds_write_b128 v3, v[60:63] offset:96
v_accvgpr_read_b32 v32, a32
v_accvgpr_read_b32 v33, a33
v_accvgpr_read_b32 v34, a34
v_accvgpr_read_b32 v35, a35
v_accvgpr_read_b32 v36, a36
v_accvgpr_read_b32 v37, a37
v_accvgpr_read_b32 v38, a38
v_accvgpr_read_b32 v39, a39
v_accvgpr_read_b32 v40, a40
v_accvgpr_read_b32 v41, a41
v_accvgpr_read_b32 v42, a42
v_accvgpr_read_b32 v43, a43
v_accvgpr_read_b32 v44, a44
v_accvgpr_read_b32 v45, a45
v_accvgpr_read_b32 v46, a46
v_accvgpr_read_b32 v47, a47
v_pk_mul_f32 v[64:65], v[32:33], v[32:33]
v_pk_mul_f32 v[66:67], v[34:35], v[34:35]
v_pk_fma_f32 v[64:65], v[64:65], v[74:75], v[72:73]
v_pk_fma_f32 v[66:67], v[66:67], v[74:75], v[72:73]
v_pk_mul_f32 v[64:65], v[64:65], v[32:33]
v_pk_mul_f32 v[66:67], v[66:67], v[34:35]
v_exp_f32 v64, v64
v_exp_f32 v66, v66
v_exp_f32 v65, v65
v_exp_f32 v67, v67
v_pk_add_f32 v[64:65], v[64:65], v[76:77]
v_pk_add_f32 v[66:67], v[66:67], v[76:77]
v_rcp_f32 v64, v64
v_rcp_f32 v66, v66
v_rcp_f32 v65, v65
v_rcp_f32 v67, v67
v_pk_mul_f32 v[32:33], v[32:33], v[64:65]
v_pk_mul_f32 v[34:35], v[34:35], v[66:67]
v_pk_mul_f32 v[64:65], v[36:37], v[36:37]
v_pk_mul_f32 v[66:67], v[38:39], v[38:39]
v_pk_fma_f32 v[64:65], v[64:65], v[74:75], v[72:73]
v_pk_fma_f32 v[66:67], v[66:67], v[74:75], v[72:73]
v_pk_mul_f32 v[64:65], v[64:65], v[36:37]
v_pk_mul_f32 v[66:67], v[66:67], v[38:39]
v_exp_f32 v64, v64
v_exp_f32 v66, v66
v_exp_f32 v65, v65
v_exp_f32 v67, v67
v_pk_add_f32 v[64:65], v[64:65], v[76:77]
v_pk_add_f32 v[66:67], v[66:67], v[76:77]
v_rcp_f32 v64, v64
v_rcp_f32 v66, v66
v_rcp_f32 v65, v65
v_rcp_f32 v67, v67
v_pk_mul_f32 v[36:37], v[36:37], v[64:65]
v_pk_mul_f32 v[38:39], v[38:39], v[66:67]
v_pk_mul_f32 v[64:65], v[40:41], v[40:41]
v_pk_mul_f32 v[66:67], v[42:43], v[42:43]
v_pk_fma_f32 v[64:65], v[64:65], v[74:75], v[72:73]
v_pk_fma_f32 v[66:67], v[66:67], v[74:75], v[72:73]
v_pk_mul_f32 v[64:65], v[64:65], v[40:41]
v_pk_mul_f32 v[66:67], v[66:67], v[42:43]
v_exp_f32 v64, v64
v_exp_f32 v66, v66
v_exp_f32 v65, v65
v_exp_f32 v67, v67
v_pk_add_f32 v[64:65], v[64:65], v[76:77]
v_pk_add_f32 v[66:67], v[66:67], v[76:77]
v_rcp_f32 v64, v64
v_rcp_f32 v66, v66
v_rcp_f32 v65, v65
v_rcp_f32 v67, v67
v_pk_mul_f32 v[40:41], v[40:41], v[64:65]
v_pk_mul_f32 v[42:43], v[42:43], v[66:67]
v_pk_mul_f32 v[64:65], v[44:45], v[44:45]
v_pk_mul_f32 v[66:67], v[46:47], v[46:47]
v_pk_fma_f32 v[64:65], v[64:65], v[74:75], v[72:73]
v_pk_fma_f32 v[66:67], v[66:67], v[74:75], v[72:73]
v_pk_mul_f32 v[64:65], v[64:65], v[44:45]
v_pk_mul_f32 v[66:67], v[66:67], v[46:47]
v_exp_f32 v64, v64
v_exp_f32 v66, v66
v_exp_f32 v65, v65
v_exp_f32 v67, v67
v_pk_add_f32 v[64:65], v[64:65], v[76:77]
v_pk_add_f32 v[66:67], v[66:67], v[76:77]
v_rcp_f32 v64, v64
v_rcp_f32 v66, v66
v_rcp_f32 v65, v65
v_rcp_f32 v67, v67
v_pk_mul_f32 v[44:45], v[44:45], v[64:65]
v_pk_mul_f32 v[46:47], v[46:47], v[66:67]
v_cvt_pk_bf16_f32 v48, v32, v33
v_cvt_pk_bf16_f32 v49, v34, v35
v_cvt_pk_bf16_f32 v50, v36, v37
v_cvt_pk_bf16_f32 v51, v38, v39
v_cvt_pk_bf16_f32 v52, v40, v41
v_cvt_pk_bf16_f32 v53, v42, v43
v_cvt_pk_bf16_f32 v54, v44, v45
v_cvt_pk_bf16_f32 v55, v46, v47
v_permlane32_swap_b32 v48, v50
v_permlane32_swap_b32 v49, v51
v_permlane32_swap_b32 v52, v54
v_permlane32_swap_b32 v53, v55
ds_write_b128 v3, v[48:51] offset:16896
ds_write_b128 v3, v[52:55] offset:16928
v_accvgpr_read_b32 v32, a48
v_accvgpr_read_b32 v33, a49
v_accvgpr_read_b32 v34, a50
v_accvgpr_read_b32 v35, a51
v_accvgpr_read_b32 v36, a52
v_accvgpr_read_b32 v37, a53
v_accvgpr_read_b32 v38, a54
v_accvgpr_read_b32 v39, a55
v_accvgpr_read_b32 v40, a56
v_accvgpr_read_b32 v41, a57
v_accvgpr_read_b32 v42, a58
v_accvgpr_read_b32 v43, a59
v_accvgpr_read_b32 v44, a60
v_accvgpr_read_b32 v45, a61
v_accvgpr_read_b32 v46, a62
v_accvgpr_read_b32 v47, a63
v_pk_mul_f32 v[64:65], v[32:33], v[32:33]
v_pk_mul_f32 v[66:67], v[34:35], v[34:35]
v_pk_fma_f32 v[64:65], v[64:65], v[74:75], v[72:73]
v_pk_fma_f32 v[66:67], v[66:67], v[74:75], v[72:73]
v_pk_mul_f32 v[64:65], v[64:65], v[32:33]
v_pk_mul_f32 v[66:67], v[66:67], v[34:35]
v_exp_f32 v64, v64
v_exp_f32 v66, v66
v_exp_f32 v65, v65
v_exp_f32 v67, v67
v_pk_add_f32 v[64:65], v[64:65], v[76:77]
v_pk_add_f32 v[66:67], v[66:67], v[76:77]
v_rcp_f32 v64, v64
v_rcp_f32 v66, v66
v_rcp_f32 v65, v65
v_rcp_f32 v67, v67
v_pk_mul_f32 v[32:33], v[32:33], v[64:65]
v_pk_mul_f32 v[34:35], v[34:35], v[66:67]
v_pk_mul_f32 v[64:65], v[36:37], v[36:37]
v_pk_mul_f32 v[66:67], v[38:39], v[38:39]
v_pk_fma_f32 v[64:65], v[64:65], v[74:75], v[72:73]
v_pk_fma_f32 v[66:67], v[66:67], v[74:75], v[72:73]
v_pk_mul_f32 v[64:65], v[64:65], v[36:37]
v_pk_mul_f32 v[66:67], v[66:67], v[38:39]
v_exp_f32 v64, v64
v_exp_f32 v66, v66
v_exp_f32 v65, v65
v_exp_f32 v67, v67
v_pk_add_f32 v[64:65], v[64:65], v[76:77]
v_pk_add_f32 v[66:67], v[66:67], v[76:77]
v_rcp_f32 v64, v64
v_rcp_f32 v66, v66
v_rcp_f32 v65, v65
v_rcp_f32 v67, v67
v_pk_mul_f32 v[36:37], v[36:37], v[64:65]
v_pk_mul_f32 v[38:39], v[38:39], v[66:67]
v_pk_mul_f32 v[64:65], v[40:41], v[40:41]
v_pk_mul_f32 v[66:67], v[42:43], v[42:43]
v_pk_fma_f32 v[64:65], v[64:65], v[74:75], v[72:73]
v_pk_fma_f32 v[66:67], v[66:67], v[74:75], v[72:73]
v_pk_mul_f32 v[64:65], v[64:65], v[40:41]
v_pk_mul_f32 v[66:67], v[66:67], v[42:43]
v_exp_f32 v64, v64
v_exp_f32 v66, v66
v_exp_f32 v65, v65
v_exp_f32 v67, v67
v_pk_add_f32 v[64:65], v[64:65], v[76:77]
v_pk_add_f32 v[66:67], v[66:67], v[76:77]
v_rcp_f32 v64, v64
v_rcp_f32 v66, v66
v_rcp_f32 v65, v65
v_rcp_f32 v67, v67
v_pk_mul_f32 v[40:41], v[40:41], v[64:65]
v_pk_mul_f32 v[42:43], v[42:43], v[66:67]
v_pk_mul_f32 v[64:65], v[44:45], v[44:45]
v_pk_mul_f32 v[66:67], v[46:47], v[46:47]
v_pk_fma_f32 v[64:65], v[64:65], v[74:75], v[72:73]
v_pk_fma_f32 v[66:67], v[66:67], v[74:75], v[72:73]
v_pk_mul_f32 v[64:65], v[64:65], v[44:45]
v_pk_mul_f32 v[66:67], v[66:67], v[46:47]
v_exp_f32 v64, v64
v_exp_f32 v66, v66
v_exp_f32 v65, v65
v_exp_f32 v67, v67
v_pk_add_f32 v[64:65], v[64:65], v[76:77]
v_pk_add_f32 v[66:67], v[66:67], v[76:77]
v_rcp_f32 v64, v64
v_rcp_f32 v66, v66
v_rcp_f32 v65, v65
v_rcp_f32 v67, v67
v_pk_mul_f32 v[44:45], v[44:45], v[64:65]
v_pk_mul_f32 v[46:47], v[46:47], v[66:67]
v_cvt_pk_bf16_f32 v56, v32, v33
v_cvt_pk_bf16_f32 v57, v34, v35
v_cvt_pk_bf16_f32 v58, v36, v37
v_cvt_pk_bf16_f32 v59, v38, v39
v_cvt_pk_bf16_f32 v60, v40, v41
v_cvt_pk_bf16_f32 v61, v42, v43
v_cvt_pk_bf16_f32 v62, v44, v45
v_cvt_pk_bf16_f32 v63, v46, v47
v_permlane32_swap_b32 v56, v58
v_permlane32_swap_b32 v57, v59
v_permlane32_swap_b32 v60, v62
v_permlane32_swap_b32 v61, v63
ds_write_b128 v3, v[56:59] offset:16960
ds_write_b128 v3, v[60:63] offset:16992
s_waitcnt lgkmcnt(0)
s_barrier
RB 32,6,0
RB 36,6,1056
RB 40,6,2112
RB 44,6,3168
RB 48,6,4224
RB 52,6,5280
RB 56,6,6336
RB 60,6,7392
s_waitcnt lgkmcnt(7)
s_add_u32 s24, s33, 0
buffer_store_dwordx4 v[32:35], v12, s[4:7], s24 offen sc1
s_waitcnt lgkmcnt(6)
s_add_u32 s24, s33, 4096
buffer_store_dwordx4 v[36:39], v12, s[4:7], s24 offen sc1
s_waitcnt lgkmcnt(5)
s_add_u32 s24, s33, 8192
buffer_store_dwordx4 v[40:43], v12, s[4:7], s24 offen sc1
s_waitcnt lgkmcnt(4)
s_add_u32 s24, s33, 12288
buffer_store_dwordx4 v[44:47], v12, s[4:7], s24 offen sc1
s_waitcnt lgkmcnt(3)
s_add_u32 s24, s33, 16384
buffer_store_dwordx4 v[48:51], v12, s[4:7], s24 offen sc1
s_waitcnt lgkmcnt(2)
s_add_u32 s24, s33, 20480
buffer_store_dwordx4 v[52:55], v12, s[4:7], s24 offen sc1
s_waitcnt lgkmcnt(1)
s_add_u32 s24, s33, 24576
buffer_store_dwordx4 v[56:59], v12, s[4:7], s24 offen sc1
s_waitcnt lgkmcnt(0)
s_add_u32 s24, s33, 28672
buffer_store_dwordx4 v[60:63], v12, s[4:7], s24 offen sc1
s_lshl_b32 s76, s77, 7
s_add_u32 s76, s76, 49152
s_waitcnt vmcnt(0)
s_barrier
s_cmp_lg_u32 s16, 0
s_cbranch_scc1 sig_138
v_mov_b32 v1, s76
v_mov_b32 v2, 4
s_mov_b64 exec, 1
buffer_atomic_add v2, v1, s[4:7], 0 offen
s_mov_b64 exec, -1
sig_138:
s_branch mega_kernel_wloop
mega_kernel_t6:
s_lshr_b32 s17, s16, 2
s_and_b32 s18, s16, 3
v_lshrrev_b32 v1, 3, v0
s_mov_b32 s24, 2048
v_mul_lo_u32 v1, v1, s24
v_lshrrev_b32 v2, 4, v0
v_and_b32 v3, 7, v0
s_mov_b32 s25, 0
s_xor_b32 s26, s25, 0
v_add_u32 v4, s26, v2
v_xor_b32 v4, v4, v3
v_lshl_add_u32 v8, v4, 4, v1
s_xor_b32 s26, s25, 4
v_add_u32 v4, s26, v2
v_xor_b32 v4, v4, v3
v_lshl_add_u32 v9, v4, 4, v1
v_lshrrev_b32 v1, 5, v0
v_and_b32 v3, 31, v0
s_mov_b32 s24, 2048
v_mul_lo_u32 v2, v1, s24
v_add_u32 v4, 0, v1
v_and_b32 v4, 3, v4
v_lshlrev_b32 v4, 2, v4
v_xor_b32 v4, v4, v3
v_lshl_add_u32 v10, v4, 4, v2
v_add_u32 v4, 2, v1
v_and_b32 v4, 3, v4
v_lshlrev_b32 v4, 2, v4
v_xor_b32 v4, v4, v3
v_lshl_add_u32 v11, v4, 4, v2
v_and_b32 v1, 31, v0
v_lshrrev_b32 v2, 5, v0
v_bfe_u32 v3, v1, 1, 3
s_mul_i32 s24, s17, 8192
v_lshlrev_b32 v4, 7, v1
v_add_u32 v4, s24, v4
v_add_u32 v5, 0, v2
v_xor_b32 v5, v5, v3
v_lshl_add_u32 v13, v5, 4, v4
v_add_u32 v5, 2, v2
v_xor_b32 v5, v5, v3
v_lshl_add_u32 v14, v5, 4, v4
v_add_u32 v5, 4, v2
v_xor_b32 v5, v5, v3
v_lshl_add_u32 v15, v5, 4, v4
v_add_u32 v5, 6, v2
v_xor_b32 v5, v5, v3
v_lshl_add_u32 v16, v5, 4, v4
v_and_b32 v1, 15, v0
v_lshrrev_b32 v2, 2, v1
v_lshrrev_b32 v3, 5, v0
v_lshl_add_u32 v3, v3, 3, v2
v_mul_u32_u24 v3, 512, v3
v_and_b32 v4, 3, v1
v_lshl_add_u32 v3, v4, 3, v3
v_bfe_u32 v4, v0, 4, 1
v_lshl_add_u32 v3, v4, 5, v3
v_add_u32 v3, 16384, v3
s_mul_i32 s24, s18, 2
s_add_u32 s24, s24, 0
v_xor_b32 v4, s24, v2
v_lshl_add_u32 v17, v4, 6, v3
s_mul_i32 s24, s18, 2
s_add_u32 s24, s24, 1
v_xor_b32 v4, s24, v2
v_lshl_add_u32 v18, v4, 6, v3
v_add_u32 v19, 49152, v13
v_add_u32 v20, 49152, v14
v_add_u32 v21, 49152, v15
v_add_u32 v22, 49152, v16
v_add_u32 v23, 49152, v17
v_add_u32 v24, 49152, v18
v_add_u32 v25, 98304, v13
v_add_u32 v26, 98304, v14
v_add_u32 v27, 98304, v15
v_add_u32 v28, 98304, v16
v_add_u32 v29, 98304, v17
v_add_u32 v30, 98304, v18
s_mul_i32 s22, s16, 2048
s_mul_i32 s23, s16, 4096
s_add_u32 s23, s23, 16384
s_mov_b32 s8, s82
s_and_b32 s9, s83, 0xffff
s_mov_b32 s10, 0x200000
s_mov_b32 s11, 0x00020000
s_lshl_b32 s28, s77, 7
s_lshl_b32 s52, s77, 6
s_add_u32 s52, s52, 960
s_cmp_ge_u32 s77, 15
s_cselect_b32 s28, s52, s28
s_and_b32 s29, s79, 3
s_lshl_b32 s29, s29, 8
s_mul_i32 s24, s16, 16
s_add_u32 s24, s24, s28
s_mul_i32 s19, s24, 2048
s_add_u32 s19, s19, 94375936
s_mul_i32 s20, s16, 16384
s_lshl_b32 s24, s29, 1
s_add_u32 s20, s20, s24
s_mul_i32 s24, s28, 2048
s_mul_i32 s25, s29, 2
s_add_u32 s24, s24, s25
s_add_u32 s33, s24, 98574336
s_add_u32 s34, s24, 85983232
s_mov_b32 s35, 0
s_lshl_b32 s24, s77, 7
s_add_u32 s24, s24, 49024
s_lshl_b32 s25, s77, 7
s_add_u32 s25, s25, 49152
s_lshl_b32 s26, s77, 7
s_add_u32 s26, s26, 49280
s_cmp_eq_u32 s77, 0
s_cselect_b32 s24, s25, s24
s_cmp_eq_u32 s77, 16
s_cselect_b32 s26, s25, s26
s_cmp_lg_u32 s16, 0
s_cbranch_scc1 wf_139
v_mov_b32 v1, 0
v_mov_b32 v2, 0
v_writelane_b32 v1, s26, 0
s_mov_b32 s27, 16
v_writelane_b32 v2, s27, 0
v_writelane_b32 v1, s25, 1
s_mov_b32 s27, 16
v_writelane_b32 v2, s27, 1
v_writelane_b32 v1, s24, 2
s_mov_b32 s27, 16
v_writelane_b32 v2, s27, 2
s_mov_b64 exec, 7
wfp_140:
s_add_u32 s63, s63, 1
s_cmp_gt_u32 s63, 262144
s_cbranch_scc0 go_141
s_endpgm
go_141:
buffer_load_dword v3, v1, s[4:7], 0 offen sc1
s_waitcnt vmcnt(0)
v_cmp_lt_u32 vcc, v3, v2
s_nop 0
s_cbranch_vccz wfd_142
s_cmp_lt_u32 s77, 13
s_cbranch_scc1 urg_143
s_sleep 2
s_branch wfp_140
urg_143:
v_sub_u32 v4, v2, v3
s_nop 0
v_readlane_b32 s27, v4, 0
s_nop 0
s_cmp_lt_i32 s27, 2
s_cbranch_scc1 lv_144
s_sleep 40
s_branch wfp_140
lv_144:
s_cmp_lt_i32 s27, 1
s_cbranch_scc1 lv_145
s_sleep 12
s_branch wfp_140
lv_145:
s_sleep 8
s_branch wfp_140
wfd_142:
s_mov_b64 exec, -1
wf_139:
s_barrier
s_add_u32 m0, s22, 0
s_add_u32 s24, s19, 4294965248
buffer_load_dwordx4 v8, s[4:7], s24 offen sc1 lds
s_add_u32 m0, s22, 1024
s_add_u32 s24, s19, 14336
buffer_load_dwordx4 v9, s[4:7], s24 offen sc1 lds
s_add_u32 m0, s23, 0
s_add_u32 s25, s20, 0
buffer_load_dwordx4 v10, s[8:11], s25 offen lds
s_add_u32 m0, s23, 1024
s_add_u32 s25, s20, 4096
buffer_load_dwordx4 v11, s[8:11], s25 offen lds
s_add_u32 m0, s23, 2048
s_add_u32 s25, s20, 8192
buffer_load_dwordx4 v10, s[8:11], s25 offen lds
s_add_u32 m0, s23, 3072
s_add_u32 s25, s20, 12288
buffer_load_dwordx4 v11, s[8:11], s25 offen lds
s_add_u32 m0, s22, 49152
s_add_u32 s24, s19, 4294965376
buffer_load_dwordx4 v8, s[4:7], s24 offen sc1 lds
s_add_u32 m0, s22, 50176
s_add_u32 s24, s19, 14464
buffer_load_dwordx4 v9, s[4:7], s24 offen sc1 lds
s_add_u32 m0, s23, 49152
s_add_u32 s25, s20, 131072
buffer_load_dwordx4 v10, s[8:11], s25 offen lds
s_add_u32 m0, s23, 50176
s_add_u32 s25, s20, 135168
buffer_load_dwordx4 v11, s[8:11], s25 offen lds
s_add_u32 m0, s23, 51200
s_add_u32 s25, s20, 139264
buffer_load_dwordx4 v10, s[8:11], s25 offen lds
s_add_u32 m0, s23, 52224
s_add_u32 s25, s20, 143360
buffer_load_dwordx4 v11, s[8:11], s25 offen lds
v_accvgpr_write_b32 a0, 0
v_accvgpr_write_b32 a1, 0
v_accvgpr_write_b32 a2, 0
v_accvgpr_write_b32 a3, 0
v_accvgpr_write_b32 a4, 0
v_accvgpr_write_b32 a5, 0
v_accvgpr_write_b32 a6, 0
v_accvgpr_write_b32 a7, 0
v_accvgpr_write_b32 a8, 0
v_accvgpr_write_b32 a9, 0
v_accvgpr_write_b32 a10, 0
v_accvgpr_write_b32 a11, 0
v_accvgpr_write_b32 a12, 0
v_accvgpr_write_b32 a13, 0
v_accvgpr_write_b32 a14, 0
v_accvgpr_write_b32 a15, 0
v_accvgpr_write_b32 a16, 0
v_accvgpr_write_b32 a17, 0
v_accvgpr_write_b32 a18, 0
v_accvgpr_write_b32 a19, 0
v_accvgpr_write_b32 a20, 0
v_accvgpr_write_b32 a21, 0
v_accvgpr_write_b32 a22, 0
v_accvgpr_write_b32 a23, 0
v_accvgpr_write_b32 a24, 0
v_accvgpr_write_b32 a25, 0
v_accvgpr_write_b32 a26, 0
v_accvgpr_write_b32 a27, 0
v_accvgpr_write_b32 a28, 0
v_accvgpr_write_b32 a29, 0
v_accvgpr_write_b32 a30, 0
v_accvgpr_write_b32 a31, 0
v_accvgpr_write_b32 a32, 0
v_accvgpr_write_b32 a33, 0
v_accvgpr_write_b32 a34, 0
v_accvgpr_write_b32 a35, 0
v_accvgpr_write_b32 a36, 0
v_accvgpr_write_b32 a37, 0
v_accvgpr_write_b32 a38, 0
v_accvgpr_write_b32 a39, 0
v_accvgpr_write_b32 a40, 0
v_accvgpr_write_b32 a41, 0
v_accvgpr_write_b32 a42, 0
v_accvgpr_write_b32 a43, 0
v_accvgpr_write_b32 a44, 0
v_accvgpr_write_b32 a45, 0
v_accvgpr_write_b32 a46, 0
v_accvgpr_write_b32 a47, 0
v_accvgpr_write_b32 a48, 0
v_accvgpr_write_b32 a49, 0
v_accvgpr_write_b32 a50, 0
v_accvgpr_write_b32 a51, 0
v_accvgpr_write_b32 a52, 0
v_accvgpr_write_b32 a53, 0
v_accvgpr_write_b32 a54, 0
v_accvgpr_write_b32 a55, 0
v_accvgpr_write_b32 a56, 0
v_accvgpr_write_b32 a57, 0
v_accvgpr_write_b32 a58, 0
v_accvgpr_write_b32 a59, 0
v_accvgpr_write_b32 a60, 0
v_accvgpr_write_b32 a61, 0
v_accvgpr_write_b32 a62, 0
v_accvgpr_write_b32 a63, 0
s_waitcnt vmcnt(6)
s_barrier
RB 32,13,0
RB 36,13,4096
RT 40,17,0
RT 42,17,2048
RT 44,18,0
RT 46,18,2048
RB 48,14,0
RB 52,14,4096
RT 56,17,8192
RT 58,17,10240
RT 60,18,8192
RT 62,18,10240
RB 64,15,0
RB 68,15,4096
RT 72,17,16384
RT 74,17,18432
RT 76,18,16384
RT 78,18,18432
s_waitcnt lgkmcnt(12)
MM 0,40,32
RB 80,16,0
RB 84,16,4096
RT 88,17,24576
MM 16,44,32
RT 90,17,26624
RT 92,18,24576
RT 94,18,26624
MM 32,40,36
s_add_u32 m0, s22, 98304
s_add_u32 s24, s19, 4294965504
buffer_load_dwordx4 v8, s[4:7], s24 offen sc1 lds
s_add_u32 m0, s22, 99328
s_add_u32 s24, s19, 14592
buffer_load_dwordx4 v9, s[4:7], s24 offen sc1 lds
s_add_u32 m0, s23, 98304
s_add_u32 s25, s20, 262144
buffer_load_dwordx4 v10, s[8:11], s25 offen lds
MM 48,44,36
s_add_u32 m0, s23, 99328
s_add_u32 s25, s20, 266240
buffer_load_dwordx4 v11, s[8:11], s25 offen lds
s_add_u32 m0, s23, 100352
s_add_u32 s25, s20, 270336
buffer_load_dwordx4 v10, s[8:11], s25 offen lds
s_add_u32 m0, s23, 101376
s_add_u32 s25, s20, 274432
buffer_load_dwordx4 v11, s[8:11], s25 offen lds
s_waitcnt lgkmcnt(0) vmcnt(6)
s_barrier
MM 0,56,48
RB 32,19,0
RB 36,19,4096
MM 16,60,48
RT 40,23,0
RT 42,23,2048
MM 32,56,52
RT 44,24,0
RT 46,24,2048
MM 48,60,52
s_add_u32 m0, s22, 0
s_add_u32 s24, s19, 4294965632
buffer_load_dwordx4 v8, s[4:7], s24 offen sc1 lds
s_waitcnt lgkmcnt(12)
MM 0,72,64
RB 48,20,0
RB 52,20,4096
MM 16,76,64
RT 56,23,8192
RT 58,23,10240
MM 32,72,68
RT 60,24,8192
RT 62,24,10240
MM 48,76,68
s_add_u32 m0, s22, 1024
s_add_u32 s24, s19, 14720
buffer_load_dwordx4 v9, s[4:7], s24 offen sc1 lds
s_add_u32 m0, s23, 0
s_add_u32 s25, s20, 393216
buffer_load_dwordx4 v10, s[8:11], s25 offen lds
s_waitcnt lgkmcnt(12)
MM 0,88,80
RB 64,21,0
RB 68,21,4096
MM 16,92,80
RT 72,23,16384
RT 74,23,18432
MM 32,88,84
RT 76,24,16384
RT 78,24,18432
MM 48,92,84
s_add_u32 m0, s23, 1024
s_add_u32 s25, s20, 397312
buffer_load_dwordx4 v11, s[8:11], s25 offen lds
s_waitcnt lgkmcnt(12)
MM 0,40,32
RB 80,22,0
RB 84,22,4096
MM 16,44,32
RT 88,23,24576
RT 90,23,26624
MM 32,40,36
RT 92,24,24576
RT 94,24,26624
MM 48,44,36
s_add_u32 m0, s23, 2048
s_add_u32 s25, s20, 401408
buffer_load_dwordx4 v10, s[8:11], s25 offen lds
s_add_u32 m0, s23, 3072
s_add_u32 s25, s20, 405504
buffer_load_dwordx4 v11, s[8:11], s25 offen lds
s_waitcnt lgkmcnt(0) vmcnt(6)
s_barrier
MM 0,56,48
RB 32,25,0
RB 36,25,4096
MM 16,60,48
RT 40,29,0
RT 42,29,2048
MM 32,56,52
RT 44,30,0
RT 46,30,2048
MM 48,60,52
s_add_u32 m0, s22, 49152
s_add_u32 s24, s19, 2560
buffer_load_dwordx4 v8, s[4:7], s24 offen sc1 lds
s_waitcnt lgkmcnt(12)
MM 0,72,64
RB 48,26,0
RB 52,26,4096
MM 16,76,64
RT 56,29,8192
RT 58,29,10240
MM 32,72,68
RT 60,30,8192
RT 62,30,10240
MM 48,76,68
s_add_u32 m0, s22, 50176
s_add_u32 s24, s19, 18944
buffer_load_dwordx4 v9, s[4:7], s24 offen sc1 lds
s_add_u32 m0, s23, 49152
s_add_u32 s25, s20, 524288
buffer_load_dwordx4 v10, s[8:11], s25 offen lds
s_waitcnt lgkmcnt(12)
MM 0,88,80
RB 64,27,0
RB 68,27,4096
MM 16,92,80
RT 72,29,16384
RT 74,29,18432
MM 32,88,84
RT 76,30,16384
RT 78,30,18432
MM 48,92,84
s_add_u32 m0, s23, 50176
s_add_u32 s25, s20, 528384
buffer_load_dwordx4 v11, s[8:11], s25 offen lds
s_waitcnt lgkmcnt(12)
MM 0,40,32
RB 80,28,0
RB 84,28,4096
MM 16,44,32
RT 88,29,24576
RT 90,29,26624
MM 32,40,36
RT 92,30,24576
RT 94,30,26624
MM 48,44,36
s_add_u32 m0, s23, 51200
s_add_u32 s25, s20, 532480
buffer_load_dwordx4 v10, s[8:11], s25 offen lds
s_add_u32 m0, s23, 52224
s_add_u32 s25, s20, 536576
buffer_load_dwordx4 v11, s[8:11], s25 offen lds
s_waitcnt lgkmcnt(0) vmcnt(6)
s_barrier
MM 0,56,48
RB 32,13,0
RB 36,13,4096
MM 16,60,48
RT 40,17,0
RT 42,17,2048
MM 32,56,52
RT 44,18,0
RT 46,18,2048
MM 48,60,52
s_add_u32 m0, s22, 98304
s_add_u32 s24, s19, 2688
buffer_load_dwordx4 v8, s[4:7], s24 offen sc1 lds
s_waitcnt lgkmcnt(12)
MM 0,72,64
RB 48,14,0
RB 52,14,4096
MM 16,76,64
RT 56,17,8192
RT 58,17,10240
MM 32,72,68
RT 60,18,8192
RT 62,18,10240
MM 48,76,68
s_add_u32 m0, s22, 99328
s_add_u32 s24, s19, 19072
buffer_load_dwordx4 v9, s[4:7], s24 offen sc1 lds
s_add_u32 m0, s23, 98304
s_add_u32 s25, s20, 655360
buffer_load_dwordx4 v10, s[8:11], s25 offen lds
s_waitcnt lgkmcnt(12)
MM 0,88,80
RB 64,15,0
RB 68,15,4096
MM 16,92,80
RT 72,17,16384
RT 74,17,18432
MM 32,88,84
RT 76,18,16384
RT 78,18,18432
MM 48,92,84
s_add_u32 m0, s23, 99328
s_add_u32 s25, s20, 659456
buffer_load_dwordx4 v11, s[8:11], s25 offen lds
s_waitcnt lgkmcnt(12)
MM 0,40,32
RB 80,16,0
RB 84,16,4096
MM 16,44,32
RT 88,17,24576
RT 90,17,26624
MM 32,40,36
RT 92,18,24576
RT 94,18,26624
MM 48,44,36
s_add_u32 m0, s23, 100352
s_add_u32 s25, s20, 663552
buffer_load_dwordx4 v10, s[8:11], s25 offen lds
s_add_u32 m0, s23, 101376
s_add_u32 s25, s20, 667648
buffer_load_dwordx4 v11, s[8:11], s25 offen lds
s_waitcnt lgkmcnt(0) vmcnt(6)
s_barrier
MM 0,56,48
RB 32,19,0
RB 36,19,4096
MM 16,60,48
RT 40,23,0
RT 42,23,2048
MM 32,56,52
RT 44,24,0
RT 46,24,2048
MM 48,60,52
s_add_u32 m0, s22, 0
s_add_u32 s24, s19, 2816
buffer_load_dwordx4 v8, s[4:7], s24 offen sc1 lds
s_waitcnt lgkmcnt(12)
MM 0,72,64
RB 48,20,0
RB 52,20,4096
MM 16,76,64
RT 56,23,8192
RT 58,23,10240
MM 32,72,68
RT 60,24,8192
RT 62,24,10240
MM 48,76,68
s_add_u32 m0, s22, 1024
s_add_u32 s24, s19, 19200
buffer_load_dwordx4 v9, s[4:7], s24 offen sc1 lds
s_add_u32 m0, s23, 0
s_add_u32 s25, s20, 786432
buffer_load_dwordx4 v10, s[8:11], s25 offen lds
s_waitcnt lgkmcnt(12)
MM 0,88,80
RB 64,21,0
RB 68,21,4096
MM 16,92,80
RT 72,23,16384
RT 74,23,18432
MM 32,88,84
RT 76,24,16384
RT 78,24,18432
MM 48,92,84
s_add_u32 m0, s23, 1024
s_add_u32 s25, s20, 790528
buffer_load_dwordx4 v11, s[8:11], s25 offen lds
s_waitcnt lgkmcnt(12)
MM 0,40,32
RB 80,22,0
RB 84,22,4096
MM 16,44,32
RT 88,23,24576
RT 90,23,26624
MM 32,40,36
RT 92,24,24576
RT 94,24,26624
MM 48,44,36
s_add_u32 m0, s23, 2048
s_add_u32 s25, s20, 794624
buffer_load_dwordx4 v10, s[8:11], s25 offen lds
s_add_u32 m0, s23, 3072
s_add_u32 s25, s20, 798720
buffer_load_dwordx4 v11, s[8:11], s25 offen lds
s_waitcnt lgkmcnt(0) vmcnt(6)
s_barrier
MM 0,56,48
RB 32,25,0
RB 36,25,4096
MM 16,60,48
RT 40,29,0
RT 42,29,2048
MM 32,56,52
RT 44,30,0
RT 46,30,2048
MM 48,60,52
s_add_u32 m0, s22, 49152
s_add_u32 s24, s19, 2944
buffer_load_dwordx4 v8, s[4:7], s24 offen sc1 lds
s_waitcnt lgkmcnt(12)
MM 0,72,64
RB 48,26,0
RB 52,26,4096
MM 16,76,64
RT 56,29,8192
RT 58,29,10240
MM 32,72,68
RT 60,30,8192
RT 62,30,10240
MM 48,76,68
s_add_u32 m0, s22, 50176
s_add_u32 s24, s19, 19328
buffer_load_dwordx4 v9, s[4:7], s24 offen sc1 lds
s_add_u32 m0, s23, 49152
s_add_u32 s25, s20, 917504
buffer_load_dwordx4 v10, s[8:11], s25 offen lds
s_waitcnt lgkmcnt(12)
MM 0,88,80
RB 64,27,0
RB 68,27,4096
MM 16,92,80
RT 72,29,16384
RT 74,29,18432
MM 32,88,84
RT 76,30,16384
RT 78,30,18432
MM 48,92,84
s_add_u32 m0, s23, 50176
s_add_u32 s25, s20, 921600
buffer_load_dwordx4 v11, s[8:11], s25 offen lds
s_waitcnt lgkmcnt(12)
MM 0,40,32
RB 80,28,0
RB 84,28,4096
MM 16,44,32
RT 88,29,24576
RT 90,29,26624
MM 32,40,36
RT 92,30,24576
RT 94,30,26624
MM 48,44,36
s_add_u32 m0, s23, 51200
s_add_u32 s25, s20, 925696
buffer_load_dwordx4 v10, s[8:11], s25 offen lds
s_add_u32 m0, s23, 52224
s_add_u32 s25, s20, 929792
buffer_load_dwordx4 v11, s[8:11], s25 offen lds
s_waitcnt lgkmcnt(0) vmcnt(6)
s_barrier
MM 0,56,48
RB 32,13,0
RB 36,13,4096
MM 16,60,48
RT 40,17,0
RT 42,17,2048
MM 32,56,52
RT 44,18,0
RT 46,18,2048
MM 48,60,52
s_add_u32 m0, s22, 98304
s_add_u32 s24, s19, 4294964224
buffer_load_dwordx4 v8, s[4:7], s24 offen sc1 lds
s_waitcnt lgkmcnt(12)
MM 0,72,64
RB 48,14,0
RB 52,14,4096
MM 16,76,64
RT 56,17,8192
RT 58,17,10240
MM 32,72,68
RT 60,18,8192
RT 62,18,10240
MM 48,76,68
s_add_u32 m0, s22, 99328
s_add_u32 s24, s19, 13312
buffer_load_dwordx4 v9, s[4:7], s24 offen sc1 lds
s_add_u32 m0, s23, 98304
s_add_u32 s25, s20, 1048576
buffer_load_dwordx4 v10, s[8:11], s25 offen lds
s_waitcnt lgkmcnt(12)
MM 0,88,80
RB 64,15,0
RB 68,15,4096
MM 16,92,80
RT 72,17,16384
RT 74,17,18432
MM 32,88,84
RT 76,18,16384
RT 78,18,18432
MM 48,92,84
s_add_u32 m0, s23, 99328
s_add_u32 s25, s20, 1052672
buffer_load_dwordx4 v11, s[8:11], s25 offen lds
s_waitcnt lgkmcnt(12)
MM 0,40,32
RB 80,16,0
RB 84,16,4096
MM 16,44,32
RT 88,17,24576
RT 90,17,26624
MM 32,40,36
RT 92,18,24576
RT 94,18,26624
MM 48,44,36
s_add_u32 m0, s23, 100352
s_add_u32 s25, s20, 1056768
buffer_load_dwordx4 v10, s[8:11], s25 offen lds
s_add_u32 m0, s23, 101376
s_add_u32 s25, s20, 1060864
buffer_load_dwordx4 v11, s[8:11], s25 offen lds
s_waitcnt lgkmcnt(0) vmcnt(6)
s_barrier
MM 0,56,48
RB 32,19,0
RB 36,19,4096
MM 16,60,48
RT 40,23,0
RT 42,23,2048
MM 32,56,52
RT 44,24,0
RT 46,24,2048
MM 48,60,52
s_add_u32 m0, s22, 0
s_add_u32 s24, s19, 4294964352
buffer_load_dwordx4 v8, s[4:7], s24 offen sc1 lds
s_waitcnt lgkmcnt(12)
MM 0,72,64
RB 48,20,0
RB 52,20,4096
MM 16,76,64
RT 56,23,8192
RT 58,23,10240
MM 32,72,68
RT 60,24,8192
RT 62,24,10240
MM 48,76,68
s_add_u32 m0, s22, 1024
s_add_u32 s24, s19, 13440
buffer_load_dwordx4 v9, s[4:7], s24 offen sc1 lds
s_add_u32 m0, s23, 0
s_add_u32 s25, s20, 1179648
buffer_load_dwordx4 v10, s[8:11], s25 offen lds
s_waitcnt lgkmcnt(12)
MM 0,88,80
RB 64,21,0
RB 68,21,4096
MM 16,92,80
RT 72,23,16384
RT 74,23,18432
MM 32,88,84
RT 76,24,16384
RT 78,24,18432
MM 48,92,84
s_add_u32 m0, s23, 1024
s_add_u32 s25, s20, 1183744
buffer_load_dwordx4 v11, s[8:11], s25 offen lds
s_waitcnt lgkmcnt(12)
MM 0,40,32
RB 80,22,0
RB 84,22,4096
MM 16,44,32
RT 88,23,24576
RT 90,23,26624
MM 32,40,36
RT 92,24,24576
RT 94,24,26624
MM 48,44,36
s_add_u32 m0, s23, 2048
s_add_u32 s25, s20, 1187840
buffer_load_dwordx4 v10, s[8:11], s25 offen lds
s_add_u32 m0, s23, 3072
s_add_u32 s25, s20, 1191936
buffer_load_dwordx4 v11, s[8:11], s25 offen lds
s_waitcnt lgkmcnt(0) vmcnt(6)
s_barrier
MM 0,56,48
RB 32,25,0
RB 36,25,4096
MM 16,60,48
RT 40,29,0
RT 42,29,2048
MM 32,56,52
RT 44,30,0
RT 46,30,2048
MM 48,60,52
s_add_u32 m0, s22, 49152
s_add_u32 s24, s19, 4294964480
buffer_load_dwordx4 v8, s[4:7], s24 offen sc1 lds
s_waitcnt lgkmcnt(12)
MM 0,72,64
RB 48,26,0
RB 52,26,4096
MM 16,76,64
RT 56,29,8192
RT 58,29,10240
MM 32,72,68
RT 60,30,8192
RT 62,30,10240
MM 48,76,68
s_add_u32 m0, s22, 50176
s_add_u32 s24, s19, 13568
buffer_load_dwordx4 v9, s[4:7], s24 offen sc1 lds
s_add_u32 m0, s23, 49152
s_add_u32 s25, s20, 1310720
buffer_load_dwordx4 v10, s[8:11], s25 offen lds
s_waitcnt lgkmcnt(12)
MM 0,88,80
RB 64,27,0
RB 68,27,4096
MM 16,92,80
RT 72,29,16384
RT 74,29,18432
MM 32,88,84
RT 76,30,16384
RT 78,30,18432
MM 48,92,84
s_add_u32 m0, s23, 50176
s_add_u32 s25, s20, 1314816
buffer_load_dwordx4 v11, s[8:11], s25 offen lds
s_waitcnt lgkmcnt(12)
MM 0,40,32
RB 80,28,0
RB 84,28,4096
MM 16,44,32
RT 88,29,24576
RT 90,29,26624
MM 32,40,36
RT 92,30,24576
RT 94,30,26624
MM 48,44,36
s_add_u32 m0, s23, 51200
s_add_u32 s25, s20, 1318912
buffer_load_dwordx4 v10, s[8:11], s25 offen lds
s_add_u32 m0, s23, 52224
s_add_u32 s25, s20, 1323008
buffer_load_dwordx4 v11, s[8:11], s25 offen lds
s_waitcnt lgkmcnt(0) vmcnt(6)
s_barrier
MM 0,56,48
RB 32,13,0
RB 36,13,4096
MM 16,60,48
RT 40,17,0
RT 42,17,2048
MM 32,56,52
RT 44,18,0
RT 46,18,2048
MM 48,60,52
s_add_u32 m0, s22, 98304
s_add_u32 s24, s19, 4294964608
buffer_load_dwordx4 v8, s[4:7], s24 offen sc1 lds
s_waitcnt lgkmcnt(12)
MM 0,72,64
RB 48,14,0
RB 52,14,4096
MM 16,76,64
RT 56,17,8192
RT 58,17,10240
MM 32,72,68
RT 60,18,8192
RT 62,18,10240
MM 48,76,68
s_add_u32 m0, s22, 99328
s_add_u32 s24, s19, 13696
buffer_load_dwordx4 v9, s[4:7], s24 offen sc1 lds
s_add_u32 m0, s23, 98304
s_add_u32 s25, s20, 1441792
buffer_load_dwordx4 v10, s[8:11], s25 offen lds
s_waitcnt lgkmcnt(12)
MM 0,88,80
RB 64,15,0
RB 68,15,4096
MM 16,92,80
RT 72,17,16384
RT 74,17,18432
MM 32,88,84
RT 76,18,16384
RT 78,18,18432
MM 48,92,84
s_add_u32 m0, s23, 99328
s_add_u32 s25, s20, 1445888
buffer_load_dwordx4 v11, s[8:11], s25 offen lds
s_waitcnt lgkmcnt(12)
MM 0,40,32
RB 80,16,0
RB 84,16,4096
MM 16,44,32
RT 88,17,24576
RT 90,17,26624
MM 32,40,36
RT 92,18,24576
RT 94,18,26624
MM 48,44,36
s_add_u32 m0, s23, 100352
s_add_u32 s25, s20, 1449984
buffer_load_dwordx4 v10, s[8:11], s25 offen lds
s_add_u32 m0, s23, 101376
s_add_u32 s25, s20, 1454080
buffer_load_dwordx4 v11, s[8:11], s25 offen lds
s_waitcnt lgkmcnt(0) vmcnt(6)
s_barrier
MM 0,56,48
RB 32,19,0
RB 36,19,4096
MM 16,60,48
RT 40,23,0
RT 42,23,2048
MM 32,56,52
RT 44,24,0
RT 46,24,2048
MM 48,60,52
s_add_u32 m0, s22, 0
s_add_u32 s24, s19, 5632
buffer_load_dwordx4 v8, s[4:7], s24 offen sc1 lds
s_waitcnt lgkmcnt(12)
MM 0,72,64
RB 48,20,0
RB 52,20,4096
MM 16,76,64
RT 56,23,8192
RT 58,23,10240
MM 32,72,68
RT 60,24,8192
RT 62,24,10240
MM 48,76,68
s_add_u32 m0, s22, 1024
s_add_u32 s24, s19, 22016
buffer_load_dwordx4 v9, s[4:7], s24 offen sc1 lds
s_add_u32 m0, s23, 0
s_add_u32 s25, s20, 1572864
buffer_load_dwordx4 v10, s[8:11], s25 offen lds
s_waitcnt lgkmcnt(12)
MM 0,88,80
RB 64,21,0
RB 68,21,4096
MM 16,92,80
RT 72,23,16384
RT 74,23,18432
MM 32,88,84
RT 76,24,16384
RT 78,24,18432
MM 48,92,84
s_add_u32 m0, s23, 1024
s_add_u32 s25, s20, 1576960
buffer_load_dwordx4 v11, s[8:11], s25 offen lds
s_waitcnt lgkmcnt(12)
MM 0,40,32
RB 80,22,0
RB 84,22,4096
MM 16,44,32
RT 88,23,24576
RT 90,23,26624
MM 32,40,36
RT 92,24,24576
RT 94,24,26624
MM 48,44,36
s_add_u32 m0, s23, 2048
s_add_u32 s25, s20, 1581056
buffer_load_dwordx4 v10, s[8:11], s25 offen lds
s_add_u32 m0, s23, 3072
s_add_u32 s25, s20, 1585152
buffer_load_dwordx4 v11, s[8:11], s25 offen lds
s_waitcnt lgkmcnt(0) vmcnt(6)
s_barrier
MM 0,56,48
RB 32,25,0
RB 36,25,4096
MM 16,60,48
RT 40,29,0
RT 42,29,2048
MM 32,56,52
RT 44,30,0
RT 46,30,2048
MM 48,60,52
s_add_u32 m0, s22, 49152
s_add_u32 s24, s19, 5760
buffer_load_dwordx4 v8, s[4:7], s24 offen sc1 lds
s_waitcnt lgkmcnt(12)
MM 0,72,64
RB 48,26,0
RB 52,26,4096
MM 16,76,64
RT 56,29,8192
RT 58,29,10240
MM 32,72,68
RT 60,30,8192
RT 62,30,10240
MM 48,76,68
s_add_u32 m0, s22, 50176
s_add_u32 s24, s19, 22144
buffer_load_dwordx4 v9, s[4:7], s24 offen sc1 lds
s_add_u32 m0, s23, 49152
s_add_u32 s25, s20, 1703936
buffer_load_dwordx4 v10, s[8:11], s25 offen lds
s_waitcnt lgkmcnt(12)
MM 0,88,80
RB 64,27,0
RB 68,27,4096
MM 16,92,80
RT 72,29,16384
RT 74,29,18432
MM 32,88,84
RT 76,30,16384
RT 78,30,18432
MM 48,92,84
s_add_u32 m0, s23, 50176
s_add_u32 s25, s20, 1708032
buffer_load_dwordx4 v11, s[8:11], s25 offen lds
s_waitcnt lgkmcnt(12)
MM 0,40,32
RB 80,28,0
RB 84,28,4096
MM 16,44,32
RT 88,29,24576
RT 90,29,26624
MM 32,40,36
RT 92,30,24576
RT 94,30,26624
MM 48,44,36
s_add_u32 m0, s23, 51200
s_add_u32 s25, s20, 1712128
buffer_load_dwordx4 v10, s[8:11], s25 offen lds
s_add_u32 m0, s23, 52224
s_add_u32 s25, s20, 1716224
buffer_load_dwordx4 v11, s[8:11], s25 offen lds
s_waitcnt lgkmcnt(0) vmcnt(6)
s_barrier
MM 0,56,48
RB 32,13,0
RB 36,13,4096
MM 16,60,48
RT 40,17,0
RT 42,17,2048
MM 32,56,52
RT 44,18,0
RT 46,18,2048
MM 48,60,52
s_add_u32 m0, s22, 98304
s_add_u32 s24, s19, 5888
buffer_load_dwordx4 v8, s[4:7], s24 offen sc1 lds
s_waitcnt lgkmcnt(12)
MM 0,72,64
RB 48,14,0
RB 52,14,4096
MM 16,76,64
RT 56,17,8192
RT 58,17,10240
MM 32,72,68
RT 60,18,8192
RT 62,18,10240
MM 48,76,68
s_add_u32 m0, s22, 99328
s_add_u32 s24, s19, 22272
buffer_load_dwordx4 v9, s[4:7], s24 offen sc1 lds
s_add_u32 m0, s23, 98304
s_add_u32 s25, s20, 1835008
buffer_load_dwordx4 v10, s[8:11], s25 offen lds
s_waitcnt lgkmcnt(12)
MM 0,88,80
RB 64,15,0
RB 68,15,4096
MM 16,92,80
RT 72,17,16384
RT 74,17,18432
MM 32,88,84
RT 76,18,16384
RT 78,18,18432
MM 48,92,84
s_add_u32 m0, s23, 99328
s_add_u32 s25, s20, 1839104
buffer_load_dwordx4 v11, s[8:11], s25 offen lds
s_waitcnt lgkmcnt(12)
MM 0,40,32
RB 80,16,0
RB 84,16,4096
MM 16,44,32
RT 88,17,24576
RT 90,17,26624
MM 32,40,36
RT 92,18,24576
RT 94,18,26624
MM 48,44,36
s_add_u32 m0, s23, 100352
s_add_u32 s25, s20, 1843200
buffer_load_dwordx4 v10, s[8:11], s25 offen lds
s_add_u32 m0, s23, 101376
s_add_u32 s25, s20, 1847296
buffer_load_dwordx4 v11, s[8:11], s25 offen lds
s_waitcnt lgkmcnt(0) vmcnt(6)
s_barrier
MM 0,56,48
RB 32,19,0
RB 36,19,4096
MM 16,60,48
RT 40,23,0
RT 42,23,2048
MM 32,56,52
RT 44,24,0
RT 46,24,2048
MM 48,60,52
s_add_u32 m0, s22, 0
s_add_u32 s24, s19, 6016
buffer_load_dwordx4 v8, s[4:7], s24 offen sc1 lds
s_waitcnt lgkmcnt(12)
MM 0,72,64
RB 48,20,0
RB 52,20,4096
MM 16,76,64
RT 56,23,8192
RT 58,23,10240
MM 32,72,68
RT 60,24,8192
RT 62,24,10240
MM 48,76,68
s_add_u32 m0, s22, 1024
s_add_u32 s24, s19, 22400
buffer_load_dwordx4 v9, s[4:7], s24 offen sc1 lds
s_add_u32 m0, s23, 0
s_add_u32 s25, s20, 1966080
buffer_load_dwordx4 v10, s[8:11], s25 offen lds
s_waitcnt lgkmcnt(12)
MM 0,88,80
RB 64,21,0
RB 68,21,4096
MM 16,92,80
RT 72,23,16384
RT 74,23,18432
MM 32,88,84
RT 76,24,16384
RT 78,24,18432
MM 48,92,84
s_add_u32 m0, s23, 1024
s_add_u32 s25, s20, 1970176
buffer_load_dwordx4 v11, s[8:11], s25 offen lds
s_waitcnt lgkmcnt(12)
MM 0,40,32
RB 80,22,0
RB 84,22,4096
MM 16,44,32
RT 88,23,24576
RT 90,23,26624
MM 32,40,36
RT 92,24,24576
RT 94,24,26624
MM 48,44,36
s_add_u32 m0, s23, 2048
s_add_u32 s25, s20, 1974272
buffer_load_dwordx4 v10, s[8:11], s25 offen lds
s_add_u32 m0, s23, 3072
s_add_u32 s25, s20, 1978368
buffer_load_dwordx4 v11, s[8:11], s25 offen lds
s_waitcnt lgkmcnt(0) vmcnt(6)
s_barrier
MM 0,56,48
RB 32,25,0
RB 36,25,4096
MM 16,60,48
RT 40,29,0
MM 32,56,52
RT 42,29,2048
RT 44,30,0
MM 48,60,52
RT 46,30,2048
s_waitcnt lgkmcnt(12)
MM 0,72,64
RB 48,26,0
RB 52,26,4096
MM 16,76,64
RT 56,29,8192
MM 32,72,68
RT 58,29,10240
RT 60,30,8192
MM 48,76,68
RT 62,30,10240
s_waitcnt lgkmcnt(12)
MM 0,88,80
RB 64,27,0
RB 68,27,4096
MM 16,92,80
RT 72,29,16384
MM 32,88,84
RT 74,29,18432
RT 76,30,16384
MM 48,92,84
RT 78,30,18432
s_waitcnt lgkmcnt(12)
MM 0,40,32
RB 80,28,0
RB 84,28,4096
MM 16,44,32
RT 88,29,24576
MM 32,40,36
RT 90,29,26624
RT 92,30,24576
MM 48,44,36
RT 94,30,26624
s_waitcnt lgkmcnt(0) vmcnt(0)
s_barrier
MM 0,56,48
RB 32,13,0
RB 36,13,4096
MM 16,60,48
RT 40,17,0
MM 32,56,52
RT 42,17,2048
RT 44,18,0
MM 48,60,52
RT 46,18,2048
s_waitcnt lgkmcnt(12)
MM 0,72,64
RB 48,14,0
RB 52,14,4096
MM 16,76,64
RT 56,17,8192
MM 32,72,68
RT 58,17,10240
RT 60,18,8192
MM 48,76,68
RT 62,18,10240
s_waitcnt lgkmcnt(12)
MM 0,88,80
RB 64,15,0
RB 68,15,4096
MM 16,92,80
RT 72,17,16384
MM 32,88,84
RT 74,17,18432
RT 76,18,16384
MM 48,92,84
RT 78,18,18432
s_waitcnt lgkmcnt(12)
MM 0,40,32
RB 80,16,0
RB 84,16,4096
MM 16,44,32
RT 88,17,24576
MM 32,40,36
RT 90,17,26624
RT 92,18,24576
MM 48,44,36
RT 94,18,26624
s_waitcnt lgkmcnt(0)
MM 0,56,48
MM 16,60,48
MM 32,56,52
MM 48,60,52
s_waitcnt lgkmcnt(0)
MM 0,72,64
MM 16,76,64
MM 32,72,68
MM 48,76,68
s_waitcnt lgkmcnt(0)
MM 0,88,80
MM 16,92,80
MM 32,88,84
MM 48,92,84
s_barrier
s_cmp_lg_u32 s16, 0
s_cbranch_scc1 tt_146
v_mov_b32 v7, s56
v_accvgpr_write_b32 a127, 1
s_mov_b64 exec, 1
buffer_atomic_add a127, v7, s[4:7], 0 offen sc0
s_mov_b64 exec, -1
tt_146:
v_and_b32 v1, 31, v0
v_lshrrev_b32 v2, 5, v0
s_mul_i32 s24, s17, 33792
s_mul_i32 s25, s18, 128
s_add_u32 s24, s24, s25
v_mul_u32_u24 v3, 528, v1
v_lshl_add_u32 v3, v2, 4, v3
v_add_u32 v3, s24, v3
v_lshrrev_b32 v4, 5, v0
v_and_b32 v5, 31, v0
s_mul_i32 s24, s16, 16
v_add_u32 v4, s24, v4
v_mul_u32_u24 v6, 528, v4
v_lshl_add_u32 v6, v5, 4, v6
s_mov_b32 s24, 2048
v_mul_lo_u32 v12, v4, s24
v_lshl_add_u32 v12, v5, 4, v12
s_add_u32 s24, s34, 0
buffer_load_dwordx4 v[72:75], v12, s[4:7], s24 offen sc1
s_add_u32 s24, s34, 4096
buffer_load_dwordx4 v[76:79], v12, s[4:7], s24 offen sc1
s_add_u32 s24, s34, 8192
buffer_load_dwordx4 v[80:83], v12, s[4:7], s24 offen sc1
s_add_u32 s24, s34, 12288
buffer_load_dwordx4 v[84:87], v12, s[4:7], s24 offen sc1
s_add_u32 s24, s34, 16384
buffer_load_dwordx4 v[88:91], v12, s[4:7], s24 offen sc1
s_add_u32 s24, s34, 20480
buffer_load_dwordx4 v[92:95], v12, s[4:7], s24 offen sc1
s_add_u32 s24, s34, 24576
buffer_load_dwordx4 v[96:99], v12, s[4:7], s24 offen sc1
s_add_u32 s24, s34, 28672
buffer_load_dwordx4 v[100:103], v12, s[4:7], s24 offen sc1
v_accvgpr_read_b32 v32, a0
v_accvgpr_read_b32 v33, a1
v_accvgpr_read_b32 v34, a2
v_accvgpr_read_b32 v35, a3
v_accvgpr_read_b32 v36, a4
v_accvgpr_read_b32 v37, a5
v_accvgpr_read_b32 v38, a6
v_accvgpr_read_b32 v39, a7
v_accvgpr_read_b32 v40, a8
v_accvgpr_read_b32 v41, a9
v_accvgpr_read_b32 v42, a10
v_accvgpr_read_b32 v43, a11
v_accvgpr_read_b32 v44, a12
v_accvgpr_read_b32 v45, a13
v_accvgpr_read_b32 v46, a14
v_accvgpr_read_b32 v47, a15
v_cvt_pk_bf16_f32 v48, v32, v33
v_cvt_pk_bf16_f32 v49, v34, v35
v_cvt_pk_bf16_f32 v50, v36, v37
v_cvt_pk_bf16_f32 v51, v38, v39
v_cvt_pk_bf16_f32 v52, v40, v41
v_cvt_pk_bf16_f32 v53, v42, v43
v_cvt_pk_bf16_f32 v54, v44, v45
v_cvt_pk_bf16_f32 v55, v46, v47
v_permlane32_swap_b32 v48, v50
v_permlane32_swap_b32 v49, v51
v_permlane32_swap_b32 v52, v54
v_permlane32_swap_b32 v53, v55
ds_write_b128 v3, v[48:51] offset:0
ds_write_b128 v3, v[52:55] offset:32
v_accvgpr_read_b32 v32, a16
v_accvgpr_read_b32 v33, a17
v_accvgpr_read_b32 v34, a18
v_accvgpr_read_b32 v35, a19
v_accvgpr_read_b32 v36, a20
v_accvgpr_read_b32 v37, a21
v_accvgpr_read_b32 v38, a22
v_accvgpr_read_b32 v39, a23
v_accvgpr_read_b32 v40, a24
v_accvgpr_read_b32 v41, a25
v_accvgpr_read_b32 v42, a26
v_accvgpr_read_b32 v43, a27
v_accvgpr_read_b32 v44, a28
v_accvgpr_read_b32 v45, a29
v_accvgpr_read_b32 v46, a30
v_accvgpr_read_b32 v47, a31
v_cvt_pk_bf16_f32 v56, v32, v33
v_cvt_pk_bf16_f32 v57, v34, v35
v_cvt_pk_bf16_f32 v58, v36, v37
v_cvt_pk_bf16_f32 v59, v38, v39
v_cvt_pk_bf16_f32 v60, v40, v41
v_cvt_pk_bf16_f32 v61, v42, v43
v_cvt_pk_bf16_f32 v62, v44, v45
v_cvt_pk_bf16_f32 v63, v46, v47
v_permlane32_swap_b32 v56, v58
v_permlane32_swap_b32 v57, v59
v_permlane32_swap_b32 v60, v62
v_permlane32_swap_b32 v61, v63
ds_write_b128 v3, v[56:59] offset:64
ds_write_b128 v3, v[60:63] offset:96
v_accvgpr_read_b32 v32, a32
v_accvgpr_read_b32 v33, a33
v_accvgpr_read_b32 v34, a34
v_accvgpr_read_b32 v35, a35
v_accvgpr_read_b32 v36, a36
v_accvgpr_read_b32 v37, a37
v_accvgpr_read_b32 v38, a38
v_accvgpr_read_b32 v39, a39
v_accvgpr_read_b32 v40, a40
v_accvgpr_read_b32 v41, a41
v_accvgpr_read_b32 v42, a42
v_accvgpr_read_b32 v43, a43
v_accvgpr_read_b32 v44, a44
v_accvgpr_read_b32 v45, a45
v_accvgpr_read_b32 v46, a46
v_accvgpr_read_b32 v47, a47
v_cvt_pk_bf16_f32 v48, v32, v33
v_cvt_pk_bf16_f32 v49, v34, v35
v_cvt_pk_bf16_f32 v50, v36, v37
v_cvt_pk_bf16_f32 v51, v38, v39
v_cvt_pk_bf16_f32 v52, v40, v41
v_cvt_pk_bf16_f32 v53, v42, v43
v_cvt_pk_bf16_f32 v54, v44, v45
v_cvt_pk_bf16_f32 v55, v46, v47
v_permlane32_swap_b32 v48, v50
v_permlane32_swap_b32 v49, v51
v_permlane32_swap_b32 v52, v54
v_permlane32_swap_b32 v53, v55
ds_write_b128 v3, v[48:51] offset:16896
ds_write_b128 v3, v[52:55] offset:16928
v_accvgpr_read_b32 v32, a48
v_accvgpr_read_b32 v33, a49
v_accvgpr_read_b32 v34, a50
v_accvgpr_read_b32 v35, a51
v_accvgpr_read_b32 v36, a52
v_accvgpr_read_b32 v37, a53
v_accvgpr_read_b32 v38, a54
v_accvgpr_read_b32 v39, a55
v_accvgpr_read_b32 v40, a56
v_accvgpr_read_b32 v41, a57
v_accvgpr_read_b32 v42, a58
v_accvgpr_read_b32 v43, a59
v_accvgpr_read_b32 v44, a60
v_accvgpr_read_b32 v45, a61
v_accvgpr_read_b32 v46, a62
v_accvgpr_read_b32 v47, a63
v_cvt_pk_bf16_f32 v56, v32, v33
v_cvt_pk_bf16_f32 v57, v34, v35
v_cvt_pk_bf16_f32 v58, v36, v37
v_cvt_pk_bf16_f32 v59, v38, v39
v_cvt_pk_bf16_f32 v60, v40, v41
v_cvt_pk_bf16_f32 v61, v42, v43
v_cvt_pk_bf16_f32 v62, v44, v45
v_cvt_pk_bf16_f32 v63, v46, v47
v_permlane32_swap_b32 v56, v58
v_permlane32_swap_b32 v57, v59
v_permlane32_swap_b32 v60, v62
v_permlane32_swap_b32 v61, v63
ds_write_b128 v3, v[56:59] offset:16960
ds_write_b128 v3, v[60:63] offset:16992
s_waitcnt lgkmcnt(0)
s_barrier
RB 32,6,0
RB 36,6,1056
RB 40,6,2112
RB 44,6,3168
RB 48,6,4224
RB 52,6,5280
RB 56,6,6336
RB 60,6,7392
s_waitcnt vmcnt(0)
s_waitcnt lgkmcnt(7)
v_lshlrev_b32 v68, 16, v32
v_and_b32 v69, 0xffff0000, v32
v_lshlrev_b32 v70, 16, v72
v_and_b32 v71, 0xffff0000, v72
v_add_f32 v68, v68, v70
v_add_f32 v69, v69, v71
v_cvt_pk_bf16_f32 v32, v68, v69
v_lshlrev_b32 v68, 16, v33
v_and_b32 v69, 0xffff0000, v33
v_lshlrev_b32 v70, 16, v73
v_and_b32 v71, 0xffff0000, v73
v_add_f32 v68, v68, v70
v_add_f32 v69, v69, v71
v_cvt_pk_bf16_f32 v33, v68, v69
v_lshlrev_b32 v68, 16, v34
v_and_b32 v69, 0xffff0000, v34
v_lshlrev_b32 v70, 16, v74
v_and_b32 v71, 0xffff0000, v74
v_add_f32 v68, v68, v70
v_add_f32 v69, v69, v71
v_cvt_pk_bf16_f32 v34, v68, v69
v_lshlrev_b32 v68, 16, v35
v_and_b32 v69, 0xffff0000, v35
v_lshlrev_b32 v70, 16, v75
v_and_b32 v71, 0xffff0000, v75
v_add_f32 v68, v68, v70
v_add_f32 v69, v69, v71
v_cvt_pk_bf16_f32 v35, v68, v69
s_add_u32 s24, s33, 0
buffer_store_dwordx4 v[32:35], v12, s[4:7], s24 offen sc1
s_waitcnt lgkmcnt(6)
v_lshlrev_b32 v68, 16, v36
v_and_b32 v69, 0xffff0000, v36
v_lshlrev_b32 v70, 16, v76
v_and_b32 v71, 0xffff0000, v76
v_add_f32 v68, v68, v70
v_add_f32 v69, v69, v71
v_cvt_pk_bf16_f32 v36, v68, v69
v_lshlrev_b32 v68, 16, v37
v_and_b32 v69, 0xffff0000, v37
v_lshlrev_b32 v70, 16, v77
v_and_b32 v71, 0xffff0000, v77
v_add_f32 v68, v68, v70
v_add_f32 v69, v69, v71
v_cvt_pk_bf16_f32 v37, v68, v69
v_lshlrev_b32 v68, 16, v38
v_and_b32 v69, 0xffff0000, v38
v_lshlrev_b32 v70, 16, v78
v_and_b32 v71, 0xffff0000, v78
v_add_f32 v68, v68, v70
v_add_f32 v69, v69, v71
v_cvt_pk_bf16_f32 v38, v68, v69
v_lshlrev_b32 v68, 16, v39
v_and_b32 v69, 0xffff0000, v39
v_lshlrev_b32 v70, 16, v79
v_and_b32 v71, 0xffff0000, v79
v_add_f32 v68, v68, v70
v_add_f32 v69, v69, v71
v_cvt_pk_bf16_f32 v39, v68, v69
s_add_u32 s24, s33, 4096
buffer_store_dwordx4 v[36:39], v12, s[4:7], s24 offen sc1
s_waitcnt lgkmcnt(5)
v_lshlrev_b32 v68, 16, v40
v_and_b32 v69, 0xffff0000, v40
v_lshlrev_b32 v70, 16, v80
v_and_b32 v71, 0xffff0000, v80
v_add_f32 v68, v68, v70
v_add_f32 v69, v69, v71
v_cvt_pk_bf16_f32 v40, v68, v69
v_lshlrev_b32 v68, 16, v41
v_and_b32 v69, 0xffff0000, v41
v_lshlrev_b32 v70, 16, v81
v_and_b32 v71, 0xffff0000, v81
v_add_f32 v68, v68, v70
v_add_f32 v69, v69, v71
v_cvt_pk_bf16_f32 v41, v68, v69
v_lshlrev_b32 v68, 16, v42
v_and_b32 v69, 0xffff0000, v42
v_lshlrev_b32 v70, 16, v82
v_and_b32 v71, 0xffff0000, v82
v_add_f32 v68, v68, v70
v_add_f32 v69, v69, v71
v_cvt_pk_bf16_f32 v42, v68, v69
v_lshlrev_b32 v68, 16, v43
v_and_b32 v69, 0xffff0000, v43
v_lshlrev_b32 v70, 16, v83
v_and_b32 v71, 0xffff0000, v83
v_add_f32 v68, v68, v70
v_add_f32 v69, v69, v71
v_cvt_pk_bf16_f32 v43, v68, v69
s_add_u32 s24, s33, 8192
buffer_store_dwordx4 v[40:43], v12, s[4:7], s24 offen sc1
s_waitcnt lgkmcnt(4)
v_lshlrev_b32 v68, 16, v44
v_and_b32 v69, 0xffff0000, v44
v_lshlrev_b32 v70, 16, v84
v_and_b32 v71, 0xffff0000, v84
v_add_f32 v68, v68, v70
v_add_f32 v69, v69, v71
v_cvt_pk_bf16_f32 v44, v68, v69
v_lshlrev_b32 v68, 16, v45
v_and_b32 v69, 0xffff0000, v45
v_lshlrev_b32 v70, 16, v85
v_and_b32 v71, 0xffff0000, v85
v_add_f32 v68, v68, v70
v_add_f32 v69, v69, v71
v_cvt_pk_bf16_f32 v45, v68, v69
v_lshlrev_b32 v68, 16, v46
v_and_b32 v69, 0xffff0000, v46
v_lshlrev_b32 v70, 16, v86
v_and_b32 v71, 0xffff0000, v86
v_add_f32 v68, v68, v70
v_add_f32 v69, v69, v71
v_cvt_pk_bf16_f32 v46, v68, v69
v_lshlrev_b32 v68, 16, v47
v_and_b32 v69, 0xffff0000, v47
v_lshlrev_b32 v70, 16, v87
v_and_b32 v71, 0xffff0000, v87
v_add_f32 v68, v68, v70
v_add_f32 v69, v69, v71
v_cvt_pk_bf16_f32 v47, v68, v69
s_add_u32 s24, s33, 12288
buffer_store_dwordx4 v[44:47], v12, s[4:7], s24 offen sc1
s_waitcnt lgkmcnt(3)
v_lshlrev_b32 v68, 16, v48
v_and_b32 v69, 0xffff0000, v48
v_lshlrev_b32 v70, 16, v88
v_and_b32 v71, 0xffff0000, v88
v_add_f32 v68, v68, v70
v_add_f32 v69, v69, v71
v_cvt_pk_bf16_f32 v48, v68, v69
v_lshlrev_b32 v68, 16, v49
v_and_b32 v69, 0xffff0000, v49
v_lshlrev_b32 v70, 16, v89
v_and_b32 v71, 0xffff0000, v89
v_add_f32 v68, v68, v70
v_add_f32 v69, v69, v71
v_cvt_pk_bf16_f32 v49, v68, v69
v_lshlrev_b32 v68, 16, v50
v_and_b32 v69, 0xffff0000, v50
v_lshlrev_b32 v70, 16, v90
v_and_b32 v71, 0xffff0000, v90
v_add_f32 v68, v68, v70
v_add_f32 v69, v69, v71
v_cvt_pk_bf16_f32 v50, v68, v69
v_lshlrev_b32 v68, 16, v51
v_and_b32 v69, 0xffff0000, v51
v_lshlrev_b32 v70, 16, v91
v_and_b32 v71, 0xffff0000, v91
v_add_f32 v68, v68, v70
v_add_f32 v69, v69, v71
v_cvt_pk_bf16_f32 v51, v68, v69
s_add_u32 s24, s33, 16384
buffer_store_dwordx4 v[48:51], v12, s[4:7], s24 offen sc1
s_waitcnt lgkmcnt(2)
v_lshlrev_b32 v68, 16, v52
v_and_b32 v69, 0xffff0000, v52
v_lshlrev_b32 v70, 16, v92
v_and_b32 v71, 0xffff0000, v92
v_add_f32 v68, v68, v70
v_add_f32 v69, v69, v71
v_cvt_pk_bf16_f32 v52, v68, v69
v_lshlrev_b32 v68, 16, v53
v_and_b32 v69, 0xffff0000, v53
v_lshlrev_b32 v70, 16, v93
v_and_b32 v71, 0xffff0000, v93
v_add_f32 v68, v68, v70
v_add_f32 v69, v69, v71
v_cvt_pk_bf16_f32 v53, v68, v69
v_lshlrev_b32 v68, 16, v54
v_and_b32 v69, 0xffff0000, v54
v_lshlrev_b32 v70, 16, v94
v_and_b32 v71, 0xffff0000, v94
v_add_f32 v68, v68, v70
v_add_f32 v69, v69, v71
v_cvt_pk_bf16_f32 v54, v68, v69
v_lshlrev_b32 v68, 16, v55
v_and_b32 v69, 0xffff0000, v55
v_lshlrev_b32 v70, 16, v95
v_and_b32 v71, 0xffff0000, v95
v_add_f32 v68, v68, v70
v_add_f32 v69, v69, v71
v_cvt_pk_bf16_f32 v55, v68, v69
s_add_u32 s24, s33, 20480
buffer_store_dwordx4 v[52:55], v12, s[4:7], s24 offen sc1
s_waitcnt lgkmcnt(1)
v_lshlrev_b32 v68, 16, v56
v_and_b32 v69, 0xffff0000, v56
v_lshlrev_b32 v70, 16, v96
v_and_b32 v71, 0xffff0000, v96
v_add_f32 v68, v68, v70
v_add_f32 v69, v69, v71
v_cvt_pk_bf16_f32 v56, v68, v69
v_lshlrev_b32 v68, 16, v57
v_and_b32 v69, 0xffff0000, v57
v_lshlrev_b32 v70, 16, v97
v_and_b32 v71, 0xffff0000, v97
v_add_f32 v68, v68, v70
v_add_f32 v69, v69, v71
v_cvt_pk_bf16_f32 v57, v68, v69
v_lshlrev_b32 v68, 16, v58
v_and_b32 v69, 0xffff0000, v58
v_lshlrev_b32 v70, 16, v98
v_and_b32 v71, 0xffff0000, v98
v_add_f32 v68, v68, v70
v_add_f32 v69, v69, v71
v_cvt_pk_bf16_f32 v58, v68, v69
v_lshlrev_b32 v68, 16, v59
v_and_b32 v69, 0xffff0000, v59
v_lshlrev_b32 v70, 16, v99
v_and_b32 v71, 0xffff0000, v99
v_add_f32 v68, v68, v70
v_add_f32 v69, v69, v71
v_cvt_pk_bf16_f32 v59, v68, v69
s_add_u32 s24, s33, 24576
buffer_store_dwordx4 v[56:59], v12, s[4:7], s24 offen sc1
s_waitcnt lgkmcnt(0)
v_lshlrev_b32 v68, 16, v60
v_and_b32 v69, 0xffff0000, v60
v_lshlrev_b32 v70, 16, v100
v_and_b32 v71, 0xffff0000, v100
v_add_f32 v68, v68, v70
v_add_f32 v69, v69, v71
v_cvt_pk_bf16_f32 v60, v68, v69
v_lshlrev_b32 v68, 16, v61
v_and_b32 v69, 0xffff0000, v61
v_lshlrev_b32 v70, 16, v101
v_and_b32 v71, 0xffff0000, v101
v_add_f32 v68, v68, v70
v_add_f32 v69, v69, v71
v_cvt_pk_bf16_f32 v61, v68, v69
v_lshlrev_b32 v68, 16, v62
v_and_b32 v69, 0xffff0000, v62
v_lshlrev_b32 v70, 16, v102
v_and_b32 v71, 0xffff0000, v102
v_add_f32 v68, v68, v70
v_add_f32 v69, v69, v71
v_cvt_pk_bf16_f32 v62, v68, v69
v_lshlrev_b32 v68, 16, v63
v_and_b32 v69, 0xffff0000, v63
v_lshlrev_b32 v70, 16, v103
v_and_b32 v71, 0xffff0000, v103
v_add_f32 v68, v68, v70
v_add_f32 v69, v69, v71
v_cvt_pk_bf16_f32 v63, v68, v69
s_add_u32 s24, s33, 28672
buffer_store_dwordx4 v[60:63], v12, s[4:7], s24 offen sc1
s_lshl_b32 s76, s77, 7
s_add_u32 s76, s76, 53248
s_waitcnt vmcnt(0)
s_barrier
s_cmp_lg_u32 s16, 0
s_cbranch_scc1 sig_147
v_mov_b32 v1, s76
v_mov_b32 v2, 4
s_mov_b64 exec, 1
buffer_atomic_add v2, v1, s[4:7], 0 offen
s_mov_b64 exec, -1
sig_147:
s_branch mega_kernel_wloop
mega_kernel_t8:
s_lshr_b32 s17, s16, 2
s_and_b32 s18, s16, 3
v_lshrrev_b32 v1, 3, v0
s_mov_b32 s24, 2048
v_mul_lo_u32 v1, v1, s24
v_lshrrev_b32 v2, 4, v0
v_and_b32 v3, 7, v0
s_mov_b32 s25, 0
s_xor_b32 s26, s25, 0
v_add_u32 v4, s26, v2
v_xor_b32 v4, v4, v3
v_lshl_add_u32 v8, v4, 4, v1
s_xor_b32 s26, s25, 4
v_add_u32 v4, s26, v2
v_xor_b32 v4, v4, v3
v_lshl_add_u32 v9, v4, 4, v1
v_lshrrev_b32 v1, 5, v0
v_and_b32 v3, 31, v0
s_mov_b32 s24, 7168
v_mul_lo_u32 v2, v1, s24
v_add_u32 v4, 0, v1
v_and_b32 v4, 3, v4
v_lshlrev_b32 v4, 2, v4
v_xor_b32 v4, v4, v3
v_lshl_add_u32 v10, v4, 4, v2
v_add_u32 v4, 2, v1
v_and_b32 v4, 3, v4
v_lshlrev_b32 v4, 2, v4
v_xor_b32 v4, v4, v3
v_lshl_add_u32 v11, v4, 4, v2
v_and_b32 v1, 31, v0
v_lshrrev_b32 v2, 5, v0
v_bfe_u32 v3, v1, 1, 3
s_mul_i32 s24, s17, 8192
v_lshlrev_b32 v4, 7, v1
v_add_u32 v4, s24, v4
v_add_u32 v5, 0, v2
v_xor_b32 v5, v5, v3
v_lshl_add_u32 v13, v5, 4, v4
v_add_u32 v5, 2, v2
v_xor_b32 v5, v5, v3
v_lshl_add_u32 v14, v5, 4, v4
v_add_u32 v5, 4, v2
v_xor_b32 v5, v5, v3
v_lshl_add_u32 v15, v5, 4, v4
v_add_u32 v5, 6, v2
v_xor_b32 v5, v5, v3
v_lshl_add_u32 v16, v5, 4, v4
v_and_b32 v1, 15, v0
v_lshrrev_b32 v2, 2, v1
v_lshrrev_b32 v3, 5, v0
v_lshl_add_u32 v3, v3, 3, v2
v_mul_u32_u24 v3, 512, v3
v_and_b32 v4, 3, v1
v_lshl_add_u32 v3, v4, 3, v3
v_bfe_u32 v4, v0, 4, 1
v_lshl_add_u32 v3, v4, 5, v3
v_add_u32 v3, 16384, v3
s_mul_i32 s24, s18, 2
s_add_u32 s24, s24, 0
v_xor_b32 v4, s24, v2
v_lshl_add_u32 v17, v4, 6, v3
s_mul_i32 s24, s18, 2
s_add_u32 s24, s24, 1
v_xor_b32 v4, s24, v2
v_lshl_add_u32 v18, v4, 6, v3
v_add_u32 v19, 49152, v13
v_add_u32 v20, 49152, v14
v_add_u32 v21, 49152, v15
v_add_u32 v22, 49152, v16
v_add_u32 v23, 49152, v17
v_add_u32 v24, 49152, v18
v_add_u32 v25, 98304, v13
v_add_u32 v26, 98304, v14
v_add_u32 v27, 98304, v15
v_add_u32 v28, 98304, v16
v_add_u32 v29, 98304, v17
v_add_u32 v30, 98304, v18
s_mul_i32 s22, s16, 2048
s_mul_i32 s23, s16, 4096
s_add_u32 s23, s23, 16384
s_mov_b32 s8, s84
s_and_b32 s9, s85, 0xffff
s_mov_b32 s10, 0x700000
s_mov_b32 s11, 0x00020000
s_lshl_b32 s28, s77, 7
s_lshl_b32 s52, s77, 6
s_add_u32 s52, s52, 960
s_cmp_ge_u32 s77, 15
s_cselect_b32 s28, s52, s28
s_lshl_b32 s29, s79, 8
s_mul_i32 s24, s16, 16
s_add_u32 s24, s24, s28
s_mul_i32 s19, s24, 2048
s_add_u32 s19, s19, 102768640
s_mul_i32 s20, s16, 57344
s_lshl_b32 s24, s29, 1
s_add_u32 s20, s20, s24
s_mul_i32 s24, s28, 7168
s_mul_i32 s25, s29, 2
s_add_u32 s24, s24, s25
s_add_u32 s33, s24, 106962944
s_add_u32 s34, s24, 0
s_mov_b32 s35, 0
s_lshl_b32 s76, s77, 7
s_add_u32 s76, s76, 57344
s_cmp_lg_u32 s16, 0
s_cbranch_scc1 wf_148
v_mov_b32 v1, 0
v_mov_b32 v2, 0
v_writelane_b32 v1, s76, 0
s_mov_b32 s27, 16
v_writelane_b32 v2, s27, 0
s_mov_b64 exec, 1
wfp_149:
s_add_u32 s63, s63, 1
s_cmp_gt_u32 s63, 262144
s_cbranch_scc0 go_150
s_endpgm
go_150:
buffer_load_dword v3, v1, s[4:7], 0 offen sc1
s_waitcnt vmcnt(0)
v_cmp_lt_u32 vcc, v3, v2
s_nop 0
s_cbranch_vccz wfd_151
s_cmp_lt_u32 s77, 13
s_cbranch_scc1 urg_152
s_sleep 2
s_branch wfp_149
urg_152:
v_sub_u32 v4, v2, v3
s_nop 0
v_readlane_b32 s27, v4, 0
s_nop 0
s_cmp_lt_i32 s27, 2
s_cbranch_scc1 lv_153
s_sleep 40
s_branch wfp_149
lv_153:
s_cmp_lt_i32 s27, 1
s_cbranch_scc1 lv_154
s_sleep 12
s_branch wfp_149
lv_154:
s_sleep 8
s_branch wfp_149
wfd_151:
s_mov_b64 exec, -1
wf_148:
s_barrier
s_add_u32 m0, s22, 0
s_add_u32 s24, s19, 0
buffer_load_dwordx4 v8, s[4:7], s24 offen sc1 lds
s_add_u32 m0, s22, 1024
s_add_u32 s24, s19, 16384
buffer_load_dwordx4 v9, s[4:7], s24 offen sc1 lds
s_add_u32 m0, s23, 0
s_add_u32 s25, s20, 0
buffer_load_dwordx4 v10, s[8:11], s25 offen lds
s_add_u32 m0, s23, 1024
s_add_u32 s25, s20, 14336
buffer_load_dwordx4 v11, s[8:11], s25 offen lds
s_add_u32 m0, s23, 2048
s_add_u32 s25, s20, 28672
buffer_load_dwordx4 v10, s[8:11], s25 offen lds
s_add_u32 m0, s23, 3072
s_add_u32 s25, s20, 43008
buffer_load_dwordx4 v11, s[8:11], s25 offen lds
s_add_u32 m0, s22, 49152
s_add_u32 s24, s19, 128
buffer_load_dwordx4 v8, s[4:7], s24 offen sc1 lds
s_add_u32 m0, s22, 50176
s_add_u32 s24, s19, 16512
buffer_load_dwordx4 v9, s[4:7], s24 offen sc1 lds
s_add_u32 m0, s23, 49152
s_add_u32 s25, s20, 458752
buffer_load_dwordx4 v10, s[8:11], s25 offen lds
s_add_u32 m0, s23, 50176
s_add_u32 s25, s20, 473088
buffer_load_dwordx4 v11, s[8:11], s25 offen lds
s_add_u32 m0, s23, 51200
s_add_u32 s25, s20, 487424
buffer_load_dwordx4 v10, s[8:11], s25 offen lds
s_add_u32 m0, s23, 52224
s_add_u32 s25, s20, 501760
buffer_load_dwordx4 v11, s[8:11], s25 offen lds
v_accvgpr_write_b32 a0, 0
v_accvgpr_write_b32 a1, 0
v_accvgpr_write_b32 a2, 0
v_accvgpr_write_b32 a3, 0
v_accvgpr_write_b32 a4, 0
v_accvgpr_write_b32 a5, 0
v_accvgpr_write_b32 a6, 0
v_accvgpr_write_b32 a7, 0
v_accvgpr_write_b32 a8, 0
v_accvgpr_write_b32 a9, 0
v_accvgpr_write_b32 a10, 0
v_accvgpr_write_b32 a11, 0
v_accvgpr_write_b32 a12, 0
v_accvgpr_write_b32 a13, 0
v_accvgpr_write_b32 a14, 0
v_accvgpr_write_b32 a15, 0
v_accvgpr_write_b32 a16, 0
v_accvgpr_write_b32 a17, 0
v_accvgpr_write_b32 a18, 0
v_accvgpr_write_b32 a19, 0
v_accvgpr_write_b32 a20, 0
v_accvgpr_write_b32 a21, 0
v_accvgpr_write_b32 a22, 0
v_accvgpr_write_b32 a23, 0
v_accvgpr_write_b32 a24, 0
v_accvgpr_write_b32 a25, 0
v_accvgpr_write_b32 a26, 0
v_accvgpr_write_b32 a27, 0
v_accvgpr_write_b32 a28, 0
v_accvgpr_write_b32 a29, 0
v_accvgpr_write_b32 a30, 0
v_accvgpr_write_b32 a31, 0
v_accvgpr_write_b32 a32, 0
v_accvgpr_write_b32 a33, 0
v_accvgpr_write_b32 a34, 0
v_accvgpr_write_b32 a35, 0
v_accvgpr_write_b32 a36, 0
v_accvgpr_write_b32 a37, 0
v_accvgpr_write_b32 a38, 0
v_accvgpr_write_b32 a39, 0
v_accvgpr_write_b32 a40, 0
v_accvgpr_write_b32 a41, 0
v_accvgpr_write_b32 a42, 0
v_accvgpr_write_b32 a43, 0
v_accvgpr_write_b32 a44, 0
v_accvgpr_write_b32 a45, 0
v_accvgpr_write_b32 a46, 0
v_accvgpr_write_b32 a47, 0
v_accvgpr_write_b32 a48, 0
v_accvgpr_write_b32 a49, 0
v_accvgpr_write_b32 a50, 0
v_accvgpr_write_b32 a51, 0
v_accvgpr_write_b32 a52, 0
v_accvgpr_write_b32 a53, 0
v_accvgpr_write_b32 a54, 0
v_accvgpr_write_b32 a55, 0
v_accvgpr_write_b32 a56, 0
v_accvgpr_write_b32 a57, 0
v_accvgpr_write_b32 a58, 0
v_accvgpr_write_b32 a59, 0
v_accvgpr_write_b32 a60, 0
v_accvgpr_write_b32 a61, 0
v_accvgpr_write_b32 a62, 0
v_accvgpr_write_b32 a63, 0
s_waitcnt vmcnt(6)
s_barrier
RB 32,13,0
RB 36,13,4096
RT 40,17,0
RT 42,17,2048
RT 44,18,0
RT 46,18,2048
RB 48,14,0
RB 52,14,4096
RT 56,17,8192
RT 58,17,10240
RT 60,18,8192
RT 62,18,10240
RB 64,15,0
RB 68,15,4096
RT 72,17,16384
RT 74,17,18432
RT 76,18,16384
RT 78,18,18432
s_waitcnt lgkmcnt(12)
MM 0,40,32
RB 80,16,0
RB 84,16,4096
RT 88,17,24576
MM 16,44,32
RT 90,17,26624
RT 92,18,24576
RT 94,18,26624
MM 32,40,36
s_add_u32 m0, s22, 98304
s_add_u32 s24, s19, 256
buffer_load_dwordx4 v8, s[4:7], s24 offen sc1 lds
s_add_u32 m0, s22, 99328
s_add_u32 s24, s19, 16640
buffer_load_dwordx4 v9, s[4:7], s24 offen sc1 lds
s_add_u32 m0, s23, 98304
s_add_u32 s25, s20, 917504
buffer_load_dwordx4 v10, s[8:11], s25 offen lds
MM 48,44,36
s_add_u32 m0, s23, 99328
s_add_u32 s25, s20, 931840
buffer_load_dwordx4 v11, s[8:11], s25 offen lds
s_add_u32 m0, s23, 100352
s_add_u32 s25, s20, 946176
buffer_load_dwordx4 v10, s[8:11], s25 offen lds
s_add_u32 m0, s23, 101376
s_add_u32 s25, s20, 960512
buffer_load_dwordx4 v11, s[8:11], s25 offen lds
s_waitcnt lgkmcnt(0) vmcnt(6)
s_barrier
MM 0,56,48
RB 32,19,0
RB 36,19,4096
MM 16,60,48
RT 40,23,0
RT 42,23,2048
MM 32,56,52
RT 44,24,0
RT 46,24,2048
MM 48,60,52
s_add_u32 m0, s22, 0
s_add_u32 s24, s19, 384
buffer_load_dwordx4 v8, s[4:7], s24 offen sc1 lds
s_waitcnt lgkmcnt(12)
MM 0,72,64
RB 48,20,0
RB 52,20,4096
MM 16,76,64
RT 56,23,8192
RT 58,23,10240
MM 32,72,68
RT 60,24,8192
RT 62,24,10240
MM 48,76,68
s_add_u32 m0, s22, 1024
s_add_u32 s24, s19, 16768
buffer_load_dwordx4 v9, s[4:7], s24 offen sc1 lds
s_add_u32 m0, s23, 0
s_add_u32 s25, s20, 1376256
buffer_load_dwordx4 v10, s[8:11], s25 offen lds
s_waitcnt lgkmcnt(12)
MM 0,88,80
RB 64,21,0
RB 68,21,4096
MM 16,92,80
RT 72,23,16384
RT 74,23,18432
MM 32,88,84
RT 76,24,16384
RT 78,24,18432
MM 48,92,84
s_add_u32 m0, s23, 1024
s_add_u32 s25, s20, 1390592
buffer_load_dwordx4 v11, s[8:11], s25 offen lds
s_waitcnt lgkmcnt(12)
MM 0,40,32
RB 80,22,0
RB 84,22,4096
MM 16,44,32
RT 88,23,24576
RT 90,23,26624
MM 32,40,36
RT 92,24,24576
RT 94,24,26624
MM 48,44,36
s_add_u32 m0, s23, 2048
s_add_u32 s25, s20, 1404928
buffer_load_dwordx4 v10, s[8:11], s25 offen lds
s_add_u32 m0, s23, 3072
s_add_u32 s25, s20, 1419264
buffer_load_dwordx4 v11, s[8:11], s25 offen lds
s_waitcnt lgkmcnt(0) vmcnt(6)
s_barrier
MM 0,56,48
RB 32,25,0
RB 36,25,4096
MM 16,60,48
RT 40,29,0
RT 42,29,2048
MM 32,56,52
RT 44,30,0
RT 46,30,2048
MM 48,60,52
s_add_u32 m0, s22, 49152
s_add_u32 s24, s19, 512
buffer_load_dwordx4 v8, s[4:7], s24 offen sc1 lds
s_waitcnt lgkmcnt(12)
MM 0,72,64
RB 48,26,0
RB 52,26,4096
MM 16,76,64
RT 56,29,8192
RT 58,29,10240
MM 32,72,68
RT 60,30,8192
RT 62,30,10240
MM 48,76,68
s_add_u32 m0, s22, 50176
s_add_u32 s24, s19, 16896
buffer_load_dwordx4 v9, s[4:7], s24 offen sc1 lds
s_add_u32 m0, s23, 49152
s_add_u32 s25, s20, 1835008
buffer_load_dwordx4 v10, s[8:11], s25 offen lds
s_waitcnt lgkmcnt(12)
MM 0,88,80
RB 64,27,0
RB 68,27,4096
MM 16,92,80
RT 72,29,16384
RT 74,29,18432
MM 32,88,84
RT 76,30,16384
RT 78,30,18432
MM 48,92,84
s_add_u32 m0, s23, 50176
s_add_u32 s25, s20, 1849344
buffer_load_dwordx4 v11, s[8:11], s25 offen lds
s_waitcnt lgkmcnt(12)
MM 0,40,32
RB 80,28,0
RB 84,28,4096
MM 16,44,32
RT 88,29,24576
RT 90,29,26624
MM 32,40,36
RT 92,30,24576
RT 94,30,26624
MM 48,44,36
s_add_u32 m0, s23, 51200
s_add_u32 s25, s20, 1863680
buffer_load_dwordx4 v10, s[8:11], s25 offen lds
s_add_u32 m0, s23, 52224
s_add_u32 s25, s20, 1878016
buffer_load_dwordx4 v11, s[8:11], s25 offen lds
s_waitcnt lgkmcnt(0) vmcnt(6)
s_barrier
MM 0,56,48
RB 32,13,0
RB 36,13,4096
MM 16,60,48
RT 40,17,0
RT 42,17,2048
MM 32,56,52
RT 44,18,0
RT 46,18,2048
MM 48,60,52
s_add_u32 m0, s22, 98304
s_add_u32 s24, s19, 640
buffer_load_dwordx4 v8, s[4:7], s24 offen sc1 lds
s_waitcnt lgkmcnt(12)
MM 0,72,64
RB 48,14,0
RB 52,14,4096
MM 16,76,64
RT 56,17,8192
RT 58,17,10240
MM 32,72,68
RT 60,18,8192
RT 62,18,10240
MM 48,76,68
s_add_u32 m0, s22, 99328
s_add_u32 s24, s19, 17024
buffer_load_dwordx4 v9, s[4:7], s24 offen sc1 lds
s_add_u32 m0, s23, 98304
s_add_u32 s25, s20, 2293760
buffer_load_dwordx4 v10, s[8:11], s25 offen lds
s_waitcnt lgkmcnt(12)
MM 0,88,80
RB 64,15,0
RB 68,15,4096
MM 16,92,80
RT 72,17,16384
RT 74,17,18432
MM 32,88,84
RT 76,18,16384
RT 78,18,18432
MM 48,92,84
s_add_u32 m0, s23, 99328
s_add_u32 s25, s20, 2308096
buffer_load_dwordx4 v11, s[8:11], s25 offen lds
s_waitcnt lgkmcnt(12)
MM 0,40,32
RB 80,16,0
RB 84,16,4096
MM 16,44,32
RT 88,17,24576
RT 90,17,26624
MM 32,40,36
RT 92,18,24576
RT 94,18,26624
MM 48,44,36
s_add_u32 m0, s23, 100352
s_add_u32 s25, s20, 2322432
buffer_load_dwordx4 v10, s[8:11], s25 offen lds
s_add_u32 m0, s23, 101376
s_add_u32 s25, s20, 2336768
buffer_load_dwordx4 v11, s[8:11], s25 offen lds
s_waitcnt lgkmcnt(0) vmcnt(6)
s_barrier
MM 0,56,48
RB 32,19,0
RB 36,19,4096
MM 16,60,48
RT 40,23,0
RT 42,23,2048
MM 32,56,52
RT 44,24,0
RT 46,24,2048
MM 48,60,52
s_add_u32 m0, s22, 0
s_add_u32 s24, s19, 768
buffer_load_dwordx4 v8, s[4:7], s24 offen sc1 lds
s_waitcnt lgkmcnt(12)
MM 0,72,64
RB 48,20,0
RB 52,20,4096
MM 16,76,64
RT 56,23,8192
RT 58,23,10240
MM 32,72,68
RT 60,24,8192
RT 62,24,10240
MM 48,76,68
s_add_u32 m0, s22, 1024
s_add_u32 s24, s19, 17152
buffer_load_dwordx4 v9, s[4:7], s24 offen sc1 lds
s_add_u32 m0, s23, 0
s_add_u32 s25, s20, 2752512
buffer_load_dwordx4 v10, s[8:11], s25 offen lds
s_waitcnt lgkmcnt(12)
MM 0,88,80
RB 64,21,0
RB 68,21,4096
MM 16,92,80
RT 72,23,16384
RT 74,23,18432
MM 32,88,84
RT 76,24,16384
RT 78,24,18432
MM 48,92,84
s_add_u32 m0, s23, 1024
s_add_u32 s25, s20, 2766848
buffer_load_dwordx4 v11, s[8:11], s25 offen lds
s_waitcnt lgkmcnt(12)
MM 0,40,32
RB 80,22,0
RB 84,22,4096
MM 16,44,32
RT 88,23,24576
RT 90,23,26624
MM 32,40,36
RT 92,24,24576
RT 94,24,26624
MM 48,44,36
s_add_u32 m0, s23, 2048
s_add_u32 s25, s20, 2781184
buffer_load_dwordx4 v10, s[8:11], s25 offen lds
s_add_u32 m0, s23, 3072
s_add_u32 s25, s20, 2795520
buffer_load_dwordx4 v11, s[8:11], s25 offen lds
s_waitcnt lgkmcnt(0) vmcnt(6)
s_barrier
MM 0,56,48
RB 32,25,0
RB 36,25,4096
MM 16,60,48
RT 40,29,0
RT 42,29,2048
MM 32,56,52
RT 44,30,0
RT 46,30,2048
MM 48,60,52
s_add_u32 m0, s22, 49152
s_add_u32 s24, s19, 896
buffer_load_dwordx4 v8, s[4:7], s24 offen sc1 lds
s_waitcnt lgkmcnt(12)
MM 0,72,64
RB 48,26,0
RB 52,26,4096
MM 16,76,64
RT 56,29,8192
RT 58,29,10240
MM 32,72,68
RT 60,30,8192
RT 62,30,10240
MM 48,76,68
s_add_u32 m0, s22, 50176
s_add_u32 s24, s19, 17280
buffer_load_dwordx4 v9, s[4:7], s24 offen sc1 lds
s_add_u32 m0, s23, 49152
s_add_u32 s25, s20, 3211264
buffer_load_dwordx4 v10, s[8:11], s25 offen lds
s_waitcnt lgkmcnt(12)
MM 0,88,80
RB 64,27,0
RB 68,27,4096
MM 16,92,80
RT 72,29,16384
RT 74,29,18432
MM 32,88,84
RT 76,30,16384
RT 78,30,18432
MM 48,92,84
s_add_u32 m0, s23, 50176
s_add_u32 s25, s20, 3225600
buffer_load_dwordx4 v11, s[8:11], s25 offen lds
s_waitcnt lgkmcnt(12)
MM 0,40,32
RB 80,28,0
RB 84,28,4096
MM 16,44,32
RT 88,29,24576
RT 90,29,26624
MM 32,40,36
RT 92,30,24576
RT 94,30,26624
MM 48,44,36
s_add_u32 m0, s23, 51200
s_add_u32 s25, s20, 3239936
buffer_load_dwordx4 v10, s[8:11], s25 offen lds
s_add_u32 m0, s23, 52224
s_add_u32 s25, s20, 3254272
buffer_load_dwordx4 v11, s[8:11], s25 offen lds
s_waitcnt lgkmcnt(0) vmcnt(6)
s_barrier
MM 0,56,48
RB 32,13,0
RB 36,13,4096
MM 16,60,48
RT 40,17,0
RT 42,17,2048
MM 32,56,52
RT 44,18,0
RT 46,18,2048
MM 48,60,52
s_add_u32 m0, s22, 98304
s_add_u32 s24, s19, 1024
buffer_load_dwordx4 v8, s[4:7], s24 offen sc1 lds
s_waitcnt lgkmcnt(12)
MM 0,72,64
RB 48,14,0
RB 52,14,4096
MM 16,76,64
RT 56,17,8192
RT 58,17,10240
MM 32,72,68
RT 60,18,8192
RT 62,18,10240
MM 48,76,68
s_add_u32 m0, s22, 99328
s_add_u32 s24, s19, 17408
buffer_load_dwordx4 v9, s[4:7], s24 offen sc1 lds
s_add_u32 m0, s23, 98304
s_add_u32 s25, s20, 3670016
buffer_load_dwordx4 v10, s[8:11], s25 offen lds
s_waitcnt lgkmcnt(12)
MM 0,88,80
RB 64,15,0
RB 68,15,4096
MM 16,92,80
RT 72,17,16384
RT 74,17,18432
MM 32,88,84
RT 76,18,16384
RT 78,18,18432
MM 48,92,84
s_add_u32 m0, s23, 99328
s_add_u32 s25, s20, 3684352
buffer_load_dwordx4 v11, s[8:11], s25 offen lds
s_waitcnt lgkmcnt(12)
MM 0,40,32
RB 80,16,0
RB 84,16,4096
MM 16,44,32
RT 88,17,24576
RT 90,17,26624
MM 32,40,36
RT 92,18,24576
RT 94,18,26624
MM 48,44,36
s_add_u32 m0, s23, 100352
s_add_u32 s25, s20, 3698688
buffer_load_dwordx4 v10, s[8:11], s25 offen lds
s_add_u32 m0, s23, 101376
s_add_u32 s25, s20, 3713024
buffer_load_dwordx4 v11, s[8:11], s25 offen lds
s_waitcnt lgkmcnt(0) vmcnt(6)
s_barrier
MM 0,56,48
RB 32,19,0
RB 36,19,4096
MM 16,60,48
RT 40,23,0
RT 42,23,2048
MM 32,56,52
RT 44,24,0
RT 46,24,2048
MM 48,60,52
s_add_u32 m0, s22, 0
s_add_u32 s24, s19, 1152
buffer_load_dwordx4 v8, s[4:7], s24 offen sc1 lds
s_waitcnt lgkmcnt(12)
MM 0,72,64
RB 48,20,0
RB 52,20,4096
MM 16,76,64
RT 56,23,8192
RT 58,23,10240
MM 32,72,68
RT 60,24,8192
RT 62,24,10240
MM 48,76,68
s_add_u32 m0, s22, 1024
s_add_u32 s24, s19, 17536
buffer_load_dwordx4 v9, s[4:7], s24 offen sc1 lds
s_add_u32 m0, s23, 0
s_add_u32 s25, s20, 4128768
buffer_load_dwordx4 v10, s[8:11], s25 offen lds
s_waitcnt lgkmcnt(12)
MM 0,88,80
RB 64,21,0
RB 68,21,4096
MM 16,92,80
RT 72,23,16384
RT 74,23,18432
MM 32,88,84
RT 76,24,16384
RT 78,24,18432
MM 48,92,84
s_add_u32 m0, s23, 1024
s_add_u32 s25, s20, 4143104
buffer_load_dwordx4 v11, s[8:11], s25 offen lds
s_waitcnt lgkmcnt(12)
MM 0,40,32
RB 80,22,0
RB 84,22,4096
MM 16,44,32
RT 88,23,24576
RT 90,23,26624
MM 32,40,36
RT 92,24,24576
RT 94,24,26624
MM 48,44,36
s_add_u32 m0, s23, 2048
s_add_u32 s25, s20, 4157440
buffer_load_dwordx4 v10, s[8:11], s25 offen lds
s_add_u32 m0, s23, 3072
s_add_u32 s25, s20, 4171776
buffer_load_dwordx4 v11, s[8:11], s25 offen lds
s_waitcnt lgkmcnt(0) vmcnt(6)
s_barrier
MM 0,56,48
RB 32,25,0
RB 36,25,4096
MM 16,60,48
RT 40,29,0
RT 42,29,2048
MM 32,56,52
RT 44,30,0
RT 46,30,2048
MM 48,60,52
s_add_u32 m0, s22, 49152
s_add_u32 s24, s19, 1280
buffer_load_dwordx4 v8, s[4:7], s24 offen sc1 lds
s_waitcnt lgkmcnt(12)
MM 0,72,64
RB 48,26,0
RB 52,26,4096
MM 16,76,64
RT 56,29,8192
RT 58,29,10240
MM 32,72,68
RT 60,30,8192
RT 62,30,10240
MM 48,76,68
s_add_u32 m0, s22, 50176
s_add_u32 s24, s19, 17664
buffer_load_dwordx4 v9, s[4:7], s24 offen sc1 lds
s_add_u32 m0, s23, 49152
s_add_u32 s25, s20, 4587520
buffer_load_dwordx4 v10, s[8:11], s25 offen lds
s_waitcnt lgkmcnt(12)
MM 0,88,80
RB 64,27,0
RB 68,27,4096
MM 16,92,80
RT 72,29,16384
RT 74,29,18432
MM 32,88,84
RT 76,30,16384
RT 78,30,18432
MM 48,92,84
s_add_u32 m0, s23, 50176
s_add_u32 s25, s20, 4601856
buffer_load_dwordx4 v11, s[8:11], s25 offen lds
s_waitcnt lgkmcnt(12)
MM 0,40,32
RB 80,28,0
RB 84,28,4096
MM 16,44,32
RT 88,29,24576
RT 90,29,26624
MM 32,40,36
RT 92,30,24576
RT 94,30,26624
MM 48,44,36
s_add_u32 m0, s23, 51200
s_add_u32 s25, s20, 4616192
buffer_load_dwordx4 v10, s[8:11], s25 offen lds
s_add_u32 m0, s23, 52224
s_add_u32 s25, s20, 4630528
buffer_load_dwordx4 v11, s[8:11], s25 offen lds
s_waitcnt lgkmcnt(0) vmcnt(6)
s_barrier
MM 0,56,48
RB 32,13,0
RB 36,13,4096
MM 16,60,48
RT 40,17,0
RT 42,17,2048
MM 32,56,52
RT 44,18,0
RT 46,18,2048
MM 48,60,52
s_add_u32 m0, s22, 98304
s_add_u32 s24, s19, 1408
buffer_load_dwordx4 v8, s[4:7], s24 offen sc1 lds
s_waitcnt lgkmcnt(12)
MM 0,72,64
RB 48,14,0
RB 52,14,4096
MM 16,76,64
RT 56,17,8192
RT 58,17,10240
MM 32,72,68
RT 60,18,8192
RT 62,18,10240
MM 48,76,68
s_add_u32 m0, s22, 99328
s_add_u32 s24, s19, 17792
buffer_load_dwordx4 v9, s[4:7], s24 offen sc1 lds
s_add_u32 m0, s23, 98304
s_add_u32 s25, s20, 5046272
buffer_load_dwordx4 v10, s[8:11], s25 offen lds
s_waitcnt lgkmcnt(12)
MM 0,88,80
RB 64,15,0
RB 68,15,4096
MM 16,92,80
RT 72,17,16384
RT 74,17,18432
MM 32,88,84
RT 76,18,16384
RT 78,18,18432
MM 48,92,84
s_add_u32 m0, s23, 99328
s_add_u32 s25, s20, 5060608
buffer_load_dwordx4 v11, s[8:11], s25 offen lds
s_waitcnt lgkmcnt(12)
MM 0,40,32
RB 80,16,0
RB 84,16,4096
MM 16,44,32
RT 88,17,24576
RT 90,17,26624
MM 32,40,36
RT 92,18,24576
RT 94,18,26624
MM 48,44,36
s_add_u32 m0, s23, 100352
s_add_u32 s25, s20, 5074944
buffer_load_dwordx4 v10, s[8:11], s25 offen lds
s_add_u32 m0, s23, 101376
s_add_u32 s25, s20, 5089280
buffer_load_dwordx4 v11, s[8:11], s25 offen lds
s_waitcnt lgkmcnt(0) vmcnt(6)
s_barrier
MM 0,56,48
RB 32,19,0
RB 36,19,4096
MM 16,60,48
RT 40,23,0
RT 42,23,2048
MM 32,56,52
RT 44,24,0
RT 46,24,2048
MM 48,60,52
s_add_u32 m0, s22, 0
s_add_u32 s24, s19, 1536
buffer_load_dwordx4 v8, s[4:7], s24 offen sc1 lds
s_waitcnt lgkmcnt(12)
MM 0,72,64
RB 48,20,0
RB 52,20,4096
MM 16,76,64
RT 56,23,8192
RT 58,23,10240
MM 32,72,68
RT 60,24,8192
RT 62,24,10240
MM 48,76,68
s_add_u32 m0, s22, 1024
s_add_u32 s24, s19, 17920
buffer_load_dwordx4 v9, s[4:7], s24 offen sc1 lds
s_add_u32 m0, s23, 0
s_add_u32 s25, s20, 5505024
buffer_load_dwordx4 v10, s[8:11], s25 offen lds
s_waitcnt lgkmcnt(12)
MM 0,88,80
RB 64,21,0
RB 68,21,4096
MM 16,92,80
RT 72,23,16384
RT 74,23,18432
MM 32,88,84
RT 76,24,16384
RT 78,24,18432
MM 48,92,84
s_add_u32 m0, s23, 1024
s_add_u32 s25, s20, 5519360
buffer_load_dwordx4 v11, s[8:11], s25 offen lds
s_waitcnt lgkmcnt(12)
MM 0,40,32
RB 80,22,0
RB 84,22,4096
MM 16,44,32
RT 88,23,24576
RT 90,23,26624
MM 32,40,36
RT 92,24,24576
RT 94,24,26624
MM 48,44,36
s_add_u32 m0, s23, 2048
s_add_u32 s25, s20, 5533696
buffer_load_dwordx4 v10, s[8:11], s25 offen lds
s_add_u32 m0, s23, 3072
s_add_u32 s25, s20, 5548032
buffer_load_dwordx4 v11, s[8:11], s25 offen lds
s_waitcnt lgkmcnt(0) vmcnt(6)
s_barrier
MM 0,56,48
RB 32,25,0
RB 36,25,4096
MM 16,60,48
RT 40,29,0
RT 42,29,2048
MM 32,56,52
RT 44,30,0
RT 46,30,2048
MM 48,60,52
s_add_u32 m0, s22, 49152
s_add_u32 s24, s19, 1664
buffer_load_dwordx4 v8, s[4:7], s24 offen sc1 lds
s_waitcnt lgkmcnt(12)
MM 0,72,64
RB 48,26,0
RB 52,26,4096
MM 16,76,64
RT 56,29,8192
RT 58,29,10240
MM 32,72,68
RT 60,30,8192
RT 62,30,10240
MM 48,76,68
s_add_u32 m0, s22, 50176
s_add_u32 s24, s19, 18048
buffer_load_dwordx4 v9, s[4:7], s24 offen sc1 lds
s_add_u32 m0, s23, 49152
s_add_u32 s25, s20, 5963776
buffer_load_dwordx4 v10, s[8:11], s25 offen lds
s_waitcnt lgkmcnt(12)
MM 0,88,80
RB 64,27,0
RB 68,27,4096
MM 16,92,80
RT 72,29,16384
RT 74,29,18432
MM 32,88,84
RT 76,30,16384
RT 78,30,18432
MM 48,92,84
s_add_u32 m0, s23, 50176
s_add_u32 s25, s20, 5978112
buffer_load_dwordx4 v11, s[8:11], s25 offen lds
s_waitcnt lgkmcnt(12)
MM 0,40,32
RB 80,28,0
RB 84,28,4096
MM 16,44,32
RT 88,29,24576
RT 90,29,26624
MM 32,40,36
RT 92,30,24576
RT 94,30,26624
MM 48,44,36
s_add_u32 m0, s23, 51200
s_add_u32 s25, s20, 5992448
buffer_load_dwordx4 v10, s[8:11], s25 offen lds
s_add_u32 m0, s23, 52224
s_add_u32 s25, s20, 6006784
buffer_load_dwordx4 v11, s[8:11], s25 offen lds
s_waitcnt lgkmcnt(0) vmcnt(6)
s_barrier
MM 0,56,48
RB 32,13,0
RB 36,13,4096
MM 16,60,48
RT 40,17,0
RT 42,17,2048
MM 32,56,52
RT 44,18,0
RT 46,18,2048
MM 48,60,52
s_add_u32 m0, s22, 98304
s_add_u32 s24, s19, 1792
buffer_load_dwordx4 v8, s[4:7], s24 offen sc1 lds
s_waitcnt lgkmcnt(12)
MM 0,72,64
RB 48,14,0
RB 52,14,4096
MM 16,76,64
RT 56,17,8192
RT 58,17,10240
MM 32,72,68
RT 60,18,8192
RT 62,18,10240
MM 48,76,68
s_add_u32 m0, s22, 99328
s_add_u32 s24, s19, 18176
buffer_load_dwordx4 v9, s[4:7], s24 offen sc1 lds
s_add_u32 m0, s23, 98304
s_add_u32 s25, s20, 6422528
buffer_load_dwordx4 v10, s[8:11], s25 offen lds
s_waitcnt lgkmcnt(12)
MM 0,88,80
RB 64,15,0
RB 68,15,4096
MM 16,92,80
RT 72,17,16384
RT 74,17,18432
MM 32,88,84
RT 76,18,16384
RT 78,18,18432
MM 48,92,84
s_add_u32 m0, s23, 99328
s_add_u32 s25, s20, 6436864
buffer_load_dwordx4 v11, s[8:11], s25 offen lds
s_waitcnt lgkmcnt(12)
MM 0,40,32
RB 80,16,0
RB 84,16,4096
MM 16,44,32
RT 88,17,24576
RT 90,17,26624
MM 32,40,36
RT 92,18,24576
RT 94,18,26624
MM 48,44,36
s_add_u32 m0, s23, 100352
s_add_u32 s25, s20, 6451200
buffer_load_dwordx4 v10, s[8:11], s25 offen lds
s_add_u32 m0, s23, 101376
s_add_u32 s25, s20, 6465536
buffer_load_dwordx4 v11, s[8:11], s25 offen lds
s_waitcnt lgkmcnt(0) vmcnt(6)
s_barrier
MM 0,56,48
RB 32,19,0
RB 36,19,4096
MM 16,60,48
RT 40,23,0
RT 42,23,2048
MM 32,56,52
RT 44,24,0
RT 46,24,2048
MM 48,60,52
s_add_u32 m0, s22, 0
s_add_u32 s24, s19, 1920
buffer_load_dwordx4 v8, s[4:7], s24 offen sc1 lds
s_waitcnt lgkmcnt(12)
MM 0,72,64
RB 48,20,0
RB 52,20,4096
MM 16,76,64
RT 56,23,8192
RT 58,23,10240
MM 32,72,68
RT 60,24,8192
RT 62,24,10240
MM 48,76,68
s_add_u32 m0, s22, 1024
s_add_u32 s24, s19, 18304
buffer_load_dwordx4 v9, s[4:7], s24 offen sc1 lds
s_add_u32 m0, s23, 0
s_add_u32 s25, s20, 6881280
buffer_load_dwordx4 v10, s[8:11], s25 offen lds
s_waitcnt lgkmcnt(12)
MM 0,88,80
RB 64,21,0
RB 68,21,4096
MM 16,92,80
RT 72,23,16384
RT 74,23,18432
MM 32,88,84
RT 76,24,16384
RT 78,24,18432
MM 48,92,84
s_add_u32 m0, s23, 1024
s_add_u32 s25, s20, 6895616
buffer_load_dwordx4 v11, s[8:11], s25 offen lds
s_waitcnt lgkmcnt(12)
MM 0,40,32
RB 80,22,0
RB 84,22,4096
MM 16,44,32
RT 88,23,24576
RT 90,23,26624
MM 32,40,36
RT 92,24,24576
RT 94,24,26624
MM 48,44,36
s_add_u32 m0, s23, 2048
s_add_u32 s25, s20, 6909952
buffer_load_dwordx4 v10, s[8:11], s25 offen lds
s_add_u32 m0, s23, 3072
s_add_u32 s25, s20, 6924288
buffer_load_dwordx4 v11, s[8:11], s25 offen lds
s_waitcnt lgkmcnt(0) vmcnt(6)
s_barrier
MM 0,56,48
RB 32,25,0
RB 36,25,4096
MM 16,60,48
RT 40,29,0
MM 32,56,52
RT 42,29,2048
RT 44,30,0
MM 48,60,52
RT 46,30,2048
s_waitcnt lgkmcnt(12)
MM 0,72,64
RB 48,26,0
RB 52,26,4096
MM 16,76,64
RT 56,29,8192
MM 32,72,68
RT 58,29,10240
RT 60,30,8192
MM 48,76,68
RT 62,30,10240
s_waitcnt lgkmcnt(12)
MM 0,88,80
RB 64,27,0
RB 68,27,4096
MM 16,92,80
RT 72,29,16384
MM 32,88,84
RT 74,29,18432
RT 76,30,16384
MM 48,92,84
RT 78,30,18432
s_waitcnt lgkmcnt(12)
MM 0,40,32
RB 80,28,0
RB 84,28,4096
MM 16,44,32
RT 88,29,24576
MM 32,40,36
RT 90,29,26624
RT 92,30,24576
MM 48,44,36
RT 94,30,26624
s_waitcnt lgkmcnt(0) vmcnt(0)
s_barrier
MM 0,56,48
RB 32,13,0
RB 36,13,4096
MM 16,60,48
RT 40,17,0
MM 32,56,52
RT 42,17,2048
RT 44,18,0
MM 48,60,52
RT 46,18,2048
s_waitcnt lgkmcnt(12)
MM 0,72,64
RB 48,14,0
RB 52,14,4096
MM 16,76,64
RT 56,17,8192
MM 32,72,68
RT 58,17,10240
RT 60,18,8192
MM 48,76,68
RT 62,18,10240
s_waitcnt lgkmcnt(12)
MM 0,88,80
RB 64,15,0
RB 68,15,4096
MM 16,92,80
RT 72,17,16384
MM 32,88,84
RT 74,17,18432
RT 76,18,16384
MM 48,92,84
RT 78,18,18432
s_waitcnt lgkmcnt(12)
MM 0,40,32
RB 80,16,0
RB 84,16,4096
MM 16,44,32
RT 88,17,24576
MM 32,40,36
RT 90,17,26624
RT 92,18,24576
MM 48,44,36
RT 94,18,26624
s_waitcnt lgkmcnt(0)
MM 0,56,48
MM 16,60,48
MM 32,56,52
MM 48,60,52
s_waitcnt lgkmcnt(0)
MM 0,72,64
MM 16,76,64
MM 32,72,68
MM 48,76,68
s_waitcnt lgkmcnt(0)
MM 0,88,80
MM 16,92,80
MM 32,88,84
MM 48,92,84
s_barrier
s_cmp_lg_u32 s16, 0
s_cbranch_scc1 tt_155
v_mov_b32 v7, s56
v_accvgpr_write_b32 a127, 1
s_mov_b64 exec, 1
buffer_atomic_add a127, v7, s[4:7], 0 offen sc0
s_mov_b64 exec, -1
tt_155:
v_and_b32 v1, 31, v0
v_lshrrev_b32 v2, 5, v0
s_mul_i32 s24, s17, 33792
s_mul_i32 s25, s18, 128
s_add_u32 s24, s24, s25
v_mul_u32_u24 v3, 528, v1
v_lshl_add_u32 v3, v2, 4, v3
v_add_u32 v3, s24, v3
v_mov_b32 v72, 0xc0135761
v_mov_b32 v74, 0xbdd2d3e8
v_mov_b32 v76, 1.0
v_mov_b32 v73, 0xc0135761
v_mov_b32 v75, 0xbdd2d3e8
v_mov_b32 v77, 1.0
v_lshrrev_b32 v4, 5, v0
v_and_b32 v5, 31, v0
s_mul_i32 s24, s16, 16
v_add_u32 v4, s24, v4
v_mul_u32_u24 v6, 528, v4
v_lshl_add_u32 v6, v5, 4, v6
s_mov_b32 s24, 7168
v_mul_lo_u32 v12, v4, s24
v_lshl_add_u32 v12, v5, 4, v12
v_accvgpr_read_b32 v32, a0
v_accvgpr_read_b32 v33, a1
v_accvgpr_read_b32 v34, a2
v_accvgpr_read_b32 v35, a3
v_accvgpr_read_b32 v36, a4
v_accvgpr_read_b32 v37, a5
v_accvgpr_read_b32 v38, a6
v_accvgpr_read_b32 v39, a7
v_accvgpr_read_b32 v40, a8
v_accvgpr_read_b32 v41, a9
v_accvgpr_read_b32 v42, a10
v_accvgpr_read_b32 v43, a11
v_accvgpr_read_b32 v44, a12
v_accvgpr_read_b32 v45, a13
v_accvgpr_read_b32 v46, a14
v_accvgpr_read_b32 v47, a15
v_pk_mul_f32 v[64:65], v[32:33], v[32:33]
v_pk_mul_f32 v[66:67], v[34:35], v[34:35]
v_pk_fma_f32 v[64:65], v[64:65], v[74:75], v[72:73]
v_pk_fma_f32 v[66:67], v[66:67], v[74:75], v[72:73]
v_pk_mul_f32 v[64:65], v[64:65], v[32:33]
v_pk_mul_f32 v[66:67], v[66:67], v[34:35]
v_exp_f32 v64, v64
v_exp_f32 v66, v66
v_exp_f32 v65, v65
v_exp_f32 v67, v67
v_pk_add_f32 v[64:65], v[64:65], v[76:77]
v_pk_add_f32 v[66:67], v[66:67], v[76:77]
v_rcp_f32 v64, v64
v_rcp_f32 v66, v66
v_rcp_f32 v65, v65
v_rcp_f32 v67, v67
v_pk_mul_f32 v[32:33], v[32:33], v[64:65]
v_pk_mul_f32 v[34:35], v[34:35], v[66:67]
v_pk_mul_f32 v[64:65], v[36:37], v[36:37]
v_pk_mul_f32 v[66:67], v[38:39], v[38:39]
v_pk_fma_f32 v[64:65], v[64:65], v[74:75], v[72:73]
v_pk_fma_f32 v[66:67], v[66:67], v[74:75], v[72:73]
v_pk_mul_f32 v[64:65], v[64:65], v[36:37]
v_pk_mul_f32 v[66:67], v[66:67], v[38:39]
v_exp_f32 v64, v64
v_exp_f32 v66, v66
v_exp_f32 v65, v65
v_exp_f32 v67, v67
v_pk_add_f32 v[64:65], v[64:65], v[76:77]
v_pk_add_f32 v[66:67], v[66:67], v[76:77]
v_rcp_f32 v64, v64
v_rcp_f32 v66, v66
v_rcp_f32 v65, v65
v_rcp_f32 v67, v67
v_pk_mul_f32 v[36:37], v[36:37], v[64:65]
v_pk_mul_f32 v[38:39], v[38:39], v[66:67]
v_pk_mul_f32 v[64:65], v[40:41], v[40:41]
v_pk_mul_f32 v[66:67], v[42:43], v[42:43]
v_pk_fma_f32 v[64:65], v[64:65], v[74:75], v[72:73]
v_pk_fma_f32 v[66:67], v[66:67], v[74:75], v[72:73]
v_pk_mul_f32 v[64:65], v[64:65], v[40:41]
v_pk_mul_f32 v[66:67], v[66:67], v[42:43]
v_exp_f32 v64, v64
v_exp_f32 v66, v66
v_exp_f32 v65, v65
v_exp_f32 v67, v67
v_pk_add_f32 v[64:65], v[64:65], v[76:77]
v_pk_add_f32 v[66:67], v[66:67], v[76:77]
v_rcp_f32 v64, v64
v_rcp_f32 v66, v66
v_rcp_f32 v65, v65
v_rcp_f32 v67, v67
v_pk_mul_f32 v[40:41], v[40:41], v[64:65]
v_pk_mul_f32 v[42:43], v[42:43], v[66:67]
v_pk_mul_f32 v[64:65], v[44:45], v[44:45]
v_pk_mul_f32 v[66:67], v[46:47], v[46:47]
v_pk_fma_f32 v[64:65], v[64:65], v[74:75], v[72:73]
v_pk_fma_f32 v[66:67], v[66:67], v[74:75], v[72:73]
v_pk_mul_f32 v[64:65], v[64:65], v[44:45]
v_pk_mul_f32 v[66:67], v[66:67], v[46:47]
v_exp_f32 v64, v64
v_exp_f32 v66, v66
v_exp_f32 v65, v65
v_exp_f32 v67, v67
v_pk_add_f32 v[64:65], v[64:65], v[76:77]
v_pk_add_f32 v[66:67], v[66:67], v[76:77]
v_rcp_f32 v64, v64
v_rcp_f32 v66, v66
v_rcp_f32 v65, v65
v_rcp_f32 v67, v67
v_pk_mul_f32 v[44:45], v[44:45], v[64:65]
v_pk_mul_f32 v[46:47], v[46:47], v[66:67]
v_cvt_pk_bf16_f32 v48, v32, v33
v_cvt_pk_bf16_f32 v49, v34, v35
v_cvt_pk_bf16_f32 v50, v36, v37
v_cvt_pk_bf16_f32 v51, v38, v39
v_cvt_pk_bf16_f32 v52, v40, v41
v_cvt_pk_bf16_f32 v53, v42, v43
v_cvt_pk_bf16_f32 v54, v44, v45
v_cvt_pk_bf16_f32 v55, v46, v47
v_permlane32_swap_b32 v48, v50
v_permlane32_swap_b32 v49, v51
v_permlane32_swap_b32 v52, v54
v_permlane32_swap_b32 v53, v55
ds_write_b128 v3, v[48:51] offset:0
ds_write_b128 v3, v[52:55] offset:32
v_accvgpr_read_b32 v32, a16
v_accvgpr_read_b32 v33, a17
v_accvgpr_read_b32 v34, a18
v_accvgpr_read_b32 v35, a19
v_accvgpr_read_b32 v36, a20
v_accvgpr_read_b32 v37, a21
v_accvgpr_read_b32 v38, a22
v_accvgpr_read_b32 v39, a23
v_accvgpr_read_b32 v40, a24
v_accvgpr_read_b32 v41, a25
v_accvgpr_read_b32 v42, a26
v_accvgpr_read_b32 v43, a27
v_accvgpr_read_b32 v44, a28
v_accvgpr_read_b32 v45, a29
v_accvgpr_read_b32 v46, a30
v_accvgpr_read_b32 v47, a31
v_pk_mul_f32 v[64:65], v[32:33], v[32:33]
v_pk_mul_f32 v[66:67], v[34:35], v[34:35]
v_pk_fma_f32 v[64:65], v[64:65], v[74:75], v[72:73]
v_pk_fma_f32 v[66:67], v[66:67], v[74:75], v[72:73]
v_pk_mul_f32 v[64:65], v[64:65], v[32:33]
v_pk_mul_f32 v[66:67], v[66:67], v[34:35]
v_exp_f32 v64, v64
v_exp_f32 v66, v66
v_exp_f32 v65, v65
v_exp_f32 v67, v67
v_pk_add_f32 v[64:65], v[64:65], v[76:77]
v_pk_add_f32 v[66:67], v[66:67], v[76:77]
v_rcp_f32 v64, v64
v_rcp_f32 v66, v66
v_rcp_f32 v65, v65
v_rcp_f32 v67, v67
v_pk_mul_f32 v[32:33], v[32:33], v[64:65]
v_pk_mul_f32 v[34:35], v[34:35], v[66:67]
v_pk_mul_f32 v[64:65], v[36:37], v[36:37]
v_pk_mul_f32 v[66:67], v[38:39], v[38:39]
v_pk_fma_f32 v[64:65], v[64:65], v[74:75], v[72:73]
v_pk_fma_f32 v[66:67], v[66:67], v[74:75], v[72:73]
v_pk_mul_f32 v[64:65], v[64:65], v[36:37]
v_pk_mul_f32 v[66:67], v[66:67], v[38:39]
v_exp_f32 v64, v64
v_exp_f32 v66, v66
v_exp_f32 v65, v65
v_exp_f32 v67, v67
v_pk_add_f32 v[64:65], v[64:65], v[76:77]
v_pk_add_f32 v[66:67], v[66:67], v[76:77]
v_rcp_f32 v64, v64
v_rcp_f32 v66, v66
v_rcp_f32 v65, v65
v_rcp_f32 v67, v67
v_pk_mul_f32 v[36:37], v[36:37], v[64:65]
v_pk_mul_f32 v[38:39], v[38:39], v[66:67]
v_pk_mul_f32 v[64:65], v[40:41], v[40:41]
v_pk_mul_f32 v[66:67], v[42:43], v[42:43]
v_pk_fma_f32 v[64:65], v[64:65], v[74:75], v[72:73]
v_pk_fma_f32 v[66:67], v[66:67], v[74:75], v[72:73]
v_pk_mul_f32 v[64:65], v[64:65], v[40:41]
v_pk_mul_f32 v[66:67], v[66:67], v[42:43]
v_exp_f32 v64, v64
v_exp_f32 v66, v66
v_exp_f32 v65, v65
v_exp_f32 v67, v67
v_pk_add_f32 v[64:65], v[64:65], v[76:77]
v_pk_add_f32 v[66:67], v[66:67], v[76:77]
v_rcp_f32 v64, v64
v_rcp_f32 v66, v66
v_rcp_f32 v65, v65
v_rcp_f32 v67, v67
v_pk_mul_f32 v[40:41], v[40:41], v[64:65]
v_pk_mul_f32 v[42:43], v[42:43], v[66:67]
v_pk_mul_f32 v[64:65], v[44:45], v[44:45]
v_pk_mul_f32 v[66:67], v[46:47], v[46:47]
v_pk_fma_f32 v[64:65], v[64:65], v[74:75], v[72:73]
v_pk_fma_f32 v[66:67], v[66:67], v[74:75], v[72:73]
v_pk_mul_f32 v[64:65], v[64:65], v[44:45]
v_pk_mul_f32 v[66:67], v[66:67], v[46:47]
v_exp_f32 v64, v64
v_exp_f32 v66, v66
v_exp_f32 v65, v65
v_exp_f32 v67, v67
v_pk_add_f32 v[64:65], v[64:65], v[76:77]
v_pk_add_f32 v[66:67], v[66:67], v[76:77]
v_rcp_f32 v64, v64
v_rcp_f32 v66, v66
v_rcp_f32 v65, v65
v_rcp_f32 v67, v67
v_pk_mul_f32 v[44:45], v[44:45], v[64:65]
v_pk_mul_f32 v[46:47], v[46:47], v[66:67]
v_cvt_pk_bf16_f32 v56, v32, v33
v_cvt_pk_bf16_f32 v57, v34, v35
v_cvt_pk_bf16_f32 v58, v36, v37
v_cvt_pk_bf16_f32 v59, v38, v39
v_cvt_pk_bf16_f32 v60, v40, v41
v_cvt_pk_bf16_f32 v61, v42, v43
v_cvt_pk_bf16_f32 v62, v44, v45
v_cvt_pk_bf16_f32 v63, v46, v47
v_permlane32_swap_b32 v56, v58
v_permlane32_swap_b32 v57, v59
v_permlane32_swap_b32 v60, v62
v_permlane32_swap_b32 v61, v63
ds_write_b128 v3, v[56:59] offset:64
ds_write_b128 v3, v[60:63] offset:96
v_accvgpr_read_b32 v32, a32
v_accvgpr_read_b32 v33, a33
v_accvgpr_read_b32 v34, a34
v_accvgpr_read_b32 v35, a35
v_accvgpr_read_b32 v36, a36
v_accvgpr_read_b32 v37, a37
v_accvgpr_read_b32 v38, a38
v_accvgpr_read_b32 v39, a39
v_accvgpr_read_b32 v40, a40
v_accvgpr_read_b32 v41, a41
v_accvgpr_read_b32 v42, a42
v_accvgpr_read_b32 v43, a43
v_accvgpr_read_b32 v44, a44
v_accvgpr_read_b32 v45, a45
v_accvgpr_read_b32 v46, a46
v_accvgpr_read_b32 v47, a47
v_pk_mul_f32 v[64:65], v[32:33], v[32:33]
v_pk_mul_f32 v[66:67], v[34:35], v[34:35]
v_pk_fma_f32 v[64:65], v[64:65], v[74:75], v[72:73]
v_pk_fma_f32 v[66:67], v[66:67], v[74:75], v[72:73]
v_pk_mul_f32 v[64:65], v[64:65], v[32:33]
v_pk_mul_f32 v[66:67], v[66:67], v[34:35]
v_exp_f32 v64, v64
v_exp_f32 v66, v66
v_exp_f32 v65, v65
v_exp_f32 v67, v67
v_pk_add_f32 v[64:65], v[64:65], v[76:77]
v_pk_add_f32 v[66:67], v[66:67], v[76:77]
v_rcp_f32 v64, v64
v_rcp_f32 v66, v66
v_rcp_f32 v65, v65
v_rcp_f32 v67, v67
v_pk_mul_f32 v[32:33], v[32:33], v[64:65]
v_pk_mul_f32 v[34:35], v[34:35], v[66:67]
v_pk_mul_f32 v[64:65], v[36:37], v[36:37]
v_pk_mul_f32 v[66:67], v[38:39], v[38:39]
v_pk_fma_f32 v[64:65], v[64:65], v[74:75], v[72:73]
v_pk_fma_f32 v[66:67], v[66:67], v[74:75], v[72:73]
v_pk_mul_f32 v[64:65], v[64:65], v[36:37]
v_pk_mul_f32 v[66:67], v[66:67], v[38:39]
v_exp_f32 v64, v64
v_exp_f32 v66, v66
v_exp_f32 v65, v65
v_exp_f32 v67, v67
v_pk_add_f32 v[64:65], v[64:65], v[76:77]
v_pk_add_f32 v[66:67], v[66:67], v[76:77]
v_rcp_f32 v64, v64
v_rcp_f32 v66, v66
v_rcp_f32 v65, v65
v_rcp_f32 v67, v67
v_pk_mul_f32 v[36:37], v[36:37], v[64:65]
v_pk_mul_f32 v[38:39], v[38:39], v[66:67]
v_pk_mul_f32 v[64:65], v[40:41], v[40:41]
v_pk_mul_f32 v[66:67], v[42:43], v[42:43]
v_pk_fma_f32 v[64:65], v[64:65], v[74:75], v[72:73]
v_pk_fma_f32 v[66:67], v[66:67], v[74:75], v[72:73]
v_pk_mul_f32 v[64:65], v[64:65], v[40:41]
v_pk_mul_f32 v[66:67], v[66:67], v[42:43]
v_exp_f32 v64, v64
v_exp_f32 v66, v66
v_exp_f32 v65, v65
v_exp_f32 v67, v67
v_pk_add_f32 v[64:65], v[64:65], v[76:77]
v_pk_add_f32 v[66:67], v[66:67], v[76:77]
v_rcp_f32 v64, v64
v_rcp_f32 v66, v66
v_rcp_f32 v65, v65
v_rcp_f32 v67, v67
v_pk_mul_f32 v[40:41], v[40:41], v[64:65]
v_pk_mul_f32 v[42:43], v[42:43], v[66:67]
v_pk_mul_f32 v[64:65], v[44:45], v[44:45]
v_pk_mul_f32 v[66:67], v[46:47], v[46:47]
v_pk_fma_f32 v[64:65], v[64:65], v[74:75], v[72:73]
v_pk_fma_f32 v[66:67], v[66:67], v[74:75], v[72:73]
v_pk_mul_f32 v[64:65], v[64:65], v[44:45]
v_pk_mul_f32 v[66:67], v[66:67], v[46:47]
v_exp_f32 v64, v64
v_exp_f32 v66, v66
v_exp_f32 v65, v65
v_exp_f32 v67, v67
v_pk_add_f32 v[64:65], v[64:65], v[76:77]
v_pk_add_f32 v[66:67], v[66:67], v[76:77]
v_rcp_f32 v64, v64
v_rcp_f32 v66, v66
v_rcp_f32 v65, v65
v_rcp_f32 v67, v67
v_pk_mul_f32 v[44:45], v[44:45], v[64:65]
v_pk_mul_f32 v[46:47], v[46:47], v[66:67]
v_cvt_pk_bf16_f32 v48, v32, v33
v_cvt_pk_bf16_f32 v49, v34, v35
v_cvt_pk_bf16_f32 v50, v36, v37
v_cvt_pk_bf16_f32 v51, v38, v39
v_cvt_pk_bf16_f32 v52, v40, v41
v_cvt_pk_bf16_f32 v53, v42, v43
v_cvt_pk_bf16_f32 v54, v44, v45
v_cvt_pk_bf16_f32 v55, v46, v47
v_permlane32_swap_b32 v48, v50
v_permlane32_swap_b32 v49, v51
v_permlane32_swap_b32 v52, v54
v_permlane32_swap_b32 v53, v55
ds_write_b128 v3, v[48:51] offset:16896
ds_write_b128 v3, v[52:55] offset:16928
v_accvgpr_read_b32 v32, a48
v_accvgpr_read_b32 v33, a49
v_accvgpr_read_b32 v34, a50
v_accvgpr_read_b32 v35, a51
v_accvgpr_read_b32 v36, a52
v_accvgpr_read_b32 v37, a53
v_accvgpr_read_b32 v38, a54
v_accvgpr_read_b32 v39, a55
v_accvgpr_read_b32 v40, a56
v_accvgpr_read_b32 v41, a57
v_accvgpr_read_b32 v42, a58
v_accvgpr_read_b32 v43, a59
v_accvgpr_read_b32 v44, a60
v_accvgpr_read_b32 v45, a61
v_accvgpr_read_b32 v46, a62
v_accvgpr_read_b32 v47, a63
v_pk_mul_f32 v[64:65], v[32:33], v[32:33]
v_pk_mul_f32 v[66:67], v[34:35], v[34:35]
v_pk_fma_f32 v[64:65], v[64:65], v[74:75], v[72:73]
v_pk_fma_f32 v[66:67], v[66:67], v[74:75], v[72:73]
v_pk_mul_f32 v[64:65], v[64:65], v[32:33]
v_pk_mul_f32 v[66:67], v[66:67], v[34:35]
v_exp_f32 v64, v64
v_exp_f32 v66, v66
v_exp_f32 v65, v65
v_exp_f32 v67, v67
v_pk_add_f32 v[64:65], v[64:65], v[76:77]
v_pk_add_f32 v[66:67], v[66:67], v[76:77]
v_rcp_f32 v64, v64
v_rcp_f32 v66, v66
v_rcp_f32 v65, v65
v_rcp_f32 v67, v67
v_pk_mul_f32 v[32:33], v[32:33], v[64:65]
v_pk_mul_f32 v[34:35], v[34:35], v[66:67]
v_pk_mul_f32 v[64:65], v[36:37], v[36:37]
v_pk_mul_f32 v[66:67], v[38:39], v[38:39]
v_pk_fma_f32 v[64:65], v[64:65], v[74:75], v[72:73]
v_pk_fma_f32 v[66:67], v[66:67], v[74:75], v[72:73]
v_pk_mul_f32 v[64:65], v[64:65], v[36:37]
v_pk_mul_f32 v[66:67], v[66:67], v[38:39]
v_exp_f32 v64, v64
v_exp_f32 v66, v66
v_exp_f32 v65, v65
v_exp_f32 v67, v67
v_pk_add_f32 v[64:65], v[64:65], v[76:77]
v_pk_add_f32 v[66:67], v[66:67], v[76:77]
v_rcp_f32 v64, v64
v_rcp_f32 v66, v66
v_rcp_f32 v65, v65
v_rcp_f32 v67, v67
v_pk_mul_f32 v[36:37], v[36:37], v[64:65]
v_pk_mul_f32 v[38:39], v[38:39], v[66:67]
v_pk_mul_f32 v[64:65], v[40:41], v[40:41]
v_pk_mul_f32 v[66:67], v[42:43], v[42:43]
v_pk_fma_f32 v[64:65], v[64:65], v[74:75], v[72:73]
v_pk_fma_f32 v[66:67], v[66:67], v[74:75], v[72:73]
v_pk_mul_f32 v[64:65], v[64:65], v[40:41]
v_pk_mul_f32 v[66:67], v[66:67], v[42:43]
v_exp_f32 v64, v64
v_exp_f32 v66, v66
v_exp_f32 v65, v65
v_exp_f32 v67, v67
v_pk_add_f32 v[64:65], v[64:65], v[76:77]
v_pk_add_f32 v[66:67], v[66:67], v[76:77]
v_rcp_f32 v64, v64
v_rcp_f32 v66, v66
v_rcp_f32 v65, v65
v_rcp_f32 v67, v67
v_pk_mul_f32 v[40:41], v[40:41], v[64:65]
v_pk_mul_f32 v[42:43], v[42:43], v[66:67]
v_pk_mul_f32 v[64:65], v[44:45], v[44:45]
v_pk_mul_f32 v[66:67], v[46:47], v[46:47]
v_pk_fma_f32 v[64:65], v[64:65], v[74:75], v[72:73]
v_pk_fma_f32 v[66:67], v[66:67], v[74:75], v[72:73]
v_pk_mul_f32 v[64:65], v[64:65], v[44:45]
v_pk_mul_f32 v[66:67], v[66:67], v[46:47]
v_exp_f32 v64, v64
v_exp_f32 v66, v66
v_exp_f32 v65, v65
v_exp_f32 v67, v67
v_pk_add_f32 v[64:65], v[64:65], v[76:77]
v_pk_add_f32 v[66:67], v[66:67], v[76:77]
v_rcp_f32 v64, v64
v_rcp_f32 v66, v66
v_rcp_f32 v65, v65
v_rcp_f32 v67, v67
v_pk_mul_f32 v[44:45], v[44:45], v[64:65]
v_pk_mul_f32 v[46:47], v[46:47], v[66:67]
v_cvt_pk_bf16_f32 v56, v32, v33
v_cvt_pk_bf16_f32 v57, v34, v35
v_cvt_pk_bf16_f32 v58, v36, v37
v_cvt_pk_bf16_f32 v59, v38, v39
v_cvt_pk_bf16_f32 v60, v40, v41
v_cvt_pk_bf16_f32 v61, v42, v43
v_cvt_pk_bf16_f32 v62, v44, v45
v_cvt_pk_bf16_f32 v63, v46, v47
v_permlane32_swap_b32 v56, v58
v_permlane32_swap_b32 v57, v59
v_permlane32_swap_b32 v60, v62
v_permlane32_swap_b32 v61, v63
ds_write_b128 v3, v[56:59] offset:16960
ds_write_b128 v3, v[60:63] offset:16992
s_waitcnt lgkmcnt(0)
s_barrier
RB 32,6,0
RB 36,6,1056
RB 40,6,2112
RB 44,6,3168
RB 48,6,4224
RB 52,6,5280
RB 56,6,6336
RB 60,6,7392
s_waitcnt lgkmcnt(7)
s_add_u32 s24, s33, 0
buffer_store_dwordx4 v[32:35], v12, s[4:7], s24 offen sc1
s_waitcnt lgkmcnt(6)
s_add_u32 s24, s33, 14336
buffer_store_dwordx4 v[36:39], v12, s[4:7], s24 offen sc1
s_waitcnt lgkmcnt(5)
s_add_u32 s24, s33, 28672
buffer_store_dwordx4 v[40:43], v12, s[4:7], s24 offen sc1
s_waitcnt lgkmcnt(4)
s_add_u32 s24, s33, 43008
buffer_store_dwordx4 v[44:47], v12, s[4:7], s24 offen sc1
s_waitcnt lgkmcnt(3)
s_add_u32 s24, s33, 57344
buffer_store_dwordx4 v[48:51], v12, s[4:7], s24 offen sc1
s_waitcnt lgkmcnt(2)
s_add_u32 s24, s33, 71680
buffer_store_dwordx4 v[52:55], v12, s[4:7], s24 offen sc1
s_waitcnt lgkmcnt(1)
s_add_u32 s24, s33, 86016
buffer_store_dwordx4 v[56:59], v12, s[4:7], s24 offen sc1
s_waitcnt lgkmcnt(0)
s_add_u32 s24, s33, 100352
buffer_store_dwordx4 v[60:63], v12, s[4:7], s24 offen sc1
s_lshl_b32 s76, s77, 3
s_add_u32 s76, s76, s60
s_lshl_b32 s76, s76, 7
s_add_u32 s76, s76, 163840
s_waitcnt vmcnt(0)
s_barrier
s_cmp_lg_u32 s16, 0
s_cbranch_scc1 sig_156
v_mov_b32 v1, s76
v_mov_b32 v2, 4
s_mov_b64 exec, 1
buffer_atomic_add v2, v1, s[4:7], 0 offen
s_mov_b64 exec, -1
sig_156:
s_branch mega_kernel_wloop
mega_kernel_t9:
s_lshr_b32 s17, s16, 2
s_and_b32 s18, s16, 3
v_lshrrev_b32 v1, 3, v0
s_mov_b32 s24, 7168
v_mul_lo_u32 v1, v1, s24
v_lshrrev_b32 v2, 4, v0
v_and_b32 v3, 7, v0
s_mov_b32 s25, 0
s_xor_b32 s26, s25, 0
v_add_u32 v4, s26, v2
v_xor_b32 v4, v4, v3
v_lshl_add_u32 v8, v4, 4, v1
s_xor_b32 s26, s25, 4
v_add_u32 v4, s26, v2
v_xor_b32 v4, v4, v3
v_lshl_add_u32 v9, v4, 4, v1
v_lshrrev_b32 v1, 5, v0
v_and_b32 v3, 31, v0
s_mov_b32 s24, 2048
v_mul_lo_u32 v2, v1, s24
v_add_u32 v4, 0, v1
v_and_b32 v4, 3, v4
v_lshlrev_b32 v4, 2, v4
v_xor_b32 v4, v4, v3
v_lshl_add_u32 v10, v4, 4, v2
v_add_u32 v4, 2, v1
v_and_b32 v4, 3, v4
v_lshlrev_b32 v4, 2, v4
v_xor_b32 v4, v4, v3
v_lshl_add_u32 v11, v4, 4, v2
v_and_b32 v1, 31, v0
v_lshrrev_b32 v2, 5, v0
v_bfe_u32 v3, v1, 1, 3
s_mul_i32 s24, s17, 8192
v_lshlrev_b32 v4, 7, v1
v_add_u32 v4, s24, v4
v_add_u32 v5, 0, v2
v_xor_b32 v5, v5, v3
v_lshl_add_u32 v13, v5, 4, v4
v_add_u32 v5, 2, v2
v_xor_b32 v5, v5, v3
v_lshl_add_u32 v14, v5, 4, v4
v_add_u32 v5, 4, v2
v_xor_b32 v5, v5, v3
v_lshl_add_u32 v15, v5, 4, v4
v_add_u32 v5, 6, v2
v_xor_b32 v5, v5, v3
v_lshl_add_u32 v16, v5, 4, v4
v_and_b32 v1, 15, v0
v_lshrrev_b32 v2, 2, v1
v_lshrrev_b32 v3, 5, v0
v_lshl_add_u32 v3, v3, 3, v2
v_mul_u32_u24 v3, 512, v3
v_and_b32 v4, 3, v1
v_lshl_add_u32 v3, v4, 3, v3
v_bfe_u32 v4, v0, 4, 1
v_lshl_add_u32 v3, v4, 5, v3
v_add_u32 v3, 16384, v3
s_mul_i32 s24, s18, 2
s_add_u32 s24, s24, 0
v_xor_b32 v4, s24, v2
v_lshl_add_u32 v17, v4, 6, v3
s_mul_i32 s24, s18, 2
s_add_u32 s24, s24, 1
v_xor_b32 v4, s24, v2
v_lshl_add_u32 v18, v4, 6, v3
v_add_u32 v19, 49152, v13
v_add_u32 v20, 49152, v14
v_add_u32 v21, 49152, v15
v_add_u32 v22, 49152, v16
v_add_u32 v23, 49152, v17
v_add_u32 v24, 49152, v18
v_add_u32 v25, 98304, v13
v_add_u32 v26, 98304, v14
v_add_u32 v27, 98304, v15
v_add_u32 v28, 98304, v16
v_add_u32 v29, 98304, v17
v_add_u32 v30, 98304, v18
s_mul_i32 s22, s16, 2048
s_mul_i32 s23, s16, 4096
s_add_u32 s23, s23, 16384
s_mov_b32 s8, s86
s_and_b32 s9, s87, 0xffff
s_mov_b32 s10, 0x700000
s_mov_b32 s11, 0x00020000
s_lshl_b32 s28, s77, 7
s_lshl_b32 s52, s77, 6
s_add_u32 s52, s52, 960
s_cmp_ge_u32 s77, 15
s_cselect_b32 s28, s52, s28
s_and_b32 s29, s79, 3
s_lshl_b32 s29, s29, 8
s_mul_i32 s24, s16, 16
s_add_u32 s24, s24, s28
s_mul_i32 s19, s24, 7168
s_add_u32 s19, s19, 106962944
s_mul_i32 s20, s16, 16384
s_lshl_b32 s24, s29, 1
s_add_u32 s20, s20, s24
s_lshr_b32 s25, s79, 2
s_mul_i32 s24, s25, 1792
s_add_u32 s19, s19, s24
s_lshr_b32 s25, s79, 2
s_mul_i32 s24, s25, 1835008
s_add_u32 s20, s20, s24
s_mul_i32 s24, s28, 4096
s_mul_i32 s25, s29, 4
s_add_u32 s24, s24, s25
s_lshr_b32 s25, s79, 2
s_mul_i32 s25, s25, 8388608
s_add_u32 s33, s24, s25
s_add_u32 s33, s33, 155197440
s_mov_b32 s34, 0
s_mov_b32 s35, 0
s_lshl_b32 s76, s77, 10
s_add_u32 s76, s76, 163840
s_cmp_lg_u32 s16, 0
s_cbranch_scc1 ws_157
v_lshlrev_b32 v1, 7, v0
v_add_u32 v1, s76, v1
s_mov_b64 exec, 0xff
wsp_158:
s_add_u32 s63, s63, 1
s_cmp_gt_u32 s63, 262144
s_cbranch_scc0 go_160
s_endpgm
go_160:
buffer_load_dword v3, v1, s[4:7], 0 offen sc1
s_waitcnt vmcnt(0)
s_mov_b32 s26, 0
v_readlane_b32 s27, v3, 0
s_nop 0
s_add_u32 s26, s26, s27
v_readlane_b32 s27, v3, 1
s_nop 0
s_add_u32 s26, s26, s27
v_readlane_b32 s27, v3, 2
s_nop 0
s_add_u32 s26, s26, s27
v_readlane_b32 s27, v3, 3
s_nop 0
s_add_u32 s26, s26, s27
v_readlane_b32 s27, v3, 4
s_nop 0
s_add_u32 s26, s26, s27
v_readlane_b32 s27, v3, 5
s_nop 0
s_add_u32 s26, s26, s27
v_readlane_b32 s27, v3, 6
s_nop 0
s_add_u32 s26, s26, s27
v_readlane_b32 s27, v3, 7
s_nop 0
s_add_u32 s26, s26, s27
s_sub_i32 s26, 56, s26
s_cmp_lt_i32 s26, 1
s_cbranch_scc1 wsd_159
s_cmp_lt_u32 s77, 13
s_cbranch_scc1 urg_161
s_sleep 2
s_branch wsp_158
urg_161:
s_cmp_lt_i32 s26, 3
s_cbranch_scc1 lv_162
s_sleep 40
s_branch wsp_158
lv_162:
s_cmp_lt_i32 s26, 1
s_cbranch_scc1 lv_163
s_sleep 12
s_branch wsp_158
lv_163:
s_sleep 8
s_branch wsp_158
wsd_159:
s_mov_b64 exec, -1
ws_157:
s_barrier
s_add_u32 m0, s22, 0
s_add_u32 s24, s19, 0
buffer_load_dwordx4 v8, s[4:7], s24 offen sc1 lds
s_add_u32 m0, s22, 1024
s_add_u32 s24, s19, 57344
buffer_load_dwordx4 v9, s[4:7], s24 offen sc1 lds
s_add_u32 m0, s23, 0
s_add_u32 s25, s20, 0
buffer_load_dwordx4 v10, s[8:11], s25 offen lds
s_add_u32 m0, s23, 1024
s_add_u32 s25, s20, 4096
buffer_load_dwordx4 v11, s[8:11], s25 offen lds
s_add_u32 m0, s23, 2048
s_add_u32 s25, s20, 8192
buffer_load_dwordx4 v10, s[8:11], s25 offen lds
s_add_u32 m0, s23, 3072
s_add_u32 s25, s20, 12288
buffer_load_dwordx4 v11, s[8:11], s25 offen lds
s_add_u32 m0, s22, 49152
s_add_u32 s24, s19, 128
buffer_load_dwordx4 v8, s[4:7], s24 offen sc1 lds
s_add_u32 m0, s22, 50176
s_add_u32 s24, s19, 57472
buffer_load_dwordx4 v9, s[4:7], s24 offen sc1 lds
s_add_u32 m0, s23, 49152
s_add_u32 s25, s20, 131072
buffer_load_dwordx4 v10, s[8:11], s25 offen lds
s_add_u32 m0, s23, 50176
s_add_u32 s25, s20, 135168
buffer_load_dwordx4 v11, s[8:11], s25 offen lds
s_add_u32 m0, s23, 51200
s_add_u32 s25, s20, 139264
buffer_load_dwordx4 v10, s[8:11], s25 offen lds
s_add_u32 m0, s23, 52224
s_add_u32 s25, s20, 143360
buffer_load_dwordx4 v11, s[8:11], s25 offen lds
v_accvgpr_write_b32 a0, 0
v_accvgpr_write_b32 a1, 0
v_accvgpr_write_b32 a2, 0
v_accvgpr_write_b32 a3, 0
v_accvgpr_write_b32 a4, 0
v_accvgpr_write_b32 a5, 0
v_accvgpr_write_b32 a6, 0
v_accvgpr_write_b32 a7, 0
v_accvgpr_write_b32 a8, 0
v_accvgpr_write_b32 a9, 0
v_accvgpr_write_b32 a10, 0
v_accvgpr_write_b32 a11, 0
v_accvgpr_write_b32 a12, 0
v_accvgpr_write_b32 a13, 0
v_accvgpr_write_b32 a14, 0
v_accvgpr_write_b32 a15, 0
v_accvgpr_write_b32 a16, 0
v_accvgpr_write_b32 a17, 0
v_accvgpr_write_b32 a18, 0
v_accvgpr_write_b32 a19, 0
v_accvgpr_write_b32 a20, 0
v_accvgpr_write_b32 a21, 0
v_accvgpr_write_b32 a22, 0
v_accvgpr_write_b32 a23, 0
v_accvgpr_write_b32 a24, 0
v_accvgpr_write_b32 a25, 0
v_accvgpr_write_b32 a26, 0
v_accvgpr_write_b32 a27, 0
v_accvgpr_write_b32 a28, 0
v_accvgpr_write_b32 a29, 0
v_accvgpr_write_b32 a30, 0
v_accvgpr_write_b32 a31, 0
v_accvgpr_write_b32 a32, 0
v_accvgpr_write_b32 a33, 0
v_accvgpr_write_b32 a34, 0
v_accvgpr_write_b32 a35, 0
v_accvgpr_write_b32 a36, 0
v_accvgpr_write_b32 a37, 0
v_accvgpr_write_b32 a38, 0
v_accvgpr_write_b32 a39, 0
v_accvgpr_write_b32 a40, 0
v_accvgpr_write_b32 a41, 0
v_accvgpr_write_b32 a42, 0
v_accvgpr_write_b32 a43, 0
v_accvgpr_write_b32 a44, 0
v_accvgpr_write_b32 a45, 0
v_accvgpr_write_b32 a46, 0
v_accvgpr_write_b32 a47, 0
v_accvgpr_write_b32 a48, 0
v_accvgpr_write_b32 a49, 0
v_accvgpr_write_b32 a50, 0
v_accvgpr_write_b32 a51, 0
v_accvgpr_write_b32 a52, 0
v_accvgpr_write_b32 a53, 0
v_accvgpr_write_b32 a54, 0
v_accvgpr_write_b32 a55, 0
v_accvgpr_write_b32 a56, 0
v_accvgpr_write_b32 a57, 0
v_accvgpr_write_b32 a58, 0
v_accvgpr_write_b32 a59, 0
v_accvgpr_write_b32 a60, 0
v_accvgpr_write_b32 a61, 0
v_accvgpr_write_b32 a62, 0
v_accvgpr_write_b32 a63, 0
s_waitcnt vmcnt(6)
s_barrier
RB 32,13,0
RB 36,13,4096
RT 40,17,0
RT 42,17,2048
RT 44,18,0
RT 46,18,2048
RB 48,14,0
RB 52,14,4096
RT 56,17,8192
RT 58,17,10240
RT 60,18,8192
RT 62,18,10240
RB 64,15,0
RB 68,15,4096
RT 72,17,16384
RT 74,17,18432
RT 76,18,16384
RT 78,18,18432
s_waitcnt lgkmcnt(12)
MM 0,40,32
RB 80,16,0
RB 84,16,4096
RT 88,17,24576
MM 16,44,32
RT 90,17,26624
RT 92,18,24576
RT 94,18,26624
MM 32,40,36
s_add_u32 m0, s22, 98304
s_add_u32 s24, s19, 256
buffer_load_dwordx4 v8, s[4:7], s24 offen sc1 lds
s_add_u32 m0, s22, 99328
s_add_u32 s24, s19, 57600
buffer_load_dwordx4 v9, s[4:7], s24 offen sc1 lds
s_add_u32 m0, s23, 98304
s_add_u32 s25, s20, 262144
buffer_load_dwordx4 v10, s[8:11], s25 offen lds
MM 48,44,36
s_add_u32 m0, s23, 99328
s_add_u32 s25, s20, 266240
buffer_load_dwordx4 v11, s[8:11], s25 offen lds
s_add_u32 m0, s23, 100352
s_add_u32 s25, s20, 270336
buffer_load_dwordx4 v10, s[8:11], s25 offen lds
s_add_u32 m0, s23, 101376
s_add_u32 s25, s20, 274432
buffer_load_dwordx4 v11, s[8:11], s25 offen lds
s_waitcnt lgkmcnt(0) vmcnt(6)
s_barrier
MM 0,56,48
RB 32,19,0
RB 36,19,4096
MM 16,60,48
RT 40,23,0
RT 42,23,2048
MM 32,56,52
RT 44,24,0
RT 46,24,2048
MM 48,60,52
s_add_u32 m0, s22, 0
s_add_u32 s24, s19, 384
buffer_load_dwordx4 v8, s[4:7], s24 offen sc1 lds
s_waitcnt lgkmcnt(12)
MM 0,72,64
RB 48,20,0
RB 52,20,4096
MM 16,76,64
RT 56,23,8192
RT 58,23,10240
MM 32,72,68
RT 60,24,8192
RT 62,24,10240
MM 48,76,68
s_add_u32 m0, s22, 1024
s_add_u32 s24, s19, 57728
buffer_load_dwordx4 v9, s[4:7], s24 offen sc1 lds
s_add_u32 m0, s23, 0
s_add_u32 s25, s20, 393216
buffer_load_dwordx4 v10, s[8:11], s25 offen lds
s_waitcnt lgkmcnt(12)
MM 0,88,80
RB 64,21,0
RB 68,21,4096
MM 16,92,80
RT 72,23,16384
RT 74,23,18432
MM 32,88,84
RT 76,24,16384
RT 78,24,18432
MM 48,92,84
s_add_u32 m0, s23, 1024
s_add_u32 s25, s20, 397312
buffer_load_dwordx4 v11, s[8:11], s25 offen lds
s_waitcnt lgkmcnt(12)
MM 0,40,32
RB 80,22,0
RB 84,22,4096
MM 16,44,32
RT 88,23,24576
RT 90,23,26624
MM 32,40,36
RT 92,24,24576
RT 94,24,26624
MM 48,44,36
s_add_u32 m0, s23, 2048
s_add_u32 s25, s20, 401408
buffer_load_dwordx4 v10, s[8:11], s25 offen lds
s_add_u32 m0, s23, 3072
s_add_u32 s25, s20, 405504
buffer_load_dwordx4 v11, s[8:11], s25 offen lds
s_waitcnt lgkmcnt(0) vmcnt(6)
s_barrier
MM 0,56,48
RB 32,25,0
RB 36,25,4096
MM 16,60,48
RT 40,29,0
RT 42,29,2048
MM 32,56,52
RT 44,30,0
RT 46,30,2048
MM 48,60,52
s_add_u32 m0, s22, 49152
s_add_u32 s24, s19, 512
buffer_load_dwordx4 v8, s[4:7], s24 offen sc1 lds
s_waitcnt lgkmcnt(12)
MM 0,72,64
RB 48,26,0
RB 52,26,4096
MM 16,76,64
RT 56,29,8192
RT 58,29,10240
MM 32,72,68
RT 60,30,8192
RT 62,30,10240
MM 48,76,68
s_add_u32 m0, s22, 50176
s_add_u32 s24, s19, 57856
buffer_load_dwordx4 v9, s[4:7], s24 offen sc1 lds
s_add_u32 m0, s23, 49152
s_add_u32 s25, s20, 524288
buffer_load_dwordx4 v10, s[8:11], s25 offen lds
s_waitcnt lgkmcnt(12)
MM 0,88,80
RB 64,27,0
RB 68,27,4096
MM 16,92,80
RT 72,29,16384
RT 74,29,18432
MM 32,88,84
RT 76,30,16384
RT 78,30,18432
MM 48,92,84
s_add_u32 m0, s23, 50176
s_add_u32 s25, s20, 528384
buffer_load_dwordx4 v11, s[8:11], s25 offen lds
s_waitcnt lgkmcnt(12)
MM 0,40,32
RB 80,28,0
RB 84,28,4096
MM 16,44,32
RT 88,29,24576
RT 90,29,26624
MM 32,40,36
RT 92,30,24576
RT 94,30,26624
MM 48,44,36
s_add_u32 m0, s23, 51200
s_add_u32 s25, s20, 532480
buffer_load_dwordx4 v10, s[8:11], s25 offen lds
s_add_u32 m0, s23, 52224
s_add_u32 s25, s20, 536576
buffer_load_dwordx4 v11, s[8:11], s25 offen lds
s_waitcnt lgkmcnt(0) vmcnt(6)
s_barrier
MM 0,56,48
RB 32,13,0
RB 36,13,4096
MM 16,60,48
RT 40,17,0
RT 42,17,2048
MM 32,56,52
RT 44,18,0
RT 46,18,2048
MM 48,60,52
s_add_u32 m0, s22, 98304
s_add_u32 s24, s19, 640
buffer_load_dwordx4 v8, s[4:7], s24 offen sc1 lds
s_waitcnt lgkmcnt(12)
MM 0,72,64
RB 48,14,0
RB 52,14,4096
MM 16,76,64
RT 56,17,8192
RT 58,17,10240
MM 32,72,68
RT 60,18,8192
RT 62,18,10240
MM 48,76,68
s_add_u32 m0, s22, 99328
s_add_u32 s24, s19, 57984
buffer_load_dwordx4 v9, s[4:7], s24 offen sc1 lds
s_add_u32 m0, s23, 98304
s_add_u32 s25, s20, 655360
buffer_load_dwordx4 v10, s[8:11], s25 offen lds
s_waitcnt lgkmcnt(12)
MM 0,88,80
RB 64,15,0
RB 68,15,4096
MM 16,92,80
RT 72,17,16384
RT 74,17,18432
MM 32,88,84
RT 76,18,16384
RT 78,18,18432
MM 48,92,84
s_add_u32 m0, s23, 99328
s_add_u32 s25, s20, 659456
buffer_load_dwordx4 v11, s[8:11], s25 offen lds
s_waitcnt lgkmcnt(12)
MM 0,40,32
RB 80,16,0
RB 84,16,4096
MM 16,44,32
RT 88,17,24576
RT 90,17,26624
MM 32,40,36
RT 92,18,24576
RT 94,18,26624
MM 48,44,36
s_add_u32 m0, s23, 100352
s_add_u32 s25, s20, 663552
buffer_load_dwordx4 v10, s[8:11], s25 offen lds
s_add_u32 m0, s23, 101376
s_add_u32 s25, s20, 667648
buffer_load_dwordx4 v11, s[8:11], s25 offen lds
s_waitcnt lgkmcnt(0) vmcnt(6)
s_barrier
MM 0,56,48
RB 32,19,0
RB 36,19,4096
MM 16,60,48
RT 40,23,0
RT 42,23,2048
MM 32,56,52
RT 44,24,0
RT 46,24,2048
MM 48,60,52
s_add_u32 m0, s22, 0
s_add_u32 s24, s19, 768
buffer_load_dwordx4 v8, s[4:7], s24 offen sc1 lds
s_waitcnt lgkmcnt(12)
MM 0,72,64
RB 48,20,0
RB 52,20,4096
MM 16,76,64
RT 56,23,8192
RT 58,23,10240
MM 32,72,68
RT 60,24,8192
RT 62,24,10240
MM 48,76,68
s_add_u32 m0, s22, 1024
s_add_u32 s24, s19, 58112
buffer_load_dwordx4 v9, s[4:7], s24 offen sc1 lds
s_add_u32 m0, s23, 0
s_add_u32 s25, s20, 786432
buffer_load_dwordx4 v10, s[8:11], s25 offen lds
s_waitcnt lgkmcnt(12)
MM 0,88,80
RB 64,21,0
RB 68,21,4096
MM 16,92,80
RT 72,23,16384
RT 74,23,18432
MM 32,88,84
RT 76,24,16384
RT 78,24,18432
MM 48,92,84
s_add_u32 m0, s23, 1024
s_add_u32 s25, s20, 790528
buffer_load_dwordx4 v11, s[8:11], s25 offen lds
s_waitcnt lgkmcnt(12)
MM 0,40,32
RB 80,22,0
RB 84,22,4096
MM 16,44,32
RT 88,23,24576
RT 90,23,26624
MM 32,40,36
RT 92,24,24576
RT 94,24,26624
MM 48,44,36
s_add_u32 m0, s23, 2048
s_add_u32 s25, s20, 794624
buffer_load_dwordx4 v10, s[8:11], s25 offen lds
s_add_u32 m0, s23, 3072
s_add_u32 s25, s20, 798720
buffer_load_dwordx4 v11, s[8:11], s25 offen lds
s_waitcnt lgkmcnt(0) vmcnt(6)
s_barrier
MM 0,56,48
RB 32,25,0
RB 36,25,4096
MM 16,60,48
RT 40,29,0
RT 42,29,2048
MM 32,56,52
RT 44,30,0
RT 46,30,2048
MM 48,60,52
s_add_u32 m0, s22, 49152
s_add_u32 s24, s19, 896
buffer_load_dwordx4 v8, s[4:7], s24 offen sc1 lds
s_waitcnt lgkmcnt(12)
MM 0,72,64
RB 48,26,0
RB 52,26,4096
MM 16,76,64
RT 56,29,8192
RT 58,29,10240
MM 32,72,68
RT 60,30,8192
RT 62,30,10240
MM 48,76,68
s_add_u32 m0, s22, 50176
s_add_u32 s24, s19, 58240
buffer_load_dwordx4 v9, s[4:7], s24 offen sc1 lds
s_add_u32 m0, s23, 49152
s_add_u32 s25, s20, 917504
buffer_load_dwordx4 v10, s[8:11], s25 offen lds
s_waitcnt lgkmcnt(12)
MM 0,88,80
RB 64,27,0
RB 68,27,4096
MM 16,92,80
RT 72,29,16384
RT 74,29,18432
MM 32,88,84
RT 76,30,16384
RT 78,30,18432
MM 48,92,84
s_add_u32 m0, s23, 50176
s_add_u32 s25, s20, 921600
buffer_load_dwordx4 v11, s[8:11], s25 offen lds
s_waitcnt lgkmcnt(12)
MM 0,40,32
RB 80,28,0
RB 84,28,4096
MM 16,44,32
RT 88,29,24576
RT 90,29,26624
MM 32,40,36
RT 92,30,24576
RT 94,30,26624
MM 48,44,36
s_add_u32 m0, s23, 51200
s_add_u32 s25, s20, 925696
buffer_load_dwordx4 v10, s[8:11], s25 offen lds
s_add_u32 m0, s23, 52224
s_add_u32 s25, s20, 929792
buffer_load_dwordx4 v11, s[8:11], s25 offen lds
s_waitcnt lgkmcnt(0) vmcnt(6)
s_barrier
MM 0,56,48
RB 32,13,0
RB 36,13,4096
MM 16,60,48
RT 40,17,0
RT 42,17,2048
MM 32,56,52
RT 44,18,0
RT 46,18,2048
MM 48,60,52
s_add_u32 m0, s22, 98304
s_add_u32 s24, s19, 1024
buffer_load_dwordx4 v8, s[4:7], s24 offen sc1 lds
s_waitcnt lgkmcnt(12)
MM 0,72,64
RB 48,14,0
RB 52,14,4096
MM 16,76,64
RT 56,17,8192
RT 58,17,10240
MM 32,72,68
RT 60,18,8192
RT 62,18,10240
MM 48,76,68
s_add_u32 m0, s22, 99328
s_add_u32 s24, s19, 58368
buffer_load_dwordx4 v9, s[4:7], s24 offen sc1 lds
s_add_u32 m0, s23, 98304
s_add_u32 s25, s20, 1048576
buffer_load_dwordx4 v10, s[8:11], s25 offen lds
s_waitcnt lgkmcnt(12)
MM 0,88,80
RB 64,15,0
RB 68,15,4096
MM 16,92,80
RT 72,17,16384
RT 74,17,18432
MM 32,88,84
RT 76,18,16384
RT 78,18,18432
MM 48,92,84
s_add_u32 m0, s23, 99328
s_add_u32 s25, s20, 1052672
buffer_load_dwordx4 v11, s[8:11], s25 offen lds
s_waitcnt lgkmcnt(12)
MM 0,40,32
RB 80,16,0
RB 84,16,4096
MM 16,44,32
RT 88,17,24576
RT 90,17,26624
MM 32,40,36
RT 92,18,24576
RT 94,18,26624
MM 48,44,36
s_add_u32 m0, s23, 100352
s_add_u32 s25, s20, 1056768
buffer_load_dwordx4 v10, s[8:11], s25 offen lds
s_add_u32 m0, s23, 101376
s_add_u32 s25, s20, 1060864
buffer_load_dwordx4 v11, s[8:11], s25 offen lds
s_waitcnt lgkmcnt(0) vmcnt(6)
s_barrier
MM 0,56,48
RB 32,19,0
RB 36,19,4096
MM 16,60,48
RT 40,23,0
RT 42,23,2048
MM 32,56,52
RT 44,24,0
RT 46,24,2048
MM 48,60,52
s_add_u32 m0, s22, 0
s_add_u32 s24, s19, 1152
buffer_load_dwordx4 v8, s[4:7], s24 offen sc1 lds
s_waitcnt lgkmcnt(12)
MM 0,72,64
RB 48,20,0
RB 52,20,4096
MM 16,76,64
RT 56,23,8192
RT 58,23,10240
MM 32,72,68
RT 60,24,8192
RT 62,24,10240
MM 48,76,68
s_add_u32 m0, s22, 1024
s_add_u32 s24, s19, 58496
buffer_load_dwordx4 v9, s[4:7], s24 offen sc1 lds
s_add_u32 m0, s23, 0
s_add_u32 s25, s20, 1179648
buffer_load_dwordx4 v10, s[8:11], s25 offen lds
s_waitcnt lgkmcnt(12)
MM 0,88,80
RB 64,21,0
RB 68,21,4096
MM 16,92,80
RT 72,23,16384
RT 74,23,18432
MM 32,88,84
RT 76,24,16384
RT 78,24,18432
MM 48,92,84
s_add_u32 m0, s23, 1024
s_add_u32 s25, s20, 1183744
buffer_load_dwordx4 v11, s[8:11], s25 offen lds
s_waitcnt lgkmcnt(12)
MM 0,40,32
RB 80,22,0
RB 84,22,4096
MM 16,44,32
RT 88,23,24576
RT 90,23,26624
MM 32,40,36
RT 92,24,24576
RT 94,24,26624
MM 48,44,36
s_add_u32 m0, s23, 2048
s_add_u32 s25, s20, 1187840
buffer_load_dwordx4 v10, s[8:11], s25 offen lds
s_add_u32 m0, s23, 3072
s_add_u32 s25, s20, 1191936
buffer_load_dwordx4 v11, s[8:11], s25 offen lds
s_waitcnt lgkmcnt(0) vmcnt(6)
s_barrier
MM 0,56,48
RB 32,25,0
RB 36,25,4096
MM 16,60,48
RT 40,29,0
RT 42,29,2048
MM 32,56,52
RT 44,30,0
RT 46,30,2048
MM 48,60,52
s_add_u32 m0, s22, 49152
s_add_u32 s24, s19, 1280
buffer_load_dwordx4 v8, s[4:7], s24 offen sc1 lds
s_waitcnt lgkmcnt(12)
MM 0,72,64
RB 48,26,0
RB 52,26,4096
MM 16,76,64
RT 56,29,8192
RT 58,29,10240
MM 32,72,68
RT 60,30,8192
RT 62,30,10240
MM 48,76,68
s_add_u32 m0, s22, 50176
s_add_u32 s24, s19, 58624
buffer_load_dwordx4 v9, s[4:7], s24 offen sc1 lds
s_add_u32 m0, s23, 49152
s_add_u32 s25, s20, 1310720
buffer_load_dwordx4 v10, s[8:11], s25 offen lds
s_waitcnt lgkmcnt(12)
MM 0,88,80
RB 64,27,0
RB 68,27,4096
MM 16,92,80
RT 72,29,16384
RT 74,29,18432
MM 32,88,84
RT 76,30,16384
RT 78,30,18432
MM 48,92,84
s_add_u32 m0, s23, 50176
s_add_u32 s25, s20, 1314816
buffer_load_dwordx4 v11, s[8:11], s25 offen lds
s_waitcnt lgkmcnt(12)
MM 0,40,32
RB 80,28,0
RB 84,28,4096
MM 16,44,32
RT 88,29,24576
RT 90,29,26624
MM 32,40,36
RT 92,30,24576
RT 94,30,26624
MM 48,44,36
s_add_u32 m0, s23, 51200
s_add_u32 s25, s20, 1318912
buffer_load_dwordx4 v10, s[8:11], s25 offen lds
s_add_u32 m0, s23, 52224
s_add_u32 s25, s20, 1323008
buffer_load_dwordx4 v11, s[8:11], s25 offen lds
s_waitcnt lgkmcnt(0) vmcnt(6)
s_barrier
MM 0,56,48
RB 32,13,0
RB 36,13,4096
MM 16,60,48
RT 40,17,0
RT 42,17,2048
MM 32,56,52
RT 44,18,0
RT 46,18,2048
MM 48,60,52
s_add_u32 m0, s22, 98304
s_add_u32 s24, s19, 1408
buffer_load_dwordx4 v8, s[4:7], s24 offen sc1 lds
s_waitcnt lgkmcnt(12)
MM 0,72,64
RB 48,14,0
RB 52,14,4096
MM 16,76,64
RT 56,17,8192
RT 58,17,10240
MM 32,72,68
RT 60,18,8192
RT 62,18,10240
MM 48,76,68
s_add_u32 m0, s22, 99328
s_add_u32 s24, s19, 58752
buffer_load_dwordx4 v9, s[4:7], s24 offen sc1 lds
s_add_u32 m0, s23, 98304
s_add_u32 s25, s20, 1441792
buffer_load_dwordx4 v10, s[8:11], s25 offen lds
s_waitcnt lgkmcnt(12)
MM 0,88,80
RB 64,15,0
RB 68,15,4096
MM 16,92,80
RT 72,17,16384
RT 74,17,18432
MM 32,88,84
RT 76,18,16384
RT 78,18,18432
MM 48,92,84
s_add_u32 m0, s23, 99328
s_add_u32 s25, s20, 1445888
buffer_load_dwordx4 v11, s[8:11], s25 offen lds
s_waitcnt lgkmcnt(12)
MM 0,40,32
RB 80,16,0
RB 84,16,4096
MM 16,44,32
RT 88,17,24576
RT 90,17,26624
MM 32,40,36
RT 92,18,24576
RT 94,18,26624
MM 48,44,36
s_add_u32 m0, s23, 100352
s_add_u32 s25, s20, 1449984
buffer_load_dwordx4 v10, s[8:11], s25 offen lds
s_add_u32 m0, s23, 101376
s_add_u32 s25, s20, 1454080
buffer_load_dwordx4 v11, s[8:11], s25 offen lds
s_waitcnt lgkmcnt(0) vmcnt(6)
s_barrier
MM 0,56,48
RB 32,19,0
RB 36,19,4096
MM 16,60,48
RT 40,23,0
RT 42,23,2048
MM 32,56,52
RT 44,24,0
RT 46,24,2048
MM 48,60,52
s_add_u32 m0, s22, 0
s_add_u32 s24, s19, 1536
buffer_load_dwordx4 v8, s[4:7], s24 offen sc1 lds
s_waitcnt lgkmcnt(12)
MM 0,72,64
RB 48,20,0
RB 52,20,4096
MM 16,76,64
RT 56,23,8192
RT 58,23,10240
MM 32,72,68
RT 60,24,8192
RT 62,24,10240
MM 48,76,68
s_add_u32 m0, s22, 1024
s_add_u32 s24, s19, 58880
buffer_load_dwordx4 v9, s[4:7], s24 offen sc1 lds
s_add_u32 m0, s23, 0
s_add_u32 s25, s20, 1572864
buffer_load_dwordx4 v10, s[8:11], s25 offen lds
s_waitcnt lgkmcnt(12)
MM 0,88,80
RB 64,21,0
RB 68,21,4096
MM 16,92,80
RT 72,23,16384
RT 74,23,18432
MM 32,88,84
RT 76,24,16384
RT 78,24,18432
MM 48,92,84
s_add_u32 m0, s23, 1024
s_add_u32 s25, s20, 1576960
buffer_load_dwordx4 v11, s[8:11], s25 offen lds
s_waitcnt lgkmcnt(12)
MM 0,40,32
RB 80,22,0
RB 84,22,4096
MM 16,44,32
RT 88,23,24576
RT 90,23,26624
MM 32,40,36
RT 92,24,24576
RT 94,24,26624
MM 48,44,36
s_add_u32 m0, s23, 2048
s_add_u32 s25, s20, 1581056
buffer_load_dwordx4 v10, s[8:11], s25 offen lds
s_add_u32 m0, s23, 3072
s_add_u32 s25, s20, 1585152
buffer_load_dwordx4 v11, s[8:11], s25 offen lds
s_waitcnt lgkmcnt(0) vmcnt(6)
s_barrier
MM 0,56,48
RB 32,25,0
RB 36,25,4096
MM 16,60,48
RT 40,29,0
RT 42,29,2048
MM 32,56,52
RT 44,30,0
RT 46,30,2048
MM 48,60,52
s_add_u32 m0, s22, 49152
s_add_u32 s24, s19, 1664
buffer_load_dwordx4 v8, s[4:7], s24 offen sc1 lds
s_waitcnt lgkmcnt(12)
MM 0,72,64
RB 48,26,0
RB 52,26,4096
MM 16,76,64
RT 56,29,8192
RT 58,29,10240
MM 32,72,68
RT 60,30,8192
RT 62,30,10240
MM 48,76,68
s_add_u32 m0, s22, 50176
s_add_u32 s24, s19, 59008
buffer_load_dwordx4 v9, s[4:7], s24 offen sc1 lds
s_add_u32 m0, s23, 49152
s_add_u32 s25, s20, 1703936
buffer_load_dwordx4 v10, s[8:11], s25 offen lds
s_waitcnt lgkmcnt(12)
MM 0,88,80
RB 64,27,0
RB 68,27,4096
MM 16,92,80
RT 72,29,16384
RT 74,29,18432
MM 32,88,84
RT 76,30,16384
RT 78,30,18432
MM 48,92,84
s_add_u32 m0, s23, 50176
s_add_u32 s25, s20, 1708032
buffer_load_dwordx4 v11, s[8:11], s25 offen lds
s_waitcnt lgkmcnt(12)
MM 0,40,32
RB 80,28,0
RB 84,28,4096
MM 16,44,32
RT 88,29,24576
RT 90,29,26624
MM 32,40,36
RT 92,30,24576
RT 94,30,26624
MM 48,44,36
s_add_u32 m0, s23, 51200
s_add_u32 s25, s20, 1712128
buffer_load_dwordx4 v10, s[8:11], s25 offen lds
s_add_u32 m0, s23, 52224
s_add_u32 s25, s20, 1716224
buffer_load_dwordx4 v11, s[8:11], s25 offen lds
s_waitcnt lgkmcnt(0) vmcnt(6)
s_barrier
MM 0,56,48
RB 32,13,0
RB 36,13,4096
MM 16,60,48
RT 40,17,0
MM 32,56,52
RT 42,17,2048
RT 44,18,0
MM 48,60,52
RT 46,18,2048
s_waitcnt lgkmcnt(12)
MM 0,72,64
RB 48,14,0
RB 52,14,4096
MM 16,76,64
RT 56,17,8192
MM 32,72,68
RT 58,17,10240
RT 60,18,8192
MM 48,76,68
RT 62,18,10240
s_waitcnt lgkmcnt(12)
MM 0,88,80
RB 64,15,0
RB 68,15,4096
MM 16,92,80
RT 72,17,16384
MM 32,88,84
RT 74,17,18432
RT 76,18,16384
MM 48,92,84
RT 78,18,18432
s_waitcnt lgkmcnt(12)
MM 0,40,32
RB 80,16,0
RB 84,16,4096
MM 16,44,32
RT 88,17,24576
MM 32,40,36
RT 90,17,26624
RT 92,18,24576
MM 48,44,36
RT 94,18,26624
s_waitcnt lgkmcnt(0) vmcnt(0)
s_barrier
MM 0,56,48
RB 32,19,0
RB 36,19,4096
MM 16,60,48
RT 40,23,0
MM 32,56,52
RT 42,23,2048
RT 44,24,0
MM 48,60,52
RT 46,24,2048
s_waitcnt lgkmcnt(12)
MM 0,72,64
RB 48,20,0
RB 52,20,4096
MM 16,76,64
RT 56,23,8192
MM 32,72,68
RT 58,23,10240
RT 60,24,8192
MM 48,76,68
RT 62,24,10240
s_waitcnt lgkmcnt(12)
MM 0,88,80
RB 64,21,0
RB 68,21,4096
MM 16,92,80
RT 72,23,16384
MM 32,88,84
RT 74,23,18432
RT 76,24,16384
MM 48,92,84
RT 78,24,18432
s_waitcnt lgkmcnt(12)
MM 0,40,32
RB 80,22,0
RB 84,22,4096
MM 16,44,32
RT 88,23,24576
MM 32,40,36
RT 90,23,26624
RT 92,24,24576
MM 48,44,36
RT 94,24,26624
s_waitcnt lgkmcnt(0)
MM 0,56,48
MM 16,60,48
MM 32,56,52
MM 48,60,52
s_waitcnt lgkmcnt(0)
MM 0,72,64
MM 16,76,64
MM 32,72,68
MM 48,76,68
s_waitcnt lgkmcnt(0)
MM 0,88,80
MM 16,92,80
MM 32,88,84
MM 48,92,84
s_barrier
s_cmp_lg_u32 s16, 0
s_cbranch_scc1 tt_164
v_mov_b32 v7, s56
v_accvgpr_write_b32 a127, 1
s_mov_b64 exec, 1
buffer_atomic_add a127, v7, s[4:7], 0 offen sc0
s_mov_b64 exec, -1
tt_164:
v_and_b32 v1, 31, v0
v_lshrrev_b32 v2, 5, v0
s_mul_i32 s24, s17, 66560
s_mul_i32 s25, s18, 256
s_add_u32 s24, s24, s25
v_mul_u32_u24 v3, 1040, v1
v_lshl_add_u32 v3, v2, 4, v3
v_add_u32 v3, s24, v3
v_lshrrev_b32 v4, 6, v0
v_and_b32 v5, 63, v0
s_mul_i32 s24, s16, 16
v_add_u32 v4, s24, v4
v_mul_u32_u24 v6, 1040, v4
v_lshl_add_u32 v6, v5, 4, v6
s_mov_b32 s24, 4096
v_mul_lo_u32 v12, v4, s24
v_lshl_add_u32 v12, v5, 4, v12
ds_write_b128 v3, a[0:3] offset:0
ds_write_b128 v3, a[4:7] offset:32
ds_write_b128 v3, a[8:11] offset:64
ds_write_b128 v3, a[12:15] offset:96
ds_write_b128 v3, a[16:19] offset:128
ds_write_b128 v3, a[20:23] offset:160
ds_write_b128 v3, a[24:27] offset:192
ds_write_b128 v3, a[28:31] offset:224
ds_write_b128 v3, a[32:35] offset:33280
ds_write_b128 v3, a[36:39] offset:33312
ds_write_b128 v3, a[40:43] offset:33344
ds_write_b128 v3, a[44:47] offset:33376
ds_write_b128 v3, a[48:51] offset:33408
ds_write_b128 v3, a[52:55] offset:33440
ds_write_b128 v3, a[56:59] offset:33472
ds_write_b128 v3, a[60:63] offset:33504
s_waitcnt lgkmcnt(0)
s_barrier
RB 32,6,0
RB 36,6,1040
RB 40,6,2080
RB 44,6,3120
RB 48,6,4160
RB 52,6,5200
RB 56,6,6240
RB 60,6,7280
s_waitcnt lgkmcnt(7)
s_add_u32 s24, s33, 0
buffer_store_dwordx4 v[32:35], v12, s[4:7], s24 offen sc1
s_waitcnt lgkmcnt(6)
s_add_u32 s24, s33, 4096
buffer_store_dwordx4 v[36:39], v12, s[4:7], s24 offen sc1
s_waitcnt lgkmcnt(5)
s_add_u32 s24, s33, 8192
buffer_store_dwordx4 v[40:43], v12, s[4:7], s24 offen sc1
s_waitcnt lgkmcnt(4)
s_add_u32 s24, s33, 12288
buffer_store_dwordx4 v[44:47], v12, s[4:7], s24 offen sc1
s_waitcnt lgkmcnt(3)
s_add_u32 s24, s33, 16384
buffer_store_dwordx4 v[48:51], v12, s[4:7], s24 offen sc1
s_waitcnt lgkmcnt(2)
s_add_u32 s24, s33, 20480
buffer_store_dwordx4 v[52:55], v12, s[4:7], s24 offen sc1
s_waitcnt lgkmcnt(1)
s_add_u32 s24, s33, 24576
buffer_store_dwordx4 v[56:59], v12, s[4:7], s24 offen sc1
s_waitcnt lgkmcnt(0)
s_add_u32 s24, s33, 28672
buffer_store_dwordx4 v[60:63], v12, s[4:7], s24 offen sc1
s_nop 1
RB 32,6,8320
RB 36,6,9360
RB 40,6,10400
RB 44,6,11440
RB 48,6,12480
RB 52,6,13520
RB 56,6,14560
RB 60,6,15600
s_waitcnt lgkmcnt(7)
s_add_u32 s24, s33, 32768
buffer_store_dwordx4 v[32:35], v12, s[4:7], s24 offen sc1
s_waitcnt lgkmcnt(6)
s_add_u32 s24, s33, 36864
buffer_store_dwordx4 v[36:39], v12, s[4:7], s24 offen sc1
s_waitcnt lgkmcnt(5)
s_add_u32 s24, s33, 40960
buffer_store_dwordx4 v[40:43], v12, s[4:7], s24 offen sc1
s_waitcnt lgkmcnt(4)
s_add_u32 s24, s33, 45056
buffer_store_dwordx4 v[44:47], v12, s[4:7], s24 offen sc1
s_waitcnt lgkmcnt(3)
s_add_u32 s24, s33, 49152
buffer_store_dwordx4 v[48:51], v12, s[4:7], s24 offen sc1
s_waitcnt lgkmcnt(2)
s_add_u32 s24, s33, 53248
buffer_store_dwordx4 v[52:55], v12, s[4:7], s24 offen sc1
s_waitcnt lgkmcnt(1)
s_add_u32 s24, s33, 57344
buffer_store_dwordx4 v[56:59], v12, s[4:7], s24 offen sc1
s_waitcnt lgkmcnt(0)
s_add_u32 s24, s33, 61440
buffer_store_dwordx4 v[60:63], v12, s[4:7], s24 offen sc1
s_lshl_b32 s76, s77, 3
s_add_u32 s76, s76, s60
s_lshl_b32 s76, s76, 7
s_add_u32 s76, s76, 196608
s_waitcnt vmcnt(0)
s_barrier
s_cmp_lg_u32 s16, 0
s_cbranch_scc1 sig_165
v_mov_b32 v1, s76
v_mov_b32 v2, 4
s_mov_b64 exec, 1
buffer_atomic_add v2, v1, s[4:7], 0 offen
s_mov_b64 exec, -1
sig_165:
s_branch mega_kernel_wloop
mega_kernel_t12:
s_lshr_b32 s17, s16, 1
s_and_b32 s18, s16, 1
v_lshrrev_b32 v1, 3, v0
s_mov_b32 s24, 2048
v_mul_lo_u32 v1, v1, s24
v_lshrrev_b32 v2, 4, v0
v_and_b32 v3, 7, v0
s_mov_b32 s25, 0
s_xor_b32 s26, s25, 0
v_add_u32 v4, s26, v2
v_xor_b32 v4, v4, v3
v_lshl_add_u32 v8, v4, 4, v1
s_xor_b32 s26, s25, 4
v_add_u32 v4, s26, v2
v_xor_b32 v4, v4, v3
v_lshl_add_u32 v9, v4, 4, v1
v_lshrrev_b32 v1, 3, v0
v_and_b32 v3, 7, v0
s_mov_b32 s24, 2048
v_mul_lo_u32 v2, v1, s24
v_bfe_u32 v4, v1, 1, 1
v_lshlrev_b32 v4, 2, v4
v_xor_b32 v4, v4, v3
v_lshl_add_u32 v10, v4, 4, v2
v_bfe_u32 v4, v1, 1, 1
v_lshlrev_b32 v4, 2, v4
v_xor_b32 v4, v4, v3
v_lshl_add_u32 v11, v4, 4, v2
v_and_b32 v1, 31, v0
v_lshrrev_b32 v2, 5, v0
v_bfe_u32 v3, v1, 1, 3
s_mul_i32 s24, s17, 4096
v_lshlrev_b32 v4, 7, v1
v_add_u32 v4, s24, v4
v_add_u32 v5, 0, v2
v_xor_b32 v5, v5, v3
v_lshl_add_u32 v13, v5, 4, v4
v_add_u32 v5, 2, v2
v_xor_b32 v5, v5, v3
v_lshl_add_u32 v14, v5, 4, v4
v_add_u32 v5, 4, v2
v_xor_b32 v5, v5, v3
v_lshl_add_u32 v15, v5, 4, v4
v_add_u32 v5, 6, v2
v_xor_b32 v5, v5, v3
v_lshl_add_u32 v16, v5, 4, v4
v_and_b32 v1, 15, v0
v_lshrrev_b32 v2, 2, v1
v_lshrrev_b32 v3, 5, v0
v_lshl_add_u32 v3, v3, 3, v2
v_mul_u32_u24 v3, 128, v3
v_and_b32 v4, 3, v1
v_lshl_add_u32 v3, v4, 3, v3
v_bfe_u32 v4, v0, 4, 1
v_lshl_add_u32 v3, v4, 5, v3
v_add_u32 v3, 16384, v3
s_mul_i32 s24, s18, 1
s_add_u32 s24, s24, 0
v_bfe_u32 v4, v2, 1, 1
v_xor_b32 v4, s24, v4
v_lshl_add_u32 v17, v4, 6, v3
v_add_u32 v18, 49152, v13
v_add_u32 v19, 49152, v14
v_add_u32 v20, 49152, v15
v_add_u32 v21, 49152, v16
v_add_u32 v22, 49152, v17
v_add_u32 v23, 98304, v13
v_add_u32 v24, 98304, v14
v_add_u32 v25, 98304, v15
v_add_u32 v26, 98304, v16
v_add_u32 v27, 98304, v17
s_mul_i32 s22, s16, 2048
s_mul_i32 s23, s16, 1024
s_add_u32 s23, s23, 16384
s_mov_b32 s8, s80
s_and_b32 s9, s81, 0xffff
s_mov_b32 s10, 0x200000
s_mov_b32 s11, 0x00020000
s_lshl_b32 s28, s77, 7
s_lshl_b32 s52, s77, 6
s_add_u32 s52, s52, 960
s_cmp_ge_u32 s77, 15
s_cselect_b32 s28, s52, s28
s_lshl_b32 s29, s60, 7
s_and_b32 s24, s79, 1
s_lshl_b32 s24, s24, 6
s_add_u32 s29, s29, s24
s_mul_i32 s24, s16, 16
s_add_u32 s24, s24, s28
s_mul_i32 s19, s24, 2048
s_add_u32 s19, s19, 90177536
s_mul_i32 s20, s16, 16384
s_lshl_b32 s24, s29, 1
s_add_u32 s20, s20, s24
s_mul_i32 s24, s28, 2048
s_mul_i32 s25, s29, 2
s_add_u32 s24, s24, s25
s_add_u32 s33, s24, 94375936
s_add_u32 s34, s24, 0
s_mov_b32 s35, 0
s_lshl_b32 s76, s77, 7
s_add_u32 s76, s76, 45056
s_cmp_lg_u32 s16, 0
s_cbranch_scc1 wf_166
v_mov_b32 v1, 0
v_mov_b32 v2, 0
v_writelane_b32 v1, s76, 0
s_mov_b32 s27, 16
v_writelane_b32 v2, s27, 0
s_mov_b64 exec, 1
wfp_167:
s_add_u32 s63, s63, 1
s_cmp_gt_u32 s63, 262144
s_cbranch_scc0 go_168
s_endpgm
go_168:
buffer_load_dword v3, v1, s[4:7], 0 offen sc1
s_waitcnt vmcnt(0)
v_cmp_lt_u32 vcc, v3, v2
s_nop 0
s_cbranch_vccz wfd_169
s_cmp_lt_u32 s77, 13
s_cbranch_scc1 urg_170
s_sleep 2
s_branch wfp_167
urg_170:
v_sub_u32 v4, v2, v3
s_nop 0
v_readlane_b32 s27, v4, 0
s_nop 0
s_cmp_lt_i32 s27, 2
s_cbranch_scc1 lv_171
s_sleep 40
s_branch wfp_167
lv_171:
s_cmp_lt_i32 s27, 1
s_cbranch_scc1 lv_172
s_sleep 12
s_branch wfp_167
lv_172:
s_sleep 8
s_branch wfp_167
wfd_169:
s_mov_b64 exec, -1
wf_166:
s_barrier
s_add_u32 m0, s22, 0
s_add_u32 s24, s19, 0
buffer_load_dwordx4 v8, s[4:7], s24 offen sc1 lds
s_add_u32 m0, s22, 1024
s_add_u32 s24, s19, 16384
buffer_load_dwordx4 v9, s[4:7], s24 offen sc1 lds
s_add_u32 m0, s23, 0
s_add_u32 s25, s20, 0
buffer_load_dwordx4 v10, s[8:11], s25 offen lds
s_add_u32 m0, s22, 24576
s_add_u32 s24, s19, 128
buffer_load_dwordx4 v8, s[4:7], s24 offen sc1 lds
s_add_u32 m0, s22, 25600
s_add_u32 s24, s19, 16512
buffer_load_dwordx4 v9, s[4:7], s24 offen sc1 lds
s_add_u32 m0, s23, 24576
s_add_u32 s25, s20, 131072
buffer_load_dwordx4 v10, s[8:11], s25 offen lds
v_accvgpr_write_b32 a0, 0
v_accvgpr_write_b32 a1, 0
v_accvgpr_write_b32 a2, 0
v_accvgpr_write_b32 a3, 0
v_accvgpr_write_b32 a4, 0
v_accvgpr_write_b32 a5, 0
v_accvgpr_write_b32 a6, 0
v_accvgpr_write_b32 a7, 0
v_accvgpr_write_b32 a8, 0
v_accvgpr_write_b32 a9, 0
v_accvgpr_write_b32 a10, 0
v_accvgpr_write_b32 a11, 0
v_accvgpr_write_b32 a12, 0
v_accvgpr_write_b32 a13, 0
v_accvgpr_write_b32 a14, 0
v_accvgpr_write_b32 a15, 0
s_waitcnt vmcnt(3)
s_barrier
RB 32,13,0
RT 36,17,0
RT 38,17,512
RB 40,14,0
RT 44,17,2048
RT 46,17,2560
RB 48,15,0
RT 52,17,4096
RT 54,17,4608
s_waitcnt lgkmcnt(6)
MM 0,36,32
RB 56,16,0
RT 60,17,6144
RT 62,17,6656
s_add_u32 m0, s22, 49152
s_add_u32 s24, s19, 256
buffer_load_dwordx4 v8, s[4:7], s24 offen sc1 lds
s_add_u32 m0, s22, 50176
s_add_u32 s24, s19, 16640
buffer_load_dwordx4 v9, s[4:7], s24 offen sc1 lds
s_add_u32 m0, s23, 49152
s_add_u32 s25, s20, 262144
buffer_load_dwordx4 v10, s[8:11], s25 offen lds
s_waitcnt lgkmcnt(6) vmcnt(3)
s_barrier
MM 0,44,40
RB 32,13,24576
RT 36,17,24576
RT 38,17,25088
s_add_u32 m0, s22, 73728
s_add_u32 s24, s19, 384
buffer_load_dwordx4 v8, s[4:7], s24 offen sc1 lds
s_waitcnt lgkmcnt(6)
MM 0,52,48
RB 40,14,24576
RT 44,17,26624
RT 46,17,27136
s_add_u32 m0, s22, 74752
s_add_u32 s24, s19, 16768
buffer_load_dwordx4 v9, s[4:7], s24 offen sc1 lds
s_add_u32 m0, s23, 73728
s_add_u32 s25, s20, 393216
buffer_load_dwordx4 v10, s[8:11], s25 offen lds
s_waitcnt lgkmcnt(6)
MM 0,60,56
RB 48,15,24576
RT 52,17,28672
RT 54,17,29184
s_add_u32 m0, s22, 98304
s_add_u32 s24, s19, 512
buffer_load_dwordx4 v8, s[4:7], s24 offen sc1 lds
s_waitcnt lgkmcnt(6)
MM 0,36,32
RB 56,16,24576
RT 60,17,30720
RT 62,17,31232
s_add_u32 m0, s22, 99328
s_add_u32 s24, s19, 16896
buffer_load_dwordx4 v9, s[4:7], s24 offen sc1 lds
s_add_u32 m0, s23, 98304
s_add_u32 s25, s20, 524288
buffer_load_dwordx4 v10, s[8:11], s25 offen lds
s_waitcnt lgkmcnt(6) vmcnt(6)
s_barrier
MM 0,44,40
RB 32,18,0
RT 36,22,0
RT 38,22,512
s_add_u32 m0, s22, 122880
s_add_u32 s24, s19, 640
buffer_load_dwordx4 v8, s[4:7], s24 offen sc1 lds
s_waitcnt lgkmcnt(6)
MM 0,52,48
RB 40,19,0
RT 44,22,2048
RT 46,22,2560
s_add_u32 m0, s22, 123904
s_add_u32 s24, s19, 17024
buffer_load_dwordx4 v9, s[4:7], s24 offen sc1 lds
s_add_u32 m0, s23, 122880
s_add_u32 s25, s20, 655360
buffer_load_dwordx4 v10, s[8:11], s25 offen lds
s_waitcnt lgkmcnt(6)
MM 0,60,56
RB 48,20,0
RT 52,22,4096
RT 54,22,4608
s_add_u32 m0, s22, 0
s_add_u32 s24, s19, 768
buffer_load_dwordx4 v8, s[4:7], s24 offen sc1 lds
s_waitcnt lgkmcnt(6)
MM 0,36,32
RB 56,21,0
RT 60,22,6144
RT 62,22,6656
s_add_u32 m0, s22, 1024
s_add_u32 s24, s19, 17152
buffer_load_dwordx4 v9, s[4:7], s24 offen sc1 lds
s_add_u32 m0, s23, 0
s_add_u32 s25, s20, 786432
buffer_load_dwordx4 v10, s[8:11], s25 offen lds
s_waitcnt lgkmcnt(6) vmcnt(9)
s_barrier
MM 0,44,40
RB 32,18,24576
RT 36,22,24576
RT 38,22,25088
s_waitcnt lgkmcnt(6)
MM 0,52,48
RB 40,19,24576
RT 44,22,26624
RT 46,22,27136
s_add_u32 m0, s22, 24576
s_add_u32 s24, s19, 896
buffer_load_dwordx4 v8, s[4:7], s24 offen sc1 lds
s_waitcnt lgkmcnt(6)
MM 0,60,56
RB 48,20,24576
RT 52,22,28672
RT 54,22,29184
s_add_u32 m0, s22, 25600
s_add_u32 s24, s19, 17280
buffer_load_dwordx4 v9, s[4:7], s24 offen sc1 lds
s_waitcnt lgkmcnt(6)
MM 0,36,32
RB 56,21,24576
RT 60,22,30720
RT 62,22,31232
s_add_u32 m0, s23, 24576
s_add_u32 s25, s20, 917504
buffer_load_dwordx4 v10, s[8:11], s25 offen lds
s_waitcnt lgkmcnt(6) vmcnt(9)
s_barrier
MM 0,44,40
RB 32,23,0
RT 36,27,0
RT 38,27,512
s_waitcnt lgkmcnt(6)
MM 0,52,48
RB 40,24,0
RT 44,27,2048
RT 46,27,2560
s_add_u32 m0, s22, 49152
s_add_u32 s24, s19, 1024
buffer_load_dwordx4 v8, s[4:7], s24 offen sc1 lds
s_waitcnt lgkmcnt(6)
MM 0,60,56
RB 48,25,0
RT 52,27,4096
RT 54,27,4608
s_add_u32 m0, s22, 50176
s_add_u32 s24, s19, 17408
buffer_load_dwordx4 v9, s[4:7], s24 offen sc1 lds
s_waitcnt lgkmcnt(6)
MM 0,36,32
RB 56,26,0
RT 60,27,6144
RT 62,27,6656
s_add_u32 m0, s23, 49152
s_add_u32 s25, s20, 1048576
buffer_load_dwordx4 v10, s[8:11], s25 offen lds
s_waitcnt lgkmcnt(6) vmcnt(9)
s_barrier
MM 0,44,40
RB 32,23,24576
RT 36,27,24576
RT 38,27,25088
s_waitcnt lgkmcnt(6)
MM 0,52,48
RB 40,24,24576
RT 44,27,26624
RT 46,27,27136
s_add_u32 m0, s22, 73728
s_add_u32 s24, s19, 1152
buffer_load_dwordx4 v8, s[4:7], s24 offen sc1 lds
s_waitcnt lgkmcnt(6)
MM 0,60,56
RB 48,25,24576
RT 52,27,28672
RT 54,27,29184
s_add_u32 m0, s22, 74752
s_add_u32 s24, s19, 17536
buffer_load_dwordx4 v9, s[4:7], s24 offen sc1 lds
s_waitcnt lgkmcnt(6)
MM 0,36,32
RB 56,26,24576
RT 60,27,30720
RT 62,27,31232
s_add_u32 m0, s23, 73728
s_add_u32 s25, s20, 1179648
buffer_load_dwordx4 v10, s[8:11], s25 offen lds
s_waitcnt lgkmcnt(6) vmcnt(9)
s_barrier
MM 0,44,40
RB 32,13,0
RT 36,17,0
RT 38,17,512
s_waitcnt lgkmcnt(6)
MM 0,52,48
RB 40,14,0
RT 44,17,2048
RT 46,17,2560
s_add_u32 m0, s22, 98304
s_add_u32 s24, s19, 1280
buffer_load_dwordx4 v8, s[4:7], s24 offen sc1 lds
s_waitcnt lgkmcnt(6)
MM 0,60,56
RB 48,15,0
RT 52,17,4096
RT 54,17,4608
s_add_u32 m0, s22, 99328
s_add_u32 s24, s19, 17664
buffer_load_dwordx4 v9, s[4:7], s24 offen sc1 lds
s_waitcnt lgkmcnt(6)
MM 0,36,32
RB 56,16,0
RT 60,17,6144
RT 62,17,6656
s_add_u32 m0, s23, 98304
s_add_u32 s25, s20, 1310720
buffer_load_dwordx4 v10, s[8:11], s25 offen lds
s_waitcnt lgkmcnt(6) vmcnt(9)
s_barrier
MM 0,44,40
RB 32,13,24576
RT 36,17,24576
RT 38,17,25088
s_waitcnt lgkmcnt(6)
MM 0,52,48
RB 40,14,24576
RT 44,17,26624
RT 46,17,27136
s_add_u32 m0, s22, 122880
s_add_u32 s24, s19, 1408
buffer_load_dwordx4 v8, s[4:7], s24 offen sc1 lds
s_waitcnt lgkmcnt(6)
MM 0,60,56
RB 48,15,24576
RT 52,17,28672
RT 54,17,29184
s_add_u32 m0, s22, 123904
s_add_u32 s24, s19, 17792
buffer_load_dwordx4 v9, s[4:7], s24 offen sc1 lds
s_waitcnt lgkmcnt(6)
MM 0,36,32
RB 56,16,24576
RT 60,17,30720
RT 62,17,31232
s_add_u32 m0, s23, 122880
s_add_u32 s25, s20, 1441792
buffer_load_dwordx4 v10, s[8:11], s25 offen lds
s_waitcnt lgkmcnt(6) vmcnt(9)
s_barrier
MM 0,44,40
RB 32,18,0
RT 36,22,0
RT 38,22,512
s_waitcnt lgkmcnt(6)
MM 0,52,48
RB 40,19,0
RT 44,22,2048
RT 46,22,2560
s_add_u32 m0, s22, 0
s_add_u32 s24, s19, 1536
buffer_load_dwordx4 v8, s[4:7], s24 offen sc1 lds
s_waitcnt lgkmcnt(6)
MM 0,60,56
RB 48,20,0
RT 52,22,4096
RT 54,22,4608
s_add_u32 m0, s22, 1024
s_add_u32 s24, s19, 17920
buffer_load_dwordx4 v9, s[4:7], s24 offen sc1 lds
s_waitcnt lgkmcnt(6)
MM 0,36,32
RB 56,21,0
RT 60,22,6144
RT 62,22,6656
s_add_u32 m0, s23, 0
s_add_u32 s25, s20, 1572864
buffer_load_dwordx4 v10, s[8:11], s25 offen lds
s_waitcnt lgkmcnt(6) vmcnt(9)
s_barrier
MM 0,44,40
RB 32,18,24576
RT 36,22,24576
RT 38,22,25088
s_waitcnt lgkmcnt(6)
MM 0,52,48
RB 40,19,24576
RT 44,22,26624
RT 46,22,27136
s_add_u32 m0, s22, 24576
s_add_u32 s24, s19, 1664
buffer_load_dwordx4 v8, s[4:7], s24 offen sc1 lds
s_waitcnt lgkmcnt(6)
MM 0,60,56
RB 48,20,24576
RT 52,22,28672
RT 54,22,29184
s_add_u32 m0, s22, 25600
s_add_u32 s24, s19, 18048
buffer_load_dwordx4 v9, s[4:7], s24 offen sc1 lds
s_waitcnt lgkmcnt(6)
MM 0,36,32
RB 56,21,24576
RT 60,22,30720
RT 62,22,31232
s_add_u32 m0, s23, 24576
s_add_u32 s25, s20, 1703936
buffer_load_dwordx4 v10, s[8:11], s25 offen lds
s_waitcnt lgkmcnt(6) vmcnt(9)
s_barrier
MM 0,44,40
RB 32,23,0
RT 36,27,0
RT 38,27,512
s_waitcnt lgkmcnt(6)
MM 0,52,48
RB 40,24,0
RT 44,27,2048
RT 46,27,2560
s_add_u32 m0, s22, 49152
s_add_u32 s24, s19, 1792
buffer_load_dwordx4 v8, s[4:7], s24 offen sc1 lds
s_waitcnt lgkmcnt(6)
MM 0,60,56
RB 48,25,0
RT 52,27,4096
RT 54,27,4608
s_add_u32 m0, s22, 50176
s_add_u32 s24, s19, 18176
buffer_load_dwordx4 v9, s[4:7], s24 offen sc1 lds
s_waitcnt lgkmcnt(6)
MM 0,36,32
RB 56,26,0
RT 60,27,6144
RT 62,27,6656
s_add_u32 m0, s23, 49152
s_add_u32 s25, s20, 1835008
buffer_load_dwordx4 v10, s[8:11], s25 offen lds
s_waitcnt lgkmcnt(6) vmcnt(9)
s_barrier
MM 0,44,40
RB 32,23,24576
RT 36,27,24576
RT 38,27,25088
s_waitcnt lgkmcnt(6)
MM 0,52,48
RB 40,24,24576
RT 44,27,26624
RT 46,27,27136
s_add_u32 m0, s22, 73728
s_add_u32 s24, s19, 1920
buffer_load_dwordx4 v8, s[4:7], s24 offen sc1 lds
s_waitcnt lgkmcnt(6)
MM 0,60,56
RB 48,25,24576
RT 52,27,28672
RT 54,27,29184
s_add_u32 m0, s22, 74752
s_add_u32 s24, s19, 18304
buffer_load_dwordx4 v9, s[4:7], s24 offen sc1 lds
s_waitcnt lgkmcnt(6)
MM 0,36,32
RB 56,26,24576
RT 60,27,30720
RT 62,27,31232
s_add_u32 m0, s23, 73728
s_add_u32 s25, s20, 1966080
buffer_load_dwordx4 v10, s[8:11], s25 offen lds
s_waitcnt lgkmcnt(6) vmcnt(9)
s_barrier
MM 0,44,40
RB 32,13,0
RT 36,17,0
RT 38,17,512
s_waitcnt lgkmcnt(6)
MM 0,52,48
RB 40,14,0
RT 44,17,2048
RT 46,17,2560
s_waitcnt lgkmcnt(6)
MM 0,60,56
RB 48,15,0
RT 52,17,4096
RT 54,17,4608
s_waitcnt lgkmcnt(6)
MM 0,36,32
RB 56,16,0
RT 60,17,6144
RT 62,17,6656
s_waitcnt lgkmcnt(6) vmcnt(6)
s_barrier
MM 0,44,40
RB 32,13,24576
RT 36,17,24576
RT 38,17,25088
s_waitcnt lgkmcnt(6)
MM 0,52,48
RB 40,14,24576
RT 44,17,26624
RT 46,17,27136
s_waitcnt lgkmcnt(6)
MM 0,60,56
RB 48,15,24576
RT 52,17,28672
RT 54,17,29184
s_waitcnt lgkmcnt(6)
MM 0,36,32
RB 56,16,24576
RT 60,17,30720
RT 62,17,31232
s_waitcnt lgkmcnt(6) vmcnt(3)
s_barrier
MM 0,44,40
RB 32,18,0
RT 36,22,0
RT 38,22,512
s_waitcnt lgkmcnt(6)
MM 0,52,48
RB 40,19,0
RT 44,22,2048
RT 46,22,2560
s_waitcnt lgkmcnt(6)
MM 0,60,56
RB 48,20,0
RT 52,22,4096
RT 54,22,4608
s_waitcnt lgkmcnt(6)
MM 0,36,32
RB 56,21,0
RT 60,22,6144
RT 62,22,6656
s_waitcnt lgkmcnt(6) vmcnt(0)
s_barrier
MM 0,44,40
RB 32,18,24576
RT 36,22,24576
RT 38,22,25088
s_waitcnt lgkmcnt(6)
MM 0,52,48
RB 40,19,24576
RT 44,22,26624
RT 46,22,27136
s_waitcnt lgkmcnt(6)
MM 0,60,56
RB 48,20,24576
RT 52,22,28672
RT 54,22,29184
s_waitcnt lgkmcnt(6)
MM 0,36,32
RB 56,21,24576
RT 60,22,30720
RT 62,22,31232
s_waitcnt lgkmcnt(0)
MM 0,44,40
s_waitcnt lgkmcnt(0)
MM 0,52,48
s_waitcnt lgkmcnt(0)
MM 0,60,56
s_barrier
s_cmp_lg_u32 s16, 0
s_cbranch_scc1 tt_173
v_mov_b32 v7, s56
v_accvgpr_write_b32 a127, 1
s_mov_b64 exec, 1
buffer_atomic_add a127, v7, s[4:7], 0 offen sc0
s_mov_b64 exec, -1
tt_173:
v_and_b32 v1, 31, v0
v_lshrrev_b32 v2, 5, v0
s_mul_i32 s24, s17, 4608
s_mul_i32 s25, s18, 64
s_add_u32 s24, s24, s25
v_mul_u32_u24 v3, 144, v1
v_lshl_add_u32 v3, v2, 4, v3
v_add_u32 v3, s24, v3
v_mov_b32 v72, 0xc0135761
v_mov_b32 v74, 0xbdd2d3e8
v_mov_b32 v76, 1.0
v_mov_b32 v73, 0xc0135761
v_mov_b32 v75, 0xbdd2d3e8
v_mov_b32 v77, 1.0
v_lshrrev_b32 v4, 3, v0
v_and_b32 v5, 7, v0
s_mul_i32 s24, s16, 16
v_add_u32 v4, s24, v4
v_mul_u32_u24 v6, 144, v4
v_lshl_add_u32 v6, v5, 4, v6
s_mov_b32 s24, 2048
v_mul_lo_u32 v12, v4, s24
v_lshl_add_u32 v12, v5, 4, v12
v_accvgpr_read_b32 v32, a0
v_accvgpr_read_b32 v33, a1
v_accvgpr_read_b32 v34, a2
v_accvgpr_read_b32 v35, a3
v_accvgpr_read_b32 v36, a4
v_accvgpr_read_b32 v37, a5
v_accvgpr_read_b32 v38, a6
v_accvgpr_read_b32 v39, a7
v_accvgpr_read_b32 v40, a8
v_accvgpr_read_b32 v41, a9
v_accvgpr_read_b32 v42, a10
v_accvgpr_read_b32 v43, a11
v_accvgpr_read_b32 v44, a12
v_accvgpr_read_b32 v45, a13
v_accvgpr_read_b32 v46, a14
v_accvgpr_read_b32 v47, a15
v_pk_mul_f32 v[64:65], v[32:33], v[32:33]
v_pk_mul_f32 v[66:67], v[34:35], v[34:35]
v_pk_fma_f32 v[64:65], v[64:65], v[74:75], v[72:73]
v_pk_fma_f32 v[66:67], v[66:67], v[74:75], v[72:73]
v_pk_mul_f32 v[64:65], v[64:65], v[32:33]
v_pk_mul_f32 v[66:67], v[66:67], v[34:35]
v_exp_f32 v64, v64
v_exp_f32 v66, v66
v_exp_f32 v65, v65
v_exp_f32 v67, v67
v_pk_add_f32 v[64:65], v[64:65], v[76:77]
v_pk_add_f32 v[66:67], v[66:67], v[76:77]
v_rcp_f32 v64, v64
v_rcp_f32 v66, v66
v_rcp_f32 v65, v65
v_rcp_f32 v67, v67
v_pk_mul_f32 v[32:33], v[32:33], v[64:65]
v_pk_mul_f32 v[34:35], v[34:35], v[66:67]
v_pk_mul_f32 v[64:65], v[36:37], v[36:37]
v_pk_mul_f32 v[66:67], v[38:39], v[38:39]
v_pk_fma_f32 v[64:65], v[64:65], v[74:75], v[72:73]
v_pk_fma_f32 v[66:67], v[66:67], v[74:75], v[72:73]
v_pk_mul_f32 v[64:65], v[64:65], v[36:37]
v_pk_mul_f32 v[66:67], v[66:67], v[38:39]
v_exp_f32 v64, v64
v_exp_f32 v66, v66
v_exp_f32 v65, v65
v_exp_f32 v67, v67
v_pk_add_f32 v[64:65], v[64:65], v[76:77]
v_pk_add_f32 v[66:67], v[66:67], v[76:77]
v_rcp_f32 v64, v64
v_rcp_f32 v66, v66
v_rcp_f32 v65, v65
v_rcp_f32 v67, v67
v_pk_mul_f32 v[36:37], v[36:37], v[64:65]
v_pk_mul_f32 v[38:39], v[38:39], v[66:67]
v_pk_mul_f32 v[64:65], v[40:41], v[40:41]
v_pk_mul_f32 v[66:67], v[42:43], v[42:43]
v_pk_fma_f32 v[64:65], v[64:65], v[74:75], v[72:73]
v_pk_fma_f32 v[66:67], v[66:67], v[74:75], v[72:73]
v_pk_mul_f32 v[64:65], v[64:65], v[40:41]
v_pk_mul_f32 v[66:67], v[66:67], v[42:43]
v_exp_f32 v64, v64
v_exp_f32 v66, v66
v_exp_f32 v65, v65
v_exp_f32 v67, v67
v_pk_add_f32 v[64:65], v[64:65], v[76:77]
v_pk_add_f32 v[66:67], v[66:67], v[76:77]
v_rcp_f32 v64, v64
v_rcp_f32 v66, v66
v_rcp_f32 v65, v65
v_rcp_f32 v67, v67
v_pk_mul_f32 v[40:41], v[40:41], v[64:65]
v_pk_mul_f32 v[42:43], v[42:43], v[66:67]
v_pk_mul_f32 v[64:65], v[44:45], v[44:45]
v_pk_mul_f32 v[66:67], v[46:47], v[46:47]
v_pk_fma_f32 v[64:65], v[64:65], v[74:75], v[72:73]
v_pk_fma_f32 v[66:67], v[66:67], v[74:75], v[72:73]
v_pk_mul_f32 v[64:65], v[64:65], v[44:45]
v_pk_mul_f32 v[66:67], v[66:67], v[46:47]
v_exp_f32 v64, v64
v_exp_f32 v66, v66
v_exp_f32 v65, v65
v_exp_f32 v67, v67
v_pk_add_f32 v[64:65], v[64:65], v[76:77]
v_pk_add_f32 v[66:67], v[66:67], v[76:77]
v_rcp_f32 v64, v64
v_rcp_f32 v66, v66
v_rcp_f32 v65, v65
v_rcp_f32 v67, v67
v_pk_mul_f32 v[44:45], v[44:45], v[64:65]
v_pk_mul_f32 v[46:47], v[46:47], v[66:67]
v_cvt_pk_bf16_f32 v48, v32, v33
v_cvt_pk_bf16_f32 v49, v34, v35
v_cvt_pk_bf16_f32 v50, v36, v37
v_cvt_pk_bf16_f32 v51, v38, v39
v_cvt_pk_bf16_f32 v52, v40, v41
v_cvt_pk_bf16_f32 v53, v42, v43
v_cvt_pk_bf16_f32 v54, v44, v45
v_cvt_pk_bf16_f32 v55, v46, v47
v_permlane32_swap_b32 v48, v50
v_permlane32_swap_b32 v49, v51
v_permlane32_swap_b32 v52, v54
v_permlane32_swap_b32 v53, v55
ds_write_b128 v3, v[48:51] offset:0
ds_write_b128 v3, v[52:55] offset:32
s_waitcnt lgkmcnt(0)
s_barrier
RB 32,6,0
RB 36,6,1152
s_waitcnt lgkmcnt(1)
s_add_u32 s24, s33, 0
buffer_store_dwordx4 v[32:35], v12, s[4:7], s24 offen sc1
s_waitcnt lgkmcnt(0)
s_add_u32 s24, s33, 16384
buffer_store_dwordx4 v[36:39], v12, s[4:7], s24 offen sc1
s_lshl_b32 s76, s77, 7
s_add_u32 s76, s76, 49152
s_waitcnt vmcnt(0)
s_barrier
s_cmp_lg_u32 s16, 0
s_cbranch_scc1 sig_174
v_mov_b32 v1, s76
v_mov_b32 v2, 1
s_mov_b64 exec, 1
buffer_atomic_add v2, v1, s[4:7], 0 offen
s_mov_b64 exec, -1
sig_174:
s_branch mega_kernel_wloop
mega_kernel_t13:
s_lshr_b32 s17, s16, 1
s_and_b32 s18, s16, 1
v_lshrrev_b32 v1, 3, v0
s_mov_b32 s24, 2048
v_mul_lo_u32 v1, v1, s24
v_lshrrev_b32 v2, 4, v0
v_and_b32 v3, 7, v0
s_mov_b32 s25, 0
s_xor_b32 s26, s25, 0
v_add_u32 v4, s26, v2
v_xor_b32 v4, v4, v3
v_lshl_add_u32 v8, v4, 4, v1
s_xor_b32 s26, s25, 4
v_add_u32 v4, s26, v2
v_xor_b32 v4, v4, v3
v_lshl_add_u32 v9, v4, 4, v1
v_lshrrev_b32 v1, 3, v0
v_and_b32 v3, 7, v0
s_mov_b32 s24, 2048
v_mul_lo_u32 v2, v1, s24
v_bfe_u32 v4, v1, 1, 1
v_lshlrev_b32 v4, 2, v4
v_xor_b32 v4, v4, v3
v_lshl_add_u32 v10, v4, 4, v2
v_bfe_u32 v4, v1, 1, 1
v_lshlrev_b32 v4, 2, v4
v_xor_b32 v4, v4, v3
v_lshl_add_u32 v11, v4, 4, v2
v_and_b32 v1, 31, v0
v_lshrrev_b32 v2, 5, v0
v_bfe_u32 v3, v1, 1, 3
s_mul_i32 s24, s17, 4096
v_lshlrev_b32 v4, 7, v1
v_add_u32 v4, s24, v4
v_add_u32 v5, 0, v2
v_xor_b32 v5, v5, v3
v_lshl_add_u32 v13, v5, 4, v4
v_add_u32 v5, 2, v2
v_xor_b32 v5, v5, v3
v_lshl_add_u32 v14, v5, 4, v4
v_add_u32 v5, 4, v2
v_xor_b32 v5, v5, v3
v_lshl_add_u32 v15, v5, 4, v4
v_add_u32 v5, 6, v2
v_xor_b32 v5, v5, v3
v_lshl_add_u32 v16, v5, 4, v4
v_and_b32 v1, 15, v0
v_lshrrev_b32 v2, 2, v1
v_lshrrev_b32 v3, 5, v0
v_lshl_add_u32 v3, v3, 3, v2
v_mul_u32_u24 v3, 128, v3
v_and_b32 v4, 3, v1
v_lshl_add_u32 v3, v4, 3, v3
v_bfe_u32 v4, v0, 4, 1
v_lshl_add_u32 v3, v4, 5, v3
v_add_u32 v3, 16384, v3
s_mul_i32 s24, s18, 1
s_add_u32 s24, s24, 0
v_bfe_u32 v4, v2, 1, 1
v_xor_b32 v4, s24, v4
v_lshl_add_u32 v17, v4, 6, v3
v_add_u32 v18, 49152, v13
v_add_u32 v19, 49152, v14
v_add_u32 v20, 49152, v15
v_add_u32 v21, 49152, v16
v_add_u32 v22, 49152, v17
v_add_u32 v23, 98304, v13
v_add_u32 v24, 98304, v14
v_add_u32 v25, 98304, v15
v_add_u32 v26, 98304, v16
v_add_u32 v27, 98304, v17
s_mul_i32 s22, s16, 2048
s_mul_i32 s23, s16, 1024
s_add_u32 s23, s23, 16384
s_mov_b32 s8, s82
s_and_b32 s9, s83, 0xffff
s_mov_b32 s10, 0x200000
s_mov_b32 s11, 0x00020000
s_lshl_b32 s28, s77, 7
s_lshl_b32 s52, s77, 6
s_add_u32 s52, s52, 960
s_cmp_ge_u32 s77, 15
s_cselect_b32 s28, s52, s28
s_lshl_b32 s29, s60, 7
s_and_b32 s24, s79, 1
s_lshl_b32 s24, s24, 6
s_add_u32 s29, s29, s24
s_mul_i32 s24, s16, 16
s_add_u32 s24, s24, s28
s_mul_i32 s19, s24, 2048
s_add_u32 s19, s19, 94375936
s_mul_i32 s20, s16, 16384
s_lshl_b32 s24, s29, 1
s_add_u32 s20, s20, s24
s_mul_i32 s24, s28, 2048
s_mul_i32 s25, s29, 2
s_add_u32 s24, s24, s25
s_add_u32 s33, s24, 98574336
s_add_u32 s34, s24, 85983232
s_mov_b32 s35, 0
s_lshl_b32 s24, s77, 7
s_add_u32 s24, s24, 49024
s_lshl_b32 s25, s77, 7
s_add_u32 s25, s25, 49152
s_lshl_b32 s26, s77, 7
s_add_u32 s26, s26, 49280
s_cmp_eq_u32 s77, 0
s_cselect_b32 s24, s25, s24
s_cmp_eq_u32 s77, 16
s_cselect_b32 s26, s25, s26
s_cmp_lg_u32 s16, 0
s_cbranch_scc1 wf_175
v_mov_b32 v1, 0
v_mov_b32 v2, 0
v_writelane_b32 v1, s26, 0
s_mov_b32 s27, 16
v_writelane_b32 v2, s27, 0
v_writelane_b32 v1, s25, 1
s_mov_b32 s27, 16
v_writelane_b32 v2, s27, 1
v_writelane_b32 v1, s24, 2
s_mov_b32 s27, 16
v_writelane_b32 v2, s27, 2
s_mov_b64 exec, 7
wfp_176:
s_add_u32 s63, s63, 1
s_cmp_gt_u32 s63, 262144
s_cbranch_scc0 go_177
s_endpgm
go_177:
buffer_load_dword v3, v1, s[4:7], 0 offen sc1
s_waitcnt vmcnt(0)
v_cmp_lt_u32 vcc, v3, v2
s_nop 0
s_cbranch_vccz wfd_178
s_cmp_lt_u32 s77, 13
s_cbranch_scc1 urg_179
s_sleep 2
s_branch wfp_176
urg_179:
v_sub_u32 v4, v2, v3
s_nop 0
v_readlane_b32 s27, v4, 0
s_nop 0
s_cmp_lt_i32 s27, 2
s_cbranch_scc1 lv_180
s_sleep 40
s_branch wfp_176
lv_180:
s_cmp_lt_i32 s27, 1
s_cbranch_scc1 lv_181
s_sleep 12
s_branch wfp_176
lv_181:
s_sleep 8
s_branch wfp_176
wfd_178:
s_mov_b64 exec, -1
wf_175:
s_barrier
s_add_u32 m0, s22, 0
s_add_u32 s24, s19, 4294965248
buffer_load_dwordx4 v8, s[4:7], s24 offen sc1 lds
s_add_u32 m0, s22, 1024
s_add_u32 s24, s19, 14336
buffer_load_dwordx4 v9, s[4:7], s24 offen sc1 lds
s_add_u32 m0, s23, 0
s_add_u32 s25, s20, 0
buffer_load_dwordx4 v10, s[8:11], s25 offen lds
s_add_u32 m0, s22, 24576
s_add_u32 s24, s19, 4294965376
buffer_load_dwordx4 v8, s[4:7], s24 offen sc1 lds
s_add_u32 m0, s22, 25600
s_add_u32 s24, s19, 14464
buffer_load_dwordx4 v9, s[4:7], s24 offen sc1 lds
s_add_u32 m0, s23, 24576
s_add_u32 s25, s20, 131072
buffer_load_dwordx4 v10, s[8:11], s25 offen lds
v_accvgpr_write_b32 a0, 0
v_accvgpr_write_b32 a1, 0
v_accvgpr_write_b32 a2, 0
v_accvgpr_write_b32 a3, 0
v_accvgpr_write_b32 a4, 0
v_accvgpr_write_b32 a5, 0
v_accvgpr_write_b32 a6, 0
v_accvgpr_write_b32 a7, 0
v_accvgpr_write_b32 a8, 0
v_accvgpr_write_b32 a9, 0
v_accvgpr_write_b32 a10, 0
v_accvgpr_write_b32 a11, 0
v_accvgpr_write_b32 a12, 0
v_accvgpr_write_b32 a13, 0
v_accvgpr_write_b32 a14, 0
v_accvgpr_write_b32 a15, 0
s_waitcnt vmcnt(3)
s_barrier
RB 32,13,0
RT 36,17,0
RT 38,17,512
RB 40,14,0
RT 44,17,2048
RT 46,17,2560
RB 48,15,0
RT 52,17,4096
RT 54,17,4608
s_waitcnt lgkmcnt(6)
MM 0,36,32
RB 56,16,0
RT 60,17,6144
RT 62,17,6656
s_add_u32 m0, s22, 49152
s_add_u32 s24, s19, 4294965504
buffer_load_dwordx4 v8, s[4:7], s24 offen sc1 lds
s_add_u32 m0, s22, 50176
s_add_u32 s24, s19, 14592
buffer_load_dwordx4 v9, s[4:7], s24 offen sc1 lds
s_add_u32 m0, s23, 49152
s_add_u32 s25, s20, 262144
buffer_load_dwordx4 v10, s[8:11], s25 offen lds
s_waitcnt lgkmcnt(6) vmcnt(3)
s_barrier
MM 0,44,40
RB 32,13,24576
RT 36,17,24576
RT 38,17,25088
s_add_u32 m0, s22, 73728
s_add_u32 s24, s19, 4294965632
buffer_load_dwordx4 v8, s[4:7], s24 offen sc1 lds
s_waitcnt lgkmcnt(6)
MM 0,52,48
RB 40,14,24576
RT 44,17,26624
RT 46,17,27136
s_add_u32 m0, s22, 74752
s_add_u32 s24, s19, 14720
buffer_load_dwordx4 v9, s[4:7], s24 offen sc1 lds
s_add_u32 m0, s23, 73728
s_add_u32 s25, s20, 393216
buffer_load_dwordx4 v10, s[8:11], s25 offen lds
s_waitcnt lgkmcnt(6)
MM 0,60,56
RB 48,15,24576
RT 52,17,28672
RT 54,17,29184
s_add_u32 m0, s22, 98304
s_add_u32 s24, s19, 2560
buffer_load_dwordx4 v8, s[4:7], s24 offen sc1 lds
s_waitcnt lgkmcnt(6)
MM 0,36,32
RB 56,16,24576
RT 60,17,30720
RT 62,17,31232
s_add_u32 m0, s22, 99328
s_add_u32 s24, s19, 18944
buffer_load_dwordx4 v9, s[4:7], s24 offen sc1 lds
s_add_u32 m0, s23, 98304
s_add_u32 s25, s20, 524288
buffer_load_dwordx4 v10, s[8:11], s25 offen lds
s_waitcnt lgkmcnt(6) vmcnt(6)
s_barrier
MM 0,44,40
RB 32,18,0
RT 36,22,0
RT 38,22,512
s_add_u32 m0, s22, 122880
s_add_u32 s24, s19, 2688
buffer_load_dwordx4 v8, s[4:7], s24 offen sc1 lds
s_waitcnt lgkmcnt(6)
MM 0,52,48
RB 40,19,0
RT 44,22,2048
RT 46,22,2560
s_add_u32 m0, s22, 123904
s_add_u32 s24, s19, 19072
buffer_load_dwordx4 v9, s[4:7], s24 offen sc1 lds
s_add_u32 m0, s23, 122880
s_add_u32 s25, s20, 655360
buffer_load_dwordx4 v10, s[8:11], s25 offen lds
s_waitcnt lgkmcnt(6)
MM 0,60,56
RB 48,20,0
RT 52,22,4096
RT 54,22,4608
s_add_u32 m0, s22, 0
s_add_u32 s24, s19, 2816
buffer_load_dwordx4 v8, s[4:7], s24 offen sc1 lds
s_waitcnt lgkmcnt(6)
MM 0,36,32
RB 56,21,0
RT 60,22,6144
RT 62,22,6656
s_add_u32 m0, s22, 1024
s_add_u32 s24, s19, 19200
buffer_load_dwordx4 v9, s[4:7], s24 offen sc1 lds
s_add_u32 m0, s23, 0
s_add_u32 s25, s20, 786432
buffer_load_dwordx4 v10, s[8:11], s25 offen lds
s_waitcnt lgkmcnt(6) vmcnt(9)
s_barrier
MM 0,44,40
RB 32,18,24576
RT 36,22,24576
RT 38,22,25088
s_waitcnt lgkmcnt(6)
MM 0,52,48
RB 40,19,24576
RT 44,22,26624
RT 46,22,27136
s_add_u32 m0, s22, 24576
s_add_u32 s24, s19, 2944
buffer_load_dwordx4 v8, s[4:7], s24 offen sc1 lds
s_waitcnt lgkmcnt(6)
MM 0,60,56
RB 48,20,24576
RT 52,22,28672
RT 54,22,29184
s_add_u32 m0, s22, 25600
s_add_u32 s24, s19, 19328
buffer_load_dwordx4 v9, s[4:7], s24 offen sc1 lds
s_waitcnt lgkmcnt(6)
MM 0,36,32
RB 56,21,24576
RT 60,22,30720
RT 62,22,31232
s_add_u32 m0, s23, 24576
s_add_u32 s25, s20, 917504
buffer_load_dwordx4 v10, s[8:11], s25 offen lds
s_waitcnt lgkmcnt(6) vmcnt(9)
s_barrier
MM 0,44,40
RB 32,23,0
RT 36,27,0
RT 38,27,512
s_waitcnt lgkmcnt(6)
MM 0,52,48
RB 40,24,0
RT 44,27,2048
RT 46,27,2560
s_add_u32 m0, s22, 49152
s_add_u32 s24, s19, 4294964224
buffer_load_dwordx4 v8, s[4:7], s24 offen sc1 lds
s_waitcnt lgkmcnt(6)
MM 0,60,56
RB 48,25,0
RT 52,27,4096
RT 54,27,4608
s_add_u32 m0, s22, 50176
s_add_u32 s24, s19, 13312
buffer_load_dwordx4 v9, s[4:7], s24 offen sc1 lds
s_waitcnt lgkmcnt(6)
MM 0,36,32
RB 56,26,0
RT 60,27,6144
RT 62,27,6656
s_add_u32 m0, s23, 49152
s_add_u32 s25, s20, 1048576
buffer_load_dwordx4 v10, s[8:11], s25 offen lds
s_waitcnt lgkmcnt(6) vmcnt(9)
s_barrier
MM 0,44,40
RB 32,23,24576
RT 36,27,24576
RT 38,27,25088
s_waitcnt lgkmcnt(6)
MM 0,52,48
RB 40,24,24576
RT 44,27,26624
RT 46,27,27136
s_add_u32 m0, s22, 73728
s_add_u32 s24, s19, 4294964352
buffer_load_dwordx4 v8, s[4:7], s24 offen sc1 lds
s_waitcnt lgkmcnt(6)
MM 0,60,56
RB 48,25,24576
RT 52,27,28672
RT 54,27,29184
s_add_u32 m0, s22, 74752
s_add_u32 s24, s19, 13440
buffer_load_dwordx4 v9, s[4:7], s24 offen sc1 lds
s_waitcnt lgkmcnt(6)
MM 0,36,32
RB 56,26,24576
RT 60,27,30720
RT 62,27,31232
s_add_u32 m0, s23, 73728
s_add_u32 s25, s20, 1179648
buffer_load_dwordx4 v10, s[8:11], s25 offen lds
s_waitcnt lgkmcnt(6) vmcnt(9)
s_barrier
MM 0,44,40
RB 32,13,0
RT 36,17,0
RT 38,17,512
s_waitcnt lgkmcnt(6)
MM 0,52,48
RB 40,14,0
RT 44,17,2048
RT 46,17,2560
s_add_u32 m0, s22, 98304
s_add_u32 s24, s19, 4294964480
buffer_load_dwordx4 v8, s[4:7], s24 offen sc1 lds
s_waitcnt lgkmcnt(6)
MM 0,60,56
RB 48,15,0
RT 52,17,4096
RT 54,17,4608
s_add_u32 m0, s22, 99328
s_add_u32 s24, s19, 13568
buffer_load_dwordx4 v9, s[4:7], s24 offen sc1 lds
s_waitcnt lgkmcnt(6)
MM 0,36,32
RB 56,16,0
RT 60,17,6144
RT 62,17,6656
s_add_u32 m0, s23, 98304
s_add_u32 s25, s20, 1310720
buffer_load_dwordx4 v10, s[8:11], s25 offen lds
s_waitcnt lgkmcnt(6) vmcnt(9)
s_barrier
MM 0,44,40
RB 32,13,24576
RT 36,17,24576
RT 38,17,25088
s_waitcnt lgkmcnt(6)
MM 0,52,48
RB 40,14,24576
RT 44,17,26624
RT 46,17,27136
s_add_u32 m0, s22, 122880
s_add_u32 s24, s19, 4294964608
buffer_load_dwordx4 v8, s[4:7], s24 offen sc1 lds
s_waitcnt lgkmcnt(6)
MM 0,60,56
RB 48,15,24576
RT 52,17,28672
RT 54,17,29184
s_add_u32 m0, s22, 123904
s_add_u32 s24, s19, 13696
buffer_load_dwordx4 v9, s[4:7], s24 offen sc1 lds
s_waitcnt lgkmcnt(6)
MM 0,36,32
RB 56,16,24576
RT 60,17,30720
RT 62,17,31232
s_add_u32 m0, s23, 122880
s_add_u32 s25, s20, 1441792
buffer_load_dwordx4 v10, s[8:11], s25 offen lds
s_waitcnt lgkmcnt(6) vmcnt(9)
s_barrier
MM 0,44,40
RB 32,18,0
RT 36,22,0
RT 38,22,512
s_waitcnt lgkmcnt(6)
MM 0,52,48
RB 40,19,0
RT 44,22,2048
RT 46,22,2560
s_add_u32 m0, s22, 0
s_add_u32 s24, s19, 5632
buffer_load_dwordx4 v8, s[4:7], s24 offen sc1 lds
s_waitcnt lgkmcnt(6)
MM 0,60,56
RB 48,20,0
RT 52,22,4096
RT 54,22,4608
s_add_u32 m0, s22, 1024
s_add_u32 s24, s19, 22016
buffer_load_dwordx4 v9, s[4:7], s24 offen sc1 lds
s_waitcnt lgkmcnt(6)
MM 0,36,32
RB 56,21,0
RT 60,22,6144
RT 62,22,6656
s_add_u32 m0, s23, 0
s_add_u32 s25, s20, 1572864
buffer_load_dwordx4 v10, s[8:11], s25 offen lds
s_waitcnt lgkmcnt(6) vmcnt(9)
s_barrier
MM 0,44,40
RB 32,18,24576
RT 36,22,24576
RT 38,22,25088
s_waitcnt lgkmcnt(6)
MM 0,52,48
RB 40,19,24576
RT 44,22,26624
RT 46,22,27136
s_add_u32 m0, s22, 24576
s_add_u32 s24, s19, 5760
buffer_load_dwordx4 v8, s[4:7], s24 offen sc1 lds
s_waitcnt lgkmcnt(6)
MM 0,60,56
RB 48,20,24576
RT 52,22,28672
RT 54,22,29184
s_add_u32 m0, s22, 25600
s_add_u32 s24, s19, 22144
buffer_load_dwordx4 v9, s[4:7], s24 offen sc1 lds
s_waitcnt lgkmcnt(6)
MM 0,36,32
RB 56,21,24576
RT 60,22,30720
RT 62,22,31232
s_add_u32 m0, s23, 24576
s_add_u32 s25, s20, 1703936
buffer_load_dwordx4 v10, s[8:11], s25 offen lds
s_waitcnt lgkmcnt(6) vmcnt(9)
s_barrier
MM 0,44,40
RB 32,23,0
RT 36,27,0
RT 38,27,512
s_waitcnt lgkmcnt(6)
MM 0,52,48
RB 40,24,0
RT 44,27,2048
RT 46,27,2560
s_add_u32 m0, s22, 49152
s_add_u32 s24, s19, 5888
buffer_load_dwordx4 v8, s[4:7], s24 offen sc1 lds
s_waitcnt lgkmcnt(6)
MM 0,60,56
RB 48,25,0
RT 52,27,4096
RT 54,27,4608
s_add_u32 m0, s22, 50176
s_add_u32 s24, s19, 22272
buffer_load_dwordx4 v9, s[4:7], s24 offen sc1 lds
s_waitcnt lgkmcnt(6)
MM 0,36,32
RB 56,26,0
RT 60,27,6144
RT 62,27,6656
s_add_u32 m0, s23, 49152
s_add_u32 s25, s20, 1835008
buffer_load_dwordx4 v10, s[8:11], s25 offen lds
s_waitcnt lgkmcnt(6) vmcnt(9)
s_barrier
MM 0,44,40
RB 32,23,24576
RT 36,27,24576
RT 38,27,25088
s_waitcnt lgkmcnt(6)
MM 0,52,48
RB 40,24,24576
RT 44,27,26624
RT 46,27,27136
s_add_u32 m0, s22, 73728
s_add_u32 s24, s19, 6016
buffer_load_dwordx4 v8, s[4:7], s24 offen sc1 lds
s_waitcnt lgkmcnt(6)
MM 0,60,56
RB 48,25,24576
RT 52,27,28672
RT 54,27,29184
s_add_u32 m0, s22, 74752
s_add_u32 s24, s19, 22400
buffer_load_dwordx4 v9, s[4:7], s24 offen sc1 lds
s_waitcnt lgkmcnt(6)
MM 0,36,32
RB 56,26,24576
RT 60,27,30720
RT 62,27,31232
s_add_u32 m0, s23, 73728
s_add_u32 s25, s20, 1966080
buffer_load_dwordx4 v10, s[8:11], s25 offen lds
s_waitcnt lgkmcnt(6) vmcnt(9)
s_barrier
MM 0,44,40
RB 32,13,0
RT 36,17,0
RT 38,17,512
s_waitcnt lgkmcnt(6)
MM 0,52,48
RB 40,14,0
RT 44,17,2048
RT 46,17,2560
s_waitcnt lgkmcnt(6)
MM 0,60,56
RB 48,15,0
RT 52,17,4096
RT 54,17,4608
s_waitcnt lgkmcnt(6)
MM 0,36,32
RB 56,16,0
RT 60,17,6144
RT 62,17,6656
s_waitcnt lgkmcnt(6) vmcnt(6)
s_barrier
MM 0,44,40
RB 32,13,24576
RT 36,17,24576
RT 38,17,25088
s_waitcnt lgkmcnt(6)
MM 0,52,48
RB 40,14,24576
RT 44,17,26624
RT 46,17,27136
s_waitcnt lgkmcnt(6)
MM 0,60,56
RB 48,15,24576
RT 52,17,28672
RT 54,17,29184
s_waitcnt lgkmcnt(6)
MM 0,36,32
RB 56,16,24576
RT 60,17,30720
RT 62,17,31232
s_waitcnt lgkmcnt(6) vmcnt(3)
s_barrier
MM 0,44,40
RB 32,18,0
RT 36,22,0
RT 38,22,512
s_waitcnt lgkmcnt(6)
MM 0,52,48
RB 40,19,0
RT 44,22,2048
RT 46,22,2560
s_waitcnt lgkmcnt(6)
MM 0,60,56
RB 48,20,0
RT 52,22,4096
RT 54,22,4608
s_waitcnt lgkmcnt(6)
MM 0,36,32
RB 56,21,0
RT 60,22,6144
RT 62,22,6656
s_waitcnt lgkmcnt(6) vmcnt(0)
s_barrier
MM 0,44,40
RB 32,18,24576
RT 36,22,24576
RT 38,22,25088
s_waitcnt lgkmcnt(6)
MM 0,52,48
RB 40,19,24576
RT 44,22,26624
RT 46,22,27136
s_waitcnt lgkmcnt(6)
MM 0,60,56
RB 48,20,24576
RT 52,22,28672
RT 54,22,29184
s_waitcnt lgkmcnt(6)
MM 0,36,32
RB 56,21,24576
RT 60,22,30720
RT 62,22,31232
s_waitcnt lgkmcnt(0)
MM 0,44,40
s_waitcnt lgkmcnt(0)
MM 0,52,48
s_waitcnt lgkmcnt(0)
MM 0,60,56
s_barrier
s_cmp_lg_u32 s16, 0
s_cbranch_scc1 tt_182
v_mov_b32 v7, s56
v_accvgpr_write_b32 a127, 1
s_mov_b64 exec, 1
buffer_atomic_add a127, v7, s[4:7], 0 offen sc0
s_mov_b64 exec, -1
tt_182:
v_and_b32 v1, 31, v0
v_lshrrev_b32 v2, 5, v0
s_mul_i32 s24, s17, 4608
s_mul_i32 s25, s18, 64
s_add_u32 s24, s24, s25
v_mul_u32_u24 v3, 144, v1
v_lshl_add_u32 v3, v2, 4, v3
v_add_u32 v3, s24, v3
v_lshrrev_b32 v4, 3, v0
v_and_b32 v5, 7, v0
s_mul_i32 s24, s16, 16
v_add_u32 v4, s24, v4
v_mul_u32_u24 v6, 144, v4
v_lshl_add_u32 v6, v5, 4, v6
s_mov_b32 s24, 2048
v_mul_lo_u32 v12, v4, s24
v_lshl_add_u32 v12, v5, 4, v12
s_add_u32 s24, s34, 0
buffer_load_dwordx4 v[72:75], v12, s[4:7], s24 offen sc1
s_add_u32 s24, s34, 16384
buffer_load_dwordx4 v[76:79], v12, s[4:7], s24 offen sc1
v_accvgpr_read_b32 v32, a0
v_accvgpr_read_b32 v33, a1
v_accvgpr_read_b32 v34, a2
v_accvgpr_read_b32 v35, a3
v_accvgpr_read_b32 v36, a4
v_accvgpr_read_b32 v37, a5
v_accvgpr_read_b32 v38, a6
v_accvgpr_read_b32 v39, a7
v_accvgpr_read_b32 v40, a8
v_accvgpr_read_b32 v41, a9
v_accvgpr_read_b32 v42, a10
v_accvgpr_read_b32 v43, a11
v_accvgpr_read_b32 v44, a12
v_accvgpr_read_b32 v45, a13
v_accvgpr_read_b32 v46, a14
v_accvgpr_read_b32 v47, a15
v_cvt_pk_bf16_f32 v48, v32, v33
v_cvt_pk_bf16_f32 v49, v34, v35
v_cvt_pk_bf16_f32 v50, v36, v37
v_cvt_pk_bf16_f32 v51, v38, v39
v_cvt_pk_bf16_f32 v52, v40, v41
v_cvt_pk_bf16_f32 v53, v42, v43
v_cvt_pk_bf16_f32 v54, v44, v45
v_cvt_pk_bf16_f32 v55, v46, v47
v_permlane32_swap_b32 v48, v50
v_permlane32_swap_b32 v49, v51
v_permlane32_swap_b32 v52, v54
v_permlane32_swap_b32 v53, v55
ds_write_b128 v3, v[48:51] offset:0
ds_write_b128 v3, v[52:55] offset:32
s_waitcnt lgkmcnt(0)
s_barrier
RB 32,6,0
RB 36,6,1152
s_waitcnt vmcnt(0)
s_waitcnt lgkmcnt(1)
v_lshlrev_b32 v68, 16, v32
v_and_b32 v69, 0xffff0000, v32
v_lshlrev_b32 v70, 16, v72
v_and_b32 v71, 0xffff0000, v72
v_add_f32 v68, v68, v70
v_add_f32 v69, v69, v71
v_cvt_pk_bf16_f32 v32, v68, v69
v_lshlrev_b32 v68, 16, v33
v_and_b32 v69, 0xffff0000, v33
v_lshlrev_b32 v70, 16, v73
v_and_b32 v71, 0xffff0000, v73
v_add_f32 v68, v68, v70
v_add_f32 v69, v69, v71
v_cvt_pk_bf16_f32 v33, v68, v69
v_lshlrev_b32 v68, 16, v34
v_and_b32 v69, 0xffff0000, v34
v_lshlrev_b32 v70, 16, v74
v_and_b32 v71, 0xffff0000, v74
v_add_f32 v68, v68, v70
v_add_f32 v69, v69, v71
v_cvt_pk_bf16_f32 v34, v68, v69
v_lshlrev_b32 v68, 16, v35
v_and_b32 v69, 0xffff0000, v35
v_lshlrev_b32 v70, 16, v75
v_and_b32 v71, 0xffff0000, v75
v_add_f32 v68, v68, v70
v_add_f32 v69, v69, v71
v_cvt_pk_bf16_f32 v35, v68, v69
s_add_u32 s24, s33, 0
buffer_store_dwordx4 v[32:35], v12, s[4:7], s24 offen sc1
s_waitcnt lgkmcnt(0)
v_lshlrev_b32 v68, 16, v36
v_and_b32 v69, 0xffff0000, v36
v_lshlrev_b32 v70, 16, v76
v_and_b32 v71, 0xffff0000, v76
v_add_f32 v68, v68, v70
v_add_f32 v69, v69, v71
v_cvt_pk_bf16_f32 v36, v68, v69
v_lshlrev_b32 v68, 16, v37
v_and_b32 v69, 0xffff0000, v37
v_lshlrev_b32 v70, 16, v77
v_and_b32 v71, 0xffff0000, v77
v_add_f32 v68, v68, v70
v_add_f32 v69, v69, v71
v_cvt_pk_bf16_f32 v37, v68, v69
v_lshlrev_b32 v68, 16, v38
v_and_b32 v69, 0xffff0000, v38
v_lshlrev_b32 v70, 16, v78
v_and_b32 v71, 0xffff0000, v78
v_add_f32 v68, v68, v70
v_add_f32 v69, v69, v71
v_cvt_pk_bf16_f32 v38, v68, v69
v_lshlrev_b32 v68, 16, v39
v_and_b32 v69, 0xffff0000, v39
v_lshlrev_b32 v70, 16, v79
v_and_b32 v71, 0xffff0000, v79
v_add_f32 v68, v68, v70
v_add_f32 v69, v69, v71
v_cvt_pk_bf16_f32 v39, v68, v69
s_add_u32 s24, s33, 16384
buffer_store_dwordx4 v[36:39], v12, s[4:7], s24 offen sc1
s_lshl_b32 s76, s77, 7
s_add_u32 s76, s76, 53248
s_waitcnt vmcnt(0)
s_barrier
s_cmp_lg_u32 s16, 0
s_cbranch_scc1 sig_183
v_mov_b32 v1, s76
v_mov_b32 v2, 1
s_mov_b64 exec, 1
buffer_atomic_add v2, v1, s[4:7], 0 offen
s_mov_b64 exec, -1
sig_183:
s_branch mega_kernel_wloop
mega_kernel_t14:
s_lshr_b32 s17, s16, 1
s_and_b32 s18, s16, 1
v_lshrrev_b32 v1, 3, v0
s_mov_b32 s24, 2048
v_mul_lo_u32 v1, v1, s24
v_lshrrev_b32 v2, 4, v0
v_and_b32 v3, 7, v0
s_mov_b32 s25, 0
s_xor_b32 s26, s25, 0
v_add_u32 v4, s26, v2
v_xor_b32 v4, v4, v3
v_lshl_add_u32 v8, v4, 4, v1
s_xor_b32 s26, s25, 4
v_add_u32 v4, s26, v2
v_xor_b32 v4, v4, v3
v_lshl_add_u32 v9, v4, 4, v1
v_lshrrev_b32 v1, 3, v0
v_and_b32 v3, 7, v0
s_mov_b32 s24, 7168
v_mul_lo_u32 v2, v1, s24
v_bfe_u32 v4, v1, 1, 1
v_lshlrev_b32 v4, 2, v4
v_xor_b32 v4, v4, v3
v_lshl_add_u32 v10, v4, 4, v2
v_bfe_u32 v4, v1, 1, 1
v_lshlrev_b32 v4, 2, v4
v_xor_b32 v4, v4, v3
v_lshl_add_u32 v11, v4, 4, v2
v_and_b32 v1, 31, v0
v_lshrrev_b32 v2, 5, v0
v_bfe_u32 v3, v1, 1, 3
s_mul_i32 s24, s17, 4096
v_lshlrev_b32 v4, 7, v1
v_add_u32 v4, s24, v4
v_add_u32 v5, 0, v2
v_xor_b32 v5, v5, v3
v_lshl_add_u32 v13, v5, 4, v4
v_add_u32 v5, 2, v2
v_xor_b32 v5, v5, v3
v_lshl_add_u32 v14, v5, 4, v4
v_add_u32 v5, 4, v2
v_xor_b32 v5, v5, v3
v_lshl_add_u32 v15, v5, 4, v4
v_add_u32 v5, 6, v2
v_xor_b32 v5, v5, v3
v_lshl_add_u32 v16, v5, 4, v4
v_and_b32 v1, 15, v0
v_lshrrev_b32 v2, 2, v1
v_lshrrev_b32 v3, 5, v0
v_lshl_add_u32 v3, v3, 3, v2
v_mul_u32_u24 v3, 128, v3
v_and_b32 v4, 3, v1
v_lshl_add_u32 v3, v4, 3, v3
v_bfe_u32 v4, v0, 4, 1
v_lshl_add_u32 v3, v4, 5, v3
v_add_u32 v3, 16384, v3
s_mul_i32 s24, s18, 1
s_add_u32 s24, s24, 0
v_bfe_u32 v4, v2, 1, 1
v_xor_b32 v4, s24, v4
v_lshl_add_u32 v17, v4, 6, v3
v_add_u32 v18, 49152, v13
v_add_u32 v19, 49152, v14
v_add_u32 v20, 49152, v15
v_add_u32 v21, 49152, v16
v_add_u32 v22, 49152, v17
v_add_u32 v23, 98304, v13
v_add_u32 v24, 98304, v14
v_add_u32 v25, 98304, v15
v_add_u32 v26, 98304, v16
v_add_u32 v27, 98304, v17
s_mul_i32 s22, s16, 2048
s_mul_i32 s23, s16, 1024
s_add_u32 s23, s23, 16384
s_mov_b32 s8, s84
s_and_b32 s9, s85, 0xffff
s_mov_b32 s10, 0x700000
s_mov_b32 s11, 0x00020000
s_lshl_b32 s28, s77, 7
s_lshl_b32 s52, s77, 6
s_add_u32 s52, s52, 960
s_cmp_ge_u32 s77, 15
s_cselect_b32 s28, s52, s28
s_lshl_b32 s29, s79, 6
s_mul_i32 s24, s16, 16
s_add_u32 s24, s24, s28
s_mul_i32 s19, s24, 2048
s_add_u32 s19, s19, 102768640
s_mul_i32 s20, s16, 57344
s_lshl_b32 s24, s29, 1
s_add_u32 s20, s20, s24
s_mul_i32 s24, s28, 7168
s_mul_i32 s25, s29, 2
s_add_u32 s24, s24, s25
s_add_u32 s33, s24, 106962944
s_add_u32 s34, s24, 0
s_mov_b32 s35, 0
s_lshl_b32 s76, s77, 7
s_add_u32 s76, s76, 57344
s_cmp_lg_u32 s16, 0
s_cbranch_scc1 wf_184
v_mov_b32 v1, 0
v_mov_b32 v2, 0
v_writelane_b32 v1, s76, 0
s_mov_b32 s27, 16
v_writelane_b32 v2, s27, 0
s_mov_b64 exec, 1
wfp_185:
s_add_u32 s63, s63, 1
s_cmp_gt_u32 s63, 262144
s_cbranch_scc0 go_186
s_endpgm
go_186:
buffer_load_dword v3, v1, s[4:7], 0 offen sc1
s_waitcnt vmcnt(0)
v_cmp_lt_u32 vcc, v3, v2
s_nop 0
s_cbranch_vccz wfd_187
s_cmp_lt_u32 s77, 13
s_cbranch_scc1 urg_188
s_sleep 2
s_branch wfp_185
urg_188:
v_sub_u32 v4, v2, v3
s_nop 0
v_readlane_b32 s27, v4, 0
s_nop 0
s_cmp_lt_i32 s27, 2
s_cbranch_scc1 lv_189
s_sleep 40
s_branch wfp_185
lv_189:
s_cmp_lt_i32 s27, 1
s_cbranch_scc1 lv_190
s_sleep 12
s_branch wfp_185
lv_190:
s_sleep 8
s_branch wfp_185
wfd_187:
s_mov_b64 exec, -1
wf_184:
s_barrier
s_add_u32 m0, s22, 0
s_add_u32 s24, s19, 0
buffer_load_dwordx4 v8, s[4:7], s24 offen sc1 lds
s_add_u32 m0, s22, 1024
s_add_u32 s24, s19, 16384
buffer_load_dwordx4 v9, s[4:7], s24 offen sc1 lds
s_add_u32 m0, s23, 0
s_add_u32 s25, s20, 0
buffer_load_dwordx4 v10, s[8:11], s25 offen lds
s_add_u32 m0, s22, 24576
s_add_u32 s24, s19, 128
buffer_load_dwordx4 v8, s[4:7], s24 offen sc1 lds
s_add_u32 m0, s22, 25600
s_add_u32 s24, s19, 16512
buffer_load_dwordx4 v9, s[4:7], s24 offen sc1 lds
s_add_u32 m0, s23, 24576
s_add_u32 s25, s20, 458752
buffer_load_dwordx4 v10, s[8:11], s25 offen lds
v_accvgpr_write_b32 a0, 0
v_accvgpr_write_b32 a1, 0
v_accvgpr_write_b32 a2, 0
v_accvgpr_write_b32 a3, 0
v_accvgpr_write_b32 a4, 0
v_accvgpr_write_b32 a5, 0
v_accvgpr_write_b32 a6, 0
v_accvgpr_write_b32 a7, 0
v_accvgpr_write_b32 a8, 0
v_accvgpr_write_b32 a9, 0
v_accvgpr_write_b32 a10, 0
v_accvgpr_write_b32 a11, 0
v_accvgpr_write_b32 a12, 0
v_accvgpr_write_b32 a13, 0
v_accvgpr_write_b32 a14, 0
v_accvgpr_write_b32 a15, 0
s_waitcnt vmcnt(3)
s_barrier
RB 32,13,0
RT 36,17,0
RT 38,17,512
RB 40,14,0
RT 44,17,2048
RT 46,17,2560
RB 48,15,0
RT 52,17,4096
RT 54,17,4608
s_waitcnt lgkmcnt(6)
MM 0,36,32
RB 56,16,0
RT 60,17,6144
RT 62,17,6656
s_add_u32 m0, s22, 49152
s_add_u32 s24, s19, 256
buffer_load_dwordx4 v8, s[4:7], s24 offen sc1 lds
s_add_u32 m0, s22, 50176
s_add_u32 s24, s19, 16640
buffer_load_dwordx4 v9, s[4:7], s24 offen sc1 lds
s_add_u32 m0, s23, 49152
s_add_u32 s25, s20, 917504
buffer_load_dwordx4 v10, s[8:11], s25 offen lds
s_waitcnt lgkmcnt(6) vmcnt(3)
s_barrier
MM 0,44,40
RB 32,13,24576
RT 36,17,24576
RT 38,17,25088
s_add_u32 m0, s22, 73728
s_add_u32 s24, s19, 384
buffer_load_dwordx4 v8, s[4:7], s24 offen sc1 lds
s_waitcnt lgkmcnt(6)
MM 0,52,48
RB 40,14,24576
RT 44,17,26624
RT 46,17,27136
s_add_u32 m0, s22, 74752
s_add_u32 s24, s19, 16768
buffer_load_dwordx4 v9, s[4:7], s24 offen sc1 lds
s_add_u32 m0, s23, 73728
s_add_u32 s25, s20, 1376256
buffer_load_dwordx4 v10, s[8:11], s25 offen lds
s_waitcnt lgkmcnt(6)
MM 0,60,56
RB 48,15,24576
RT 52,17,28672
RT 54,17,29184
s_add_u32 m0, s22, 98304
s_add_u32 s24, s19, 512
buffer_load_dwordx4 v8, s[4:7], s24 offen sc1 lds
s_waitcnt lgkmcnt(6)
MM 0,36,32
RB 56,16,24576
RT 60,17,30720
RT 62,17,31232
s_add_u32 m0, s22, 99328
s_add_u32 s24, s19, 16896
buffer_load_dwordx4 v9, s[4:7], s24 offen sc1 lds
s_add_u32 m0, s23, 98304
s_add_u32 s25, s20, 1835008
buffer_load_dwordx4 v10, s[8:11], s25 offen lds
s_waitcnt lgkmcnt(6) vmcnt(6)
s_barrier
MM 0,44,40
RB 32,18,0
RT 36,22,0
RT 38,22,512
s_add_u32 m0, s22, 122880
s_add_u32 s24, s19, 640
buffer_load_dwordx4 v8, s[4:7], s24 offen sc1 lds
s_waitcnt lgkmcnt(6)
MM 0,52,48
RB 40,19,0
RT 44,22,2048
RT 46,22,2560
s_add_u32 m0, s22, 123904
s_add_u32 s24, s19, 17024
buffer_load_dwordx4 v9, s[4:7], s24 offen sc1 lds
s_add_u32 m0, s23, 122880
s_add_u32 s25, s20, 2293760
buffer_load_dwordx4 v10, s[8:11], s25 offen lds
s_waitcnt lgkmcnt(6)
MM 0,60,56
RB 48,20,0
RT 52,22,4096
RT 54,22,4608
s_add_u32 m0, s22, 0
s_add_u32 s24, s19, 768
buffer_load_dwordx4 v8, s[4:7], s24 offen sc1 lds
s_waitcnt lgkmcnt(6)
MM 0,36,32
RB 56,21,0
RT 60,22,6144
RT 62,22,6656
s_add_u32 m0, s22, 1024
s_add_u32 s24, s19, 17152
buffer_load_dwordx4 v9, s[4:7], s24 offen sc1 lds
s_add_u32 m0, s23, 0
s_add_u32 s25, s20, 2752512
buffer_load_dwordx4 v10, s[8:11], s25 offen lds
s_waitcnt lgkmcnt(6) vmcnt(9)
s_barrier
MM 0,44,40
RB 32,18,24576
RT 36,22,24576
RT 38,22,25088
s_waitcnt lgkmcnt(6)
MM 0,52,48
RB 40,19,24576
RT 44,22,26624
RT 46,22,27136
s_add_u32 m0, s22, 24576
s_add_u32 s24, s19, 896
buffer_load_dwordx4 v8, s[4:7], s24 offen sc1 lds
s_waitcnt lgkmcnt(6)
MM 0,60,56
RB 48,20,24576
RT 52,22,28672
RT 54,22,29184
s_add_u32 m0, s22, 25600
s_add_u32 s24, s19, 17280
buffer_load_dwordx4 v9, s[4:7], s24 offen sc1 lds
s_waitcnt lgkmcnt(6)
MM 0,36,32
RB 56,21,24576
RT 60,22,30720
RT 62,22,31232
s_add_u32 m0, s23, 24576
s_add_u32 s25, s20, 3211264
buffer_load_dwordx4 v10, s[8:11], s25 offen lds
s_waitcnt lgkmcnt(6) vmcnt(9)
s_barrier
MM 0,44,40
RB 32,23,0
RT 36,27,0
RT 38,27,512
s_waitcnt lgkmcnt(6)
MM 0,52,48
RB 40,24,0
RT 44,27,2048
RT 46,27,2560
s_add_u32 m0, s22, 49152
s_add_u32 s24, s19, 1024
buffer_load_dwordx4 v8, s[4:7], s24 offen sc1 lds
s_waitcnt lgkmcnt(6)
MM 0,60,56
RB 48,25,0
RT 52,27,4096
RT 54,27,4608
s_add_u32 m0, s22, 50176
s_add_u32 s24, s19, 17408
buffer_load_dwordx4 v9, s[4:7], s24 offen sc1 lds
s_waitcnt lgkmcnt(6)
MM 0,36,32
RB 56,26,0
RT 60,27,6144
RT 62,27,6656
s_add_u32 m0, s23, 49152
s_add_u32 s25, s20, 3670016
buffer_load_dwordx4 v10, s[8:11], s25 offen lds
s_waitcnt lgkmcnt(6) vmcnt(9)
s_barrier
MM 0,44,40
RB 32,23,24576
RT 36,27,24576
RT 38,27,25088
s_waitcnt lgkmcnt(6)
MM 0,52,48
RB 40,24,24576
RT 44,27,26624
RT 46,27,27136
s_add_u32 m0, s22, 73728
s_add_u32 s24, s19, 1152
buffer_load_dwordx4 v8, s[4:7], s24 offen sc1 lds
s_waitcnt lgkmcnt(6)
MM 0,60,56
RB 48,25,24576
RT 52,27,28672
RT 54,27,29184
s_add_u32 m0, s22, 74752
s_add_u32 s24, s19, 17536
buffer_load_dwordx4 v9, s[4:7], s24 offen sc1 lds
s_waitcnt lgkmcnt(6)
MM 0,36,32
RB 56,26,24576
RT 60,27,30720
RT 62,27,31232
s_add_u32 m0, s23, 73728
s_add_u32 s25, s20, 4128768
buffer_load_dwordx4 v10, s[8:11], s25 offen lds
s_waitcnt lgkmcnt(6) vmcnt(9)
s_barrier
MM 0,44,40
RB 32,13,0
RT 36,17,0
RT 38,17,512
s_waitcnt lgkmcnt(6)
MM 0,52,48
RB 40,14,0
RT 44,17,2048
RT 46,17,2560
s_add_u32 m0, s22, 98304
s_add_u32 s24, s19, 1280
buffer_load_dwordx4 v8, s[4:7], s24 offen sc1 lds
s_waitcnt lgkmcnt(6)
MM 0,60,56
RB 48,15,0
RT 52,17,4096
RT 54,17,4608
s_add_u32 m0, s22, 99328
s_add_u32 s24, s19, 17664
buffer_load_dwordx4 v9, s[4:7], s24 offen sc1 lds
s_waitcnt lgkmcnt(6)
MM 0,36,32
RB 56,16,0
RT 60,17,6144
RT 62,17,6656
s_add_u32 m0, s23, 98304
s_add_u32 s25, s20, 4587520
buffer_load_dwordx4 v10, s[8:11], s25 offen lds
s_waitcnt lgkmcnt(6) vmcnt(9)
s_barrier
MM 0,44,40
RB 32,13,24576
RT 36,17,24576
RT 38,17,25088
s_waitcnt lgkmcnt(6)
MM 0,52,48
RB 40,14,24576
RT 44,17,26624
RT 46,17,27136
s_add_u32 m0, s22, 122880
s_add_u32 s24, s19, 1408
buffer_load_dwordx4 v8, s[4:7], s24 offen sc1 lds
s_waitcnt lgkmcnt(6)
MM 0,60,56
RB 48,15,24576
RT 52,17,28672
RT 54,17,29184
s_add_u32 m0, s22, 123904
s_add_u32 s24, s19, 17792
buffer_load_dwordx4 v9, s[4:7], s24 offen sc1 lds
s_waitcnt lgkmcnt(6)
MM 0,36,32
RB 56,16,24576
RT 60,17,30720
RT 62,17,31232
s_add_u32 m0, s23, 122880
s_add_u32 s25, s20, 5046272
buffer_load_dwordx4 v10, s[8:11], s25 offen lds
s_waitcnt lgkmcnt(6) vmcnt(9)
s_barrier
MM 0,44,40
RB 32,18,0
RT 36,22,0
RT 38,22,512
s_waitcnt lgkmcnt(6)
MM 0,52,48
RB 40,19,0
RT 44,22,2048
RT 46,22,2560
s_add_u32 m0, s22, 0
s_add_u32 s24, s19, 1536
buffer_load_dwordx4 v8, s[4:7], s24 offen sc1 lds
s_waitcnt lgkmcnt(6)
MM 0,60,56
RB 48,20,0
RT 52,22,4096
RT 54,22,4608
s_add_u32 m0, s22, 1024
s_add_u32 s24, s19, 17920
buffer_load_dwordx4 v9, s[4:7], s24 offen sc1 lds
s_waitcnt lgkmcnt(6)
MM 0,36,32
RB 56,21,0
RT 60,22,6144
RT 62,22,6656
s_add_u32 m0, s23, 0
s_add_u32 s25, s20, 5505024
buffer_load_dwordx4 v10, s[8:11], s25 offen lds
s_waitcnt lgkmcnt(6) vmcnt(9)
s_barrier
MM 0,44,40
RB 32,18,24576
RT 36,22,24576
RT 38,22,25088
s_waitcnt lgkmcnt(6)
MM 0,52,48
RB 40,19,24576
RT 44,22,26624
RT 46,22,27136
s_add_u32 m0, s22, 24576
s_add_u32 s24, s19, 1664
buffer_load_dwordx4 v8, s[4:7], s24 offen sc1 lds
s_waitcnt lgkmcnt(6)
MM 0,60,56
RB 48,20,24576
RT 52,22,28672
RT 54,22,29184
s_add_u32 m0, s22, 25600
s_add_u32 s24, s19, 18048
buffer_load_dwordx4 v9, s[4:7], s24 offen sc1 lds
s_waitcnt lgkmcnt(6)
MM 0,36,32
RB 56,21,24576
RT 60,22,30720
RT 62,22,31232
s_add_u32 m0, s23, 24576
s_add_u32 s25, s20, 5963776
buffer_load_dwordx4 v10, s[8:11], s25 offen lds
s_waitcnt lgkmcnt(6) vmcnt(9)
s_barrier
MM 0,44,40
RB 32,23,0
RT 36,27,0
RT 38,27,512
s_waitcnt lgkmcnt(6)
MM 0,52,48
RB 40,24,0
RT 44,27,2048
RT 46,27,2560
s_add_u32 m0, s22, 49152
s_add_u32 s24, s19, 1792
buffer_load_dwordx4 v8, s[4:7], s24 offen sc1 lds
s_waitcnt lgkmcnt(6)
MM 0,60,56
RB 48,25,0
RT 52,27,4096
RT 54,27,4608
s_add_u32 m0, s22, 50176
s_add_u32 s24, s19, 18176
buffer_load_dwordx4 v9, s[4:7], s24 offen sc1 lds
s_waitcnt lgkmcnt(6)
MM 0,36,32
RB 56,26,0
RT 60,27,6144
RT 62,27,6656
s_add_u32 m0, s23, 49152
s_add_u32 s25, s20, 6422528
buffer_load_dwordx4 v10, s[8:11], s25 offen lds
s_waitcnt lgkmcnt(6) vmcnt(9)
s_barrier
MM 0,44,40
RB 32,23,24576
RT 36,27,24576
RT 38,27,25088
s_waitcnt lgkmcnt(6)
MM 0,52,48
RB 40,24,24576
RT 44,27,26624
RT 46,27,27136
s_add_u32 m0, s22, 73728
s_add_u32 s24, s19, 1920
buffer_load_dwordx4 v8, s[4:7], s24 offen sc1 lds
s_waitcnt lgkmcnt(6)
MM 0,60,56
RB 48,25,24576
RT 52,27,28672
RT 54,27,29184
s_add_u32 m0, s22, 74752
s_add_u32 s24, s19, 18304
buffer_load_dwordx4 v9, s[4:7], s24 offen sc1 lds
s_waitcnt lgkmcnt(6)
MM 0,36,32
RB 56,26,24576
RT 60,27,30720
RT 62,27,31232
s_add_u32 m0, s23, 73728
s_add_u32 s25, s20, 6881280
buffer_load_dwordx4 v10, s[8:11], s25 offen lds
s_waitcnt lgkmcnt(6) vmcnt(9)
s_barrier
MM 0,44,40
RB 32,13,0
RT 36,17,0
RT 38,17,512
s_waitcnt lgkmcnt(6)
MM 0,52,48
RB 40,14,0
RT 44,17,2048
RT 46,17,2560
s_waitcnt lgkmcnt(6)
MM 0,60,56
RB 48,15,0
RT 52,17,4096
RT 54,17,4608
s_waitcnt lgkmcnt(6)
MM 0,36,32
RB 56,16,0
RT 60,17,6144
RT 62,17,6656
s_waitcnt lgkmcnt(6) vmcnt(6)
s_barrier
MM 0,44,40
RB 32,13,24576
RT 36,17,24576
RT 38,17,25088
s_waitcnt lgkmcnt(6)
MM 0,52,48
RB 40,14,24576
RT 44,17,26624
RT 46,17,27136
s_waitcnt lgkmcnt(6)
MM 0,60,56
RB 48,15,24576
RT 52,17,28672
RT 54,17,29184
s_waitcnt lgkmcnt(6)
MM 0,36,32
RB 56,16,24576
RT 60,17,30720
RT 62,17,31232
s_waitcnt lgkmcnt(6) vmcnt(3)
s_barrier
MM 0,44,40
RB 32,18,0
RT 36,22,0
RT 38,22,512
s_waitcnt lgkmcnt(6)
MM 0,52,48
RB 40,19,0
RT 44,22,2048
RT 46,22,2560
s_waitcnt lgkmcnt(6)
MM 0,60,56
RB 48,20,0
RT 52,22,4096
RT 54,22,4608
s_waitcnt lgkmcnt(6)
MM 0,36,32
RB 56,21,0
RT 60,22,6144
RT 62,22,6656
s_waitcnt lgkmcnt(6) vmcnt(0)
s_barrier
MM 0,44,40
RB 32,18,24576
RT 36,22,24576
RT 38,22,25088
s_waitcnt lgkmcnt(6)
MM 0,52,48
RB 40,19,24576
RT 44,22,26624
RT 46,22,27136
s_waitcnt lgkmcnt(6)
MM 0,60,56
RB 48,20,24576
RT 52,22,28672
RT 54,22,29184
s_waitcnt lgkmcnt(6)
MM 0,36,32
RB 56,21,24576
RT 60,22,30720
RT 62,22,31232
s_waitcnt lgkmcnt(0)
MM 0,44,40
s_waitcnt lgkmcnt(0)
MM 0,52,48
s_waitcnt lgkmcnt(0)
MM 0,60,56
s_barrier
s_cmp_lg_u32 s16, 0
s_cbranch_scc1 tt_191
v_mov_b32 v7, s56
v_accvgpr_write_b32 a127, 1
s_mov_b64 exec, 1
buffer_atomic_add a127, v7, s[4:7], 0 offen sc0
s_mov_b64 exec, -1
tt_191:
v_and_b32 v1, 31, v0
v_lshrrev_b32 v2, 5, v0
s_mul_i32 s24, s17, 4608
s_mul_i32 s25, s18, 64
s_add_u32 s24, s24, s25
v_mul_u32_u24 v3, 144, v1
v_lshl_add_u32 v3, v2, 4, v3
v_add_u32 v3, s24, v3
v_mov_b32 v72, 0xc0135761
v_mov_b32 v74, 0xbdd2d3e8
v_mov_b32 v76, 1.0
v_mov_b32 v73, 0xc0135761
v_mov_b32 v75, 0xbdd2d3e8
v_mov_b32 v77, 1.0
v_lshrrev_b32 v4, 3, v0
v_and_b32 v5, 7, v0
s_mul_i32 s24, s16, 16
v_add_u32 v4, s24, v4
v_mul_u32_u24 v6, 144, v4
v_lshl_add_u32 v6, v5, 4, v6
s_mov_b32 s24, 7168
v_mul_lo_u32 v12, v4, s24
v_lshl_add_u32 v12, v5, 4, v12
v_accvgpr_read_b32 v32, a0
v_accvgpr_read_b32 v33, a1
v_accvgpr_read_b32 v34, a2
v_accvgpr_read_b32 v35, a3
v_accvgpr_read_b32 v36, a4
v_accvgpr_read_b32 v37, a5
v_accvgpr_read_b32 v38, a6
v_accvgpr_read_b32 v39, a7
v_accvgpr_read_b32 v40, a8
v_accvgpr_read_b32 v41, a9
v_accvgpr_read_b32 v42, a10
v_accvgpr_read_b32 v43, a11
v_accvgpr_read_b32 v44, a12
v_accvgpr_read_b32 v45, a13
v_accvgpr_read_b32 v46, a14
v_accvgpr_read_b32 v47, a15
v_pk_mul_f32 v[64:65], v[32:33], v[32:33]
v_pk_mul_f32 v[66:67], v[34:35], v[34:35]
v_pk_fma_f32 v[64:65], v[64:65], v[74:75], v[72:73]
v_pk_fma_f32 v[66:67], v[66:67], v[74:75], v[72:73]
v_pk_mul_f32 v[64:65], v[64:65], v[32:33]
v_pk_mul_f32 v[66:67], v[66:67], v[34:35]
v_exp_f32 v64, v64
v_exp_f32 v66, v66
v_exp_f32 v65, v65
v_exp_f32 v67, v67
v_pk_add_f32 v[64:65], v[64:65], v[76:77]
v_pk_add_f32 v[66:67], v[66:67], v[76:77]
v_rcp_f32 v64, v64
v_rcp_f32 v66, v66
v_rcp_f32 v65, v65
v_rcp_f32 v67, v67
v_pk_mul_f32 v[32:33], v[32:33], v[64:65]
v_pk_mul_f32 v[34:35], v[34:35], v[66:67]
v_pk_mul_f32 v[64:65], v[36:37], v[36:37]
v_pk_mul_f32 v[66:67], v[38:39], v[38:39]
v_pk_fma_f32 v[64:65], v[64:65], v[74:75], v[72:73]
v_pk_fma_f32 v[66:67], v[66:67], v[74:75], v[72:73]
v_pk_mul_f32 v[64:65], v[64:65], v[36:37]
v_pk_mul_f32 v[66:67], v[66:67], v[38:39]
v_exp_f32 v64, v64
v_exp_f32 v66, v66
v_exp_f32 v65, v65
v_exp_f32 v67, v67
v_pk_add_f32 v[64:65], v[64:65], v[76:77]
v_pk_add_f32 v[66:67], v[66:67], v[76:77]
v_rcp_f32 v64, v64
v_rcp_f32 v66, v66
v_rcp_f32 v65, v65
v_rcp_f32 v67, v67
v_pk_mul_f32 v[36:37], v[36:37], v[64:65]
v_pk_mul_f32 v[38:39], v[38:39], v[66:67]
v_pk_mul_f32 v[64:65], v[40:41], v[40:41]
v_pk_mul_f32 v[66:67], v[42:43], v[42:43]
v_pk_fma_f32 v[64:65], v[64:65], v[74:75], v[72:73]
v_pk_fma_f32 v[66:67], v[66:67], v[74:75], v[72:73]
v_pk_mul_f32 v[64:65], v[64:65], v[40:41]
v_pk_mul_f32 v[66:67], v[66:67], v[42:43]
v_exp_f32 v64, v64
v_exp_f32 v66, v66
v_exp_f32 v65, v65
v_exp_f32 v67, v67
v_pk_add_f32 v[64:65], v[64:65], v[76:77]
v_pk_add_f32 v[66:67], v[66:67], v[76:77]
v_rcp_f32 v64, v64
v_rcp_f32 v66, v66
v_rcp_f32 v65, v65
v_rcp_f32 v67, v67
v_pk_mul_f32 v[40:41], v[40:41], v[64:65]
v_pk_mul_f32 v[42:43], v[42:43], v[66:67]
v_pk_mul_f32 v[64:65], v[44:45], v[44:45]
v_pk_mul_f32 v[66:67], v[46:47], v[46:47]
v_pk_fma_f32 v[64:65], v[64:65], v[74:75], v[72:73]
v_pk_fma_f32 v[66:67], v[66:67], v[74:75], v[72:73]
v_pk_mul_f32 v[64:65], v[64:65], v[44:45]
v_pk_mul_f32 v[66:67], v[66:67], v[46:47]
v_exp_f32 v64, v64
v_exp_f32 v66, v66
v_exp_f32 v65, v65
v_exp_f32 v67, v67
v_pk_add_f32 v[64:65], v[64:65], v[76:77]
v_pk_add_f32 v[66:67], v[66:67], v[76:77]
v_rcp_f32 v64, v64
v_rcp_f32 v66, v66
v_rcp_f32 v65, v65
v_rcp_f32 v67, v67
v_pk_mul_f32 v[44:45], v[44:45], v[64:65]
v_pk_mul_f32 v[46:47], v[46:47], v[66:67]
v_cvt_pk_bf16_f32 v48, v32, v33
v_cvt_pk_bf16_f32 v49, v34, v35
v_cvt_pk_bf16_f32 v50, v36, v37
v_cvt_pk_bf16_f32 v51, v38, v39
v_cvt_pk_bf16_f32 v52, v40, v41
v_cvt_pk_bf16_f32 v53, v42, v43
v_cvt_pk_bf16_f32 v54, v44, v45
v_cvt_pk_bf16_f32 v55, v46, v47
v_permlane32_swap_b32 v48, v50
v_permlane32_swap_b32 v49, v51
v_permlane32_swap_b32 v52, v54
v_permlane32_swap_b32 v53, v55
ds_write_b128 v3, v[48:51] offset:0
ds_write_b128 v3, v[52:55] offset:32
s_waitcnt lgkmcnt(0)
s_barrier
RB 32,6,0
RB 36,6,1152
s_waitcnt lgkmcnt(1)
s_add_u32 s24, s33, 0
buffer_store_dwordx4 v[32:35], v12, s[4:7], s24 offen sc1
s_waitcnt lgkmcnt(0)
s_add_u32 s24, s33, 57344
buffer_store_dwordx4 v[36:39], v12, s[4:7], s24 offen sc1
s_lshl_b32 s76, s77, 3
s_add_u32 s76, s76, s60
s_lshl_b32 s76, s76, 7
s_add_u32 s76, s76, 163840
s_waitcnt vmcnt(0)
s_barrier
s_cmp_lg_u32 s16, 0
s_cbranch_scc1 sig_192
v_mov_b32 v1, s76
v_mov_b32 v2, 1
s_mov_b64 exec, 1
buffer_atomic_add v2, v1, s[4:7], 0 offen
s_mov_b64 exec, -1
sig_192:
s_branch mega_kernel_wloop
mega_kernel_t15:
s_lshr_b32 s17, s16, 1
s_and_b32 s18, s16, 1
v_lshrrev_b32 v1, 3, v0
s_mov_b32 s24, 7168
v_mul_lo_u32 v1, v1, s24
v_lshrrev_b32 v2, 4, v0
v_and_b32 v3, 7, v0
s_mov_b32 s25, 0
s_xor_b32 s26, s25, 0
v_add_u32 v4, s26, v2
v_xor_b32 v4, v4, v3
v_lshl_add_u32 v8, v4, 4, v1
s_xor_b32 s26, s25, 4
v_add_u32 v4, s26, v2
v_xor_b32 v4, v4, v3
v_lshl_add_u32 v9, v4, 4, v1
v_lshrrev_b32 v1, 3, v0
v_and_b32 v3, 7, v0
s_mov_b32 s24, 2048
v_mul_lo_u32 v2, v1, s24
v_bfe_u32 v4, v1, 1, 1
v_lshlrev_b32 v4, 2, v4
v_xor_b32 v4, v4, v3
v_lshl_add_u32 v10, v4, 4, v2
v_bfe_u32 v4, v1, 1, 1
v_lshlrev_b32 v4, 2, v4
v_xor_b32 v4, v4, v3
v_lshl_add_u32 v11, v4, 4, v2
v_and_b32 v1, 31, v0
v_lshrrev_b32 v2, 5, v0
v_bfe_u32 v3, v1, 1, 3
s_mul_i32 s24, s17, 4096
v_lshlrev_b32 v4, 7, v1
v_add_u32 v4, s24, v4
v_add_u32 v5, 0, v2
v_xor_b32 v5, v5, v3
v_lshl_add_u32 v13, v5, 4, v4
v_add_u32 v5, 2, v2
v_xor_b32 v5, v5, v3
v_lshl_add_u32 v14, v5, 4, v4
v_add_u32 v5, 4, v2
v_xor_b32 v5, v5, v3
v_lshl_add_u32 v15, v5, 4, v4
v_add_u32 v5, 6, v2
v_xor_b32 v5, v5, v3
v_lshl_add_u32 v16, v5, 4, v4
v_and_b32 v1, 15, v0
v_lshrrev_b32 v2, 2, v1
v_lshrrev_b32 v3, 5, v0
v_lshl_add_u32 v3, v3, 3, v2
v_mul_u32_u24 v3, 128, v3
v_and_b32 v4, 3, v1
v_lshl_add_u32 v3, v4, 3, v3
v_bfe_u32 v4, v0, 4, 1
v_lshl_add_u32 v3, v4, 5, v3
v_add_u32 v3, 16384, v3
s_mul_i32 s24, s18, 1
s_add_u32 s24, s24, 0
v_bfe_u32 v4, v2, 1, 1
v_xor_b32 v4, s24, v4
v_lshl_add_u32 v17, v4, 6, v3
v_add_u32 v18, 49152, v13
v_add_u32 v19, 49152, v14
v_add_u32 v20, 49152, v15
v_add_u32 v21, 49152, v16
v_add_u32 v22, 49152, v17
v_add_u32 v23, 98304, v13
v_add_u32 v24, 98304, v14
v_add_u32 v25, 98304, v15
v_add_u32 v26, 98304, v16
v_add_u32 v27, 98304, v17
s_mul_i32 s22, s16, 2048
s_mul_i32 s23, s16, 1024
s_add_u32 s23, s23, 16384
s_mov_b32 s8, s86
s_and_b32 s9, s87, 0xffff
s_mov_b32 s10, 0x700000
s_mov_b32 s11, 0x00020000
s_lshl_b32 s28, s77, 7
s_lshl_b32 s52, s77, 6
s_add_u32 s52, s52, 960
s_cmp_ge_u32 s77, 15
s_cselect_b32 s28, s52, s28
s_lshl_b32 s29, s60, 7
s_and_b32 s24, s79, 1
s_lshl_b32 s24, s24, 6
s_add_u32 s29, s29, s24
s_mul_i32 s24, s16, 16
s_add_u32 s24, s24, s28
s_mul_i32 s19, s24, 7168
s_add_u32 s19, s19, 106962944
s_mul_i32 s20, s16, 16384
s_lshl_b32 s24, s29, 1
s_add_u32 s20, s20, s24
s_lshr_b32 s25, s79, 1
s_mul_i32 s24, s25, 1792
s_add_u32 s19, s19, s24
s_lshr_b32 s25, s79, 1
s_mul_i32 s24, s25, 1835008
s_add_u32 s20, s20, s24
s_mul_i32 s24, s28, 4096
s_mul_i32 s25, s29, 4
s_add_u32 s24, s24, s25
s_lshr_b32 s25, s79, 1
s_mul_i32 s25, s25, 8388608
s_add_u32 s33, s24, s25
s_add_u32 s33, s33, 155197440
s_mov_b32 s34, 0
s_mov_b32 s35, 0
s_lshl_b32 s76, s77, 10
s_add_u32 s76, s76, 163840
s_cmp_lg_u32 s16, 0
s_cbranch_scc1 ws_193
v_lshlrev_b32 v1, 7, v0
v_add_u32 v1, s76, v1
s_mov_b64 exec, 0xff
wsp_194:
s_add_u32 s63, s63, 1
s_cmp_gt_u32 s63, 262144
s_cbranch_scc0 go_196
s_endpgm
go_196:
buffer_load_dword v3, v1, s[4:7], 0 offen sc1
s_waitcnt vmcnt(0)
s_mov_b32 s26, 0
v_readlane_b32 s27, v3, 0
s_nop 0
s_add_u32 s26, s26, s27
v_readlane_b32 s27, v3, 1
s_nop 0
s_add_u32 s26, s26, s27
v_readlane_b32 s27, v3, 2
s_nop 0
s_add_u32 s26, s26, s27
v_readlane_b32 s27, v3, 3
s_nop 0
s_add_u32 s26, s26, s27
v_readlane_b32 s27, v3, 4
s_nop 0
s_add_u32 s26, s26, s27
v_readlane_b32 s27, v3, 5
s_nop 0
s_add_u32 s26, s26, s27
v_readlane_b32 s27, v3, 6
s_nop 0
s_add_u32 s26, s26, s27
v_readlane_b32 s27, v3, 7
s_nop 0
s_add_u32 s26, s26, s27
s_sub_i32 s26, 56, s26
s_cmp_lt_i32 s26, 1
s_cbranch_scc1 wsd_195
s_cmp_lt_u32 s77, 13
s_cbranch_scc1 urg_197
s_sleep 2
s_branch wsp_194
urg_197:
s_cmp_lt_i32 s26, 3
s_cbranch_scc1 lv_198
s_sleep 40
s_branch wsp_194
lv_198:
s_cmp_lt_i32 s26, 1
s_cbranch_scc1 lv_199
s_sleep 12
s_branch wsp_194
lv_199:
s_sleep 8
s_branch wsp_194
wsd_195:
s_mov_b64 exec, -1
ws_193:
s_barrier
s_add_u32 m0, s22, 0
s_add_u32 s24, s19, 0
buffer_load_dwordx4 v8, s[4:7], s24 offen sc1 lds
s_add_u32 m0, s22, 1024
s_add_u32 s24, s19, 57344
buffer_load_dwordx4 v9, s[4:7], s24 offen sc1 lds
s_add_u32 m0, s23, 0
s_add_u32 s25, s20, 0
buffer_load_dwordx4 v10, s[8:11], s25 offen lds
s_add_u32 m0, s22, 24576
s_add_u32 s24, s19, 128
buffer_load_dwordx4 v8, s[4:7], s24 offen sc1 lds
s_add_u32 m0, s22, 25600
s_add_u32 s24, s19, 57472
buffer_load_dwordx4 v9, s[4:7], s24 offen sc1 lds
s_add_u32 m0, s23, 24576
s_add_u32 s25, s20, 131072
buffer_load_dwordx4 v10, s[8:11], s25 offen lds
v_accvgpr_write_b32 a0, 0
v_accvgpr_write_b32 a1, 0
v_accvgpr_write_b32 a2, 0
v_accvgpr_write_b32 a3, 0
v_accvgpr_write_b32 a4, 0
v_accvgpr_write_b32 a5, 0
v_accvgpr_write_b32 a6, 0
v_accvgpr_write_b32 a7, 0
v_accvgpr_write_b32 a8, 0
v_accvgpr_write_b32 a9, 0
v_accvgpr_write_b32 a10, 0
v_accvgpr_write_b32 a11, 0
v_accvgpr_write_b32 a12, 0
v_accvgpr_write_b32 a13, 0
v_accvgpr_write_b32 a14, 0
v_accvgpr_write_b32 a15, 0
s_waitcnt vmcnt(3)
s_barrier
RB 32,13,0
RT 36,17,0
RT 38,17,512
RB 40,14,0
RT 44,17,2048
RT 46,17,2560
RB 48,15,0
RT 52,17,4096
RT 54,17,4608
s_waitcnt lgkmcnt(6)
MM 0,36,32
RB 56,16,0
RT 60,17,6144
RT 62,17,6656
s_add_u32 m0, s22, 49152
s_add_u32 s24, s19, 256
buffer_load_dwordx4 v8, s[4:7], s24 offen sc1 lds
s_add_u32 m0, s22, 50176
s_add_u32 s24, s19, 57600
buffer_load_dwordx4 v9, s[4:7], s24 offen sc1 lds
s_add_u32 m0, s23, 49152
s_add_u32 s25, s20, 262144
buffer_load_dwordx4 v10, s[8:11], s25 offen lds
s_waitcnt lgkmcnt(6) vmcnt(3)
s_barrier
MM 0,44,40
RB 32,13,24576
RT 36,17,24576
RT 38,17,25088
s_add_u32 m0, s22, 73728
s_add_u32 s24, s19, 384
buffer_load_dwordx4 v8, s[4:7], s24 offen sc1 lds
s_waitcnt lgkmcnt(6)
MM 0,52,48
RB 40,14,24576
RT 44,17,26624
RT 46,17,27136
s_add_u32 m0, s22, 74752
s_add_u32 s24, s19, 57728
buffer_load_dwordx4 v9, s[4:7], s24 offen sc1 lds
s_add_u32 m0, s23, 73728
s_add_u32 s25, s20, 393216
buffer_load_dwordx4 v10, s[8:11], s25 offen lds
s_waitcnt lgkmcnt(6)
MM 0,60,56
RB 48,15,24576
RT 52,17,28672
RT 54,17,29184
s_add_u32 m0, s22, 98304
s_add_u32 s24, s19, 512
buffer_load_dwordx4 v8, s[4:7], s24 offen sc1 lds
s_waitcnt lgkmcnt(6)
MM 0,36,32
RB 56,16,24576
RT 60,17,30720
RT 62,17,31232
s_add_u32 m0, s22, 99328
s_add_u32 s24, s19, 57856
buffer_load_dwordx4 v9, s[4:7], s24 offen sc1 lds
s_add_u32 m0, s23, 98304
s_add_u32 s25, s20, 524288
buffer_load_dwordx4 v10, s[8:11], s25 offen lds
s_waitcnt lgkmcnt(6) vmcnt(6)
s_barrier
MM 0,44,40
RB 32,18,0
RT 36,22,0
RT 38,22,512
s_add_u32 m0, s22, 122880
s_add_u32 s24, s19, 640
buffer_load_dwordx4 v8, s[4:7], s24 offen sc1 lds
s_waitcnt lgkmcnt(6)
MM 0,52,48
RB 40,19,0
RT 44,22,2048
RT 46,22,2560
s_add_u32 m0, s22, 123904
s_add_u32 s24, s19, 57984
buffer_load_dwordx4 v9, s[4:7], s24 offen sc1 lds
s_add_u32 m0, s23, 122880
s_add_u32 s25, s20, 655360
buffer_load_dwordx4 v10, s[8:11], s25 offen lds
s_waitcnt lgkmcnt(6)
MM 0,60,56
RB 48,20,0
RT 52,22,4096
RT 54,22,4608
s_add_u32 m0, s22, 0
s_add_u32 s24, s19, 768
buffer_load_dwordx4 v8, s[4:7], s24 offen sc1 lds
s_waitcnt lgkmcnt(6)
MM 0,36,32
RB 56,21,0
RT 60,22,6144
RT 62,22,6656
s_add_u32 m0, s22, 1024
s_add_u32 s24, s19, 58112
buffer_load_dwordx4 v9, s[4:7], s24 offen sc1 lds
s_add_u32 m0, s23, 0
s_add_u32 s25, s20, 786432
buffer_load_dwordx4 v10, s[8:11], s25 offen lds
s_waitcnt lgkmcnt(6) vmcnt(9)
s_barrier
MM 0,44,40
RB 32,18,24576
RT 36,22,24576
RT 38,22,25088
s_waitcnt lgkmcnt(6)
MM 0,52,48
RB 40,19,24576
RT 44,22,26624
RT 46,22,27136
s_add_u32 m0, s22, 24576
s_add_u32 s24, s19, 896
buffer_load_dwordx4 v8, s[4:7], s24 offen sc1 lds
s_waitcnt lgkmcnt(6)
MM 0,60,56
RB 48,20,24576
RT 52,22,28672
RT 54,22,29184
s_add_u32 m0, s22, 25600
s_add_u32 s24, s19, 58240
buffer_load_dwordx4 v9, s[4:7], s24 offen sc1 lds
s_waitcnt lgkmcnt(6)
MM 0,36,32
RB 56,21,24576
RT 60,22,30720
RT 62,22,31232
s_add_u32 m0, s23, 24576
s_add_u32 s25, s20, 917504
buffer_load_dwordx4 v10, s[8:11], s25 offen lds
s_waitcnt lgkmcnt(6) vmcnt(9)
s_barrier
MM 0,44,40
RB 32,23,0
RT 36,27,0
RT 38,27,512
s_waitcnt lgkmcnt(6)
MM 0,52,48
RB 40,24,0
RT 44,27,2048
RT 46,27,2560
s_add_u32 m0, s22, 49152
s_add_u32 s24, s19, 1024
buffer_load_dwordx4 v8, s[4:7], s24 offen sc1 lds
s_waitcnt lgkmcnt(6)
MM 0,60,56
RB 48,25,0
RT 52,27,4096
RT 54,27,4608
s_add_u32 m0, s22, 50176
s_add_u32 s24, s19, 58368
buffer_load_dwordx4 v9, s[4:7], s24 offen sc1 lds
s_waitcnt lgkmcnt(6)
MM 0,36,32
RB 56,26,0
RT 60,27,6144
RT 62,27,6656
s_add_u32 m0, s23, 49152
s_add_u32 s25, s20, 1048576
buffer_load_dwordx4 v10, s[8:11], s25 offen lds
s_waitcnt lgkmcnt(6) vmcnt(9)
s_barrier
MM 0,44,40
RB 32,23,24576
RT 36,27,24576
RT 38,27,25088
s_waitcnt lgkmcnt(6)
MM 0,52,48
RB 40,24,24576
RT 44,27,26624
RT 46,27,27136
s_add_u32 m0, s22, 73728
s_add_u32 s24, s19, 1152
buffer_load_dwordx4 v8, s[4:7], s24 offen sc1 lds
s_waitcnt lgkmcnt(6)
MM 0,60,56
RB 48,25,24576
RT 52,27,28672
RT 54,27,29184
s_add_u32 m0, s22, 74752
s_add_u32 s24, s19, 58496
buffer_load_dwordx4 v9, s[4:7], s24 offen sc1 lds
s_waitcnt lgkmcnt(6)
MM 0,36,32
RB 56,26,24576
RT 60,27,30720
RT 62,27,31232
s_add_u32 m0, s23, 73728
s_add_u32 s25, s20, 1179648
buffer_load_dwordx4 v10, s[8:11], s25 offen lds
s_waitcnt lgkmcnt(6) vmcnt(9)
s_barrier
MM 0,44,40
RB 32,13,0
RT 36,17,0
RT 38,17,512
s_waitcnt lgkmcnt(6)
MM 0,52,48
RB 40,14,0
RT 44,17,2048
RT 46,17,2560
s_add_u32 m0, s22, 98304
s_add_u32 s24, s19, 1280
buffer_load_dwordx4 v8, s[4:7], s24 offen sc1 lds
s_waitcnt lgkmcnt(6)
MM 0,60,56
RB 48,15,0
RT 52,17,4096
RT 54,17,4608
s_add_u32 m0, s22, 99328
s_add_u32 s24, s19, 58624
buffer_load_dwordx4 v9, s[4:7], s24 offen sc1 lds
s_waitcnt lgkmcnt(6)
MM 0,36,32
RB 56,16,0
RT 60,17,6144
RT 62,17,6656
s_add_u32 m0, s23, 98304
s_add_u32 s25, s20, 1310720
buffer_load_dwordx4 v10, s[8:11], s25 offen lds
s_waitcnt lgkmcnt(6) vmcnt(9)
s_barrier
MM 0,44,40
RB 32,13,24576
RT 36,17,24576
RT 38,17,25088
s_waitcnt lgkmcnt(6)
MM 0,52,48
RB 40,14,24576
RT 44,17,26624
RT 46,17,27136
s_add_u32 m0, s22, 122880
s_add_u32 s24, s19, 1408
buffer_load_dwordx4 v8, s[4:7], s24 offen sc1 lds
s_waitcnt lgkmcnt(6)
MM 0,60,56
RB 48,15,24576
RT 52,17,28672
RT 54,17,29184
s_add_u32 m0, s22, 123904
s_add_u32 s24, s19, 58752
buffer_load_dwordx4 v9, s[4:7], s24 offen sc1 lds
s_waitcnt lgkmcnt(6)
MM 0,36,32
RB 56,16,24576
RT 60,17,30720
RT 62,17,31232
s_add_u32 m0, s23, 122880
s_add_u32 s25, s20, 1441792
buffer_load_dwordx4 v10, s[8:11], s25 offen lds
s_waitcnt lgkmcnt(6) vmcnt(9)
s_barrier
MM 0,44,40
RB 32,18,0
RT 36,22,0
RT 38,22,512
s_waitcnt lgkmcnt(6)
MM 0,52,48
RB 40,19,0
RT 44,22,2048
RT 46,22,2560
s_add_u32 m0, s22, 0
s_add_u32 s24, s19, 1536
buffer_load_dwordx4 v8, s[4:7], s24 offen sc1 lds
s_waitcnt lgkmcnt(6)
MM 0,60,56
RB 48,20,0
RT 52,22,4096
RT 54,22,4608
s_add_u32 m0, s22, 1024
s_add_u32 s24, s19, 58880
buffer_load_dwordx4 v9, s[4:7], s24 offen sc1 lds
s_waitcnt lgkmcnt(6)
MM 0,36,32
RB 56,21,0
RT 60,22,6144
RT 62,22,6656
s_add_u32 m0, s23, 0
s_add_u32 s25, s20, 1572864
buffer_load_dwordx4 v10, s[8:11], s25 offen lds
s_waitcnt lgkmcnt(6) vmcnt(9)
s_barrier
MM 0,44,40
RB 32,18,24576
RT 36,22,24576
RT 38,22,25088
s_waitcnt lgkmcnt(6)
MM 0,52,48
RB 40,19,24576
RT 44,22,26624
RT 46,22,27136
s_add_u32 m0, s22, 24576
s_add_u32 s24, s19, 1664
buffer_load_dwordx4 v8, s[4:7], s24 offen sc1 lds
s_waitcnt lgkmcnt(6)
MM 0,60,56
RB 48,20,24576
RT 52,22,28672
RT 54,22,29184
s_add_u32 m0, s22, 25600
s_add_u32 s24, s19, 59008
buffer_load_dwordx4 v9, s[4:7], s24 offen sc1 lds
s_waitcnt lgkmcnt(6)
MM 0,36,32
RB 56,21,24576
RT 60,22,30720
RT 62,22,31232
s_add_u32 m0, s23, 24576
s_add_u32 s25, s20, 1703936
buffer_load_dwordx4 v10, s[8:11], s25 offen lds
s_waitcnt lgkmcnt(6) vmcnt(9)
s_barrier
MM 0,44,40
RB 32,23,0
RT 36,27,0
RT 38,27,512
s_waitcnt lgkmcnt(6)
MM 0,52,48
RB 40,24,0
RT 44,27,2048
RT 46,27,2560
s_waitcnt lgkmcnt(6)
MM 0,60,56
RB 48,25,0
RT 52,27,4096
RT 54,27,4608
s_waitcnt lgkmcnt(6)
MM 0,36,32
RB 56,26,0
RT 60,27,6144
RT 62,27,6656
s_waitcnt lgkmcnt(6) vmcnt(6)
s_barrier
MM 0,44,40
RB 32,23,24576
RT 36,27,24576
RT 38,27,25088
s_waitcnt lgkmcnt(6)
MM 0,52,48
RB 40,24,24576
RT 44,27,26624
RT 46,27,27136
s_waitcnt lgkmcnt(6)
MM 0,60,56
RB 48,25,24576
RT 52,27,28672
RT 54,27,29184
s_waitcnt lgkmcnt(6)
MM 0,36,32
RB 56,26,24576
RT 60,27,30720
RT 62,27,31232
s_waitcnt lgkmcnt(6) vmcnt(3)
s_barrier
MM 0,44,40
RB 32,13,0
RT 36,17,0
RT 38,17,512
s_waitcnt lgkmcnt(6)
MM 0,52,48
RB 40,14,0
RT 44,17,2048
RT 46,17,2560
s_waitcnt lgkmcnt(6)
MM 0,60,56
RB 48,15,0
RT 52,17,4096
RT 54,17,4608
s_waitcnt lgkmcnt(6)
MM 0,36,32
RB 56,16,0
RT 60,17,6144
RT 62,17,6656
s_waitcnt lgkmcnt(6) vmcnt(0)
s_barrier
MM 0,44,40
RB 32,13,24576
RT 36,17,24576
RT 38,17,25088
s_waitcnt lgkmcnt(6)
MM 0,52,48
RB 40,14,24576
RT 44,17,26624
RT 46,17,27136
s_waitcnt lgkmcnt(6)
MM 0,60,56
RB 48,15,24576
RT 52,17,28672
RT 54,17,29184
s_waitcnt lgkmcnt(6)
MM 0,36,32
RB 56,16,24576
RT 60,17,30720
RT 62,17,31232
s_waitcnt lgkmcnt(0)
MM 0,44,40
s_waitcnt lgkmcnt(0)
MM 0,52,48
s_waitcnt lgkmcnt(0)
MM 0,60,56
s_barrier
s_cmp_lg_u32 s16, 0
s_cbranch_scc1 tt_200
v_mov_b32 v7, s56
v_accvgpr_write_b32 a127, 1
s_mov_b64 exec, 1
buffer_atomic_add a127, v7, s[4:7], 0 offen sc0
s_mov_b64 exec, -1
tt_200:
v_and_b32 v1, 31, v0
v_lshrrev_b32 v2, 5, v0
s_mul_i32 s24, s17, 8704
s_mul_i32 s25, s18, 128
s_add_u32 s24, s24, s25
v_mul_u32_u24 v3, 272, v1
v_lshl_add_u32 v3, v2, 4, v3
v_add_u32 v3, s24, v3
v_lshrrev_b32 v4, 4, v0
v_and_b32 v5, 15, v0
s_mul_i32 s24, s16, 16
v_add_u32 v4, s24, v4
v_mul_u32_u24 v6, 272, v4
v_lshl_add_u32 v6, v5, 4, v6
s_mov_b32 s24, 4096
v_mul_lo_u32 v12, v4, s24
v_lshl_add_u32 v12, v5, 4, v12
ds_write_b128 v3, a[0:3] offset:0
ds_write_b128 v3, a[4:7] offset:32
ds_write_b128 v3, a[8:11] offset:64
ds_write_b128 v3, a[12:15] offset:96
s_waitcnt lgkmcnt(0)
s_barrier
RB 32,6,0
RB 36,6,1088
RB 40,6,2176
RB 44,6,3264
s_waitcnt lgkmcnt(3)
s_add_u32 s24, s33, 0
buffer_store_dwordx4 v[32:35], v12, s[4:7], s24 offen sc1
s_waitcnt lgkmcnt(2)
s_add_u32 s24, s33, 16384
buffer_store_dwordx4 v[36:39], v12, s[4:7], s24 offen sc1
s_waitcnt lgkmcnt(1)
s_add_u32 s24, s33, 32768
buffer_store_dwordx4 v[40:43], v12, s[4:7], s24 offen sc1
s_waitcnt lgkmcnt(0)
s_add_u32 s24, s33, 49152
buffer_store_dwordx4 v[44:47], v12, s[4:7], s24 offen sc1
s_lshl_b32 s76, s77, 3
s_add_u32 s76, s76, s60
s_lshl_b32 s76, s76, 7
s_add_u32 s76, s76, 196608
s_waitcnt vmcnt(0)
s_barrier
s_cmp_lg_u32 s16, 0
s_cbranch_scc1 sig_201
v_mov_b32 v1, s76
v_mov_b32 v2, 1
s_mov_b64 exec, 1
buffer_atomic_add v2, v1, s[4:7], 0 offen
s_mov_b64 exec, -1
sig_201:
s_branch mega_kernel_wloop
mega_kernel_t19:
s_bfe_u32 s17, s16, 65537
s_and_b32 s18, s16, 1
s_lshr_b32 s52, s16, 2
v_lshrrev_b32 v1, 3, v0
s_mov_b32 s24, 2048
v_mul_lo_u32 v1, v1, s24
v_lshrrev_b32 v2, 4, v0
v_and_b32 v3, 7, v0
s_and_b32 s25, s16, 1
s_lshl_b32 s25, s25, 2
v_add_u32 v4, s25, v2
v_xor_b32 v4, v4, v3
v_lshl_add_u32 v8, v4, 4, v1
v_lshrrev_b32 v1, 3, v0
v_and_b32 v3, 7, v0
s_mov_b32 s24, 2048
v_mul_lo_u32 v2, v1, s24
v_bfe_u32 v4, v1, 1, 1
v_lshlrev_b32 v4, 2, v4
v_xor_b32 v4, v4, v3
v_lshl_add_u32 v10, v4, 4, v2
v_and_b32 v1, 31, v0
v_lshrrev_b32 v2, 5, v0
v_bfe_u32 v3, v1, 1, 3
s_mul_i32 s24, s17, 4096
v_lshlrev_b32 v4, 7, v1
v_add_u32 v4, s24, v4
s_lshl_b32 s25, s52, 2
s_add_u32 s26, s25, 0
v_add_u32 v5, s26, v2
v_xor_b32 v5, v5, v3
v_lshl_add_u32 v13, v5, 4, v4
s_add_u32 s26, s25, 2
v_add_u32 v5, s26, v2
v_xor_b32 v5, v5, v3
v_lshl_add_u32 v14, v5, 4, v4
v_and_b32 v1, 15, v0
v_lshrrev_b32 v2, 2, v1
v_lshrrev_b32 v3, 5, v0
v_lshl_add_u32 v3, v3, 3, v2
s_lshl_b32 s24, s52, 5
v_add_u32 v3, s24, v3
v_lshlrev_b32 v3, 7, v3
v_and_b32 v4, 3, v1
v_lshl_add_u32 v3, v4, 3, v3
v_bfe_u32 v4, v0, 4, 1
v_lshl_add_u32 v3, v4, 5, v3
v_add_u32 v3, 8192, v3
v_bfe_u32 v4, v2, 1, 1
v_xor_b32 v4, s18, v4
v_lshl_add_u32 v15, v4, 6, v3
v_add_u32 v16, 65536, v13
v_add_u32 v17, 65536, v14
v_add_u32 v18, 65536, v15
s_lshl_b32 s22, s16, 10
s_add_u32 s23, s22, 8192
s_mov_b32 s8, s80
s_and_b32 s9, s81, 0xffff
s_mov_b32 s10, 0x200000
s_mov_b32 s11, 0x00020000
s_lshl_b32 s28, s77, 7
s_lshl_b32 s52, s77, 6
s_add_u32 s52, s52, 960
s_cmp_ge_u32 s77, 15
s_cselect_b32 s28, s52, s28
s_lshl_b32 s29, s60, 7
s_and_b32 s24, s79, 1
s_lshl_b32 s24, s24, 6
s_add_u32 s29, s29, s24
s_mul_i32 s24, s16, 8
s_add_u32 s24, s24, s28
s_mul_i32 s19, s24, 2048
s_add_u32 s19, s19, 90177536
s_mul_i32 s20, s16, 16384
s_lshl_b32 s24, s29, 1
s_add_u32 s20, s20, s24
s_mul_i32 s24, s28, 2048
s_mul_i32 s25, s29, 2
s_add_u32 s24, s24, s25
s_add_u32 s33, s24, 94375936
s_add_u32 s34, s24, 0
s_mov_b32 s35, 0
s_lshl_b32 s76, s77, 7
s_add_u32 s76, s76, 45056
s_cmp_lg_u32 s16, 0
s_cbranch_scc1 wf_202
v_mov_b32 v1, 0
v_mov_b32 v2, 0
v_writelane_b32 v1, s76, 0
s_mov_b32 s27, 16
v_writelane_b32 v2, s27, 0
s_mov_b64 exec, 1
wfp_203:
s_add_u32 s63, s63, 1
s_cmp_gt_u32 s63, 262144
s_cbranch_scc0 go_204
s_endpgm
go_204:
buffer_load_dword v3, v1, s[4:7], 0 offen sc1
s_waitcnt vmcnt(0)
v_cmp_lt_u32 vcc, v3, v2
s_nop 0
s_cbranch_vccz wfd_205
s_cmp_lt_u32 s77, 13
s_cbranch_scc1 urg_206
s_sleep 2
s_branch wfp_203
urg_206:
v_sub_u32 v4, v2, v3
s_nop 0
v_readlane_b32 s27, v4, 0
s_nop 0
s_cmp_lt_i32 s27, 2
s_cbranch_scc1 lv_207
s_sleep 40
s_branch wfp_203
lv_207:
s_cmp_lt_i32 s27, 1
s_cbranch_scc1 lv_208
s_sleep 12
s_branch wfp_203
lv_208:
s_sleep 8
s_branch wfp_203
wfd_205:
s_mov_b64 exec, -1
wf_202:
s_barrier
s_add_u32 m0, s22, 0
s_add_u32 s24, s19, 0
buffer_load_dwordx4 v8, s[4:7], s24 offen sc1 lds
s_add_u32 m0, s23, 0
s_add_u32 s25, s20, 0
buffer_load_dwordx4 v10, s[8:11], s25 offen lds
s_add_u32 m0, s22, 16384
s_add_u32 s24, s19, 128
buffer_load_dwordx4 v8, s[4:7], s24 offen sc1 lds
s_add_u32 m0, s23, 16384
s_add_u32 s25, s20, 131072
buffer_load_dwordx4 v10, s[8:11], s25 offen lds
s_add_u32 m0, s22, 32768
s_add_u32 s24, s19, 256
buffer_load_dwordx4 v8, s[4:7], s24 offen sc1 lds
s_add_u32 m0, s23, 32768
s_add_u32 s25, s20, 262144
buffer_load_dwordx4 v10, s[8:11], s25 offen lds
v_accvgpr_write_b32 a0, 0
v_accvgpr_write_b32 a1, 0
v_accvgpr_write_b32 a2, 0
v_accvgpr_write_b32 a3, 0
v_accvgpr_write_b32 a4, 0
v_accvgpr_write_b32 a5, 0
v_accvgpr_write_b32 a6, 0
v_accvgpr_write_b32 a7, 0
v_accvgpr_write_b32 a8, 0
v_accvgpr_write_b32 a9, 0
v_accvgpr_write_b32 a10, 0
v_accvgpr_write_b32 a11, 0
v_accvgpr_write_b32 a12, 0
v_accvgpr_write_b32 a13, 0
v_accvgpr_write_b32 a14, 0
v_accvgpr_write_b32 a15, 0
s_waitcnt vmcnt(4)
s_barrier
RB 32,13,0
RT 36,15,0
RT 38,15,512
RB 40,14,0
RT 44,15,2048
RT 46,15,2560
s_waitcnt vmcnt(2)
s_barrier
RB 48,13,16384
RT 52,15,16384
RT 54,15,16896
RB 56,14,16384
RT 60,15,18432
RT 62,15,18944
s_waitcnt lgkmcnt(6)
MM 0,36,32
MM 0,44,40
s_add_u32 m0, s22, 49152
s_add_u32 s24, s19, 384
buffer_load_dwordx4 v8, s[4:7], s24 offen sc1 lds
s_add_u32 m0, s23, 49152
s_add_u32 s25, s20, 393216
buffer_load_dwordx4 v10, s[8:11], s25 offen lds
s_add_u32 m0, s22, 65536
s_add_u32 s24, s19, 512
buffer_load_dwordx4 v8, s[4:7], s24 offen sc1 lds
s_add_u32 m0, s23, 65536
s_add_u32 s25, s20, 524288
buffer_load_dwordx4 v10, s[8:11], s25 offen lds
s_waitcnt vmcnt(4)
s_barrier
RB 32,13,32768
RT 36,15,32768
RT 38,15,33280
RB 40,14,32768
RT 44,15,34816
RT 46,15,35328
s_waitcnt lgkmcnt(6)
MM 0,52,48
MM 0,60,56
s_add_u32 m0, s22, 81920
s_add_u32 s24, s19, 640
buffer_load_dwordx4 v8, s[4:7], s24 offen sc1 lds
s_add_u32 m0, s23, 81920
s_add_u32 s25, s20, 655360
buffer_load_dwordx4 v10, s[8:11], s25 offen lds
s_add_u32 m0, s22, 0
s_add_u32 s24, s19, 768
buffer_load_dwordx4 v8, s[4:7], s24 offen sc1 lds
s_add_u32 m0, s23, 0
s_add_u32 s25, s20, 786432
buffer_load_dwordx4 v10, s[8:11], s25 offen lds
s_waitcnt vmcnt(6)
s_barrier
RB 48,13,49152
RT 52,15,49152
RT 54,15,49664
RB 56,14,49152
RT 60,15,51200
RT 62,15,51712
s_waitcnt lgkmcnt(6)
MM 0,36,32
MM 0,44,40
s_add_u32 m0, s22, 16384
s_add_u32 s24, s19, 896
buffer_load_dwordx4 v8, s[4:7], s24 offen sc1 lds
s_add_u32 m0, s23, 16384
s_add_u32 s25, s20, 917504
buffer_load_dwordx4 v10, s[8:11], s25 offen lds
s_waitcnt vmcnt(6)
s_barrier
RB 32,16,0
RT 36,18,0
RT 38,18,512
RB 40,17,0
RT 44,18,2048
RT 46,18,2560
s_waitcnt lgkmcnt(6)
MM 0,52,48
MM 0,60,56
s_add_u32 m0, s22, 32768
s_add_u32 s24, s19, 1024
buffer_load_dwordx4 v8, s[4:7], s24 offen sc1 lds
s_add_u32 m0, s23, 32768
s_add_u32 s25, s20, 1048576
buffer_load_dwordx4 v10, s[8:11], s25 offen lds
s_waitcnt vmcnt(6)
s_barrier
RB 48,16,16384
RT 52,18,16384
RT 54,18,16896
RB 56,17,16384
RT 60,18,18432
RT 62,18,18944
s_waitcnt lgkmcnt(6)
MM 0,36,32
MM 0,44,40
s_add_u32 m0, s22, 49152
s_add_u32 s24, s19, 1152
buffer_load_dwordx4 v8, s[4:7], s24 offen sc1 lds
s_add_u32 m0, s23, 49152
s_add_u32 s25, s20, 1179648
buffer_load_dwordx4 v10, s[8:11], s25 offen lds
s_waitcnt vmcnt(6)
s_barrier
RB 32,13,0
RT 36,15,0
RT 38,15,512
RB 40,14,0
RT 44,15,2048
RT 46,15,2560
s_waitcnt lgkmcnt(6)
MM 0,52,48
MM 0,60,56
s_add_u32 m0, s22, 65536
s_add_u32 s24, s19, 1280
buffer_load_dwordx4 v8, s[4:7], s24 offen sc1 lds
s_add_u32 m0, s23, 65536
s_add_u32 s25, s20, 1310720
buffer_load_dwordx4 v10, s[8:11], s25 offen lds
s_waitcnt vmcnt(6)
s_barrier
RB 48,13,16384
RT 52,15,16384
RT 54,15,16896
RB 56,14,16384
RT 60,15,18432
RT 62,15,18944
s_waitcnt lgkmcnt(6)
MM 0,36,32
MM 0,44,40
s_add_u32 m0, s22, 81920
s_add_u32 s24, s19, 1408
buffer_load_dwordx4 v8, s[4:7], s24 offen sc1 lds
s_add_u32 m0, s23, 81920
s_add_u32 s25, s20, 1441792
buffer_load_dwordx4 v10, s[8:11], s25 offen lds
s_waitcnt vmcnt(6)
s_barrier
RB 32,13,32768
RT 36,15,32768
RT 38,15,33280
RB 40,14,32768
RT 44,15,34816
RT 46,15,35328
s_waitcnt lgkmcnt(6)
MM 0,52,48
MM 0,60,56
s_add_u32 m0, s22, 0
s_add_u32 s24, s19, 1536
buffer_load_dwordx4 v8, s[4:7], s24 offen sc1 lds
s_add_u32 m0, s23, 0
s_add_u32 s25, s20, 1572864
buffer_load_dwordx4 v10, s[8:11], s25 offen lds
s_waitcnt vmcnt(6)
s_barrier
RB 48,13,49152
RT 52,15,49152
RT 54,15,49664
RB 56,14,49152
RT 60,15,51200
RT 62,15,51712
s_waitcnt lgkmcnt(6)
MM 0,36,32
MM 0,44,40
s_add_u32 m0, s22, 16384
s_add_u32 s24, s19, 1664
buffer_load_dwordx4 v8, s[4:7], s24 offen sc1 lds
s_add_u32 m0, s23, 16384
s_add_u32 s25, s20, 1703936
buffer_load_dwordx4 v10, s[8:11], s25 offen lds
s_waitcnt vmcnt(6)
s_barrier
RB 32,16,0
RT 36,18,0
RT 38,18,512
RB 40,17,0
RT 44,18,2048
RT 46,18,2560
s_waitcnt lgkmcnt(6)
MM 0,52,48
MM 0,60,56
s_add_u32 m0, s22, 32768
s_add_u32 s24, s19, 1792
buffer_load_dwordx4 v8, s[4:7], s24 offen sc1 lds
s_add_u32 m0, s23, 32768
s_add_u32 s25, s20, 1835008
buffer_load_dwordx4 v10, s[8:11], s25 offen lds
s_waitcnt vmcnt(6)
s_barrier
RB 48,16,16384
RT 52,18,16384
RT 54,18,16896
RB 56,17,16384
RT 60,18,18432
RT 62,18,18944
s_waitcnt lgkmcnt(6)
MM 0,36,32
MM 0,44,40
s_add_u32 m0, s22, 49152
s_add_u32 s24, s19, 1920
buffer_load_dwordx4 v8, s[4:7], s24 offen sc1 lds
s_add_u32 m0, s23, 49152
s_add_u32 s25, s20, 1966080
buffer_load_dwordx4 v10, s[8:11], s25 offen lds
s_waitcnt vmcnt(6)
s_barrier
RB 32,13,0
RT 36,15,0
RT 38,15,512
RB 40,14,0
RT 44,15,2048
RT 46,15,2560
s_waitcnt lgkmcnt(6)
MM 0,52,48
MM 0,60,56
s_waitcnt vmcnt(4)
s_barrier
RB 48,13,16384
RT 52,15,16384
RT 54,15,16896
RB 56,14,16384
RT 60,15,18432
RT 62,15,18944
s_waitcnt lgkmcnt(6)
MM 0,36,32
MM 0,44,40
s_waitcnt vmcnt(2)
s_barrier
RB 32,13,32768
RT 36,15,32768
RT 38,15,33280
RB 40,14,32768
RT 44,15,34816
RT 46,15,35328
s_waitcnt lgkmcnt(6)
MM 0,52,48
MM 0,60,56
s_waitcnt vmcnt(0)
s_barrier
RB 48,13,49152
RT 52,15,49152
RT 54,15,49664
RB 56,14,49152
RT 60,15,51200
RT 62,15,51712
s_waitcnt lgkmcnt(6)
MM 0,36,32
MM 0,44,40
s_waitcnt lgkmcnt(0)
MM 0,52,48
MM 0,60,56
s_barrier
s_and_b32 s24, s16, 3
s_lshl_b32 s24, s24, 12
v_lshlrev_b32 v1, 4, v0
v_add_u32 v1, s24, v1
v_add_u32 v1, 65536, v1
s_cmp_lt_u32 s16, 4
s_cbranch_scc1 ksr_209
s_nop 3
ds_write_b128 v1, a[0:3] offset:0
ds_write_b128 v1, a[4:7] offset:1024
ds_write_b128 v1, a[8:11] offset:2048
ds_write_b128 v1, a[12:15] offset:3072
s_waitcnt lgkmcnt(0)
ksr_209:
s_barrier
s_cmp_ge_u32 s16, 4
s_cbranch_scc1 kse_210
RB 32,1,0
RB 36,1,1024
RB 40,1,2048
RB 44,1,3072
v_accvgpr_read_b32 v48, a0
v_accvgpr_read_b32 v49, a1
v_accvgpr_read_b32 v50, a2
v_accvgpr_read_b32 v51, a3
v_accvgpr_read_b32 v52, a4
v_accvgpr_read_b32 v53, a5
v_accvgpr_read_b32 v54, a6
v_accvgpr_read_b32 v55, a7
v_accvgpr_read_b32 v56, a8
v_accvgpr_read_b32 v57, a9
v_accvgpr_read_b32 v58, a10
v_accvgpr_read_b32 v59, a11
v_accvgpr_read_b32 v60, a12
v_accvgpr_read_b32 v61, a13
v_accvgpr_read_b32 v62, a14
v_accvgpr_read_b32 v63, a15
s_waitcnt lgkmcnt(0)
v_add_f32 v48, v48, v32
v_add_f32 v49, v49, v33
v_add_f32 v50, v50, v34
v_add_f32 v51, v51, v35
v_add_f32 v52, v52, v36
v_add_f32 v53, v53, v37
v_add_f32 v54, v54, v38
v_add_f32 v55, v55, v39
v_add_f32 v56, v56, v40
v_add_f32 v57, v57, v41
v_add_f32 v58, v58, v42
v_add_f32 v59, v59, v43
v_add_f32 v60, v60, v44
v_add_f32 v61, v61, v45
v_add_f32 v62, v62, v46
v_add_f32 v63, v63, v47
v_accvgpr_write_b32 a0, v48
v_accvgpr_write_b32 a1, v49
v_accvgpr_write_b32 a2, v50
v_accvgpr_write_b32 a3, v51
v_accvgpr_write_b32 a4, v52
v_accvgpr_write_b32 a5, v53
v_accvgpr_write_b32 a6, v54
v_accvgpr_write_b32 a7, v55
v_accvgpr_write_b32 a8, v56
v_accvgpr_write_b32 a9, v57
v_accvgpr_write_b32 a10, v58
v_accvgpr_write_b32 a11, v59
v_accvgpr_write_b32 a12, v60
v_accvgpr_write_b32 a13, v61
v_accvgpr_write_b32 a14, v62
v_accvgpr_write_b32 a15, v63
kse_210:
s_cmp_lg_u32 s16, 0
s_cbranch_scc1 tt_211
v_mov_b32 v7, s56
v_accvgpr_write_b32 a127, 1
s_mov_b64 exec, 1
buffer_atomic_add a127, v7, s[4:7], 0 offen sc0
s_mov_b64 exec, -1
tt_211:
v_and_b32 v1, 31, v0
v_lshrrev_b32 v2, 5, v0
s_mul_i32 s24, s17, 4608
s_mul_i32 s25, s18, 64
s_add_u32 s24, s24, s25
v_mul_u32_u24 v3, 144, v1
v_lshl_add_u32 v3, v2, 4, v3
v_add_u32 v3, s24, v3
v_mov_b32 v72, 0xc0135761
v_mov_b32 v74, 0xbdd2d3e8
v_mov_b32 v76, 1.0
v_mov_b32 v73, 0xc0135761
v_mov_b32 v75, 0xbdd2d3e8
v_mov_b32 v77, 1.0
v_lshrrev_b32 v4, 3, v0
v_and_b32 v5, 7, v0
s_mul_i32 s24, s16, 8
v_add_u32 v4, s24, v4
v_mul_u32_u24 v6, 144, v4
v_lshl_add_u32 v6, v5, 4, v6
s_mov_b32 s24, 2048
v_mul_lo_u32 v12, v4, s24
v_lshl_add_u32 v12, v5, 4, v12
s_cmp_ge_u32 s16, 4
s_cbranch_scc1 epw_212
v_accvgpr_read_b32 v32, a0
v_accvgpr_read_b32 v33, a1
v_accvgpr_read_b32 v34, a2
v_accvgpr_read_b32 v35, a3
v_accvgpr_read_b32 v36, a4
v_accvgpr_read_b32 v37, a5
v_accvgpr_read_b32 v38, a6
v_accvgpr_read_b32 v39, a7
v_accvgpr_read_b32 v40, a8
v_accvgpr_read_b32 v41, a9
v_accvgpr_read_b32 v42, a10
v_accvgpr_read_b32 v43, a11
v_accvgpr_read_b32 v44, a12
v_accvgpr_read_b32 v45, a13
v_accvgpr_read_b32 v46, a14
v_accvgpr_read_b32 v47, a15
v_pk_mul_f32 v[64:65], v[32:33], v[32:33]
v_pk_mul_f32 v[66:67], v[34:35], v[34:35]
v_pk_fma_f32 v[64:65], v[64:65], v[74:75], v[72:73]
v_pk_fma_f32 v[66:67], v[66:67], v[74:75], v[72:73]
v_pk_mul_f32 v[64:65], v[64:65], v[32:33]
v_pk_mul_f32 v[66:67], v[66:67], v[34:35]
v_exp_f32 v64, v64
v_exp_f32 v66, v66
v_exp_f32 v65, v65
v_exp_f32 v67, v67
v_pk_add_f32 v[64:65], v[64:65], v[76:77]
v_pk_add_f32 v[66:67], v[66:67], v[76:77]
v_rcp_f32 v64, v64
v_rcp_f32 v66, v66
v_rcp_f32 v65, v65
v_rcp_f32 v67, v67
v_pk_mul_f32 v[32:33], v[32:33], v[64:65]
v_pk_mul_f32 v[34:35], v[34:35], v[66:67]
v_pk_mul_f32 v[64:65], v[36:37], v[36:37]
v_pk_mul_f32 v[66:67], v[38:39], v[38:39]
v_pk_fma_f32 v[64:65], v[64:65], v[74:75], v[72:73]
v_pk_fma_f32 v[66:67], v[66:67], v[74:75], v[72:73]
v_pk_mul_f32 v[64:65], v[64:65], v[36:37]
v_pk_mul_f32 v[66:67], v[66:67], v[38:39]
v_exp_f32 v64, v64
v_exp_f32 v66, v66
v_exp_f32 v65, v65
v_exp_f32 v67, v67
v_pk_add_f32 v[64:65], v[64:65], v[76:77]
v_pk_add_f32 v[66:67], v[66:67], v[76:77]
v_rcp_f32 v64, v64
v_rcp_f32 v66, v66
v_rcp_f32 v65, v65
v_rcp_f32 v67, v67
v_pk_mul_f32 v[36:37], v[36:37], v[64:65]
v_pk_mul_f32 v[38:39], v[38:39], v[66:67]
v_pk_mul_f32 v[64:65], v[40:41], v[40:41]
v_pk_mul_f32 v[66:67], v[42:43], v[42:43]
v_pk_fma_f32 v[64:65], v[64:65], v[74:75], v[72:73]
v_pk_fma_f32 v[66:67], v[66:67], v[74:75], v[72:73]
v_pk_mul_f32 v[64:65], v[64:65], v[40:41]
v_pk_mul_f32 v[66:67], v[66:67], v[42:43]
v_exp_f32 v64, v64
v_exp_f32 v66, v66
v_exp_f32 v65, v65
v_exp_f32 v67, v67
v_pk_add_f32 v[64:65], v[64:65], v[76:77]
v_pk_add_f32 v[66:67], v[66:67], v[76:77]
v_rcp_f32 v64, v64
v_rcp_f32 v66, v66
v_rcp_f32 v65, v65
v_rcp_f32 v67, v67
v_pk_mul_f32 v[40:41], v[40:41], v[64:65]
v_pk_mul_f32 v[42:43], v[42:43], v[66:67]
v_pk_mul_f32 v[64:65], v[44:45], v[44:45]
v_pk_mul_f32 v[66:67], v[46:47], v[46:47]
v_pk_fma_f32 v[64:65], v[64:65], v[74:75], v[72:73]
v_pk_fma_f32 v[66:67], v[66:67], v[74:75], v[72:73]
v_pk_mul_f32 v[64:65], v[64:65], v[44:45]
v_pk_mul_f32 v[66:67], v[66:67], v[46:47]
v_exp_f32 v64, v64
v_exp_f32 v66, v66
v_exp_f32 v65, v65
v_exp_f32 v67, v67
v_pk_add_f32 v[64:65], v[64:65], v[76:77]
v_pk_add_f32 v[66:67], v[66:67], v[76:77]
v_rcp_f32 v64, v64
v_rcp_f32 v66, v66
v_rcp_f32 v65, v65
v_rcp_f32 v67, v67
v_pk_mul_f32 v[44:45], v[44:45], v[64:65]
v_pk_mul_f32 v[46:47], v[46:47], v[66:67]
v_cvt_pk_bf16_f32 v48, v32, v33
v_cvt_pk_bf16_f32 v49, v34, v35
v_cvt_pk_bf16_f32 v50, v36, v37
v_cvt_pk_bf16_f32 v51, v38, v39
v_cvt_pk_bf16_f32 v52, v40, v41
v_cvt_pk_bf16_f32 v53, v42, v43
v_cvt_pk_bf16_f32 v54, v44, v45
v_cvt_pk_bf16_f32 v55, v46, v47
v_permlane32_swap_b32 v48, v50
v_permlane32_swap_b32 v49, v51
v_permlane32_swap_b32 v52, v54
v_permlane32_swap_b32 v53, v55
ds_write_b128 v3, v[48:51] offset:0
ds_write_b128 v3, v[52:55] offset:32
epw_212:
s_waitcnt lgkmcnt(0)
s_barrier
RB 32,6,0
s_waitcnt lgkmcnt(0)
s_add_u32 s24, s33, 0
buffer_store_dwordx4 v[32:35], v12, s[4:7], s24 offen sc1
s_lshl_b32 s76, s77, 7
s_add_u32 s76, s76, 49152
s_waitcnt vmcnt(0)
s_barrier
s_cmp_lg_u32 s16, 0
s_cbranch_scc1 sig_213
v_mov_b32 v1, s76
v_mov_b32 v2, 1
s_mov_b64 exec, 1
buffer_atomic_add v2, v1, s[4:7], 0 offen
s_mov_b64 exec, -1
sig_213:
s_branch mega_kernel_wloop
mega_kernel_t20:
s_bfe_u32 s17, s16, 65537
s_and_b32 s18, s16, 1
s_lshr_b32 s52, s16, 2
v_lshrrev_b32 v1, 3, v0
s_mov_b32 s24, 2048
v_mul_lo_u32 v1, v1, s24
v_lshrrev_b32 v2, 4, v0
v_and_b32 v3, 7, v0
s_and_b32 s25, s16, 1
s_lshl_b32 s25, s25, 2
v_add_u32 v4, s25, v2
v_xor_b32 v4, v4, v3
v_lshl_add_u32 v8, v4, 4, v1
v_lshrrev_b32 v1, 3, v0
v_and_b32 v3, 7, v0
s_mov_b32 s24, 2048
v_mul_lo_u32 v2, v1, s24
v_bfe_u32 v4, v1, 1, 1
v_lshlrev_b32 v4, 2, v4
v_xor_b32 v4, v4, v3
v_lshl_add_u32 v10, v4, 4, v2
v_and_b32 v1, 31, v0
v_lshrrev_b32 v2, 5, v0
v_bfe_u32 v3, v1, 1, 3
s_mul_i32 s24, s17, 4096
v_lshlrev_b32 v4, 7, v1
v_add_u32 v4, s24, v4
s_lshl_b32 s25, s52, 2
s_add_u32 s26, s25, 0
v_add_u32 v5, s26, v2
v_xor_b32 v5, v5, v3
v_lshl_add_u32 v13, v5, 4, v4
s_add_u32 s26, s25, 2
v_add_u32 v5, s26, v2
v_xor_b32 v5, v5, v3
v_lshl_add_u32 v14, v5, 4, v4
v_and_b32 v1, 15, v0
v_lshrrev_b32 v2, 2, v1
v_lshrrev_b32 v3, 5, v0
v_lshl_add_u32 v3, v3, 3, v2
s_lshl_b32 s24, s52, 5
v_add_u32 v3, s24, v3
v_lshlrev_b32 v3, 7, v3
v_and_b32 v4, 3, v1
v_lshl_add_u32 v3, v4, 3, v3
v_bfe_u32 v4, v0, 4, 1
v_lshl_add_u32 v3, v4, 5, v3
v_add_u32 v3, 8192, v3
v_bfe_u32 v4, v2, 1, 1
v_xor_b32 v4, s18, v4
v_lshl_add_u32 v15, v4, 6, v3
v_add_u32 v16, 65536, v13
v_add_u32 v17, 65536, v14
v_add_u32 v18, 65536, v15
s_lshl_b32 s22, s16, 10
s_add_u32 s23, s22, 8192
s_mov_b32 s8, s82
s_and_b32 s9, s83, 0xffff
s_mov_b32 s10, 0x200000
s_mov_b32 s11, 0x00020000
s_lshl_b32 s28, s77, 7
s_lshl_b32 s52, s77, 6
s_add_u32 s52, s52, 960
s_cmp_ge_u32 s77, 15
s_cselect_b32 s28, s52, s28
s_lshl_b32 s29, s60, 7
s_and_b32 s24, s79, 1
s_lshl_b32 s24, s24, 6
s_add_u32 s29, s29, s24
s_mul_i32 s24, s16, 8
s_add_u32 s24, s24, s28
s_mul_i32 s19, s24, 2048
s_add_u32 s19, s19, 94375936
s_mul_i32 s20, s16, 16384
s_lshl_b32 s24, s29, 1
s_add_u32 s20, s20, s24
s_mul_i32 s24, s28, 2048
s_mul_i32 s25, s29, 2
s_add_u32 s24, s24, s25
s_add_u32 s33, s24, 98574336
s_add_u32 s34, s24, 85983232
s_mov_b32 s35, 0
s_lshl_b32 s24, s77, 7
s_add_u32 s24, s24, 49024
s_lshl_b32 s25, s77, 7
s_add_u32 s25, s25, 49152
s_lshl_b32 s26, s77, 7
s_add_u32 s26, s26, 49280
s_cmp_eq_u32 s77, 0
s_cselect_b32 s24, s25, s24
s_cmp_eq_u32 s77, 16
s_cselect_b32 s26, s25, s26
s_cmp_lg_u32 s16, 0
s_cbranch_scc1 wf_214
v_mov_b32 v1, 0
v_mov_b32 v2, 0
v_writelane_b32 v1, s26, 0
s_mov_b32 s27, 16
v_writelane_b32 v2, s27, 0
v_writelane_b32 v1, s25, 1
s_mov_b32 s27, 16
v_writelane_b32 v2, s27, 1
v_writelane_b32 v1, s24, 2
s_mov_b32 s27, 16
v_writelane_b32 v2, s27, 2
s_mov_b64 exec, 7
wfp_215:
s_add_u32 s63, s63, 1
s_cmp_gt_u32 s63, 262144
s_cbranch_scc0 go_216
s_endpgm
go_216:
buffer_load_dword v3, v1, s[4:7], 0 offen sc1
s_waitcnt vmcnt(0)
v_cmp_lt_u32 vcc, v3, v2
s_nop 0
s_cbranch_vccz wfd_217
s_cmp_lt_u32 s77, 13
s_cbranch_scc1 urg_218
s_sleep 2
s_branch wfp_215
urg_218:
v_sub_u32 v4, v2, v3
s_nop 0
v_readlane_b32 s27, v4, 0
s_nop 0
s_cmp_lt_i32 s27, 2
s_cbranch_scc1 lv_219
s_sleep 40
s_branch wfp_215
lv_219:
s_cmp_lt_i32 s27, 1
s_cbranch_scc1 lv_220
s_sleep 12
s_branch wfp_215
lv_220:
s_sleep 8
s_branch wfp_215
wfd_217:
s_mov_b64 exec, -1
wf_214:
s_barrier
s_add_u32 m0, s22, 0
s_add_u32 s24, s19, 4294965248
buffer_load_dwordx4 v8, s[4:7], s24 offen sc1 lds
s_add_u32 m0, s23, 0
s_add_u32 s25, s20, 0
buffer_load_dwordx4 v10, s[8:11], s25 offen lds
s_add_u32 m0, s22, 16384
s_add_u32 s24, s19, 4294965376
buffer_load_dwordx4 v8, s[4:7], s24 offen sc1 lds
s_add_u32 m0, s23, 16384
s_add_u32 s25, s20, 131072
buffer_load_dwordx4 v10, s[8:11], s25 offen lds
s_add_u32 m0, s22, 32768
s_add_u32 s24, s19, 4294965504
buffer_load_dwordx4 v8, s[4:7], s24 offen sc1 lds
s_add_u32 m0, s23, 32768
s_add_u32 s25, s20, 262144
buffer_load_dwordx4 v10, s[8:11], s25 offen lds
v_accvgpr_write_b32 a0, 0
v_accvgpr_write_b32 a1, 0
v_accvgpr_write_b32 a2, 0
v_accvgpr_write_b32 a3, 0
v_accvgpr_write_b32 a4, 0
v_accvgpr_write_b32 a5, 0
v_accvgpr_write_b32 a6, 0
v_accvgpr_write_b32 a7, 0
v_accvgpr_write_b32 a8, 0
v_accvgpr_write_b32 a9, 0
v_accvgpr_write_b32 a10, 0
v_accvgpr_write_b32 a11, 0
v_accvgpr_write_b32 a12, 0
v_accvgpr_write_b32 a13, 0
v_accvgpr_write_b32 a14, 0
v_accvgpr_write_b32 a15, 0
s_waitcnt vmcnt(4)
s_barrier
RB 32,13,0
RT 36,15,0
RT 38,15,512
RB 40,14,0
RT 44,15,2048
RT 46,15,2560
s_waitcnt vmcnt(2)
s_barrier
RB 48,13,16384
RT 52,15,16384
RT 54,15,16896
RB 56,14,16384
RT 60,15,18432
RT 62,15,18944
s_waitcnt lgkmcnt(6)
MM 0,36,32
MM 0,44,40
s_add_u32 m0, s22, 49152
s_add_u32 s24, s19, 4294965632
buffer_load_dwordx4 v8, s[4:7], s24 offen sc1 lds
s_add_u32 m0, s23, 49152
s_add_u32 s25, s20, 393216
buffer_load_dwordx4 v10, s[8:11], s25 offen lds
s_add_u32 m0, s22, 65536
s_add_u32 s24, s19, 2560
buffer_load_dwordx4 v8, s[4:7], s24 offen sc1 lds
s_add_u32 m0, s23, 65536
s_add_u32 s25, s20, 524288
buffer_load_dwordx4 v10, s[8:11], s25 offen lds
s_waitcnt vmcnt(4)
s_barrier
RB 32,13,32768
RT 36,15,32768
RT 38,15,33280
RB 40,14,32768
RT 44,15,34816
RT 46,15,35328
s_waitcnt lgkmcnt(6)
MM 0,52,48
MM 0,60,56
s_add_u32 m0, s22, 81920
s_add_u32 s24, s19, 2688
buffer_load_dwordx4 v8, s[4:7], s24 offen sc1 lds
s_add_u32 m0, s23, 81920
s_add_u32 s25, s20, 655360
buffer_load_dwordx4 v10, s[8:11], s25 offen lds
s_add_u32 m0, s22, 0
s_add_u32 s24, s19, 2816
buffer_load_dwordx4 v8, s[4:7], s24 offen sc1 lds
s_add_u32 m0, s23, 0
s_add_u32 s25, s20, 786432
buffer_load_dwordx4 v10, s[8:11], s25 offen lds
s_waitcnt vmcnt(6)
s_barrier
RB 48,13,49152
RT 52,15,49152
RT 54,15,49664
RB 56,14,49152
RT 60,15,51200
RT 62,15,51712
s_waitcnt lgkmcnt(6)
MM 0,36,32
MM 0,44,40
s_add_u32 m0, s22, 16384
s_add_u32 s24, s19, 2944
buffer_load_dwordx4 v8, s[4:7], s24 offen sc1 lds
s_add_u32 m0, s23, 16384
s_add_u32 s25, s20, 917504
buffer_load_dwordx4 v10, s[8:11], s25 offen lds
s_waitcnt vmcnt(6)
s_barrier
RB 32,16,0
RT 36,18,0
RT 38,18,512
RB 40,17,0
RT 44,18,2048
RT 46,18,2560
s_waitcnt lgkmcnt(6)
MM 0,52,48
MM 0,60,56
s_add_u32 m0, s22, 32768
s_add_u32 s24, s19, 4294964224
buffer_load_dwordx4 v8, s[4:7], s24 offen sc1 lds
s_add_u32 m0, s23, 32768
s_add_u32 s25, s20, 1048576
buffer_load_dwordx4 v10, s[8:11], s25 offen lds
s_waitcnt vmcnt(6)
s_barrier
RB 48,16,16384
RT 52,18,16384
RT 54,18,16896
RB 56,17,16384
RT 60,18,18432
RT 62,18,18944
s_waitcnt lgkmcnt(6)
MM 0,36,32
MM 0,44,40
s_add_u32 m0, s22, 49152
s_add_u32 s24, s19, 4294964352
buffer_load_dwordx4 v8, s[4:7], s24 offen sc1 lds
s_add_u32 m0, s23, 49152
s_add_u32 s25, s20, 1179648
buffer_load_dwordx4 v10, s[8:11], s25 offen lds
s_waitcnt vmcnt(6)
s_barrier
RB 32,13,0
RT 36,15,0
RT 38,15,512
RB 40,14,0
RT 44,15,2048
RT 46,15,2560
s_waitcnt lgkmcnt(6)
MM 0,52,48
MM 0,60,56
s_add_u32 m0, s22, 65536
s_add_u32 s24, s19, 4294964480
buffer_load_dwordx4 v8, s[4:7], s24 offen sc1 lds
s_add_u32 m0, s23, 65536
s_add_u32 s25, s20, 1310720
buffer_load_dwordx4 v10, s[8:11], s25 offen lds
s_waitcnt vmcnt(6)
s_barrier
RB 48,13,16384
RT 52,15,16384
RT 54,15,16896
RB 56,14,16384
RT 60,15,18432
RT 62,15,18944
s_waitcnt lgkmcnt(6)
MM 0,36,32
MM 0,44,40
s_add_u32 m0, s22, 81920
s_add_u32 s24, s19, 4294964608
buffer_load_dwordx4 v8, s[4:7], s24 offen sc1 lds
s_add_u32 m0, s23, 81920
s_add_u32 s25, s20, 1441792
buffer_load_dwordx4 v10, s[8:11], s25 offen lds
s_waitcnt vmcnt(6)
s_barrier
RB 32,13,32768
RT 36,15,32768
RT 38,15,33280
RB 40,14,32768
RT 44,15,34816
RT 46,15,35328
s_waitcnt lgkmcnt(6)
MM 0,52,48
MM 0,60,56
s_add_u32 m0, s22, 0
s_add_u32 s24, s19, 5632
buffer_load_dwordx4 v8, s[4:7], s24 offen sc1 lds
s_add_u32 m0, s23, 0
s_add_u32 s25, s20, 1572864
buffer_load_dwordx4 v10, s[8:11], s25 offen lds
s_waitcnt vmcnt(6)
s_barrier
RB 48,13,49152
RT 52,15,49152
RT 54,15,49664
RB 56,14,49152
RT 60,15,51200
RT 62,15,51712
s_waitcnt lgkmcnt(6)
MM 0,36,32
MM 0,44,40
s_add_u32 m0, s22, 16384
s_add_u32 s24, s19, 5760
buffer_load_dwordx4 v8, s[4:7], s24 offen sc1 lds
s_add_u32 m0, s23, 16384
s_add_u32 s25, s20, 1703936
buffer_load_dwordx4 v10, s[8:11], s25 offen lds
s_waitcnt vmcnt(6)
s_barrier
RB 32,16,0
RT 36,18,0
RT 38,18,512
RB 40,17,0
RT 44,18,2048
RT 46,18,2560
s_waitcnt lgkmcnt(6)
MM 0,52,48
MM 0,60,56
s_add_u32 m0, s22, 32768
s_add_u32 s24, s19, 5888
buffer_load_dwordx4 v8, s[4:7], s24 offen sc1 lds
s_add_u32 m0, s23, 32768
s_add_u32 s25, s20, 1835008
buffer_load_dwordx4 v10, s[8:11], s25 offen lds
s_waitcnt vmcnt(6)
s_barrier
RB 48,16,16384
RT 52,18,16384
RT 54,18,16896
RB 56,17,16384
RT 60,18,18432
RT 62,18,18944
s_waitcnt lgkmcnt(6)
MM 0,36,32
MM 0,44,40
s_add_u32 m0, s22, 49152
s_add_u32 s24, s19, 6016
buffer_load_dwordx4 v8, s[4:7], s24 offen sc1 lds
s_add_u32 m0, s23, 49152
s_add_u32 s25, s20, 1966080
buffer_load_dwordx4 v10, s[8:11], s25 offen lds
s_waitcnt vmcnt(6)
s_barrier
RB 32,13,0
RT 36,15,0
RT 38,15,512
RB 40,14,0
RT 44,15,2048
RT 46,15,2560
s_waitcnt lgkmcnt(6)
MM 0,52,48
MM 0,60,56
s_waitcnt vmcnt(4)
s_barrier
RB 48,13,16384
RT 52,15,16384
RT 54,15,16896
RB 56,14,16384
RT 60,15,18432
RT 62,15,18944
s_waitcnt lgkmcnt(6)
MM 0,36,32
MM 0,44,40
s_waitcnt vmcnt(2)
s_barrier
RB 32,13,32768
RT 36,15,32768
RT 38,15,33280
RB 40,14,32768
RT 44,15,34816
RT 46,15,35328
s_waitcnt lgkmcnt(6)
MM 0,52,48
MM 0,60,56
s_waitcnt vmcnt(0)
s_barrier
RB 48,13,49152
RT 52,15,49152
RT 54,15,49664
RB 56,14,49152
RT 60,15,51200
RT 62,15,51712
s_waitcnt lgkmcnt(6)
MM 0,36,32
MM 0,44,40
s_waitcnt lgkmcnt(0)
MM 0,52,48
MM 0,60,56
s_barrier
s_and_b32 s24, s16, 3
s_lshl_b32 s24, s24, 12
v_lshlrev_b32 v1, 4, v0
v_add_u32 v1, s24, v1
v_add_u32 v1, 65536, v1
s_cmp_lt_u32 s16, 4
s_cbranch_scc1 ksr_221
s_nop 3
ds_write_b128 v1, a[0:3] offset:0
ds_write_b128 v1, a[4:7] offset:1024
ds_write_b128 v1, a[8:11] offset:2048
ds_write_b128 v1, a[12:15] offset:3072
s_waitcnt lgkmcnt(0)
ksr_221:
s_barrier
s_cmp_ge_u32 s16, 4
s_cbranch_scc1 kse_222
RB 32,1,0
RB 36,1,1024
RB 40,1,2048
RB 44,1,3072
v_accvgpr_read_b32 v48, a0
v_accvgpr_read_b32 v49, a1
v_accvgpr_read_b32 v50, a2
v_accvgpr_read_b32 v51, a3
v_accvgpr_read_b32 v52, a4
v_accvgpr_read_b32 v53, a5
v_accvgpr_read_b32 v54, a6
v_accvgpr_read_b32 v55, a7
v_accvgpr_read_b32 v56, a8
v_accvgpr_read_b32 v57, a9
v_accvgpr_read_b32 v58, a10
v_accvgpr_read_b32 v59, a11
v_accvgpr_read_b32 v60, a12
v_accvgpr_read_b32 v61, a13
v_accvgpr_read_b32 v62, a14
v_accvgpr_read_b32 v63, a15
s_waitcnt lgkmcnt(0)
v_add_f32 v48, v48, v32
v_add_f32 v49, v49, v33
v_add_f32 v50, v50, v34
v_add_f32 v51, v51, v35
v_add_f32 v52, v52, v36
v_add_f32 v53, v53, v37
v_add_f32 v54, v54, v38
v_add_f32 v55, v55, v39
v_add_f32 v56, v56, v40
v_add_f32 v57, v57, v41
v_add_f32 v58, v58, v42
v_add_f32 v59, v59, v43
v_add_f32 v60, v60, v44
v_add_f32 v61, v61, v45
v_add_f32 v62, v62, v46
v_add_f32 v63, v63, v47
v_accvgpr_write_b32 a0, v48
v_accvgpr_write_b32 a1, v49
v_accvgpr_write_b32 a2, v50
v_accvgpr_write_b32 a3, v51
v_accvgpr_write_b32 a4, v52
v_accvgpr_write_b32 a5, v53
v_accvgpr_write_b32 a6, v54
v_accvgpr_write_b32 a7, v55
v_accvgpr_write_b32 a8, v56
v_accvgpr_write_b32 a9, v57
v_accvgpr_write_b32 a10, v58
v_accvgpr_write_b32 a11, v59
v_accvgpr_write_b32 a12, v60
v_accvgpr_write_b32 a13, v61
v_accvgpr_write_b32 a14, v62
v_accvgpr_write_b32 a15, v63
kse_222:
s_cmp_lg_u32 s16, 0
s_cbranch_scc1 tt_223
v_mov_b32 v7, s56
v_accvgpr_write_b32 a127, 1
s_mov_b64 exec, 1
buffer_atomic_add a127, v7, s[4:7], 0 offen sc0
s_mov_b64 exec, -1
tt_223:
v_and_b32 v1, 31, v0
v_lshrrev_b32 v2, 5, v0
s_mul_i32 s24, s17, 4608
s_mul_i32 s25, s18, 64
s_add_u32 s24, s24, s25
v_mul_u32_u24 v3, 144, v1
v_lshl_add_u32 v3, v2, 4, v3
v_add_u32 v3, s24, v3
v_lshrrev_b32 v4, 3, v0
v_and_b32 v5, 7, v0
s_mul_i32 s24, s16, 8
v_add_u32 v4, s24, v4
v_mul_u32_u24 v6, 144, v4
v_lshl_add_u32 v6, v5, 4, v6
s_mov_b32 s24, 2048
v_mul_lo_u32 v12, v4, s24
v_lshl_add_u32 v12, v5, 4, v12
s_add_u32 s24, s34, 0
buffer_load_dwordx4 v[72:75], v12, s[4:7], s24 offen sc1
s_cmp_ge_u32 s16, 4
s_cbranch_scc1 epw_224
v_accvgpr_read_b32 v32, a0
v_accvgpr_read_b32 v33, a1
v_accvgpr_read_b32 v34, a2
v_accvgpr_read_b32 v35, a3
v_accvgpr_read_b32 v36, a4
v_accvgpr_read_b32 v37, a5
v_accvgpr_read_b32 v38, a6
v_accvgpr_read_b32 v39, a7
v_accvgpr_read_b32 v40, a8
v_accvgpr_read_b32 v41, a9
v_accvgpr_read_b32 v42, a10
v_accvgpr_read_b32 v43, a11
v_accvgpr_read_b32 v44, a12
v_accvgpr_read_b32 v45, a13
v_accvgpr_read_b32 v46, a14
v_accvgpr_read_b32 v47, a15
v_cvt_pk_bf16_f32 v48, v32, v33
v_cvt_pk_bf16_f32 v49, v34, v35
v_cvt_pk_bf16_f32 v50, v36, v37
v_cvt_pk_bf16_f32 v51, v38, v39
v_cvt_pk_bf16_f32 v52, v40, v41
v_cvt_pk_bf16_f32 v53, v42, v43
v_cvt_pk_bf16_f32 v54, v44, v45
v_cvt_pk_bf16_f32 v55, v46, v47
v_permlane32_swap_b32 v48, v50
v_permlane32_swap_b32 v49, v51
v_permlane32_swap_b32 v52, v54
v_permlane32_swap_b32 v53, v55
ds_write_b128 v3, v[48:51] offset:0
ds_write_b128 v3, v[52:55] offset:32
epw_224:
s_waitcnt lgkmcnt(0)
s_barrier
RB 32,6,0
s_waitcnt vmcnt(0)
s_waitcnt lgkmcnt(0)
v_lshlrev_b32 v68, 16, v32
v_and_b32 v69, 0xffff0000, v32
v_lshlrev_b32 v70, 16, v72
v_and_b32 v71, 0xffff0000, v72
v_add_f32 v68, v68, v70
v_add_f32 v69, v69, v71
v_cvt_pk_bf16_f32 v32, v68, v69
v_lshlrev_b32 v68, 16, v33
v_and_b32 v69, 0xffff0000, v33
v_lshlrev_b32 v70, 16, v73
v_and_b32 v71, 0xffff0000, v73
v_add_f32 v68, v68, v70
v_add_f32 v69, v69, v71
v_cvt_pk_bf16_f32 v33, v68, v69
v_lshlrev_b32 v68, 16, v34
v_and_b32 v69, 0xffff0000, v34
v_lshlrev_b32 v70, 16, v74
v_and_b32 v71, 0xffff0000, v74
v_add_f32 v68, v68, v70
v_add_f32 v69, v69, v71
v_cvt_pk_bf16_f32 v34, v68, v69
v_lshlrev_b32 v68, 16, v35
v_and_b32 v69, 0xffff0000, v35
v_lshlrev_b32 v70, 16, v75
v_and_b32 v71, 0xffff0000, v75
v_add_f32 v68, v68, v70
v_add_f32 v69, v69, v71
v_cvt_pk_bf16_f32 v35, v68, v69
s_add_u32 s24, s33, 0
buffer_store_dwordx4 v[32:35], v12, s[4:7], s24 offen sc1
s_lshl_b32 s76, s77, 7
s_add_u32 s76, s76, 53248
s_waitcnt vmcnt(0)
s_barrier
s_cmp_lg_u32 s16, 0
s_cbranch_scc1 sig_225
v_mov_b32 v1, s76
v_mov_b32 v2, 1
s_mov_b64 exec, 1
buffer_atomic_add v2, v1, s[4:7], 0 offen
s_mov_b64 exec, -1
sig_225:
s_branch mega_kernel_wloop
mega_kernel_t21:
s_bfe_u32 s17, s16, 65537
s_and_b32 s18, s16, 1
s_lshr_b32 s52, s16, 2
v_lshrrev_b32 v1, 3, v0
s_mov_b32 s24, 2048
v_mul_lo_u32 v1, v1, s24
v_lshrrev_b32 v2, 4, v0
v_and_b32 v3, 7, v0
s_and_b32 s25, s16, 1
s_lshl_b32 s25, s25, 2
v_add_u32 v4, s25, v2
v_xor_b32 v4, v4, v3
v_lshl_add_u32 v8, v4, 4, v1
v_lshrrev_b32 v1, 3, v0
v_and_b32 v3, 7, v0
s_mov_b32 s24, 7168
v_mul_lo_u32 v2, v1, s24
v_bfe_u32 v4, v1, 1, 1
v_lshlrev_b32 v4, 2, v4
v_xor_b32 v4, v4, v3
v_lshl_add_u32 v10, v4, 4, v2
v_and_b32 v1, 31, v0
v_lshrrev_b32 v2, 5, v0
v_bfe_u32 v3, v1, 1, 3
s_mul_i32 s24, s17, 4096
v_lshlrev_b32 v4, 7, v1
v_add_u32 v4, s24, v4
s_lshl_b32 s25, s52, 2
s_add_u32 s26, s25, 0
v_add_u32 v5, s26, v2
v_xor_b32 v5, v5, v3
v_lshl_add_u32 v13, v5, 4, v4
s_add_u32 s26, s25, 2
v_add_u32 v5, s26, v2
v_xor_b32 v5, v5, v3
v_lshl_add_u32 v14, v5, 4, v4
v_and_b32 v1, 15, v0
v_lshrrev_b32 v2, 2, v1
v_lshrrev_b32 v3, 5, v0
v_lshl_add_u32 v3, v3, 3, v2
s_lshl_b32 s24, s52, 5
v_add_u32 v3, s24, v3
v_lshlrev_b32 v3, 7, v3
v_and_b32 v4, 3, v1
v_lshl_add_u32 v3, v4, 3, v3
v_bfe_u32 v4, v0, 4, 1
v_lshl_add_u32 v3, v4, 5, v3
v_add_u32 v3, 8192, v3
v_bfe_u32 v4, v2, 1, 1
v_xor_b32 v4, s18, v4
v_lshl_add_u32 v15, v4, 6, v3
v_add_u32 v16, 65536, v13
v_add_u32 v17, 65536, v14
v_add_u32 v18, 65536, v15
s_lshl_b32 s22, s16, 10
s_add_u32 s23, s22, 8192
s_mov_b32 s8, s84
s_and_b32 s9, s85, 0xffff
s_mov_b32 s10, 0x700000
s_mov_b32 s11, 0x00020000
s_lshl_b32 s28, s77, 7
s_lshl_b32 s52, s77, 6
s_add_u32 s52, s52, 960
s_cmp_ge_u32 s77, 15
s_cselect_b32 s28, s52, s28
s_lshl_b32 s29, s79, 6
s_mul_i32 s24, s16, 8
s_add_u32 s24, s24, s28
s_mul_i32 s19, s24, 2048
s_add_u32 s19, s19, 102768640
s_mul_i32 s20, s16, 57344
s_lshl_b32 s24, s29, 1
s_add_u32 s20, s20, s24
s_mul_i32 s24, s28, 7168
s_mul_i32 s25, s29, 2
s_add_u32 s24, s24, s25
s_add_u32 s33, s24, 106962944
s_add_u32 s34, s24, 0
s_mov_b32 s35, 0
s_lshl_b32 s76, s77, 7
s_add_u32 s76, s76, 57344
s_cmp_lg_u32 s16, 0
s_cbranch_scc1 wf_226
v_mov_b32 v1, 0
v_mov_b32 v2, 0
v_writelane_b32 v1, s76, 0
s_mov_b32 s27, 16
v_writelane_b32 v2, s27, 0
s_mov_b64 exec, 1
wfp_227:
s_add_u32 s63, s63, 1
s_cmp_gt_u32 s63, 262144
s_cbranch_scc0 go_228
s_endpgm
go_228:
buffer_load_dword v3, v1, s[4:7], 0 offen sc1
s_waitcnt vmcnt(0)
v_cmp_lt_u32 vcc, v3, v2
s_nop 0
s_cbranch_vccz wfd_229
s_cmp_lt_u32 s77, 13
s_cbranch_scc1 urg_230
s_sleep 2
s_branch wfp_227
urg_230:
v_sub_u32 v4, v2, v3
s_nop 0
v_readlane_b32 s27, v4, 0
s_nop 0
s_cmp_lt_i32 s27, 2
s_cbranch_scc1 lv_231
s_sleep 40
s_branch wfp_227
lv_231:
s_cmp_lt_i32 s27, 1
s_cbranch_scc1 lv_232
s_sleep 12
s_branch wfp_227
lv_232:
s_sleep 8
s_branch wfp_227
wfd_229:
s_mov_b64 exec, -1
wf_226:
s_barrier
s_add_u32 m0, s22, 0
s_add_u32 s24, s19, 0
buffer_load_dwordx4 v8, s[4:7], s24 offen sc1 lds
s_add_u32 m0, s23, 0
s_add_u32 s25, s20, 0
buffer_load_dwordx4 v10, s[8:11], s25 offen lds
s_add_u32 m0, s22, 16384
s_add_u32 s24, s19, 128
buffer_load_dwordx4 v8, s[4:7], s24 offen sc1 lds
s_add_u32 m0, s23, 16384
s_add_u32 s25, s20, 458752
buffer_load_dwordx4 v10, s[8:11], s25 offen lds
s_add_u32 m0, s22, 32768
s_add_u32 s24, s19, 256
buffer_load_dwordx4 v8, s[4:7], s24 offen sc1 lds
s_add_u32 m0, s23, 32768
s_add_u32 s25, s20, 917504
buffer_load_dwordx4 v10, s[8:11], s25 offen lds
v_accvgpr_write_b32 a0, 0
v_accvgpr_write_b32 a1, 0
v_accvgpr_write_b32 a2, 0
v_accvgpr_write_b32 a3, 0
v_accvgpr_write_b32 a4, 0
v_accvgpr_write_b32 a5, 0
v_accvgpr_write_b32 a6, 0
v_accvgpr_write_b32 a7, 0
v_accvgpr_write_b32 a8, 0
v_accvgpr_write_b32 a9, 0
v_accvgpr_write_b32 a10, 0
v_accvgpr_write_b32 a11, 0
v_accvgpr_write_b32 a12, 0
v_accvgpr_write_b32 a13, 0
v_accvgpr_write_b32 a14, 0
v_accvgpr_write_b32 a15, 0
s_waitcnt vmcnt(4)
s_barrier
RB 32,13,0
RT 36,15,0
RT 38,15,512
RB 40,14,0
RT 44,15,2048
RT 46,15,2560
s_waitcnt vmcnt(2)
s_barrier
RB 48,13,16384
RT 52,15,16384
RT 54,15,16896
RB 56,14,16384
RT 60,15,18432
RT 62,15,18944
s_waitcnt lgkmcnt(6)
MM 0,36,32
MM 0,44,40
s_add_u32 m0, s22, 49152
s_add_u32 s24, s19, 384
buffer_load_dwordx4 v8, s[4:7], s24 offen sc1 lds
s_add_u32 m0, s23, 49152
s_add_u32 s25, s20, 1376256
buffer_load_dwordx4 v10, s[8:11], s25 offen lds
s_add_u32 m0, s22, 65536
s_add_u32 s24, s19, 512
buffer_load_dwordx4 v8, s[4:7], s24 offen sc1 lds
s_add_u32 m0, s23, 65536
s_add_u32 s25, s20, 1835008
buffer_load_dwordx4 v10, s[8:11], s25 offen lds
s_waitcnt vmcnt(4)
s_barrier
RB 32,13,32768
RT 36,15,32768
RT 38,15,33280
RB 40,14,32768
RT 44,15,34816
RT 46,15,35328
s_waitcnt lgkmcnt(6)
MM 0,52,48
MM 0,60,56
s_add_u32 m0, s22, 81920
s_add_u32 s24, s19, 640
buffer_load_dwordx4 v8, s[4:7], s24 offen sc1 lds
s_add_u32 m0, s23, 81920
s_add_u32 s25, s20, 2293760
buffer_load_dwordx4 v10, s[8:11], s25 offen lds
s_add_u32 m0, s22, 0
s_add_u32 s24, s19, 768
buffer_load_dwordx4 v8, s[4:7], s24 offen sc1 lds
s_add_u32 m0, s23, 0
s_add_u32 s25, s20, 2752512
buffer_load_dwordx4 v10, s[8:11], s25 offen lds
s_waitcnt vmcnt(6)
s_barrier
RB 48,13,49152
RT 52,15,49152
RT 54,15,49664
RB 56,14,49152
RT 60,15,51200
RT 62,15,51712
s_waitcnt lgkmcnt(6)
MM 0,36,32
MM 0,44,40
s_add_u32 m0, s22, 16384
s_add_u32 s24, s19, 896
buffer_load_dwordx4 v8, s[4:7], s24 offen sc1 lds
s_add_u32 m0, s23, 16384
s_add_u32 s25, s20, 3211264
buffer_load_dwordx4 v10, s[8:11], s25 offen lds
s_waitcnt vmcnt(6)
s_barrier
RB 32,16,0
RT 36,18,0
RT 38,18,512
RB 40,17,0
RT 44,18,2048
RT 46,18,2560
s_waitcnt lgkmcnt(6)
MM 0,52,48
MM 0,60,56
s_add_u32 m0, s22, 32768
s_add_u32 s24, s19, 1024
buffer_load_dwordx4 v8, s[4:7], s24 offen sc1 lds
s_add_u32 m0, s23, 32768
s_add_u32 s25, s20, 3670016
buffer_load_dwordx4 v10, s[8:11], s25 offen lds
s_waitcnt vmcnt(6)
s_barrier
RB 48,16,16384
RT 52,18,16384
RT 54,18,16896
RB 56,17,16384
RT 60,18,18432
RT 62,18,18944
s_waitcnt lgkmcnt(6)
MM 0,36,32
MM 0,44,40
s_add_u32 m0, s22, 49152
s_add_u32 s24, s19, 1152
buffer_load_dwordx4 v8, s[4:7], s24 offen sc1 lds
s_add_u32 m0, s23, 49152
s_add_u32 s25, s20, 4128768
buffer_load_dwordx4 v10, s[8:11], s25 offen lds
s_waitcnt vmcnt(6)
s_barrier
RB 32,13,0
RT 36,15,0
RT 38,15,512
RB 40,14,0
RT 44,15,2048
RT 46,15,2560
s_waitcnt lgkmcnt(6)
MM 0,52,48
MM 0,60,56
s_add_u32 m0, s22, 65536
s_add_u32 s24, s19, 1280
buffer_load_dwordx4 v8, s[4:7], s24 offen sc1 lds
s_add_u32 m0, s23, 65536
s_add_u32 s25, s20, 4587520
buffer_load_dwordx4 v10, s[8:11], s25 offen lds
s_waitcnt vmcnt(6)
s_barrier
RB 48,13,16384
RT 52,15,16384
RT 54,15,16896
RB 56,14,16384
RT 60,15,18432
RT 62,15,18944
s_waitcnt lgkmcnt(6)
MM 0,36,32
MM 0,44,40
s_add_u32 m0, s22, 81920
s_add_u32 s24, s19, 1408
buffer_load_dwordx4 v8, s[4:7], s24 offen sc1 lds
s_add_u32 m0, s23, 81920
s_add_u32 s25, s20, 5046272
buffer_load_dwordx4 v10, s[8:11], s25 offen lds
s_waitcnt vmcnt(6)
s_barrier
RB 32,13,32768
RT 36,15,32768
RT 38,15,33280
RB 40,14,32768
RT 44,15,34816
RT 46,15,35328
s_waitcnt lgkmcnt(6)
MM 0,52,48
MM 0,60,56
s_add_u32 m0, s22, 0
s_add_u32 s24, s19, 1536
buffer_load_dwordx4 v8, s[4:7], s24 offen sc1 lds
s_add_u32 m0, s23, 0
s_add_u32 s25, s20, 5505024
buffer_load_dwordx4 v10, s[8:11], s25 offen lds
s_waitcnt vmcnt(6)
s_barrier
RB 48,13,49152
RT 52,15,49152
RT 54,15,49664
RB 56,14,49152
RT 60,15,51200
RT 62,15,51712
s_waitcnt lgkmcnt(6)
MM 0,36,32
MM 0,44,40
s_add_u32 m0, s22, 16384
s_add_u32 s24, s19, 1664
buffer_load_dwordx4 v8, s[4:7], s24 offen sc1 lds
s_add_u32 m0, s23, 16384
s_add_u32 s25, s20, 5963776
buffer_load_dwordx4 v10, s[8:11], s25 offen lds
s_waitcnt vmcnt(6)
s_barrier
RB 32,16,0
RT 36,18,0
RT 38,18,512
RB 40,17,0
RT 44,18,2048
RT 46,18,2560
s_waitcnt lgkmcnt(6)
MM 0,52,48
MM 0,60,56
s_add_u32 m0, s22, 32768
s_add_u32 s24, s19, 1792
buffer_load_dwordx4 v8, s[4:7], s24 offen sc1 lds
s_add_u32 m0, s23, 32768
s_add_u32 s25, s20, 6422528
buffer_load_dwordx4 v10, s[8:11], s25 offen lds
s_waitcnt vmcnt(6)
s_barrier
RB 48,16,16384
RT 52,18,16384
RT 54,18,16896
RB 56,17,16384
RT 60,18,18432
RT 62,18,18944
s_waitcnt lgkmcnt(6)
MM 0,36,32
MM 0,44,40
s_add_u32 m0, s22, 49152
s_add_u32 s24, s19, 1920
buffer_load_dwordx4 v8, s[4:7], s24 offen sc1 lds
s_add_u32 m0, s23, 49152
s_add_u32 s25, s20, 6881280
buffer_load_dwordx4 v10, s[8:11], s25 offen lds
s_waitcnt vmcnt(6)
s_barrier
RB 32,13,0
RT 36,15,0
RT 38,15,512
RB 40,14,0
RT 44,15,2048
RT 46,15,2560
s_waitcnt lgkmcnt(6)
MM 0,52,48
MM 0,60,56
s_waitcnt vmcnt(4)
s_barrier
RB 48,13,16384
RT 52,15,16384
RT 54,15,16896
RB 56,14,16384
RT 60,15,18432
RT 62,15,18944
s_waitcnt lgkmcnt(6)
MM 0,36,32
MM 0,44,40
s_waitcnt vmcnt(2)
s_barrier
RB 32,13,32768
RT 36,15,32768
RT 38,15,33280
RB 40,14,32768
RT 44,15,34816
RT 46,15,35328
s_waitcnt lgkmcnt(6)
MM 0,52,48
MM 0,60,56
s_waitcnt vmcnt(0)
s_barrier
RB 48,13,49152
RT 52,15,49152
RT 54,15,49664
RB 56,14,49152
RT 60,15,51200
RT 62,15,51712
s_waitcnt lgkmcnt(6)
MM 0,36,32
MM 0,44,40
s_waitcnt lgkmcnt(0)
MM 0,52,48
MM 0,60,56
s_barrier
s_and_b32 s24, s16, 3
s_lshl_b32 s24, s24, 12
v_lshlrev_b32 v1, 4, v0
v_add_u32 v1, s24, v1
v_add_u32 v1, 65536, v1
s_cmp_lt_u32 s16, 4
s_cbranch_scc1 ksr_233
s_nop 3
ds_write_b128 v1, a[0:3] offset:0
ds_write_b128 v1, a[4:7] offset:1024
ds_write_b128 v1, a[8:11] offset:2048
ds_write_b128 v1, a[12:15] offset:3072
s_waitcnt lgkmcnt(0)
ksr_233:
s_barrier
s_cmp_ge_u32 s16, 4
s_cbranch_scc1 kse_234
RB 32,1,0
RB 36,1,1024
RB 40,1,2048
RB 44,1,3072
v_accvgpr_read_b32 v48, a0
v_accvgpr_read_b32 v49, a1
v_accvgpr_read_b32 v50, a2
v_accvgpr_read_b32 v51, a3
v_accvgpr_read_b32 v52, a4
v_accvgpr_read_b32 v53, a5
v_accvgpr_read_b32 v54, a6
v_accvgpr_read_b32 v55, a7
v_accvgpr_read_b32 v56, a8
v_accvgpr_read_b32 v57, a9
v_accvgpr_read_b32 v58, a10
v_accvgpr_read_b32 v59, a11
v_accvgpr_read_b32 v60, a12
v_accvgpr_read_b32 v61, a13
v_accvgpr_read_b32 v62, a14
v_accvgpr_read_b32 v63, a15
s_waitcnt lgkmcnt(0)
v_add_f32 v48, v48, v32
v_add_f32 v49, v49, v33
v_add_f32 v50, v50, v34
v_add_f32 v51, v51, v35
v_add_f32 v52, v52, v36
v_add_f32 v53, v53, v37
v_add_f32 v54, v54, v38
v_add_f32 v55, v55, v39
v_add_f32 v56, v56, v40
v_add_f32 v57, v57, v41
v_add_f32 v58, v58, v42
v_add_f32 v59, v59, v43
v_add_f32 v60, v60, v44
v_add_f32 v61, v61, v45
v_add_f32 v62, v62, v46
v_add_f32 v63, v63, v47
v_accvgpr_write_b32 a0, v48
v_accvgpr_write_b32 a1, v49
v_accvgpr_write_b32 a2, v50
v_accvgpr_write_b32 a3, v51
v_accvgpr_write_b32 a4, v52
v_accvgpr_write_b32 a5, v53
v_accvgpr_write_b32 a6, v54
v_accvgpr_write_b32 a7, v55
v_accvgpr_write_b32 a8, v56
v_accvgpr_write_b32 a9, v57
v_accvgpr_write_b32 a10, v58
v_accvgpr_write_b32 a11, v59
v_accvgpr_write_b32 a12, v60
v_accvgpr_write_b32 a13, v61
v_accvgpr_write_b32 a14, v62
v_accvgpr_write_b32 a15, v63
kse_234:
s_cmp_lg_u32 s16, 0
s_cbranch_scc1 tt_235
v_mov_b32 v7, s56
v_accvgpr_write_b32 a127, 1
s_mov_b64 exec, 1
buffer_atomic_add a127, v7, s[4:7], 0 offen sc0
s_mov_b64 exec, -1
tt_235:
v_and_b32 v1, 31, v0
v_lshrrev_b32 v2, 5, v0
s_mul_i32 s24, s17, 4608
s_mul_i32 s25, s18, 64
s_add_u32 s24, s24, s25
v_mul_u32_u24 v3, 144, v1
v_lshl_add_u32 v3, v2, 4, v3
v_add_u32 v3, s24, v3
v_mov_b32 v72, 0xc0135761
v_mov_b32 v74, 0xbdd2d3e8
v_mov_b32 v76, 1.0
v_mov_b32 v73, 0xc0135761
v_mov_b32 v75, 0xbdd2d3e8
v_mov_b32 v77, 1.0
v_lshrrev_b32 v4, 3, v0
v_and_b32 v5, 7, v0
s_mul_i32 s24, s16, 8
v_add_u32 v4, s24, v4
v_mul_u32_u24 v6, 144, v4
v_lshl_add_u32 v6, v5, 4, v6
s_mov_b32 s24, 7168
v_mul_lo_u32 v12, v4, s24
v_lshl_add_u32 v12, v5, 4, v12
s_cmp_ge_u32 s16, 4
s_cbranch_scc1 epw_236
v_accvgpr_read_b32 v32, a0
v_accvgpr_read_b32 v33, a1
v_accvgpr_read_b32 v34, a2
v_accvgpr_read_b32 v35, a3
v_accvgpr_read_b32 v36, a4
v_accvgpr_read_b32 v37, a5
v_accvgpr_read_b32 v38, a6
v_accvgpr_read_b32 v39, a7
v_accvgpr_read_b32 v40, a8
v_accvgpr_read_b32 v41, a9
v_accvgpr_read_b32 v42, a10
v_accvgpr_read_b32 v43, a11
v_accvgpr_read_b32 v44, a12
v_accvgpr_read_b32 v45, a13
v_accvgpr_read_b32 v46, a14
v_accvgpr_read_b32 v47, a15
v_pk_mul_f32 v[64:65], v[32:33], v[32:33]
v_pk_mul_f32 v[66:67], v[34:35], v[34:35]
v_pk_fma_f32 v[64:65], v[64:65], v[74:75], v[72:73]
v_pk_fma_f32 v[66:67], v[66:67], v[74:75], v[72:73]
v_pk_mul_f32 v[64:65], v[64:65], v[32:33]
v_pk_mul_f32 v[66:67], v[66:67], v[34:35]
v_exp_f32 v64, v64
v_exp_f32 v66, v66
v_exp_f32 v65, v65
v_exp_f32 v67, v67
v_pk_add_f32 v[64:65], v[64:65], v[76:77]
v_pk_add_f32 v[66:67], v[66:67], v[76:77]
v_rcp_f32 v64, v64
v_rcp_f32 v66, v66
v_rcp_f32 v65, v65
v_rcp_f32 v67, v67
v_pk_mul_f32 v[32:33], v[32:33], v[64:65]
v_pk_mul_f32 v[34:35], v[34:35], v[66:67]
v_pk_mul_f32 v[64:65], v[36:37], v[36:37]
v_pk_mul_f32 v[66:67], v[38:39], v[38:39]
v_pk_fma_f32 v[64:65], v[64:65], v[74:75], v[72:73]
v_pk_fma_f32 v[66:67], v[66:67], v[74:75], v[72:73]
v_pk_mul_f32 v[64:65], v[64:65], v[36:37]
v_pk_mul_f32 v[66:67], v[66:67], v[38:39]
v_exp_f32 v64, v64
v_exp_f32 v66, v66
v_exp_f32 v65, v65
v_exp_f32 v67, v67
v_pk_add_f32 v[64:65], v[64:65], v[76:77]
v_pk_add_f32 v[66:67], v[66:67], v[76:77]
v_rcp_f32 v64, v64
v_rcp_f32 v66, v66
v_rcp_f32 v65, v65
v_rcp_f32 v67, v67
v_pk_mul_f32 v[36:37], v[36:37], v[64:65]
v_pk_mul_f32 v[38:39], v[38:39], v[66:67]
v_pk_mul_f32 v[64:65], v[40:41], v[40:41]
v_pk_mul_f32 v[66:67], v[42:43], v[42:43]
v_pk_fma_f32 v[64:65], v[64:65], v[74:75], v[72:73]
v_pk_fma_f32 v[66:67], v[66:67], v[74:75], v[72:73]
v_pk_mul_f32 v[64:65], v[64:65], v[40:41]
v_pk_mul_f32 v[66:67], v[66:67], v[42:43]
v_exp_f32 v64, v64
v_exp_f32 v66, v66
v_exp_f32 v65, v65
v_exp_f32 v67, v67
v_pk_add_f32 v[64:65], v[64:65], v[76:77]
v_pk_add_f32 v[66:67], v[66:67], v[76:77]
v_rcp_f32 v64, v64
v_rcp_f32 v66, v66
v_rcp_f32 v65, v65
v_rcp_f32 v67, v67
v_pk_mul_f32 v[40:41], v[40:41], v[64:65]
v_pk_mul_f32 v[42:43], v[42:43], v[66:67]
v_pk_mul_f32 v[64:65], v[44:45], v[44:45]
v_pk_mul_f32 v[66:67], v[46:47], v[46:47]
v_pk_fma_f32 v[64:65], v[64:65], v[74:75], v[72:73]
v_pk_fma_f32 v[66:67], v[66:67], v[74:75], v[72:73]
v_pk_mul_f32 v[64:65], v[64:65], v[44:45]
v_pk_mul_f32 v[66:67], v[66:67], v[46:47]
v_exp_f32 v64, v64
v_exp_f32 v66, v66
v_exp_f32 v65, v65
v_exp_f32 v67, v67
v_pk_add_f32 v[64:65], v[64:65], v[76:77]
v_pk_add_f32 v[66:67], v[66:67], v[76:77]
v_rcp_f32 v64, v64
v_rcp_f32 v66, v66
v_rcp_f32 v65, v65
v_rcp_f32 v67, v67
v_pk_mul_f32 v[44:45], v[44:45], v[64:65]
v_pk_mul_f32 v[46:47], v[46:47], v[66:67]
v_cvt_pk_bf16_f32 v48, v32, v33
v_cvt_pk_bf16_f32 v49, v34, v35
v_cvt_pk_bf16_f32 v50, v36, v37
v_cvt_pk_bf16_f32 v51, v38, v39
v_cvt_pk_bf16_f32 v52, v40, v41
v_cvt_pk_bf16_f32 v53, v42, v43
v_cvt_pk_bf16_f32 v54, v44, v45
v_cvt_pk_bf16_f32 v55, v46, v47
v_permlane32_swap_b32 v48, v50
v_permlane32_swap_b32 v49, v51
v_permlane32_swap_b32 v52, v54
v_permlane32_swap_b32 v53, v55
ds_write_b128 v3, v[48:51] offset:0
ds_write_b128 v3, v[52:55] offset:32
epw_236:
s_waitcnt lgkmcnt(0)
s_barrier
RB 32,6,0
s_waitcnt lgkmcnt(0)
s_add_u32 s24, s33, 0
buffer_store_dwordx4 v[32:35], v12, s[4:7], s24 offen sc1
s_lshl_b32 s76, s77, 3
s_add_u32 s76, s76, s60
s_lshl_b32 s76, s76, 7
s_add_u32 s76, s76, 163840
s_waitcnt vmcnt(0)
s_barrier
s_cmp_lg_u32 s16, 0
s_cbranch_scc1 sig_237
v_mov_b32 v1, s76
v_mov_b32 v2, 1
s_mov_b64 exec, 1
buffer_atomic_add v2, v1, s[4:7], 0 offen
s_mov_b64 exec, -1
sig_237:
s_branch mega_kernel_wloop
mega_kernel_t22:
s_bfe_u32 s17, s16, 65537
s_and_b32 s18, s16, 1
s_lshr_b32 s52, s16, 2
v_lshrrev_b32 v1, 3, v0
s_mov_b32 s24, 7168
v_mul_lo_u32 v1, v1, s24
v_lshrrev_b32 v2, 4, v0
v_and_b32 v3, 7, v0
s_and_b32 s25, s16, 1
s_lshl_b32 s25, s25, 2
v_add_u32 v4, s25, v2
v_xor_b32 v4, v4, v3
v_lshl_add_u32 v8, v4, 4, v1
v_lshrrev_b32 v1, 3, v0
v_and_b32 v3, 7, v0
s_mov_b32 s24, 2048
v_mul_lo_u32 v2, v1, s24
v_bfe_u32 v4, v1, 1, 1
v_lshlrev_b32 v4, 2, v4
v_xor_b32 v4, v4, v3
v_lshl_add_u32 v10, v4, 4, v2
v_and_b32 v1, 31, v0
v_lshrrev_b32 v2, 5, v0
v_bfe_u32 v3, v1, 1, 3
s_mul_i32 s24, s17, 4096
v_lshlrev_b32 v4, 7, v1
v_add_u32 v4, s24, v4
s_lshl_b32 s25, s52, 2
s_add_u32 s26, s25, 0
v_add_u32 v5, s26, v2
v_xor_b32 v5, v5, v3
v_lshl_add_u32 v13, v5, 4, v4
s_add_u32 s26, s25, 2
v_add_u32 v5, s26, v2
v_xor_b32 v5, v5, v3
v_lshl_add_u32 v14, v5, 4, v4
v_and_b32 v1, 15, v0
v_lshrrev_b32 v2, 2, v1
v_lshrrev_b32 v3, 5, v0
v_lshl_add_u32 v3, v3, 3, v2
s_lshl_b32 s24, s52, 5
v_add_u32 v3, s24, v3
v_lshlrev_b32 v3, 7, v3
v_and_b32 v4, 3, v1
v_lshl_add_u32 v3, v4, 3, v3
v_bfe_u32 v4, v0, 4, 1
v_lshl_add_u32 v3, v4, 5, v3
v_add_u32 v3, 8192, v3
v_bfe_u32 v4, v2, 1, 1
v_xor_b32 v4, s18, v4
v_lshl_add_u32 v15, v4, 6, v3
v_add_u32 v16, 65536, v13
v_add_u32 v17, 65536, v14
v_add_u32 v18, 65536, v15
s_lshl_b32 s22, s16, 10
s_add_u32 s23, s22, 8192
s_mov_b32 s8, s86
s_and_b32 s9, s87, 0xffff
s_mov_b32 s10, 0x700000
s_mov_b32 s11, 0x00020000
s_lshl_b32 s28, s77, 7
s_lshl_b32 s52, s77, 6
s_add_u32 s52, s52, 960
s_cmp_ge_u32 s77, 15
s_cselect_b32 s28, s52, s28
s_lshl_b32 s29, s60, 7
s_and_b32 s24, s79, 1
s_lshl_b32 s24, s24, 6
s_add_u32 s29, s29, s24
s_mul_i32 s24, s16, 8
s_add_u32 s24, s24, s28
s_mul_i32 s19, s24, 7168
s_add_u32 s19, s19, 106962944
s_mul_i32 s20, s16, 16384
s_lshl_b32 s24, s29, 1
s_add_u32 s20, s20, s24
s_lshr_b32 s25, s79, 1
s_mul_i32 s24, s25, 1792
s_add_u32 s19, s19, s24
s_lshr_b32 s25, s79, 1
s_mul_i32 s24, s25, 1835008
s_add_u32 s20, s20, s24
s_mul_i32 s24, s28, 4096
s_mul_i32 s25, s29, 4
s_add_u32 s24, s24, s25
s_lshr_b32 s25, s79, 1
s_mul_i32 s25, s25, 8388608
s_add_u32 s33, s24, s25
s_add_u32 s33, s33, 155197440
s_mov_b32 s34, 0
s_mov_b32 s35, 0
s_lshl_b32 s76, s77, 10
s_add_u32 s76, s76, 163840
s_cmp_lg_u32 s16, 0
s_cbranch_scc1 ws_238
v_lshlrev_b32 v1, 7, v0
v_add_u32 v1, s76, v1
s_mov_b64 exec, 0xff
wsp_239:
s_add_u32 s63, s63, 1
s_cmp_gt_u32 s63, 262144
s_cbranch_scc0 go_241
s_endpgm
go_241:
buffer_load_dword v3, v1, s[4:7], 0 offen sc1
s_waitcnt vmcnt(0)
s_mov_b32 s26, 0
v_readlane_b32 s27, v3, 0
s_nop 0
s_add_u32 s26, s26, s27
v_readlane_b32 s27, v3, 1
s_nop 0
s_add_u32 s26, s26, s27
v_readlane_b32 s27, v3, 2
s_nop 0
s_add_u32 s26, s26, s27
v_readlane_b32 s27, v3, 3
s_nop 0
s_add_u32 s26, s26, s27
v_readlane_b32 s27, v3, 4
s_nop 0
s_add_u32 s26, s26, s27
v_readlane_b32 s27, v3, 5
s_nop 0
s_add_u32 s26, s26, s27
v_readlane_b32 s27, v3, 6
s_nop 0
s_add_u32 s26, s26, s27
v_readlane_b32 s27, v3, 7
s_nop 0
s_add_u32 s26, s26, s27
s_sub_i32 s26, 56, s26
s_cmp_lt_i32 s26, 1
s_cbranch_scc1 wsd_240
s_cmp_lt_u32 s77, 13
s_cbranch_scc1 urg_242
s_sleep 2
s_branch wsp_239
urg_242:
s_cmp_lt_i32 s26, 3
s_cbranch_scc1 lv_243
s_sleep 40
s_branch wsp_239
lv_243:
s_cmp_lt_i32 s26, 1
s_cbranch_scc1 lv_244
s_sleep 12
s_branch wsp_239
lv_244:
s_sleep 8
s_branch wsp_239
wsd_240:
s_mov_b64 exec, -1
ws_238:
s_barrier
s_add_u32 m0, s22, 0
s_add_u32 s24, s19, 0
buffer_load_dwordx4 v8, s[4:7], s24 offen sc1 lds
s_add_u32 m0, s23, 0
s_add_u32 s25, s20, 0
buffer_load_dwordx4 v10, s[8:11], s25 offen lds
s_add_u32 m0, s22, 16384
s_add_u32 s24, s19, 128
buffer_load_dwordx4 v8, s[4:7], s24 offen sc1 lds
s_add_u32 m0, s23, 16384
s_add_u32 s25, s20, 131072
buffer_load_dwordx4 v10, s[8:11], s25 offen lds
s_add_u32 m0, s22, 32768
s_add_u32 s24, s19, 256
buffer_load_dwordx4 v8, s[4:7], s24 offen sc1 lds
s_add_u32 m0, s23, 32768
s_add_u32 s25, s20, 262144
buffer_load_dwordx4 v10, s[8:11], s25 offen lds
v_accvgpr_write_b32 a0, 0
v_accvgpr_write_b32 a1, 0
v_accvgpr_write_b32 a2, 0
v_accvgpr_write_b32 a3, 0
v_accvgpr_write_b32 a4, 0
v_accvgpr_write_b32 a5, 0
v_accvgpr_write_b32 a6, 0
v_accvgpr_write_b32 a7, 0
v_accvgpr_write_b32 a8, 0
v_accvgpr_write_b32 a9, 0
v_accvgpr_write_b32 a10, 0
v_accvgpr_write_b32 a11, 0
v_accvgpr_write_b32 a12, 0
v_accvgpr_write_b32 a13, 0
v_accvgpr_write_b32 a14, 0
v_accvgpr_write_b32 a15, 0
s_waitcnt vmcnt(4)
s_barrier
RB 32,13,0
RT 36,15,0
RT 38,15,512
RB 40,14,0
RT 44,15,2048
RT 46,15,2560
s_waitcnt vmcnt(2)
s_barrier
RB 48,13,16384
RT 52,15,16384
RT 54,15,16896
RB 56,14,16384
RT 60,15,18432
RT 62,15,18944
s_waitcnt lgkmcnt(6)
MM 0,36,32
MM 0,44,40
s_add_u32 m0, s22, 49152
s_add_u32 s24, s19, 384
buffer_load_dwordx4 v8, s[4:7], s24 offen sc1 lds
s_add_u32 m0, s23, 49152
s_add_u32 s25, s20, 393216
buffer_load_dwordx4 v10, s[8:11], s25 offen lds
s_add_u32 m0, s22, 65536
s_add_u32 s24, s19, 512
buffer_load_dwordx4 v8, s[4:7], s24 offen sc1 lds
s_add_u32 m0, s23, 65536
s_add_u32 s25, s20, 524288
buffer_load_dwordx4 v10, s[8:11], s25 offen lds
s_waitcnt vmcnt(4)
s_barrier
RB 32,13,32768
RT 36,15,32768
RT 38,15,33280
RB 40,14,32768
RT 44,15,34816
RT 46,15,35328
s_waitcnt lgkmcnt(6)
MM 0,52,48
MM 0,60,56
s_add_u32 m0, s22, 81920
s_add_u32 s24, s19, 640
buffer_load_dwordx4 v8, s[4:7], s24 offen sc1 lds
s_add_u32 m0, s23, 81920
s_add_u32 s25, s20, 655360
buffer_load_dwordx4 v10, s[8:11], s25 offen lds
s_add_u32 m0, s22, 0
s_add_u32 s24, s19, 768
buffer_load_dwordx4 v8, s[4:7], s24 offen sc1 lds
s_add_u32 m0, s23, 0
s_add_u32 s25, s20, 786432
buffer_load_dwordx4 v10, s[8:11], s25 offen lds
s_waitcnt vmcnt(6)
s_barrier
RB 48,13,49152
RT 52,15,49152
RT 54,15,49664
RB 56,14,49152
RT 60,15,51200
RT 62,15,51712
s_waitcnt lgkmcnt(6)
MM 0,36,32
MM 0,44,40
s_add_u32 m0, s22, 16384
s_add_u32 s24, s19, 896
buffer_load_dwordx4 v8, s[4:7], s24 offen sc1 lds
s_add_u32 m0, s23, 16384
s_add_u32 s25, s20, 917504
buffer_load_dwordx4 v10, s[8:11], s25 offen lds
s_waitcnt vmcnt(6)
s_barrier
RB 32,16,0
RT 36,18,0
RT 38,18,512
RB 40,17,0
RT 44,18,2048
RT 46,18,2560
s_waitcnt lgkmcnt(6)
MM 0,52,48
MM 0,60,56
s_add_u32 m0, s22, 32768
s_add_u32 s24, s19, 1024
buffer_load_dwordx4 v8, s[4:7], s24 offen sc1 lds
s_add_u32 m0, s23, 32768
s_add_u32 s25, s20, 1048576
buffer_load_dwordx4 v10, s[8:11], s25 offen lds
s_waitcnt vmcnt(6)
s_barrier
RB 48,16,16384
RT 52,18,16384
RT 54,18,16896
RB 56,17,16384
RT 60,18,18432
RT 62,18,18944
s_waitcnt lgkmcnt(6)
MM 0,36,32
MM 0,44,40
s_add_u32 m0, s22, 49152
s_add_u32 s24, s19, 1152
buffer_load_dwordx4 v8, s[4:7], s24 offen sc1 lds
s_add_u32 m0, s23, 49152
s_add_u32 s25, s20, 1179648
buffer_load_dwordx4 v10, s[8:11], s25 offen lds
s_waitcnt vmcnt(6)
s_barrier
RB 32,13,0
RT 36,15,0
RT 38,15,512
RB 40,14,0
RT 44,15,2048
RT 46,15,2560
s_waitcnt lgkmcnt(6)
MM 0,52,48
MM 0,60,56
s_add_u32 m0, s22, 65536
s_add_u32 s24, s19, 1280
buffer_load_dwordx4 v8, s[4:7], s24 offen sc1 lds
s_add_u32 m0, s23, 65536
s_add_u32 s25, s20, 1310720
buffer_load_dwordx4 v10, s[8:11], s25 offen lds
s_waitcnt vmcnt(6)
s_barrier
RB 48,13,16384
RT 52,15,16384
RT 54,15,16896
RB 56,14,16384
RT 60,15,18432
RT 62,15,18944
s_waitcnt lgkmcnt(6)
MM 0,36,32
MM 0,44,40
s_add_u32 m0, s22, 81920
s_add_u32 s24, s19, 1408
buffer_load_dwordx4 v8, s[4:7], s24 offen sc1 lds
s_add_u32 m0, s23, 81920
s_add_u32 s25, s20, 1441792
buffer_load_dwordx4 v10, s[8:11], s25 offen lds
s_waitcnt vmcnt(6)
s_barrier
RB 32,13,32768
RT 36,15,32768
RT 38,15,33280
RB 40,14,32768
RT 44,15,34816
RT 46,15,35328
s_waitcnt lgkmcnt(6)
MM 0,52,48
MM 0,60,56
s_add_u32 m0, s22, 0
s_add_u32 s24, s19, 1536
buffer_load_dwordx4 v8, s[4:7], s24 offen sc1 lds
s_add_u32 m0, s23, 0
s_add_u32 s25, s20, 1572864
buffer_load_dwordx4 v10, s[8:11], s25 offen lds
s_waitcnt vmcnt(6)
s_barrier
RB 48,13,49152
RT 52,15,49152
RT 54,15,49664
RB 56,14,49152
RT 60,15,51200
RT 62,15,51712
s_waitcnt lgkmcnt(6)
MM 0,36,32
MM 0,44,40
s_add_u32 m0, s22, 16384
s_add_u32 s24, s19, 1664
buffer_load_dwordx4 v8, s[4:7], s24 offen sc1 lds
s_add_u32 m0, s23, 16384
s_add_u32 s25, s20, 1703936
buffer_load_dwordx4 v10, s[8:11], s25 offen lds
s_waitcnt vmcnt(6)
s_barrier
RB 32,16,0
RT 36,18,0
RT 38,18,512
RB 40,17,0
RT 44,18,2048
RT 46,18,2560
s_waitcnt lgkmcnt(6)
MM 0,52,48
MM 0,60,56
s_waitcnt vmcnt(4)
s_barrier
RB 48,16,16384
RT 52,18,16384
RT 54,18,16896
RB 56,17,16384
RT 60,18,18432
RT 62,18,18944
s_waitcnt lgkmcnt(6)
MM 0,36,32
MM 0,44,40
s_waitcnt vmcnt(2)
s_barrier
RB 32,13,0
RT 36,15,0
RT 38,15,512
RB 40,14,0
RT 44,15,2048
RT 46,15,2560
s_waitcnt lgkmcnt(6)
MM 0,52,48
MM 0,60,56
s_waitcnt vmcnt(0)
s_barrier
RB 48,13,16384
RT 52,15,16384
RT 54,15,16896
RB 56,14,16384
RT 60,15,18432
RT 62,15,18944
s_waitcnt lgkmcnt(6)
MM 0,36,32
MM 0,44,40
s_waitcnt lgkmcnt(0)
MM 0,52,48
MM 0,60,56
s_barrier
s_and_b32 s24, s16, 3
s_lshl_b32 s24, s24, 12
v_lshlrev_b32 v1, 4, v0
v_add_u32 v1, s24, v1
v_add_u32 v1, 65536, v1
s_cmp_lt_u32 s16, 4
s_cbranch_scc1 ksr_245
s_nop 3
ds_write_b128 v1, a[0:3] offset:0
ds_write_b128 v1, a[4:7] offset:1024
ds_write_b128 v1, a[8:11] offset:2048
ds_write_b128 v1, a[12:15] offset:3072
s_waitcnt lgkmcnt(0)
ksr_245:
s_barrier
s_cmp_ge_u32 s16, 4
s_cbranch_scc1 kse_246
RB 32,1,0
RB 36,1,1024
RB 40,1,2048
RB 44,1,3072
v_accvgpr_read_b32 v48, a0
v_accvgpr_read_b32 v49, a1
v_accvgpr_read_b32 v50, a2
v_accvgpr_read_b32 v51, a3
v_accvgpr_read_b32 v52, a4
v_accvgpr_read_b32 v53, a5
v_accvgpr_read_b32 v54, a6
v_accvgpr_read_b32 v55, a7
v_accvgpr_read_b32 v56, a8
v_accvgpr_read_b32 v57, a9
v_accvgpr_read_b32 v58, a10
v_accvgpr_read_b32 v59, a11
v_accvgpr_read_b32 v60, a12
v_accvgpr_read_b32 v61, a13
v_accvgpr_read_b32 v62, a14
v_accvgpr_read_b32 v63, a15
s_waitcnt lgkmcnt(0)
v_add_f32 v48, v48, v32
v_add_f32 v49, v49, v33
v_add_f32 v50, v50, v34
v_add_f32 v51, v51, v35
v_add_f32 v52, v52, v36
v_add_f32 v53, v53, v37
v_add_f32 v54, v54, v38
v_add_f32 v55, v55, v39
v_add_f32 v56, v56, v40
v_add_f32 v57, v57, v41
v_add_f32 v58, v58, v42
v_add_f32 v59, v59, v43
v_add_f32 v60, v60, v44
v_add_f32 v61, v61, v45
v_add_f32 v62, v62, v46
v_add_f32 v63, v63, v47
v_accvgpr_write_b32 a0, v48
v_accvgpr_write_b32 a1, v49
v_accvgpr_write_b32 a2, v50
v_accvgpr_write_b32 a3, v51
v_accvgpr_write_b32 a4, v52
v_accvgpr_write_b32 a5, v53
v_accvgpr_write_b32 a6, v54
v_accvgpr_write_b32 a7, v55
v_accvgpr_write_b32 a8, v56
v_accvgpr_write_b32 a9, v57
v_accvgpr_write_b32 a10, v58
v_accvgpr_write_b32 a11, v59
v_accvgpr_write_b32 a12, v60
v_accvgpr_write_b32 a13, v61
v_accvgpr_write_b32 a14, v62
v_accvgpr_write_b32 a15, v63
kse_246:
s_cmp_lg_u32 s16, 0
s_cbranch_scc1 tt_247
v_mov_b32 v7, s56
v_accvgpr_write_b32 a127, 1
s_mov_b64 exec, 1
buffer_atomic_add a127, v7, s[4:7], 0 offen sc0
s_mov_b64 exec, -1
tt_247:
v_and_b32 v1, 31, v0
v_lshrrev_b32 v2, 5, v0
s_mul_i32 s24, s17, 8704
s_mul_i32 s25, s18, 128
s_add_u32 s24, s24, s25
v_mul_u32_u24 v3, 272, v1
v_lshl_add_u32 v3, v2, 4, v3
v_add_u32 v3, s24, v3
v_lshrrev_b32 v4, 4, v0
v_and_b32 v5, 15, v0
s_mul_i32 s24, s16, 8
v_add_u32 v4, s24, v4
v_mul_u32_u24 v6, 272, v4
v_lshl_add_u32 v6, v5, 4, v6
s_mov_b32 s24, 4096
v_mul_lo_u32 v12, v4, s24
v_lshl_add_u32 v12, v5, 4, v12
s_cmp_ge_u32 s16, 4
s_cbranch_scc1 epw_248
ds_write_b128 v3, a[0:3] offset:0
ds_write_b128 v3, a[4:7] offset:32
ds_write_b128 v3, a[8:11] offset:64
ds_write_b128 v3, a[12:15] offset:96
epw_248:
s_waitcnt lgkmcnt(0)
s_barrier
RB 32,6,0
RB 36,6,1088
s_waitcnt lgkmcnt(1)
s_add_u32 s24, s33, 0
buffer_store_dwordx4 v[32:35], v12, s[4:7], s24 offen sc1
s_waitcnt lgkmcnt(0)
s_add_u32 s24, s33, 16384
buffer_store_dwordx4 v[36:39], v12, s[4:7], s24 offen sc1
s_lshl_b32 s76, s77, 3
s_add_u32 s76, s76, s60
s_lshl_b32 s76, s76, 7
s_add_u32 s76, s76, 196608
s_waitcnt vmcnt(0)
s_barrier
s_cmp_lg_u32 s16, 0
s_cbranch_scc1 sig_249
v_mov_b32 v1, s76
v_mov_b32 v2, 1
s_mov_b64 exec, 1
buffer_atomic_add v2, v1, s[4:7], 0 offen
s_mov_b64 exec, -1
sig_249:
s_branch mega_kernel_wloop
mega_kernel_t17:
s_lshr_b32 s17, s16, 2
s_and_b32 s18, s16, 3
v_lshrrev_b32 v1, 3, v0
s_mov_b32 s24, 7168
v_mul_lo_u32 v1, v1, s24
v_lshrrev_b32 v2, 4, v0
v_and_b32 v3, 7, v0
s_mov_b32 s25, 0
s_xor_b32 s26, s25, 0
v_add_u32 v4, s26, v2
v_xor_b32 v4, v4, v3
v_lshl_add_u32 v8, v4, 4, v1
s_xor_b32 s26, s25, 4
v_add_u32 v4, s26, v2
v_xor_b32 v4, v4, v3
v_lshl_add_u32 v9, v4, 4, v1
v_lshrrev_b32 v1, 5, v0
v_and_b32 v3, 31, v0
s_mov_b32 s24, 2048
v_mul_lo_u32 v2, v1, s24
v_add_u32 v4, 0, v1
v_and_b32 v4, 3, v4
v_lshlrev_b32 v4, 2, v4
v_xor_b32 v4, v4, v3
v_lshl_add_u32 v10, v4, 4, v2
v_add_u32 v4, 2, v1
v_and_b32 v4, 3, v4
v_lshlrev_b32 v4, 2, v4
v_xor_b32 v4, v4, v3
v_lshl_add_u32 v11, v4, 4, v2
v_and_b32 v1, 31, v0
v_lshrrev_b32 v2, 5, v0
v_bfe_u32 v3, v1, 1, 3
s_mul_i32 s24, s17, 8192
v_lshlrev_b32 v4, 7, v1
v_add_u32 v4, s24, v4
v_add_u32 v5, 0, v2
v_xor_b32 v5, v5, v3
v_lshl_add_u32 v13, v5, 4, v4
v_add_u32 v5, 2, v2
v_xor_b32 v5, v5, v3
v_lshl_add_u32 v14, v5, 4, v4
v_add_u32 v5, 4, v2
v_xor_b32 v5, v5, v3
v_lshl_add_u32 v15, v5, 4, v4
v_add_u32 v5, 6, v2
v_xor_b32 v5, v5, v3
v_lshl_add_u32 v16, v5, 4, v4
v_and_b32 v1, 15, v0
v_lshrrev_b32 v2, 2, v1
v_lshrrev_b32 v3, 5, v0
v_lshl_add_u32 v3, v3, 3, v2
v_mul_u32_u24 v3, 512, v3
v_and_b32 v4, 3, v1
v_lshl_add_u32 v3, v4, 3, v3
v_bfe_u32 v4, v0, 4, 1
v_lshl_add_u32 v3, v4, 5, v3
v_add_u32 v3, 16384, v3
s_mul_i32 s24, s18, 2
s_add_u32 s24, s24, 0
v_xor_b32 v4, s24, v2
v_lshl_add_u32 v17, v4, 6, v3
s_mul_i32 s24, s18, 2
s_add_u32 s24, s24, 1
v_xor_b32 v4, s24, v2
v_lshl_add_u32 v18, v4, 6, v3
v_add_u32 v19, 49152, v13
v_add_u32 v20, 49152, v14
v_add_u32 v21, 49152, v15
v_add_u32 v22, 49152, v16
v_add_u32 v23, 49152, v17
v_add_u32 v24, 49152, v18
v_add_u32 v25, 98304, v13
v_add_u32 v26, 98304, v14
v_add_u32 v27, 98304, v15
v_add_u32 v28, 98304, v16
v_add_u32 v29, 98304, v17
v_add_u32 v30, 98304, v18
s_mul_i32 s22, s16, 2048
s_mul_i32 s23, s16, 4096
s_add_u32 s23, s23, 16384
s_mov_b32 s8, s86
s_and_b32 s9, s87, 0xffff
s_mov_b32 s10, 0x700000
s_mov_b32 s11, 0x00020000
s_mov_b32 s12, s90
s_and_b32 s13, s91, 0xffff
s_mov_b32 s14, 0x400000
s_mov_b32 s15, 0x00020000
s_lshl_b32 s28, s77, 7
s_lshl_b32 s52, s77, 6
s_add_u32 s52, s52, 960
s_cmp_ge_u32 s77, 15
s_cselect_b32 s28, s52, s28
s_and_b32 s29, s79, 3
s_lshl_b32 s29, s29, 8
s_mul_i32 s24, s16, 16
s_add_u32 s24, s24, s28
s_mul_i32 s19, s24, 7168
s_add_u32 s19, s19, 106962944
s_mul_i32 s20, s16, 16384
s_lshl_b32 s24, s29, 1
s_add_u32 s20, s20, s24
s_lshl_b32 s24, s28, 11
s_lshl_b32 s25, s29, 1
s_add_u32 s33, s24, s25
s_add_u32 s34, s33, 98574336
s_add_u32 s35, s33, 81788928
s_lshl_b32 s76, s77, 10
s_add_u32 s76, s76, 163840
s_cmp_lg_u32 s16, 0
s_cbranch_scc1 ws_250
v_lshlrev_b32 v1, 7, v0
v_add_u32 v1, s76, v1
s_mov_b64 exec, 0xff
wsp_251:
s_add_u32 s63, s63, 1
s_cmp_gt_u32 s63, 262144
s_cbranch_scc0 go_253
s_endpgm
go_253:
buffer_load_dword v3, v1, s[4:7], 0 offen sc1
s_waitcnt vmcnt(0)
s_mov_b32 s26, 0
v_readlane_b32 s27, v3, 0
s_nop 0
s_add_u32 s26, s26, s27
v_readlane_b32 s27, v3, 1
s_nop 0
s_add_u32 s26, s26, s27
v_readlane_b32 s27, v3, 2
s_nop 0
s_add_u32 s26, s26, s27
v_readlane_b32 s27, v3, 3
s_nop 0
s_add_u32 s26, s26, s27
v_readlane_b32 s27, v3, 4
s_nop 0
s_add_u32 s26, s26, s27
v_readlane_b32 s27, v3, 5
s_nop 0
s_add_u32 s26, s26, s27
v_readlane_b32 s27, v3, 6
s_nop 0
s_add_u32 s26, s26, s27
v_readlane_b32 s27, v3, 7
s_nop 0
s_add_u32 s26, s26, s27
s_sub_i32 s26, 56, s26
s_cmp_lt_i32 s26, 1
s_cbranch_scc1 wsd_252
s_cmp_lt_u32 s77, 13
s_cbranch_scc1 urg_254
s_sleep 2
s_branch wsp_251
urg_254:
s_cmp_lt_i32 s26, 3
s_cbranch_scc1 lv_255
s_sleep 40
s_branch wsp_251
lv_255:
s_cmp_lt_i32 s26, 1
s_cbranch_scc1 lv_256
s_sleep 12
s_branch wsp_251
lv_256:
s_sleep 8
s_branch wsp_251
wsd_252:
s_mov_b64 exec, -1
ws_250:
s_barrier
s_add_u32 m0, s22, 0
s_add_u32 s24, s19, 0
buffer_load_dwordx4 v8, s[4:7], s24 offen sc1 lds
s_add_u32 m0, s22, 1024
s_add_u32 s24, s19, 57344
buffer_load_dwordx4 v9, s[4:7], s24 offen sc1 lds
s_add_u32 m0, s23, 0
s_add_u32 s25, s20, 0
buffer_load_dwordx4 v10, s[8:11], s25 offen lds
s_add_u32 m0, s23, 1024
s_add_u32 s25, s20, 4096
buffer_load_dwordx4 v11, s[8:11], s25 offen lds
s_add_u32 m0, s23, 2048
s_add_u32 s25, s20, 8192
buffer_load_dwordx4 v10, s[8:11], s25 offen lds
s_add_u32 m0, s23, 3072
s_add_u32 s25, s20, 12288
buffer_load_dwordx4 v11, s[8:11], s25 offen lds
s_add_u32 m0, s22, 49152
s_add_u32 s24, s19, 128
buffer_load_dwordx4 v8, s[4:7], s24 offen sc1 lds
s_add_u32 m0, s22, 50176
s_add_u32 s24, s19, 57472
buffer_load_dwordx4 v9, s[4:7], s24 offen sc1 lds
s_add_u32 m0, s23, 49152
s_add_u32 s25, s20, 131072
buffer_load_dwordx4 v10, s[8:11], s25 offen lds
s_add_u32 m0, s23, 50176
s_add_u32 s25, s20, 135168
buffer_load_dwordx4 v11, s[8:11], s25 offen lds
s_add_u32 m0, s23, 51200
s_add_u32 s25, s20, 139264
buffer_load_dwordx4 v10, s[8:11], s25 offen lds
s_add_u32 m0, s23, 52224
s_add_u32 s25, s20, 143360
buffer_load_dwordx4 v11, s[8:11], s25 offen lds
v_accvgpr_write_b32 a0, 0
v_accvgpr_write_b32 a1, 0
v_accvgpr_write_b32 a2, 0
v_accvgpr_write_b32 a3, 0
v_accvgpr_write_b32 a4, 0
v_accvgpr_write_b32 a5, 0
v_accvgpr_write_b32 a6, 0
v_accvgpr_write_b32 a7, 0
v_accvgpr_write_b32 a8, 0
v_accvgpr_write_b32 a9, 0
v_accvgpr_write_b32 a10, 0
v_accvgpr_write_b32 a11, 0
v_accvgpr_write_b32 a12, 0
v_accvgpr_write_b32 a13, 0
v_accvgpr_write_b32 a14, 0
v_accvgpr_write_b32 a15, 0
v_accvgpr_write_b32 a16, 0
v_accvgpr_write_b32 a17, 0
v_accvgpr_write_b32 a18, 0
v_accvgpr_write_b32 a19, 0
v_accvgpr_write_b32 a20, 0
v_accvgpr_write_b32 a21, 0
v_accvgpr_write_b32 a22, 0
v_accvgpr_write_b32 a23, 0
v_accvgpr_write_b32 a24, 0
v_accvgpr_write_b32 a25, 0
v_accvgpr_write_b32 a26, 0
v_accvgpr_write_b32 a27, 0
v_accvgpr_write_b32 a28, 0
v_accvgpr_write_b32 a29, 0
v_accvgpr_write_b32 a30, 0
v_accvgpr_write_b32 a31, 0
v_accvgpr_write_b32 a32, 0
v_accvgpr_write_b32 a33, 0
v_accvgpr_write_b32 a34, 0
v_accvgpr_write_b32 a35, 0
v_accvgpr_write_b32 a36, 0
v_accvgpr_write_b32 a37, 0
v_accvgpr_write_b32 a38, 0
v_accvgpr_write_b32 a39, 0
v_accvgpr_write_b32 a40, 0
v_accvgpr_write_b32 a41, 0
v_accvgpr_write_b32 a42, 0
v_accvgpr_write_b32 a43, 0
v_accvgpr_write_b32 a44, 0
v_accvgpr_write_b32 a45, 0
v_accvgpr_write_b32 a46, 0
v_accvgpr_write_b32 a47, 0
v_accvgpr_write_b32 a48, 0
v_accvgpr_write_b32 a49, 0
v_accvgpr_write_b32 a50, 0
v_accvgpr_write_b32 a51, 0
v_accvgpr_write_b32 a52, 0
v_accvgpr_write_b32 a53, 0
v_accvgpr_write_b32 a54, 0
v_accvgpr_write_b32 a55, 0
v_accvgpr_write_b32 a56, 0
v_accvgpr_write_b32 a57, 0
v_accvgpr_write_b32 a58, 0
v_accvgpr_write_b32 a59, 0
v_accvgpr_write_b32 a60, 0
v_accvgpr_write_b32 a61, 0
v_accvgpr_write_b32 a62, 0
v_accvgpr_write_b32 a63, 0
s_waitcnt vmcnt(6)
s_barrier
RB 32,13,0
RB 36,13,4096
RT 40,17,0
RT 42,17,2048
RT 44,18,0
RT 46,18,2048
RB 48,14,0
RB 52,14,4096
RT 56,17,8192
RT 58,17,10240
RT 60,18,8192
RT 62,18,10240
RB 64,15,0
RB 68,15,4096
RT 72,17,16384
RT 74,17,18432
RT 76,18,16384
RT 78,18,18432
s_waitcnt lgkmcnt(12)
MM 0,40,32
RB 80,16,0
RB 84,16,4096
RT 88,17,24576
MM 16,44,32
RT 90,17,26624
RT 92,18,24576
RT 94,18,26624
MM 32,40,36
s_add_u32 m0, s22, 98304
s_add_u32 s24, s19, 256
buffer_load_dwordx4 v8, s[4:7], s24 offen sc1 lds
s_add_u32 m0, s22, 99328
s_add_u32 s24, s19, 57600
buffer_load_dwordx4 v9, s[4:7], s24 offen sc1 lds
s_add_u32 m0, s23, 98304
s_add_u32 s25, s20, 262144
buffer_load_dwordx4 v10, s[8:11], s25 offen lds
MM 48,44,36
s_add_u32 m0, s23, 99328
s_add_u32 s25, s20, 266240
buffer_load_dwordx4 v11, s[8:11], s25 offen lds
s_add_u32 m0, s23, 100352
s_add_u32 s25, s20, 270336
buffer_load_dwordx4 v10, s[8:11], s25 offen lds
s_add_u32 m0, s23, 101376
s_add_u32 s25, s20, 274432
buffer_load_dwordx4 v11, s[8:11], s25 offen lds
s_add_u32 s19, s19, 0
s_add_u32 s20, s20, 0
s_mov_b32 s21, 0
mega_kernel_t17_kloop:
s_waitcnt lgkmcnt(0) vmcnt(6)
s_barrier
MM 0,56,48
RB 32,19,0
RB 36,19,4096
MM 16,60,48
RT 40,23,0
RT 42,23,2048
MM 32,56,52
RT 44,24,0
RT 46,24,2048
MM 48,60,52
s_add_u32 m0, s22, 0
s_add_u32 s24, s19, 384
buffer_load_dwordx4 v8, s[4:7], s24 offen sc1 lds
s_waitcnt lgkmcnt(12)
MM 0,72,64
RB 48,20,0
RB 52,20,4096
MM 16,76,64
RT 56,23,8192
RT 58,23,10240
MM 32,72,68
RT 60,24,8192
RT 62,24,10240
MM 48,76,68
s_add_u32 m0, s22, 1024
s_add_u32 s24, s19, 57728
buffer_load_dwordx4 v9, s[4:7], s24 offen sc1 lds
s_add_u32 m0, s23, 0
s_add_u32 s25, s20, 393216
buffer_load_dwordx4 v10, s[8:11], s25 offen lds
s_waitcnt lgkmcnt(12)
MM 0,88,80
RB 64,21,0
RB 68,21,4096
MM 16,92,80
RT 72,23,16384
RT 74,23,18432
MM 32,88,84
RT 76,24,16384
RT 78,24,18432
MM 48,92,84
s_add_u32 m0, s23, 1024
s_add_u32 s25, s20, 397312
buffer_load_dwordx4 v11, s[8:11], s25 offen lds
s_waitcnt lgkmcnt(12)
MM 0,40,32
RB 80,22,0
RB 84,22,4096
MM 16,44,32
RT 88,23,24576
RT 90,23,26624
MM 32,40,36
RT 92,24,24576
RT 94,24,26624
MM 48,44,36
s_add_u32 m0, s23, 2048
s_add_u32 s25, s20, 401408
buffer_load_dwordx4 v10, s[8:11], s25 offen lds
s_add_u32 m0, s23, 3072
s_add_u32 s25, s20, 405504
buffer_load_dwordx4 v11, s[8:11], s25 offen lds
s_waitcnt lgkmcnt(0) vmcnt(6)
s_barrier
MM 0,56,48
RB 32,25,0
RB 36,25,4096
MM 16,60,48
RT 40,29,0
RT 42,29,2048
MM 32,56,52
RT 44,30,0
RT 46,30,2048
MM 48,60,52
s_add_u32 m0, s22, 49152
s_add_u32 s24, s19, 512
buffer_load_dwordx4 v8, s[4:7], s24 offen sc1 lds
s_waitcnt lgkmcnt(12)
MM 0,72,64
RB 48,26,0
RB 52,26,4096
MM 16,76,64
RT 56,29,8192
RT 58,29,10240
MM 32,72,68
RT 60,30,8192
RT 62,30,10240
MM 48,76,68
s_add_u32 m0, s22, 50176
s_add_u32 s24, s19, 57856
buffer_load_dwordx4 v9, s[4:7], s24 offen sc1 lds
s_add_u32 m0, s23, 49152
s_add_u32 s25, s20, 524288
buffer_load_dwordx4 v10, s[8:11], s25 offen lds
s_waitcnt lgkmcnt(12)
MM 0,88,80
RB 64,27,0
RB 68,27,4096
MM 16,92,80
RT 72,29,16384
RT 74,29,18432
MM 32,88,84
RT 76,30,16384
RT 78,30,18432
MM 48,92,84
s_add_u32 m0, s23, 50176
s_add_u32 s25, s20, 528384
buffer_load_dwordx4 v11, s[8:11], s25 offen lds
s_waitcnt lgkmcnt(12)
MM 0,40,32
RB 80,28,0
RB 84,28,4096
MM 16,44,32
RT 88,29,24576
RT 90,29,26624
MM 32,40,36
RT 92,30,24576
RT 94,30,26624
MM 48,44,36
s_add_u32 m0, s23, 51200
s_add_u32 s25, s20, 532480
buffer_load_dwordx4 v10, s[8:11], s25 offen lds
s_add_u32 m0, s23, 52224
s_add_u32 s25, s20, 536576
buffer_load_dwordx4 v11, s[8:11], s25 offen lds
s_waitcnt lgkmcnt(0) vmcnt(6)
s_barrier
MM 0,56,48
RB 32,13,0
RB 36,13,4096
MM 16,60,48
RT 40,17,0
RT 42,17,2048
MM 32,56,52
RT 44,18,0
RT 46,18,2048
MM 48,60,52
s_add_u32 m0, s22, 98304
s_add_u32 s24, s19, 640
buffer_load_dwordx4 v8, s[4:7], s24 offen sc1 lds
s_waitcnt lgkmcnt(12)
MM 0,72,64
RB 48,14,0
RB 52,14,4096
MM 16,76,64
RT 56,17,8192
RT 58,17,10240
MM 32,72,68
RT 60,18,8192
RT 62,18,10240
MM 48,76,68
s_add_u32 m0, s22, 99328
s_add_u32 s24, s19, 57984
buffer_load_dwordx4 v9, s[4:7], s24 offen sc1 lds
s_add_u32 m0, s23, 98304
s_add_u32 s25, s20, 655360
buffer_load_dwordx4 v10, s[8:11], s25 offen lds
s_waitcnt lgkmcnt(12)
MM 0,88,80
RB 64,15,0
RB 68,15,4096
MM 16,92,80
RT 72,17,16384
RT 74,17,18432
MM 32,88,84
RT 76,18,16384
RT 78,18,18432
MM 48,92,84
s_add_u32 m0, s23, 99328
s_add_u32 s25, s20, 659456
buffer_load_dwordx4 v11, s[8:11], s25 offen lds
s_waitcnt lgkmcnt(12)
MM 0,40,32
RB 80,16,0
RB 84,16,4096
MM 16,44,32
RT 88,17,24576
RT 90,17,26624
MM 32,40,36
RT 92,18,24576
RT 94,18,26624
MM 48,44,36
s_add_u32 m0, s23, 100352
s_add_u32 s25, s20, 663552
buffer_load_dwordx4 v10, s[8:11], s25 offen lds
s_add_u32 m0, s23, 101376
s_add_u32 s25, s20, 667648
buffer_load_dwordx4 v11, s[8:11], s25 offen lds
s_add_u32 s19, s19, 384
s_add_u32 s20, s20, 393216
s_add_u32 s21, s21, 1
s_cmp_lt_u32 s21, 17
s_cbranch_scc1 mega_kernel_t17_kloop
s_waitcnt lgkmcnt(0) vmcnt(6)
s_barrier
MM 0,56,48
RB 32,19,0
RB 36,19,4096
MM 16,60,48
RT 40,23,0
RT 42,23,2048
MM 32,56,52
RT 44,24,0
RT 46,24,2048
MM 48,60,52
s_add_u32 m0, s22, 0
s_add_u32 s24, s19, 384
buffer_load_dwordx4 v8, s[4:7], s24 offen sc1 lds
s_waitcnt lgkmcnt(12)
MM 0,72,64
RB 48,20,0
RB 52,20,4096
MM 16,76,64
RT 56,23,8192
RT 58,23,10240
MM 32,72,68
RT 60,24,8192
RT 62,24,10240
MM 48,76,68
s_add_u32 m0, s22, 1024
s_add_u32 s24, s19, 57728
buffer_load_dwordx4 v9, s[4:7], s24 offen sc1 lds
s_add_u32 m0, s23, 0
s_add_u32 s25, s20, 393216
buffer_load_dwordx4 v10, s[8:11], s25 offen lds
s_waitcnt lgkmcnt(12)
MM 0,88,80
RB 64,21,0
RB 68,21,4096
MM 16,92,80
RT 72,23,16384
RT 74,23,18432
MM 32,88,84
RT 76,24,16384
RT 78,24,18432
MM 48,92,84
s_add_u32 m0, s23, 1024
s_add_u32 s25, s20, 397312
buffer_load_dwordx4 v11, s[8:11], s25 offen lds
s_waitcnt lgkmcnt(12)
MM 0,40,32
RB 80,22,0
RB 84,22,4096
MM 16,44,32
RT 88,23,24576
RT 90,23,26624
MM 32,40,36
RT 92,24,24576
RT 94,24,26624
MM 48,44,36
s_add_u32 m0, s23, 2048
s_add_u32 s25, s20, 401408
buffer_load_dwordx4 v10, s[8:11], s25 offen lds
s_add_u32 m0, s23, 3072
s_add_u32 s25, s20, 405504
buffer_load_dwordx4 v11, s[8:11], s25 offen lds
s_waitcnt lgkmcnt(0) vmcnt(6)
s_barrier
MM 0,56,48
RB 32,25,0
RB 36,25,4096
MM 16,60,48
RT 40,29,0
RT 42,29,2048
MM 32,56,52
RT 44,30,0
RT 46,30,2048
MM 48,60,52
s_add_u32 m0, s22, 49152
s_add_u32 s24, s19, 512
buffer_load_dwordx4 v8, s[4:7], s24 offen sc1 lds
s_waitcnt lgkmcnt(12)
MM 0,72,64
RB 48,26,0
RB 52,26,4096
MM 16,76,64
RT 56,29,8192
RT 58,29,10240
MM 32,72,68
RT 60,30,8192
RT 62,30,10240
MM 48,76,68
s_add_u32 m0, s22, 50176
s_add_u32 s24, s19, 57856
buffer_load_dwordx4 v9, s[4:7], s24 offen sc1 lds
s_add_u32 m0, s23, 49152
s_add_u32 s25, s20, 524288
buffer_load_dwordx4 v10, s[8:11], s25 offen lds
s_waitcnt lgkmcnt(12)
MM 0,88,80
RB 64,27,0
RB 68,27,4096
MM 16,92,80
RT 72,29,16384
RT 74,29,18432
MM 32,88,84
RT 76,30,16384
RT 78,30,18432
MM 48,92,84
s_add_u32 m0, s23, 50176
s_add_u32 s25, s20, 528384
buffer_load_dwordx4 v11, s[8:11], s25 offen lds
s_waitcnt lgkmcnt(12)
MM 0,40,32
RB 80,28,0
RB 84,28,4096
MM 16,44,32
RT 88,29,24576
RT 90,29,26624
MM 32,40,36
RT 92,30,24576
RT 94,30,26624
MM 48,44,36
s_add_u32 m0, s23, 51200
s_add_u32 s25, s20, 532480
buffer_load_dwordx4 v10, s[8:11], s25 offen lds
s_add_u32 m0, s23, 52224
s_add_u32 s25, s20, 536576
buffer_load_dwordx4 v11, s[8:11], s25 offen lds
s_waitcnt lgkmcnt(0) vmcnt(6)
s_barrier
MM 0,56,48
RB 32,13,0
RB 36,13,4096
MM 16,60,48
RT 40,17,0
MM 32,56,52
RT 42,17,2048
RT 44,18,0
MM 48,60,52
RT 46,18,2048
s_waitcnt lgkmcnt(12)
MM 0,72,64
RB 48,14,0
RB 52,14,4096
MM 16,76,64
RT 56,17,8192
MM 32,72,68
RT 58,17,10240
RT 60,18,8192
MM 48,76,68
RT 62,18,10240
s_waitcnt lgkmcnt(12)
MM 0,88,80
RB 64,15,0
RB 68,15,4096
MM 16,92,80
RT 72,17,16384
MM 32,88,84
RT 74,17,18432
RT 76,18,16384
MM 48,92,84
RT 78,18,18432
s_waitcnt lgkmcnt(12)
MM 0,40,32
RB 80,16,0
RB 84,16,4096
MM 16,44,32
RT 88,17,24576
MM 32,40,36
RT 90,17,26624
RT 92,18,24576
MM 48,44,36
RT 94,18,26624
s_waitcnt lgkmcnt(0) vmcnt(0)
s_barrier
MM 0,56,48
RB 32,19,0
RB 36,19,4096
MM 16,60,48
RT 40,23,0
MM 32,56,52
RT 42,23,2048
RT 44,24,0
MM 48,60,52
RT 46,24,2048
s_waitcnt lgkmcnt(12)
MM 0,72,64
RB 48,20,0
RB 52,20,4096
MM 16,76,64
RT 56,23,8192
MM 32,72,68
RT 58,23,10240
RT 60,24,8192
MM 48,76,68
RT 62,24,10240
s_waitcnt lgkmcnt(12)
MM 0,88,80
RB 64,21,0
RB 68,21,4096
MM 16,92,80
RT 72,23,16384
MM 32,88,84
RT 74,23,18432
RT 76,24,16384
MM 48,92,84
RT 78,24,18432
s_waitcnt lgkmcnt(12)
MM 0,40,32
RB 80,22,0
RB 84,22,4096
MM 16,44,32
RT 88,23,24576
MM 32,40,36
RT 90,23,26624
RT 92,24,24576
MM 48,44,36
RT 94,24,26624
s_waitcnt lgkmcnt(0)
MM 0,56,48
MM 16,60,48
MM 32,56,52
MM 48,60,52
s_waitcnt lgkmcnt(0)
MM 0,72,64
MM 16,76,64
MM 32,72,68
MM 48,76,68
s_waitcnt lgkmcnt(0)
MM 0,88,80
MM 16,92,80
MM 32,88,84
MM 48,92,84
s_barrier
s_cmp_lg_u32 s16, 0
s_cbranch_scc1 tt_257
v_mov_b32 v7, s56
v_accvgpr_write_b32 a127, 1
s_mov_b64 exec, 1
buffer_atomic_add a127, v7, s[4:7], 0 offen sc0
s_mov_b64 exec, -1
tt_257:
v_and_b32 v1, 31, v0
v_lshrrev_b32 v2, 5, v0
s_mul_i32 s24, s17, 33792
s_mul_i32 s25, s18, 128
s_add_u32 s24, s24, s25
v_mul_u32_u24 v3, 528, v1
v_lshl_add_u32 v3, v2, 4, v3
v_add_u32 v3, s24, v3
v_lshrrev_b32 v4, 5, v0
v_and_b32 v5, 31, v0
s_mul_i32 s24, s16, 16
v_add_u32 v4, s24, v4
v_mul_u32_u24 v6, 528, v4
v_lshl_add_u32 v6, v5, 4, v6
s_mov_b32 s24, 2048
v_mul_lo_u32 v12, v4, s24
v_lshl_add_u32 v12, v5, 4, v12
s_add_u32 s24, s34, 0
buffer_load_dwordx4 v[72:75], v12, s[4:7], s24 offen sc1
s_add_u32 s24, s35, 0
buffer_load_dwordx4 v[88:91], v12, s[4:7], s24 offen sc1
s_add_u32 s24, s34, 4096
buffer_load_dwordx4 v[76:79], v12, s[4:7], s24 offen sc1
s_add_u32 s24, s35, 4096
buffer_load_dwordx4 v[92:95], v12, s[4:7], s24 offen sc1
s_add_u32 s24, s34, 8192
buffer_load_dwordx4 v[80:83], v12, s[4:7], s24 offen sc1
s_add_u32 s24, s35, 8192
buffer_load_dwordx4 v[96:99], v12, s[4:7], s24 offen sc1
s_add_u32 s24, s34, 12288
buffer_load_dwordx4 v[84:87], v12, s[4:7], s24 offen sc1
s_add_u32 s24, s35, 12288
buffer_load_dwordx4 v[100:103], v12, s[4:7], s24 offen sc1
v_accvgpr_read_b32 v32, a0
v_accvgpr_read_b32 v33, a1
v_accvgpr_read_b32 v34, a2
v_accvgpr_read_b32 v35, a3
v_accvgpr_read_b32 v36, a4
v_accvgpr_read_b32 v37, a5
v_accvgpr_read_b32 v38, a6
v_accvgpr_read_b32 v39, a7
v_accvgpr_read_b32 v40, a8
v_accvgpr_read_b32 v41, a9
v_accvgpr_read_b32 v42, a10
v_accvgpr_read_b32 v43, a11
v_accvgpr_read_b32 v44, a12
v_accvgpr_read_b32 v45, a13
v_accvgpr_read_b32 v46, a14
v_accvgpr_read_b32 v47, a15
v_cvt_pk_bf16_f32 v48, v32, v33
v_cvt_pk_bf16_f32 v49, v34, v35
v_cvt_pk_bf16_f32 v50, v36, v37
v_cvt_pk_bf16_f32 v51, v38, v39
v_cvt_pk_bf16_f32 v52, v40, v41
v_cvt_pk_bf16_f32 v53, v42, v43
v_cvt_pk_bf16_f32 v54, v44, v45
v_cvt_pk_bf16_f32 v55, v46, v47
v_permlane32_swap_b32 v48, v50
v_permlane32_swap_b32 v49, v51
v_permlane32_swap_b32 v52, v54
v_permlane32_swap_b32 v53, v55
ds_write_b128 v3, v[48:51] offset:0
ds_write_b128 v3, v[52:55] offset:32
v_accvgpr_read_b32 v32, a16
v_accvgpr_read_b32 v33, a17
v_accvgpr_read_b32 v34, a18
v_accvgpr_read_b32 v35, a19
v_accvgpr_read_b32 v36, a20
v_accvgpr_read_b32 v37, a21
v_accvgpr_read_b32 v38, a22
v_accvgpr_read_b32 v39, a23
v_accvgpr_read_b32 v40, a24
v_accvgpr_read_b32 v41, a25
v_accvgpr_read_b32 v42, a26
v_accvgpr_read_b32 v43, a27
v_accvgpr_read_b32 v44, a28
v_accvgpr_read_b32 v45, a29
v_accvgpr_read_b32 v46, a30
v_accvgpr_read_b32 v47, a31
v_cvt_pk_bf16_f32 v56, v32, v33
v_cvt_pk_bf16_f32 v57, v34, v35
v_cvt_pk_bf16_f32 v58, v36, v37
v_cvt_pk_bf16_f32 v59, v38, v39
v_cvt_pk_bf16_f32 v60, v40, v41
v_cvt_pk_bf16_f32 v61, v42, v43
v_cvt_pk_bf16_f32 v62, v44, v45
v_cvt_pk_bf16_f32 v63, v46, v47
v_permlane32_swap_b32 v56, v58
v_permlane32_swap_b32 v57, v59
v_permlane32_swap_b32 v60, v62
v_permlane32_swap_b32 v61, v63
ds_write_b128 v3, v[56:59] offset:64
ds_write_b128 v3, v[60:63] offset:96
v_accvgpr_read_b32 v32, a32
v_accvgpr_read_b32 v33, a33
v_accvgpr_read_b32 v34, a34
v_accvgpr_read_b32 v35, a35
v_accvgpr_read_b32 v36, a36
v_accvgpr_read_b32 v37, a37
v_accvgpr_read_b32 v38, a38
v_accvgpr_read_b32 v39, a39
v_accvgpr_read_b32 v40, a40
v_accvgpr_read_b32 v41, a41
v_accvgpr_read_b32 v42, a42
v_accvgpr_read_b32 v43, a43
v_accvgpr_read_b32 v44, a44
v_accvgpr_read_b32 v45, a45
v_accvgpr_read_b32 v46, a46
v_accvgpr_read_b32 v47, a47
v_cvt_pk_bf16_f32 v48, v32, v33
v_cvt_pk_bf16_f32 v49, v34, v35
v_cvt_pk_bf16_f32 v50, v36, v37
v_cvt_pk_bf16_f32 v51, v38, v39
v_cvt_pk_bf16_f32 v52, v40, v41
v_cvt_pk_bf16_f32 v53, v42, v43
v_cvt_pk_bf16_f32 v54, v44, v45
v_cvt_pk_bf16_f32 v55, v46, v47
v_permlane32_swap_b32 v48, v50
v_permlane32_swap_b32 v49, v51
v_permlane32_swap_b32 v52, v54
v_permlane32_swap_b32 v53, v55
ds_write_b128 v3, v[48:51] offset:16896
ds_write_b128 v3, v[52:55] offset:16928
v_accvgpr_read_b32 v32, a48
v_accvgpr_read_b32 v33, a49
v_accvgpr_read_b32 v34, a50
v_accvgpr_read_b32 v35, a51
v_accvgpr_read_b32 v36, a52
v_accvgpr_read_b32 v37, a53
v_accvgpr_read_b32 v38, a54
v_accvgpr_read_b32 v39, a55
v_accvgpr_read_b32 v40, a56
v_accvgpr_read_b32 v41, a57
v_accvgpr_read_b32 v42, a58
v_accvgpr_read_b32 v43, a59
v_accvgpr_read_b32 v44, a60
v_accvgpr_read_b32 v45, a61
v_accvgpr_read_b32 v46, a62
v_accvgpr_read_b32 v47, a63
v_cvt_pk_bf16_f32 v56, v32, v33
v_cvt_pk_bf16_f32 v57, v34, v35
v_cvt_pk_bf16_f32 v58, v36, v37
v_cvt_pk_bf16_f32 v59, v38, v39
v_cvt_pk_bf16_f32 v60, v40, v41
v_cvt_pk_bf16_f32 v61, v42, v43
v_cvt_pk_bf16_f32 v62, v44, v45
v_cvt_pk_bf16_f32 v63, v46, v47
v_permlane32_swap_b32 v56, v58
v_permlane32_swap_b32 v57, v59
v_permlane32_swap_b32 v60, v62
v_permlane32_swap_b32 v61, v63
ds_write_b128 v3, v[56:59] offset:16960
ds_write_b128 v3, v[60:63] offset:16992
s_waitcnt lgkmcnt(0)
s_barrier
RB 32,6,0
RB 36,6,1056
RB 40,6,2112
RB 44,6,3168
s_waitcnt vmcnt(0)
s_waitcnt lgkmcnt(3)
v_lshlrev_b32 v68, 16, v32
v_and_b32 v69, 0xffff0000, v32
v_lshlrev_b32 v70, 16, v72
v_and_b32 v71, 0xffff0000, v72
v_add_f32 v68, v68, v70
v_add_f32 v69, v69, v71
v_cvt_pk_bf16_f32 v32, v68, v69
v_lshlrev_b32 v68, 16, v32
v_and_b32 v69, 0xffff0000, v32
v_lshlrev_b32 v70, 16, v88
v_and_b32 v71, 0xffff0000, v88
v_add_f32 v68, v68, v70
v_add_f32 v69, v69, v71
v_cvt_pk_bf16_f32 v32, v68, v69
v_lshlrev_b32 v68, 16, v33
v_and_b32 v69, 0xffff0000, v33
v_lshlrev_b32 v70, 16, v73
v_and_b32 v71, 0xffff0000, v73
v_add_f32 v68, v68, v70
v_add_f32 v69, v69, v71
v_cvt_pk_bf16_f32 v33, v68, v69
v_lshlrev_b32 v68, 16, v33
v_and_b32 v69, 0xffff0000, v33
v_lshlrev_b32 v70, 16, v89
v_and_b32 v71, 0xffff0000, v89
v_add_f32 v68, v68, v70
v_add_f32 v69, v69, v71
v_cvt_pk_bf16_f32 v33, v68, v69
v_lshlrev_b32 v68, 16, v34
v_and_b32 v69, 0xffff0000, v34
v_lshlrev_b32 v70, 16, v74
v_and_b32 v71, 0xffff0000, v74
v_add_f32 v68, v68, v70
v_add_f32 v69, v69, v71
v_cvt_pk_bf16_f32 v34, v68, v69
v_lshlrev_b32 v68, 16, v34
v_and_b32 v69, 0xffff0000, v34
v_lshlrev_b32 v70, 16, v90
v_and_b32 v71, 0xffff0000, v90
v_add_f32 v68, v68, v70
v_add_f32 v69, v69, v71
v_cvt_pk_bf16_f32 v34, v68, v69
v_lshlrev_b32 v68, 16, v35
v_and_b32 v69, 0xffff0000, v35
v_lshlrev_b32 v70, 16, v75
v_and_b32 v71, 0xffff0000, v75
v_add_f32 v68, v68, v70
v_add_f32 v69, v69, v71
v_cvt_pk_bf16_f32 v35, v68, v69
v_lshlrev_b32 v68, 16, v35
v_and_b32 v69, 0xffff0000, v35
v_lshlrev_b32 v70, 16, v91
v_and_b32 v71, 0xffff0000, v91
v_add_f32 v68, v68, v70
v_add_f32 v69, v69, v71
v_cvt_pk_bf16_f32 v35, v68, v69
s_add_u32 s24, s33, 0
buffer_store_dwordx4 v[32:35], v12, s[12:15], s24 offen
s_waitcnt lgkmcnt(2)
v_lshlrev_b32 v68, 16, v36
v_and_b32 v69, 0xffff0000, v36
v_lshlrev_b32 v70, 16, v76
v_and_b32 v71, 0xffff0000, v76
v_add_f32 v68, v68, v70
v_add_f32 v69, v69, v71
v_cvt_pk_bf16_f32 v36, v68, v69
v_lshlrev_b32 v68, 16, v36
v_and_b32 v69, 0xffff0000, v36
v_lshlrev_b32 v70, 16, v92
v_and_b32 v71, 0xffff0000, v92
v_add_f32 v68, v68, v70
v_add_f32 v69, v69, v71
v_cvt_pk_bf16_f32 v36, v68, v69
v_lshlrev_b32 v68, 16, v37
v_and_b32 v69, 0xffff0000, v37
v_lshlrev_b32 v70, 16, v77
v_and_b32 v71, 0xffff0000, v77
v_add_f32 v68, v68, v70
v_add_f32 v69, v69, v71
v_cvt_pk_bf16_f32 v37, v68, v69
v_lshlrev_b32 v68, 16, v37
v_and_b32 v69, 0xffff0000, v37
v_lshlrev_b32 v70, 16, v93
v_and_b32 v71, 0xffff0000, v93
v_add_f32 v68, v68, v70
v_add_f32 v69, v69, v71
v_cvt_pk_bf16_f32 v37, v68, v69
v_lshlrev_b32 v68, 16, v38
v_and_b32 v69, 0xffff0000, v38
v_lshlrev_b32 v70, 16, v78
v_and_b32 v71, 0xffff0000, v78
v_add_f32 v68, v68, v70
v_add_f32 v69, v69, v71
v_cvt_pk_bf16_f32 v38, v68, v69
v_lshlrev_b32 v68, 16, v38
v_and_b32 v69, 0xffff0000, v38
v_lshlrev_b32 v70, 16, v94
v_and_b32 v71, 0xffff0000, v94
v_add_f32 v68, v68, v70
v_add_f32 v69, v69, v71
v_cvt_pk_bf16_f32 v38, v68, v69
v_lshlrev_b32 v68, 16, v39
v_and_b32 v69, 0xffff0000, v39
v_lshlrev_b32 v70, 16, v79
v_and_b32 v71, 0xffff0000, v79
v_add_f32 v68, v68, v70
v_add_f32 v69, v69, v71
v_cvt_pk_bf16_f32 v39, v68, v69
v_lshlrev_b32 v68, 16, v39
v_and_b32 v69, 0xffff0000, v39
v_lshlrev_b32 v70, 16, v95
v_and_b32 v71, 0xffff0000, v95
v_add_f32 v68, v68, v70
v_add_f32 v69, v69, v71
v_cvt_pk_bf16_f32 v39, v68, v69
s_add_u32 s24, s33, 4096
buffer_store_dwordx4 v[36:39], v12, s[12:15], s24 offen
s_waitcnt lgkmcnt(1)
v_lshlrev_b32 v68, 16, v40
v_and_b32 v69, 0xffff0000, v40
v_lshlrev_b32 v70, 16, v80
v_and_b32 v71, 0xffff0000, v80
v_add_f32 v68, v68, v70
v_add_f32 v69, v69, v71
v_cvt_pk_bf16_f32 v40, v68, v69
v_lshlrev_b32 v68, 16, v40
v_and_b32 v69, 0xffff0000, v40
v_lshlrev_b32 v70, 16, v96
v_and_b32 v71, 0xffff0000, v96
v_add_f32 v68, v68, v70
v_add_f32 v69, v69, v71
v_cvt_pk_bf16_f32 v40, v68, v69
v_lshlrev_b32 v68, 16, v41
v_and_b32 v69, 0xffff0000, v41
v_lshlrev_b32 v70, 16, v81
v_and_b32 v71, 0xffff0000, v81
v_add_f32 v68, v68, v70
v_add_f32 v69, v69, v71
v_cvt_pk_bf16_f32 v41, v68, v69
v_lshlrev_b32 v68, 16, v41
v_and_b32 v69, 0xffff0000, v41
v_lshlrev_b32 v70, 16, v97
v_and_b32 v71, 0xffff0000, v97
v_add_f32 v68, v68, v70
v_add_f32 v69, v69, v71
v_cvt_pk_bf16_f32 v41, v68, v69
v_lshlrev_b32 v68, 16, v42
v_and_b32 v69, 0xffff0000, v42
v_lshlrev_b32 v70, 16, v82
v_and_b32 v71, 0xffff0000, v82
v_add_f32 v68, v68, v70
v_add_f32 v69, v69, v71
v_cvt_pk_bf16_f32 v42, v68, v69
v_lshlrev_b32 v68, 16, v42
v_and_b32 v69, 0xffff0000, v42
v_lshlrev_b32 v70, 16, v98
v_and_b32 v71, 0xffff0000, v98
v_add_f32 v68, v68, v70
v_add_f32 v69, v69, v71
v_cvt_pk_bf16_f32 v42, v68, v69
v_lshlrev_b32 v68, 16, v43
v_and_b32 v69, 0xffff0000, v43
v_lshlrev_b32 v70, 16, v83
v_and_b32 v71, 0xffff0000, v83
v_add_f32 v68, v68, v70
v_add_f32 v69, v69, v71
v_cvt_pk_bf16_f32 v43, v68, v69
v_lshlrev_b32 v68, 16, v43
v_and_b32 v69, 0xffff0000, v43
v_lshlrev_b32 v70, 16, v99
v_and_b32 v71, 0xffff0000, v99
v_add_f32 v68, v68, v70
v_add_f32 v69, v69, v71
v_cvt_pk_bf16_f32 v43, v68, v69
s_add_u32 s24, s33, 8192
buffer_store_dwordx4 v[40:43], v12, s[12:15], s24 offen
s_waitcnt lgkmcnt(0)
v_lshlrev_b32 v68, 16, v44
v_and_b32 v69, 0xffff0000, v44
v_lshlrev_b32 v70, 16, v84
v_and_b32 v71, 0xffff0000, v84
v_add_f32 v68, v68, v70
v_add_f32 v69, v69, v71
v_cvt_pk_bf16_f32 v44, v68, v69
v_lshlrev_b32 v68, 16, v44
v_and_b32 v69, 0xffff0000, v44
v_lshlrev_b32 v70, 16, v100
v_and_b32 v71, 0xffff0000, v100
v_add_f32 v68, v68, v70
v_add_f32 v69, v69, v71
v_cvt_pk_bf16_f32 v44, v68, v69
v_lshlrev_b32 v68, 16, v45
v_and_b32 v69, 0xffff0000, v45
v_lshlrev_b32 v70, 16, v85
v_and_b32 v71, 0xffff0000, v85
v_add_f32 v68, v68, v70
v_add_f32 v69, v69, v71
v_cvt_pk_bf16_f32 v45, v68, v69
v_lshlrev_b32 v68, 16, v45
v_and_b32 v69, 0xffff0000, v45
v_lshlrev_b32 v70, 16, v101
v_and_b32 v71, 0xffff0000, v101
v_add_f32 v68, v68, v70
v_add_f32 v69, v69, v71
v_cvt_pk_bf16_f32 v45, v68, v69
v_lshlrev_b32 v68, 16, v46
v_and_b32 v69, 0xffff0000, v46
v_lshlrev_b32 v70, 16, v86
v_and_b32 v71, 0xffff0000, v86
v_add_f32 v68, v68, v70
v_add_f32 v69, v69, v71
v_cvt_pk_bf16_f32 v46, v68, v69
v_lshlrev_b32 v68, 16, v46
v_and_b32 v69, 0xffff0000, v46
v_lshlrev_b32 v70, 16, v102
v_and_b32 v71, 0xffff0000, v102
v_add_f32 v68, v68, v70
v_add_f32 v69, v69, v71
v_cvt_pk_bf16_f32 v46, v68, v69
v_lshlrev_b32 v68, 16, v47
v_and_b32 v69, 0xffff0000, v47
v_lshlrev_b32 v70, 16, v87
v_and_b32 v71, 0xffff0000, v87
v_add_f32 v68, v68, v70
v_add_f32 v69, v69, v71
v_cvt_pk_bf16_f32 v47, v68, v69
v_lshlrev_b32 v68, 16, v47
v_and_b32 v69, 0xffff0000, v47
v_lshlrev_b32 v70, 16, v103
v_and_b32 v71, 0xffff0000, v103
v_add_f32 v68, v68, v70
v_add_f32 v69, v69, v71
v_cvt_pk_bf16_f32 v47, v68, v69
s_add_u32 s24, s33, 12288
buffer_store_dwordx4 v[44:47], v12, s[12:15], s24 offen
s_nop 1
RB 32,6,4224
RB 36,6,5280
RB 40,6,6336
RB 44,6,7392
s_add_u32 s24, s34, 16384
buffer_load_dwordx4 v[72:75], v12, s[4:7], s24 offen sc1
s_add_u32 s24, s35, 16384
buffer_load_dwordx4 v[88:91], v12, s[4:7], s24 offen sc1
s_add_u32 s24, s34, 20480
buffer_load_dwordx4 v[76:79], v12, s[4:7], s24 offen sc1
s_add_u32 s24, s35, 20480
buffer_load_dwordx4 v[92:95], v12, s[4:7], s24 offen sc1
s_add_u32 s24, s34, 24576
buffer_load_dwordx4 v[80:83], v12, s[4:7], s24 offen sc1
s_add_u32 s24, s35, 24576
buffer_load_dwordx4 v[96:99], v12, s[4:7], s24 offen sc1
s_add_u32 s24, s34, 28672
buffer_load_dwordx4 v[84:87], v12, s[4:7], s24 offen sc1
s_add_u32 s24, s35, 28672
buffer_load_dwordx4 v[100:103], v12, s[4:7], s24 offen sc1
s_waitcnt vmcnt(0)
s_waitcnt lgkmcnt(3)
v_lshlrev_b32 v68, 16, v32
v_and_b32 v69, 0xffff0000, v32
v_lshlrev_b32 v70, 16, v72
v_and_b32 v71, 0xffff0000, v72
v_add_f32 v68, v68, v70
v_add_f32 v69, v69, v71
v_cvt_pk_bf16_f32 v32, v68, v69
v_lshlrev_b32 v68, 16, v32
v_and_b32 v69, 0xffff0000, v32
v_lshlrev_b32 v70, 16, v88
v_and_b32 v71, 0xffff0000, v88
v_add_f32 v68, v68, v70
v_add_f32 v69, v69, v71
v_cvt_pk_bf16_f32 v32, v68, v69
v_lshlrev_b32 v68, 16, v33
v_and_b32 v69, 0xffff0000, v33
v_lshlrev_b32 v70, 16, v73
v_and_b32 v71, 0xffff0000, v73
v_add_f32 v68, v68, v70
v_add_f32 v69, v69, v71
v_cvt_pk_bf16_f32 v33, v68, v69
v_lshlrev_b32 v68, 16, v33
v_and_b32 v69, 0xffff0000, v33
v_lshlrev_b32 v70, 16, v89
v_and_b32 v71, 0xffff0000, v89
v_add_f32 v68, v68, v70
v_add_f32 v69, v69, v71
v_cvt_pk_bf16_f32 v33, v68, v69
v_lshlrev_b32 v68, 16, v34
v_and_b32 v69, 0xffff0000, v34
v_lshlrev_b32 v70, 16, v74
v_and_b32 v71, 0xffff0000, v74
v_add_f32 v68, v68, v70
v_add_f32 v69, v69, v71
v_cvt_pk_bf16_f32 v34, v68, v69
v_lshlrev_b32 v68, 16, v34
v_and_b32 v69, 0xffff0000, v34
v_lshlrev_b32 v70, 16, v90
v_and_b32 v71, 0xffff0000, v90
v_add_f32 v68, v68, v70
v_add_f32 v69, v69, v71
v_cvt_pk_bf16_f32 v34, v68, v69
v_lshlrev_b32 v68, 16, v35
v_and_b32 v69, 0xffff0000, v35
v_lshlrev_b32 v70, 16, v75
v_and_b32 v71, 0xffff0000, v75
v_add_f32 v68, v68, v70
v_add_f32 v69, v69, v71
v_cvt_pk_bf16_f32 v35, v68, v69
v_lshlrev_b32 v68, 16, v35
v_and_b32 v69, 0xffff0000, v35
v_lshlrev_b32 v70, 16, v91
v_and_b32 v71, 0xffff0000, v91
v_add_f32 v68, v68, v70
v_add_f32 v69, v69, v71
v_cvt_pk_bf16_f32 v35, v68, v69
s_add_u32 s24, s33, 16384
buffer_store_dwordx4 v[32:35], v12, s[12:15], s24 offen
s_waitcnt lgkmcnt(2)
v_lshlrev_b32 v68, 16, v36
v_and_b32 v69, 0xffff0000, v36
v_lshlrev_b32 v70, 16, v76
v_and_b32 v71, 0xffff0000, v76
v_add_f32 v68, v68, v70
v_add_f32 v69, v69, v71
v_cvt_pk_bf16_f32 v36, v68, v69
v_lshlrev_b32 v68, 16, v36
v_and_b32 v69, 0xffff0000, v36
v_lshlrev_b32 v70, 16, v92
v_and_b32 v71, 0xffff0000, v92
v_add_f32 v68, v68, v70
v_add_f32 v69, v69, v71
v_cvt_pk_bf16_f32 v36, v68, v69
v_lshlrev_b32 v68, 16, v37
v_and_b32 v69, 0xffff0000, v37
v_lshlrev_b32 v70, 16, v77
v_and_b32 v71, 0xffff0000, v77
v_add_f32 v68, v68, v70
v_add_f32 v69, v69, v71
v_cvt_pk_bf16_f32 v37, v68, v69
v_lshlrev_b32 v68, 16, v37
v_and_b32 v69, 0xffff0000, v37
v_lshlrev_b32 v70, 16, v93
v_and_b32 v71, 0xffff0000, v93
v_add_f32 v68, v68, v70
v_add_f32 v69, v69, v71
v_cvt_pk_bf16_f32 v37, v68, v69
v_lshlrev_b32 v68, 16, v38
v_and_b32 v69, 0xffff0000, v38
v_lshlrev_b32 v70, 16, v78
v_and_b32 v71, 0xffff0000, v78
v_add_f32 v68, v68, v70
v_add_f32 v69, v69, v71
v_cvt_pk_bf16_f32 v38, v68, v69
v_lshlrev_b32 v68, 16, v38
v_and_b32 v69, 0xffff0000, v38
v_lshlrev_b32 v70, 16, v94
v_and_b32 v71, 0xffff0000, v94
v_add_f32 v68, v68, v70
v_add_f32 v69, v69, v71
v_cvt_pk_bf16_f32 v38, v68, v69
v_lshlrev_b32 v68, 16, v39
v_and_b32 v69, 0xffff0000, v39
v_lshlrev_b32 v70, 16, v79
v_and_b32 v71, 0xffff0000, v79
v_add_f32 v68, v68, v70
v_add_f32 v69, v69, v71
v_cvt_pk_bf16_f32 v39, v68, v69
v_lshlrev_b32 v68, 16, v39
v_and_b32 v69, 0xffff0000, v39
v_lshlrev_b32 v70, 16, v95
v_and_b32 v71, 0xffff0000, v95
v_add_f32 v68, v68, v70
v_add_f32 v69, v69, v71
v_cvt_pk_bf16_f32 v39, v68, v69
s_add_u32 s24, s33, 20480
buffer_store_dwordx4 v[36:39], v12, s[12:15], s24 offen
s_waitcnt lgkmcnt(1)
v_lshlrev_b32 v68, 16, v40
v_and_b32 v69, 0xffff0000, v40
v_lshlrev_b32 v70, 16, v80
v_and_b32 v71, 0xffff0000, v80
v_add_f32 v68, v68, v70
v_add_f32 v69, v69, v71
v_cvt_pk_bf16_f32 v40, v68, v69
v_lshlrev_b32 v68, 16, v40
v_and_b32 v69, 0xffff0000, v40
v_lshlrev_b32 v70, 16, v96
v_and_b32 v71, 0xffff0000, v96
v_add_f32 v68, v68, v70
v_add_f32 v69, v69, v71
v_cvt_pk_bf16_f32 v40, v68, v69
v_lshlrev_b32 v68, 16, v41
v_and_b32 v69, 0xffff0000, v41
v_lshlrev_b32 v70, 16, v81
v_and_b32 v71, 0xffff0000, v81
v_add_f32 v68, v68, v70
v_add_f32 v69, v69, v71
v_cvt_pk_bf16_f32 v41, v68, v69
v_lshlrev_b32 v68, 16, v41
v_and_b32 v69, 0xffff0000, v41
v_lshlrev_b32 v70, 16, v97
v_and_b32 v71, 0xffff0000, v97
v_add_f32 v68, v68, v70
v_add_f32 v69, v69, v71
v_cvt_pk_bf16_f32 v41, v68, v69
v_lshlrev_b32 v68, 16, v42
v_and_b32 v69, 0xffff0000, v42
v_lshlrev_b32 v70, 16, v82
v_and_b32 v71, 0xffff0000, v82
v_add_f32 v68, v68, v70
v_add_f32 v69, v69, v71
v_cvt_pk_bf16_f32 v42, v68, v69
v_lshlrev_b32 v68, 16, v42
v_and_b32 v69, 0xffff0000, v42
v_lshlrev_b32 v70, 16, v98
v_and_b32 v71, 0xffff0000, v98
v_add_f32 v68, v68, v70
v_add_f32 v69, v69, v71
v_cvt_pk_bf16_f32 v42, v68, v69
v_lshlrev_b32 v68, 16, v43
v_and_b32 v69, 0xffff0000, v43
v_lshlrev_b32 v70, 16, v83
v_and_b32 v71, 0xffff0000, v83
v_add_f32 v68, v68, v70
v_add_f32 v69, v69, v71
v_cvt_pk_bf16_f32 v43, v68, v69
v_lshlrev_b32 v68, 16, v43
v_and_b32 v69, 0xffff0000, v43
v_lshlrev_b32 v70, 16, v99
v_and_b32 v71, 0xffff0000, v99
v_add_f32 v68, v68, v70
v_add_f32 v69, v69, v71
v_cvt_pk_bf16_f32 v43, v68, v69
s_add_u32 s24, s33, 24576
buffer_store_dwordx4 v[40:43], v12, s[12:15], s24 offen
s_waitcnt lgkmcnt(0)
v_lshlrev_b32 v68, 16, v44
v_and_b32 v69, 0xffff0000, v44
v_lshlrev_b32 v70, 16, v84
v_and_b32 v71, 0xffff0000, v84
v_add_f32 v68, v68, v70
v_add_f32 v69, v69, v71
v_cvt_pk_bf16_f32 v44, v68, v69
v_lshlrev_b32 v68, 16, v44
v_and_b32 v69, 0xffff0000, v44
v_lshlrev_b32 v70, 16, v100
v_and_b32 v71, 0xffff0000, v100
v_add_f32 v68, v68, v70
v_add_f32 v69, v69, v71
v_cvt_pk_bf16_f32 v44, v68, v69
v_lshlrev_b32 v68, 16, v45
v_and_b32 v69, 0xffff0000, v45
v_lshlrev_b32 v70, 16, v85
v_and_b32 v71, 0xffff0000, v85
v_add_f32 v68, v68, v70
v_add_f32 v69, v69, v71
v_cvt_pk_bf16_f32 v45, v68, v69
v_lshlrev_b32 v68, 16, v45
v_and_b32 v69, 0xffff0000, v45
v_lshlrev_b32 v70, 16, v101
v_and_b32 v71, 0xffff0000, v101
v_add_f32 v68, v68, v70
v_add_f32 v69, v69, v71
v_cvt_pk_bf16_f32 v45, v68, v69
v_lshlrev_b32 v68, 16, v46
v_and_b32 v69, 0xffff0000, v46
v_lshlrev_b32 v70, 16, v86
v_and_b32 v71, 0xffff0000, v86
v_add_f32 v68, v68, v70
v_add_f32 v69, v69, v71
v_cvt_pk_bf16_f32 v46, v68, v69
v_lshlrev_b32 v68, 16, v46
v_and_b32 v69, 0xffff0000, v46
v_lshlrev_b32 v70, 16, v102
v_and_b32 v71, 0xffff0000, v102
v_add_f32 v68, v68, v70
v_add_f32 v69, v69, v71
v_cvt_pk_bf16_f32 v46, v68, v69
v_lshlrev_b32 v68, 16, v47
v_and_b32 v69, 0xffff0000, v47
v_lshlrev_b32 v70, 16, v87
v_and_b32 v71, 0xffff0000, v87
v_add_f32 v68, v68, v70
v_add_f32 v69, v69, v71
v_cvt_pk_bf16_f32 v47, v68, v69
v_lshlrev_b32 v68, 16, v47
v_and_b32 v69, 0xffff0000, v47
v_lshlrev_b32 v70, 16, v103
v_and_b32 v71, 0xffff0000, v103
v_add_f32 v68, v68, v70
v_add_f32 v69, v69, v71
v_cvt_pk_bf16_f32 v47, v68, v69
s_add_u32 s24, s33, 28672
buffer_store_dwordx4 v[44:47], v12, s[12:15], s24 offen
s_branch mega_kernel_wloop
mega_kernel_wend:
mega_kernel_end:
s_endpgm
.p2align 6
.type mega_kernel_table,@object
mega_kernel_table:
    .long 16, 1040, 2064, 3088, 4112, 5136, 6160, 7184, 8208, 9232, 10256, 11280, 12304, 13328, 14352, 15376
    .long 32, 1056, 2080, 3104, 64, 1088, 2112, 3136, 96, 1120, 2144, 3168, 128, 1152, 2176, 3200
    .long 1, 1025, 160, 1184, 2208, 3232, 192, 1216, 2240, 3264, 33, 1057, 2, 224, 1248, 2272
    .long 3296, 256, 1280, 2304, 3328, 1026, 65, 1089, 288, 1312, 2336, 3360, 3, 1027, 2051, 3075
    .long 34, 320, 1344, 2368, 3392, 1058, 97, 1121, 4, 1028, 352, 1376, 2400, 3424, 35, 1059
    .long 2083, 3107, 66, 384, 1408, 2432, 3456, 1090, 129, 1153, 416, 1440, 2464, 3488, 36, 1060
    .long 67, 1091, 2115, 3139, 98, 448, 1472, 2496, 3520, 1122, 480, 1504, 2528, 3552, 161, 1185
    .long 68, 1092, 99, 1123, 2147, 3171, 130, 1154, 193, 1217, 6, 100, 1124, 131, 1155, 2179
    .long 3203, 162, 1186, 225, 1249, 38, 7, 1031, 132, 1156, 163, 1187, 2211, 3235, 194, 257
    .long 1281, 1218, 70, 39, 1063, 164, 1188, 195, 1219, 2243, 3267, 226, 8, 8200, 289, 1313
    .long 1250, 102, 71, 1095, 196, 1220, 227, 1251, 2275, 3299, 258, 40, 8232, 17, 321, 1345
    .long 1282, 134, 103, 1127, 228, 1252, 259, 1283, 2307, 3331, 290, 72, 8264, 353, 1377, 1314
    .long 166, 135, 1159, 260, 1284, 291, 1315, 2339, 3363, 104, 8296, 385, 1409, 81, 322, 198
    .long 167, 1191, 292, 1316, 1346, 136, 8328, 417, 1441, 331, 1355, 2379, 3403, 4427, 5451, 6475
    .long 7499, 354, 230, 199, 1223, 1378, 324, 1348, 449, 1473, 168, 8360, 145, 363, 1387, 2411
    .long 3435, 4459, 5483, 6507, 7531, 386, 262, 332, 1356, 231, 1255, 1410, 481, 1505, 356, 1380
    .long 200, 8392, 395, 1419, 2443, 3467, 4491, 5515, 6539, 7563, 418, 294, 364, 1388, 263, 1287
    .long 1442, 333, 1357, 388, 1412, 232, 8424, 209, 427, 1451, 2475, 3499, 4523, 5547, 6571, 7595
    .long 450, 396, 1420, 295, 1319, 1474, 365, 1389, 420, 1444, 264, 8456, 459, 1483, 2507, 3531
    .long 4555, 5579, 6603, 7627, 482, 428, 1452, 1506, 397, 1421, 452, 1476, 327, 1351, 296, 8488
    .long 265, 4361, 498, 1522, 2546, 3570, 4594, 5618, 6642, 7666, 8690, 9714, 10738, 11762, 12786, 13810
    .long 14834, 15858, 484, 460, 1484, 530, 1554, 2578, 3602, 4626, 5650, 6674, 7698, 8722, 9746, 10770
    .long 11794, 12818, 13842, 14866, 15890, 334, 1358, 16718, 17742, 33102, 34126, 49486, 50510, 429, 1453, 516
    .long 359, 1383, 297, 4393, 499, 366, 1523, 1390, 16750, 17774, 33134, 34158, 49518, 50542, 461, 1485
    .long 391, 1415, 531, 1555, 335, 1359, 2383, 3407, 4431, 5455, 6479, 7503, 500, 1524, 398, 1422
    .long 16782, 17806, 33166, 34190, 49550, 50574, 423, 1447, 532, 1556, 367, 1391, 2415, 3439, 4463, 5487
    .long 6511, 7535, 487, 430, 1454, 16814, 17838, 33198, 34222, 49582, 50606, 455, 1479, 519, 399, 1423
    .long 2447, 3471, 4495, 5519, 6543, 7567, 462, 1486, 16846, 17870, 33230, 34254, 49614, 50638, 501, 1525
    .long 16885, 17909, 33269, 34293, 49653, 50677, 533, 1557, 16917, 17941, 33301, 34325, 49685, 50709, 431, 1455
    .long 2479, 3503, 4527, 5551, 6575, 7599, 266, 1290, 330, 1354, 502, 1526, 2550, 3574, 4598, 5622
    .long 6646, 7670, 463, 1487, 2511, 3535, 4559, 5583, 6607, 7631, 534, 1558, 2582, 3606, 4630, 5654
    .long 6678, 7702, 298, 1322, 362, 1386, 394, 1418, 426, 1450, 490, 522, 458, 1482, 31
    .long 16, 1040, 2064, 3088, 4112, 5136, 6160, 7184, 8208, 9232, 10256, 11280, 12304, 13328, 14352, 15376
    .long 32, 1056, 2080, 3104, 64, 1088, 2112, 3136, 96, 1120, 2144, 3168, 128, 1152, 2176, 3200
    .long 1, 1025, 160, 1184, 2208, 3232, 192, 1216, 2240, 3264, 33, 1057, 2, 224, 1248, 2272
    .long 3296, 256, 1280, 2304, 3328, 1026, 65, 1089, 288, 1312, 2336, 3360, 3, 1027, 2051, 3075
    .long 34, 320, 1344, 2368, 3392, 1058, 97, 1121, 4, 1028, 352, 1376, 2400, 3424, 35, 1059
    .long 2083, 3107, 66, 384, 1408, 2432, 3456, 1090, 129, 1153, 416, 1440, 2464, 3488, 36, 1060
    .long 67, 1091, 2115, 3139, 98, 448, 1472, 2496, 3520, 1122, 480, 1504, 2528, 3552, 161, 1185
    .long 68, 1092, 99, 1123, 2147, 3171, 130, 1154, 193, 1217, 1030, 100, 1124, 131, 1155, 2179
    .long 3203, 162, 1186, 225, 1249, 1062, 7, 1031, 132, 1156, 163, 1187, 2211, 3235, 194, 257
    .long 1281, 1218, 1094, 39, 1063, 164, 1188, 195, 1219, 2243, 3267, 226, 1032, 9224, 289, 1313
    .long 1250, 1126, 71, 1095, 196, 1220, 227, 1251, 2275, 3299, 258, 1064, 9256, 321, 1345, 1282
    .long 1158, 103, 1127, 228, 1252, 259, 1283, 2307, 3331, 290, 1096, 9288, 353, 1377, 49, 1314
    .long 1190, 135, 1159, 260, 1284, 291, 1315, 2339, 3363, 1128, 9320, 385, 1409, 322, 1222, 167
    .long 1191, 292, 1316, 1346, 1160, 9352, 417, 1441, 113, 331, 1355, 2379, 3403, 4427, 5451, 6475
    .long 7499, 354, 1254, 199, 1223, 1378, 324, 1348, 449, 1473, 1192, 9384, 363, 1387, 2411, 3435
    .long 4459, 5483, 6507, 7531, 386, 1286, 332, 1356, 231, 1255, 1410, 481, 1505, 356, 1380, 1224
    .long 9416, 177, 395, 1419, 2443, 3467, 4491, 5515, 6539, 7563, 418, 1318, 364, 1388, 263, 1287
    .long 1442, 333, 1357, 388, 1412, 1256, 9448, 427, 1451, 2475, 3499, 4523, 5547, 6571, 7595, 450
    .long 396, 1420, 295, 1319, 1474, 365, 1389, 420, 1444, 1288, 9480, 241, 459, 1483, 2507, 3531
    .long 4555, 5579, 6603, 7627, 482, 428, 1452, 1506, 397, 1421, 452, 1476, 327, 1351, 1320, 9512
    .long 8457, 12553, 498, 1522, 2546, 3570, 4594, 5618, 6642, 7666, 8690, 9714, 10738, 11762, 12786, 13810
    .long 14834, 15858, 484, 460, 1484, 530, 1554, 2578, 3602, 4626, 5650, 6674, 7698, 8722, 9746, 10770
    .long 11794, 12818, 13842, 14866, 15890, 2382, 3406, 18766, 19790, 35150, 36174, 51534, 52558, 429, 1453, 516
    .long 359, 1383, 8489, 12585, 499, 1523, 2414, 3438, 18798, 19822, 35182, 36206, 51566, 52590, 461, 1485
    .long 391, 1415, 531, 1555, 335, 1359, 2383, 3407, 4431, 5455, 6479, 7503, 500, 1524, 2446, 3470
    .long 18830, 19854, 35214, 36238, 51598, 52622, 423, 1447, 532, 1556, 367, 1391, 2415, 3439, 4463, 5487
    .long 6511, 7535, 487, 2478, 3502, 18862, 19886, 35246, 36270, 51630, 52654, 455, 1479, 519, 399, 1423
    .long 2447, 3471, 4495, 5519, 6543, 7567, 2510, 3534, 18894, 19918, 35278, 36302, 51662, 52686, 2549, 3573
    .long 18933, 19957, 35317, 36341, 51701, 52725, 2581, 3605, 18965, 19989, 35349, 36373, 51733, 52757, 431, 1455
    .long 2479, 3503, 4527, 5551, 6575, 7599, 266, 1290, 330, 1354, 502, 1526, 2550, 3574, 4598, 5622
    .long 6646, 7670, 463, 1487, 2511, 3535, 4559, 5583, 6607, 7631, 534, 1558, 2582, 3606, 4630, 5654
    .long 6678, 7702, 298, 1322, 362, 1386, 394, 1418, 426, 1450, 490, 522, 458, 1482, 31
    .long 16, 1040, 2064, 3088, 4112, 5136, 6160, 7184, 8208, 9232, 10256, 11280, 12304, 13328, 14352, 15376
    .long 32, 1056, 2080, 3104, 64, 1088, 2112, 3136, 96, 1120, 2144, 3168, 128, 1152, 2176, 3200
    .long 1, 1025, 160, 1184, 2208, 3232, 192, 1216, 2240, 3264, 33, 1057, 2, 224, 1248, 2272
    .long 3296, 256, 1280, 2304, 3328, 1026, 65, 1089, 288, 1312, 2336, 3360, 3, 1027, 2051, 3075
    .long 34, 320, 1344, 2368, 3392, 1058, 97, 1121, 4, 1028, 352, 1376, 2400, 3424, 35, 1059
    .long 2083, 3107, 66, 384, 1408, 2432, 3456, 1090, 129, 1153, 416, 1440, 2464, 3488, 36, 1060
    .long 67, 1091, 2115, 3139, 98, 448, 1472, 2496, 3520, 1122, 480, 1504, 2528, 3552, 161, 1185
    .long 68, 1092, 99, 1123, 2147, 3171, 130, 1154, 193, 1217, 2054, 100, 1124, 131, 1155, 2179
    .long 3203, 162, 1186, 225, 1249, 2086, 7, 1031, 132, 1156, 163, 1187, 2211, 3235, 194, 257
    .long 1281, 1218, 2118, 39, 1063, 164, 1188, 195, 1219, 2243, 3267, 226, 2056, 10248, 289, 1313
    .long 1250, 2150, 71, 1095, 196, 1220, 227, 1251, 2275, 3299, 258, 2088, 10280, 1041, 321, 1345
    .long 1282, 2182, 103, 1127, 228, 1252, 259, 1283, 2307, 3331, 290, 2120, 10312, 353, 1377, 1314
    .long 2214, 135, 1159, 260, 1284, 291, 1315, 2339, 3363, 2152, 10344, 385, 1409, 1105, 322, 2246
    .long 167, 1191, 292, 1316, 1346, 2184, 10376, 417, 1441, 331, 1355, 2379, 3403, 4427, 5451, 6475
    .long 7499, 354, 2278, 199, 1223, 1378, 324, 1348, 449, 1473, 2216, 10408, 1169, 363, 1387, 2411
    .long 3435, 4459, 5483, 6507, 7531, 386, 2310, 332, 1356, 231, 1255, 1410, 481, 1505, 356, 1380
    .long 2248, 10440, 395, 1419, 2443, 3467, 4491, 5515, 6539, 7563, 418, 2342, 364, 1388, 263, 1287
    .long 1442, 333, 1357, 388, 1412, 2280, 10472, 1233, 427, 1451, 2475, 3499, 4523, 5547, 6571, 7595
    .long 450, 396, 1420, 295, 1319, 1474, 365, 1389, 420, 1444, 2312, 10504, 459, 1483, 2507, 3531
    .long 4555, 5579, 6603, 7627, 482, 428, 1452, 1506, 397, 1421, 452, 1476, 327, 1351, 2344, 10536
    .long 1289, 5385, 498, 1522, 2546, 3570, 4594, 5618, 6642, 7666, 8690, 9714, 10738, 11762, 12786, 13810
    .long 14834, 15858, 484, 460, 1484, 530, 1554, 2578, 3602, 4626, 5650, 6674, 7698, 8722, 9746, 10770
    .long 11794, 12818, 13842, 14866, 15890, 4430, 5454, 20814, 21838, 37198, 38222, 53582, 54606, 429, 1453, 516
    .long 359, 1383, 1321, 5417, 499, 1523, 4462, 5486, 20846, 21870, 37230, 38254, 53614, 54638, 461, 1485
    .long 391, 1415, 531, 1555, 335, 1359, 2383, 3407, 4431, 5455, 6479, 7503, 500, 1524, 4494, 5518
    .long 20878, 21902, 37262, 38286, 53646, 54670, 423, 1447, 532, 1556, 367, 1391, 2415, 3439, 4463, 5487
    .long 6511, 7535, 487, 4526, 5550, 20910, 21934, 37294, 38318, 53678, 54702, 455, 1479, 519, 399, 1423
    .long 2447, 3471, 4495, 5519, 6543, 7567, 4558, 5582, 20942, 21966, 37326, 38350, 53710, 54734, 4597, 5621
    .long 20981, 22005, 37365, 38389, 53749, 54773, 4629, 5653, 21013, 22037, 37397, 38421, 53781, 54805, 431, 1455
    .long 2479, 3503, 4527, 5551, 6575, 7599, 266, 1290, 330, 1354, 502, 1526, 2550, 3574, 4598, 5622
    .long 6646, 7670, 463, 1487, 2511, 3535, 4559, 5583, 6607, 7631, 534, 1558, 2582, 3606, 4630, 5654
    .long 6678, 7702, 298, 1322, 362, 1386, 394, 1418, 426, 1450, 490, 522, 458, 1482, 31
    .long 16, 1040, 2064, 3088, 4112, 5136, 6160, 7184, 8208, 9232, 10256, 11280, 12304, 13328, 14352, 15376
    .long 32, 1056, 2080, 3104, 64, 1088, 2112, 3136, 96, 1120, 2144, 3168, 128, 1152, 2176, 3200
    .long 1, 1025, 160, 1184, 2208, 3232, 192, 1216, 2240, 3264, 33, 1057, 2, 224, 1248, 2272
    .long 3296, 256, 1280, 2304, 3328, 1026, 65, 1089, 288, 1312, 2336, 3360, 3, 1027, 2051, 3075
    .long 34, 320, 1344, 2368, 3392, 1058, 97, 1121, 4, 1028, 352, 1376, 2400, 3424, 35, 1059
    .long 2083, 3107, 66, 384, 1408, 2432, 3456, 1090, 129, 1153, 416, 1440, 2464, 3488, 36, 1060
    .long 67, 1091, 2115, 3139, 98, 448, 1472, 2496, 3520, 1122, 480, 1504, 2528, 3552, 161, 1185
    .long 68, 1092, 99, 1123, 2147, 3171, 130, 1154, 193, 1217, 3078, 100, 1124, 131, 1155, 2179
    .long 3203, 162, 1186, 225, 1249, 3110, 7, 1031, 132, 1156, 163, 1187, 2211, 3235, 194, 257
    .long 1281, 1218, 3142, 39, 1063, 164, 1188, 195, 1219, 2243, 3267, 226, 3080, 11272, 289, 1313
    .long 1250, 3174, 71, 1095, 196, 1220, 227, 1251, 2275, 3299, 258, 3112, 11304, 321, 1345, 1282
    .long 3206, 103, 1127, 228, 1252, 259, 1283, 2307, 3331, 290, 3144, 11336, 353, 1377, 1073, 1314
    .long 3238, 135, 1159, 260, 1284, 291, 1315, 2339, 3363, 3176, 11368, 385, 1409, 322, 3270, 167
    .long 1191, 292, 1316, 1346, 3208, 11400, 417, 1441, 1137, 331, 1355, 2379, 3403, 4427, 5451, 6475
    .long 7499, 354, 3302, 199, 1223, 1378, 324, 1348, 449, 1473, 3240, 11432, 363, 1387, 2411, 3435
    .long 4459, 5483, 6507, 7531, 386, 3334, 332, 1356, 231, 1255, 1410, 481, 1505, 356, 1380, 3272
    .long 11464, 1201, 395, 1419, 2443, 3467, 4491, 5515, 6539, 7563, 418, 3366, 364, 1388, 263, 1287
    .long 1442, 333, 1357, 388, 1412, 3304, 11496, 427, 1451, 2475, 3499, 4523, 5547, 6571, 7595, 450
    .long 396, 1420, 295, 1319, 1474, 365, 1389, 420, 1444, 3336, 11528, 1265, 459, 1483, 2507, 3531
    .long 4555, 5579, 6603, 7627, 482, 428, 1452, 1506, 397, 1421, 452, 1476, 327, 1351, 3368, 11560
    .long 9481, 13577, 498, 1522, 2546, 3570, 4594, 5618, 6642, 7666, 8690, 9714, 10738, 11762, 12786, 13810
    .long 14834, 15858, 484, 460, 1484, 530, 1554, 2578, 3602, 4626, 5650, 6674, 7698, 8722, 9746, 10770
    .long 11794, 12818, 13842, 14866, 15890, 6478, 7502, 22862, 23886, 39246, 40270, 55630, 56654, 429, 1453, 516
    .long 359, 1383, 9513, 13609, 499, 1523, 6510, 7534, 22894, 23918, 39278, 40302, 55662, 56686, 461, 1485
    .long 391, 1415, 531, 1555, 335, 1359, 2383, 3407, 4431, 5455, 6479, 7503, 500, 1524, 6542, 7566
    .long 22926, 23950, 39310, 40334, 55694, 56718, 423, 1447, 532, 1556, 367, 1391, 2415, 3439, 4463, 5487
    .long 6511, 7535, 487, 6574, 7598, 22958, 23982, 39342, 40366, 55726, 56750, 455, 1479, 519, 399, 1423
    .long 2447, 3471, 4495, 5519, 6543, 7567, 6606, 7630, 22990, 24014, 39374, 40398, 55758, 56782, 6645, 7669
    .long 23029, 24053, 39413, 40437, 55797, 56821, 6677, 7701, 23061, 24085, 39445, 40469, 55829, 56853, 431, 1455
    .long 2479, 3503, 4527, 5551, 6575, 7599, 266, 1290, 330, 1354, 502, 1526, 2550, 3574, 4598, 5622
    .long 6646, 7670, 463, 1487, 2511, 3535, 4559, 5583, 6607, 7631, 534, 1558, 2582, 3606, 4630, 5654
    .long 6678, 7702, 298, 1322, 362, 1386, 394, 1418, 426, 1450, 490, 522, 458, 1482, 31
    .long 16, 1040, 2064, 3088, 4112, 5136, 6160, 7184, 8208, 9232, 10256, 11280, 12304, 13328, 14352, 15376
    .long 32, 1056, 2080, 3104, 64, 1088, 2112, 3136, 96, 1120, 2144, 3168, 128, 1152, 2176, 3200
    .long 1, 1025, 160, 1184, 2208, 3232, 192, 1216, 2240, 3264, 33, 1057, 2, 224, 1248, 2272
    .long 3296, 256, 1280, 2304, 3328, 1026, 65, 1089, 288, 1312, 2336, 3360, 3, 1027, 2051, 3075
    .long 34, 320, 1344, 2368, 3392, 1058, 97, 1121, 4, 1028, 352, 1376, 2400, 3424, 35, 1059
    .long 2083, 3107, 66, 384, 1408, 2432, 3456, 1090, 129, 1153, 416, 1440, 2464, 3488, 36, 1060
    .long 67, 1091, 2115, 3139, 98, 448, 1472, 2496, 3520, 1122, 480, 1504, 2528, 3552, 161, 1185
    .long 68, 1092, 99, 1123, 2147, 3171, 130, 1154, 193, 1217, 100, 1124, 131, 1155, 2179, 3203
    .long 162, 1186, 225, 1249, 7, 1031, 132, 1156, 163, 1187, 2211, 3235, 194, 257, 1281, 1218
    .long 39, 1063, 164, 1188, 195, 1219, 2243, 3267, 226, 4104, 12296, 289, 1313, 1250, 71, 1095
    .long 196, 1220, 227, 1251, 2275, 3299, 258, 4136, 12328, 2065, 321, 1345, 1282, 103, 1127, 228
    .long 1252, 259, 1283, 2307, 3331, 290, 4168, 12360, 353, 1377, 1314, 135, 1159, 260, 1284, 291
    .long 1315, 2339, 3363, 4200, 12392, 385, 1409, 2129, 322, 167, 1191, 292, 1316, 1346, 4232, 12424
    .long 417, 1441, 331, 1355, 2379, 3403, 4427, 5451, 6475, 7499, 354, 199, 1223, 1378, 324, 1348
    .long 449, 1473, 4264, 12456, 2193, 363, 1387, 2411, 3435, 4459, 5483, 6507, 7531, 386, 332, 1356
    .long 231, 1255, 1410, 481, 1505, 356, 1380, 4296, 12488, 395, 1419, 2443, 3467, 4491, 5515, 6539
    .long 7563, 418, 364, 1388, 263, 1287, 1442, 333, 1357, 388, 1412, 4328, 12520, 2257, 427, 1451
    .long 2475, 3499, 4523, 5547, 6571, 7595, 450, 396, 1420, 295, 1319, 1474, 365, 1389, 420, 1444
    .long 4360, 12552, 459, 1483, 2507, 3531, 4555, 5579, 6603, 7627, 482, 428, 1452, 1506, 397, 1421
    .long 452, 1476, 327, 1351, 4392, 12584, 2313, 6409, 498, 1522, 2546, 3570, 4594, 5618, 6642, 7666
    .long 8690, 9714, 10738, 11762, 12786, 13810, 14834, 15858, 484, 460, 1484, 530, 1554, 2578, 3602, 4626
    .long 5650, 6674, 7698, 8722, 9746, 10770, 11794, 12818, 13842, 14866, 15890, 8526, 9550, 24910, 25934, 41294
    .long 42318, 429, 1453, 516, 359, 1383, 2345, 6441, 499, 1523, 8558, 9582, 24942, 25966, 41326, 42350
    .long 461, 1485, 391, 1415, 531, 1555, 335, 1359, 2383, 3407, 4431, 5455, 6479, 7503, 500, 1524
    .long 8590, 9614, 24974, 25998, 41358, 42382, 423, 1447, 532, 1556, 367, 1391, 2415, 3439, 4463, 5487
    .long 6511, 7535, 487, 8622, 9646, 25006, 26030, 41390, 42414, 455, 1479, 519, 399, 1423, 2447, 3471
    .long 4495, 5519, 6543, 7567, 8654, 9678, 25038, 26062, 41422, 42446, 8693, 9717, 25077, 26101, 41461, 42485
    .long 8725, 9749, 25109, 26133, 41493, 42517, 431, 1455, 2479, 3503, 4527, 5551, 6575, 7599, 266, 1290
    .long 330, 1354, 502, 1526, 2550, 3574, 4598, 5622, 6646, 7670, 463, 1487, 2511, 3535, 4559, 5583
    .long 6607, 7631, 534, 1558, 2582, 3606, 4630, 5654, 6678, 7702, 298, 1322, 362, 1386, 394, 1418
    .long 426, 1450, 490, 522, 458, 1482, 31, 31, 31, 31, 31, 31, 31, 31, 31, 31
    .long 31, 31, 31, 31, 31, 31, 31, 31, 31, 31, 31, 31, 31, 31, 31
    .long 16, 1040, 2064, 3088, 4112, 5136, 6160, 7184, 8208, 9232, 10256, 11280, 12304, 13328, 14352, 15376
    .long 32, 1056, 2080, 3104, 64, 1088, 2112, 3136, 96, 1120, 2144, 3168, 128, 1152, 2176, 3200
    .long 1, 1025, 160, 1184, 2208, 3232, 192, 1216, 2240, 3264, 33, 1057, 2, 224, 1248, 2272
    .long 3296, 256, 1280, 2304, 3328, 1026, 65, 1089, 288, 1312, 2336, 3360, 3, 1027, 2051, 3075
    .long 34, 320, 1344, 2368, 3392, 1058, 97, 1121, 4, 1028, 352, 1376, 2400, 3424, 35, 1059
    .long 2083, 3107, 66, 384, 1408, 2432, 3456, 1090, 129, 1153, 416, 1440, 2464, 3488, 36, 1060
    .long 67, 1091, 2115, 3139, 98, 448, 1472, 2496, 3520, 1122, 480, 1504, 2528, 3552, 161, 1185
    .long 68, 1092, 99, 1123, 2147, 3171, 130, 1154, 193, 1217, 100, 1124, 131, 1155, 2179, 3203
    .long 162, 1186, 225, 1249, 7, 1031, 132, 1156, 163, 1187, 2211, 3235, 194, 257, 1281, 1218
    .long 39, 1063, 164, 1188, 195, 1219, 2243, 3267, 226, 5128, 13320, 289, 1313, 1250, 71, 1095
    .long 196, 1220, 227, 1251, 2275, 3299, 258, 5160, 13352, 321, 1345, 1282, 103, 1127, 228, 1252
    .long 259, 1283, 2307, 3331, 290, 5192, 13384, 353, 1377, 2097, 1314, 135, 1159, 260, 1284, 291
    .long 1315, 2339, 3363, 5224, 13416, 385, 1409, 322, 167, 1191, 292, 1316, 1346, 5256, 13448, 417
    .long 1441, 2161, 331, 1355, 2379, 3403, 4427, 5451, 6475, 7499, 354, 199, 1223, 1378, 324, 1348
    .long 449, 1473, 5288, 13480, 363, 1387, 2411, 3435, 4459, 5483, 6507, 7531, 386, 332, 1356, 231
    .long 1255, 1410, 481, 1505, 356, 1380, 5320, 13512, 2225, 395, 1419, 2443, 3467, 4491, 5515, 6539
    .long 7563, 418, 364, 1388, 263, 1287, 1442, 333, 1357, 388, 1412, 5352, 13544, 427, 1451, 2475
    .long 3499, 4523, 5547, 6571, 7595, 450, 396, 1420, 295, 1319, 1474, 365, 1389, 420, 1444, 5384
    .long 13576, 2289, 459, 1483, 2507, 3531, 4555, 5579, 6603, 7627, 482, 428, 1452, 1506, 397, 1421
    .long 452, 1476, 327, 1351, 5416, 13608, 10505, 14601, 498, 1522, 2546, 3570, 4594, 5618, 6642, 7666
    .long 8690, 9714, 10738, 11762, 12786, 13810, 14834, 15858, 484, 460, 1484, 530, 1554, 2578, 3602, 4626
    .long 5650, 6674, 7698, 8722, 9746, 10770, 11794, 12818, 13842, 14866, 15890, 10574, 11598, 26958, 27982, 43342
    .long 44366, 429, 1453, 516, 359, 1383, 10537, 14633, 499, 1523, 10606, 11630, 26990, 28014, 43374, 44398
    .long 461, 1485, 391, 1415, 531, 1555, 335, 1359, 2383, 3407, 4431, 5455, 6479, 7503, 500, 1524
    .long 10638, 11662, 27022, 28046, 43406, 44430, 423, 1447, 532, 1556, 367, 1391, 2415, 3439, 4463, 5487
    .long 6511, 7535, 487, 10670, 11694, 27054, 28078, 43438, 44462, 455, 1479, 519, 399, 1423, 2447, 3471
    .long 4495, 5519, 6543, 7567, 10702, 11726, 27086, 28110, 43470, 44494, 10741, 11765, 27125, 28149, 43509, 44533
    .long 10773, 11797, 27157, 28181, 43541, 44565, 431, 1455, 2479, 3503, 4527, 5551, 6575, 7599, 266, 1290
    .long 330, 1354, 502, 1526, 2550, 3574, 4598, 5622, 6646, 7670, 463, 1487, 2511, 3535, 4559, 5583
    .long 6607, 7631, 534, 1558, 2582, 3606, 4630, 5654, 6678, 7702, 298, 1322, 362, 1386, 394, 1418
    .long 426, 1450, 490, 522, 458, 1482, 31, 31, 31, 31, 31, 31, 31, 31, 31, 31
    .long 31, 31, 31, 31, 31, 31, 31, 31, 31, 31, 31, 31, 31, 31, 31
    .long 16, 1040, 2064, 3088, 4112, 5136, 6160, 7184, 8208, 9232, 10256, 11280, 12304, 13328, 14352, 15376
    .long 32, 1056, 2080, 3104, 64, 1088, 2112, 3136, 96, 1120, 2144, 3168, 128, 1152, 2176, 3200
    .long 1, 1025, 160, 1184, 2208, 3232, 192, 1216, 2240, 3264, 33, 1057, 2, 224, 1248, 2272
    .long 3296, 256, 1280, 2304, 3328, 1026, 65, 1089, 288, 1312, 2336, 3360, 3, 1027, 2051, 3075
    .long 34, 320, 1344, 2368, 3392, 1058, 97, 1121, 4, 1028, 352, 1376, 2400, 3424, 35, 1059
    .long 2083, 3107, 66, 5, 2053, 384, 1408, 2432, 3456, 1090, 129, 1153, 416, 1440, 2464, 3488
    .long 36, 1060, 67, 1091, 2115, 3139, 98, 37, 2085, 448, 1472, 2496, 3520, 1122, 480, 1504
    .long 2528, 3552, 161, 1185, 68, 1092, 99, 1123, 2147, 3171, 130, 69, 2117, 1154, 193, 1217
    .long 100, 1124, 131, 1155, 2179, 3203, 162, 101, 2149, 1186, 225, 1249, 7, 1031, 132, 1156
    .long 163, 1187, 2211, 3235, 194, 133, 2181, 257, 1281, 1218, 39, 1063, 164, 1188, 195, 1219
    .long 2243, 3267, 226, 165, 2213, 6152, 289, 1313, 1250, 71, 1095, 196, 1220, 227, 1251, 2275
    .long 3299, 258, 197, 2245, 6184, 3089, 321, 1345, 1282, 103, 1127, 228, 1252, 259, 1283, 2307
    .long 3331, 290, 229, 2277, 6216, 353, 1377, 1314, 135, 1159, 260, 1284, 291, 1315, 2339, 3363
    .long 261, 2309, 6248, 385, 1409, 3153, 322, 167, 1191, 292, 1316, 1346, 293, 2341, 6280, 417
    .long 1441, 331, 1355, 2379, 3403, 4427, 5451, 6475, 7499, 354, 199, 1223, 1378, 324, 1348, 449
    .long 1473, 6312, 3217, 363, 1387, 2411, 3435, 4459, 5483, 6507, 7531, 386, 332, 1356, 231, 1255
    .long 1410, 481, 1505, 356, 1380, 6344, 395, 1419, 2443, 3467, 4491, 5515, 6539, 7563, 418, 364
    .long 1388, 263, 1287, 1442, 333, 1357, 388, 1412, 6376, 3281, 427, 1451, 2475, 3499, 4523, 5547
    .long 6571, 7595, 450, 396, 1420, 295, 1319, 1474, 365, 1389, 420, 1444, 6408, 459, 1483, 2507
    .long 3531, 4555, 5579, 6603, 7627, 482, 428, 1452, 1506, 397, 1421, 452, 1476, 327, 1351, 6440
    .long 3337, 7433, 498, 1522, 2546, 3570, 4594, 5618, 6642, 7666, 8690, 9714, 10738, 11762, 12786, 13810
    .long 14834, 15858, 484, 460, 1484, 530, 1554, 2578, 3602, 4626, 5650, 6674, 7698, 8722, 9746, 10770
    .long 11794, 12818, 13842, 14866, 15890, 12622, 13646, 29006, 30030, 45390, 46414, 429, 1453, 516, 359, 1383
    .long 3369, 7465, 499, 1523, 12654, 13678, 29038, 30062, 45422, 46446, 461, 1485, 391, 1415, 531, 1555
    .long 335, 1359, 2383, 3407, 4431, 5455, 6479, 7503, 500, 1524, 12686, 13710, 29070, 30094, 45454, 46478
    .long 423, 1447, 532, 1556, 367, 1391, 2415, 3439, 4463, 5487, 6511, 7535, 487, 12718, 13742, 29102
    .long 30126, 45486, 46510, 455, 1479, 519, 399, 1423, 2447, 3471, 4495, 5519, 6543, 7567, 12750, 13774
    .long 29134, 30158, 45518, 46542, 12789, 13813, 29173, 30197, 45557, 46581, 12821, 13845, 29205, 30229, 45589, 46613
    .long 431, 1455, 2479, 3503, 4527, 5551, 6575, 7599, 266, 1290, 330, 1354, 502, 1526, 2550, 3574
    .long 4598, 5622, 6646, 7670, 463, 1487, 2511, 3535, 4559, 5583, 6607, 7631, 534, 1558, 2582, 3606
    .long 4630, 5654, 6678, 7702, 298, 1322, 362, 1386, 394, 1418, 426, 1450, 490, 522, 458, 1482
    .long 31, 31, 31, 31, 31, 31, 31, 31, 31, 31, 31, 31, 31, 31, 31
    .long 16, 1040, 2064, 3088, 4112, 5136, 6160, 7184, 8208, 9232, 10256, 11280, 12304, 13328, 14352, 15376
    .long 32, 1056, 2080, 3104, 64, 1088, 2112, 3136, 96, 1120, 2144, 3168, 128, 1152, 2176, 3200
    .long 1, 1025, 160, 1184, 2208, 3232, 192, 1216, 2240, 3264, 33, 1057, 2, 224, 1248, 2272
    .long 3296, 256, 1280, 2304, 3328, 1026, 65, 1089, 288, 1312, 2336, 3360, 3, 1027, 2051, 3075
    .long 34, 320, 1344, 2368, 3392, 1058, 97, 1121, 4, 1028, 352, 1376, 2400, 3424, 35, 1059
    .long 2083, 3107, 66, 1029, 3077, 384, 1408, 2432, 3456, 1090, 129, 1153, 416, 1440, 2464, 3488
    .long 36, 1060, 67, 1091, 2115, 3139, 98, 1061, 3109, 448, 1472, 2496, 3520, 1122, 480, 1504
    .long 2528, 3552, 161, 1185, 68, 1092, 99, 1123, 2147, 3171, 130, 1093, 3141, 1154, 193, 1217
    .long 100, 1124, 131, 1155, 2179, 3203, 162, 1125, 3173, 1186, 225, 1249, 7, 1031, 132, 1156
    .long 163, 1187, 2211, 3235, 194, 1157, 3205, 257, 1281, 1218, 39, 1063, 164, 1188, 195, 1219
    .long 2243, 3267, 226, 1189, 3237, 7176, 289, 1313, 1250, 71, 1095, 196, 1220, 227, 1251, 2275
    .long 3299, 258, 1221, 3269, 7208, 321, 1345, 1282, 103, 1127, 228, 1252, 259, 1283, 2307, 3331
    .long 290, 1253, 3301, 7240, 353, 1377, 3121, 1314, 135, 1159, 260, 1284, 291, 1315, 2339, 3363
    .long 1285, 3333, 7272, 385, 1409, 322, 167, 1191, 292, 1316, 1346, 1317, 3365, 7304, 417, 1441
    .long 3185, 331, 1355, 2379, 3403, 4427, 5451, 6475, 7499, 354, 199, 1223, 1378, 324, 1348, 449
    .long 1473, 7336, 363, 1387, 2411, 3435, 4459, 5483, 6507, 7531, 386, 332, 1356, 231, 1255, 1410
    .long 481, 1505, 356, 1380, 7368, 3249, 395, 1419, 2443, 3467, 4491, 5515, 6539, 7563, 418, 364
    .long 1388, 263, 1287, 1442, 333, 1357, 388, 1412, 7400, 427, 1451, 2475, 3499, 4523, 5547, 6571
    .long 7595, 450, 396, 1420, 295, 1319, 1474, 365, 1389, 420, 1444, 7432, 3313, 459, 1483, 2507
    .long 3531, 4555, 5579, 6603, 7627, 482, 428, 1452, 1506, 397, 1421, 452, 1476, 327, 1351, 7464
    .long 11529, 15625, 498, 1522, 2546, 3570, 4594, 5618, 6642, 7666, 8690, 9714, 10738, 11762, 12786, 13810
    .long 14834, 15858, 484, 460, 1484, 530, 1554, 2578, 3602, 4626, 5650, 6674, 7698, 8722, 9746, 10770
    .long 11794, 12818, 13842, 14866, 15890, 14670, 15694, 31054, 32078, 47438, 48462, 429, 1453, 516, 359, 1383
    .long 11561, 15657, 499, 1523, 14702, 15726, 31086, 32110, 47470, 48494, 461, 1485, 391, 1415, 531, 1555
    .long 335, 1359, 2383, 3407, 4431, 5455, 6479, 7503, 500, 1524, 14734, 15758, 31118, 32142, 47502, 48526
    .long 423, 1447, 532, 1556, 367, 1391, 2415, 3439, 4463, 5487, 6511, 7535, 487, 14766, 15790, 31150
    .long 32174, 47534, 48558, 455, 1479, 519, 399, 1423, 2447, 3471, 4495, 5519, 6543, 7567, 14798, 15822
    .long 31182, 32206, 47566, 48590, 14837, 15861, 31221, 32245, 47605, 48629, 14869, 15893, 31253, 32277, 47637, 48661
    .long 431, 1455, 2479, 3503, 4527, 5551, 6575, 7599, 266, 1290, 330, 1354, 502, 1526, 2550, 3574
    .long 4598, 5622, 6646, 7670, 463, 1487, 2511, 3535, 4559, 5583, 6607, 7631, 534, 1558, 2582, 3606
    .long 4630, 5654, 6678, 7702, 298, 1322, 362, 1386, 394, 1418, 426, 1450, 490, 522, 458, 1482
    .long 31, 31, 31, 31, 31, 31, 31, 31, 31, 31, 31, 31, 31, 31, 31
    .long 31
    .long 31
    .long 31
    .long 31
    .long 31
    .long 31
    .long 31
    .long 31
.section .rodata,"a"
.p2align 6
.amdhsa_kernel prep_kernel
  .amdhsa_next_free_vgpr 72
  .amdhsa_next_free_sgpr 32
  .amdhsa_accum_offset 72
  .amdhsa_group_segment_fixed_size 0
  .amdhsa_kernarg_size 120
  .amdhsa_user_sgpr_count 2
  .amdhsa_user_sgpr_kernarg_segment_ptr 1
  .amdhsa_system_sgpr_workgroup_id_x 1
  .amdhsa_float_denorm_mode_32 3
.end_amdhsa_kernel
.p2align 6
.amdhsa_kernel mega_kernel
  .amdhsa_next_free_vgpr 256
  .amdhsa_next_free_sgpr 102
  .amdhsa_accum_offset 128
  .amdhsa_group_segment_fixed_size 0
  .amdhsa_kernarg_size 120
  .amdhsa_user_sgpr_count 2
  .amdhsa_user_sgpr_kernarg_segment_ptr 1
  .amdhsa_system_sgpr_workgroup_id_x 1
  .amdhsa_float_denorm_mode_32 3
.end_amdhsa_kernel
```
